```python
import torch

def _softmax(x, axis=-1):
    return torch.softmax(x, dim=axis)
def _gelu(x):
    return torch.nn.functional.gelu(x, approximate="tanh")
def _silu(x):
    return torch.nn.functional.silu(x)
def _sigmoid(x):
    return torch.sigmoid(x)
def _layernorm(x, axis=-1, eps=1e-5):
    m = x.mean(dim=axis, keepdim=True)
    v = x.var(dim=axis, keepdim=True, unbiased=False)
    return (x - m) / torch.sqrt(v + eps)
def _scatter_add(tgt, idx, src, axis=0):
    return tgt.clone().index_add_(axis, idx, src)
def _segment_sum(src, seg, n):
    out = torch.zeros((n,) + src.shape[1:], dtype=src.dtype)
    return out.index_add_(0, seg, src)
def _pad(x, pw):
    flat = tuple(v for pair in reversed(pw) for v in pair)
    return torch.nn.functional.pad(x, flat)

kernel_name = 'concat_heads__gqa_block_cached__mha_block_cached__near_ridge'

def setup_inputs():

    _w = (lambda a: (lambda t: t.to(torch.bfloat16) if t.is_floating_point() else t)(torch.as_tensor(a)))
    def _A_setup():
        B, Sq, D = 8, 80, 576
        Hq, Hkv, Sk, Dh = 32, 16, 1024, 128
        assert Hq % Hkv == 0, (Hq, Hkv)
        return {
            "x": _w((lambda *s: torch.randn(*s, dtype=torch.bfloat16) * 0.8)(B, Sq, D)),
            "k_cache": _w((lambda *s: torch.randn(*s, dtype=torch.bfloat16) * 0.8)(B, Hkv, Sk, Dh)),
            "v_cache": _w((lambda *s: torch.randn(*s, dtype=torch.bfloat16) * 0.05)(B, Hkv, Sk, Dh)),
            "wq": _w((lambda *s: torch.randn(*s, dtype=torch.bfloat16) * 0.8)(D, Hq * Dh) * (D ** -0.5)),
            "wo": _w((lambda *s: torch.randn(*s, dtype=torch.bfloat16) * 0.05)(Hq * Dh, D) * ((Hq * Dh) ** -0.5)),
        }
    _A_in = _A_setup()

    def _B_setup():
        B, Sq, D = 8, 80, 576
        H, Sk, Dh = 32, 1024, 128
        return {
            "x": _w((lambda *s: torch.randn(*s, dtype=torch.bfloat16) * 0.8)(B, Sq, D)),
            "k_cache": _w((lambda *s: torch.randn(*s, dtype=torch.bfloat16) * 0.8)(B, H, Sk, Dh)),
            "v_cache": _w((lambda *s: torch.randn(*s, dtype=torch.bfloat16) * 0.05)(B, H, Sk, Dh)),
            "wq": _w((lambda *s: torch.randn(*s, dtype=torch.bfloat16) * 0.8)(D, H * Dh) * (D ** -0.5)),
            "wo": _w((lambda *s: torch.randn(*s, dtype=torch.bfloat16) * 0.05)(H * Dh, D) * ((H * Dh) ** -0.5)),
        }
    _B_in = _B_setup()

    return {
        "A_x": _A_in["x"],
        "A_k_cache": _A_in["k_cache"],
        "A_v_cache": _A_in["v_cache"],
        "A_wq": _A_in["wq"],
        "A_wo": _A_in["wo"],
        "B_x": _B_in["x"],
        "B_k_cache": _B_in["k_cache"],
        "B_v_cache": _B_in["v_cache"],
        "B_wq": _B_in["wq"],
        "B_wo": _B_in["wo"],
    }

def reference(A_x, A_k_cache, A_v_cache, A_wq, A_wo, B_x, B_k_cache, B_v_cache, B_wq, B_wo):
    def _A_ref(x, k_cache, v_cache, wq, wo):
        B, Sq, D = x.shape
        Hq, Dh = 32, 128
        Hkv = k_cache.shape[1]
        rep = Hq // Hkv
        q = (lambda x, *d: x.permute(*d))((x @ wq).reshape(B, Sq, Hq, Dh), 0, 2, 1, 3)
        k = (lambda x, n, axis: torch.repeat_interleave(x, n, dim=axis))(k_cache, rep, axis=1)
        v = (lambda x, n, axis: torch.repeat_interleave(x, n, dim=axis))(v_cache, rep, axis=1)
        scores = torch.einsum("bhqd,bhkd->bhqk", q, k) * (Dh ** -0.5)
        p = _softmax(scores, axis=-1)
        o = torch.einsum("bhqk,bhkd->bhqd", p, v)
        return (lambda x, *d: x.permute(*d))(o, 0, 2, 1, 3).reshape(B, Sq, Hq * Dh) @ wo

    def _B_ref(x, k_cache, v_cache, wq, wo):
        B, Sq, D = x.shape
        H, Dh = 32, 128
        q = (lambda x, *d: x.permute(*d))((x @ wq).reshape(B, Sq, H, Dh), 0, 2, 1, 3)
        scores = torch.einsum("bhqd,bhkd->bhqk", q, k_cache) * (Dh ** -0.5)
        p = _softmax(scores, axis=-1)
        o = torch.einsum("bhqk,bhkd->bhqd", p, v_cache)
        return (lambda x, *d: x.permute(*d))(o, 0, 2, 1, 3).reshape(B, Sq, H * Dh) @ wo

    a = _A_ref(A_x, A_k_cache, A_v_cache, A_wq, A_wo)
    b = _B_ref(B_x, B_k_cache, B_v_cache, B_wq, B_wo)
    return torch.concatenate([a, b], axis=-1)
```

```asm
; @launch grid=(256,1,1) block=(256,1,1) lds=163840
.amdgcn_target "amdgcn-amd-amdhsa--gfx950"
.text
.globl concat_heads__gqa_block_cached__mha_block_cached__near_ridge_kernel
.p2align 8
.type concat_heads__gqa_block_cached__mha_block_cached__near_ridge_kernel,@function
concat_heads__gqa_block_cached__mha_block_cached__near_ridge_kernel:
s_cmp_ge_u32 s2, 256
s_cbranch_scc1 att_end
s_load_dwordx2 s[60:61], s[0:1], 40
s_load_dwordx2 s[62:63], s[0:1], 64
v_lshrrev_b32 v1, 6, v0
v_and_b32 v210, 63, v0
v_readfirstlane_b32 s3, v1
v_lshlrev_b32 v209, 4, v210
s_and_b32 s46, s2, 7
s_lshr_b32 s47, s2, 3
s_and_b32 s48, s47, 7
s_bfe_u32 s40, s47, 0x10003
s_lshl_b32 s40, s40, 1
s_lshl_b32 s49, s46, 2
s_add_u32 s49, s49, s40
v_lshlrev_b32 v169, 7, v210
s_waitcnt lgkmcnt(0)
s_mov_b32 s92, s60
s_and_b32 s93, s61, 0xffff
s_mov_b32 s94, 737280
s_mov_b32 s95, 0x20000
s_lshl_b32 s40, s46, 10
s_add_u32 s96, s62, s40
s_addc_u32 s97, s63, 0
s_and_b32 s97, s97, 0xffff
s_mov_b32 s98, 0
s_mov_b32 s99, 0x20000
s_sub_u32 s98, 4718592, s40
s_mul_i32 s40, s47, 1
s_lshl_b32 s41, s3, 5
s_add_u32 s40, s40, s41
s_lshl_b32 s40, s40, 13
buffer_load_dwordx4 v[232:235], v209, s[96:99], s40 offen
s_add_u32 s40, s40, 1048576
buffer_load_dwordx4 v[232:235], v209, s[96:99], s40 offen
s_add_u32 s40, s40, 1048576
buffer_load_dwordx4 v[232:235], v209, s[96:99], s40 offen
s_add_u32 s40, s40, 1048576
buffer_load_dwordx4 v[232:235], v209, s[96:99], s40 offen
s_add_u32 s40, s40, 1048576
buffer_load_dwordx4 v[232:235], v209, s[96:99], s40 offen
s_add_u32 s40, s40, 1048576
s_lshl_b32 s40, s47, 2
s_add_u32 s40, s40, s3
s_mul_i32 s40, s40, 5760
buffer_load_dword v229, v169, s[92:95], s40 offen
s_add_u32 s40, s40, 8192
s_cmp_ge_u32 s47, 16
s_cbranch_scc1 att_A
s_load_dwordx4 s[60:63], s[0:1], 40
s_load_dwordx4 s[64:67], s[0:1], 56
s_load_dwordx2 s[50:51], s[0:1], 96
s_waitcnt lgkmcnt(0)
s_mul_i32 s40, s48, 92160
s_add_u32 s8, s60, s40
s_addc_u32 s9, s61, 0
s_and_b32 s9, s9, 0xffff
s_mov_b32 s10, 92160
s_mov_b32 s11, 0x20000
s_lshl_b32 s40, s49, 8
s_add_u32 s12, s66, s40
s_addc_u32 s13, s67, 0
s_and_b32 s13, s13, 0xffff
s_mov_b32 s14, 0
s_mov_b32 s15, 0x20000
s_sub_u32 s14, 4718592, s40
s_lshl_b32 s40, s48, 5
s_add_u32 s40, s40, s49
s_lshl_b32 s40, s40, 18
s_add_u32 s16, s62, s40
s_addc_u32 s17, s63, 0
s_and_b32 s17, s17, 0xffff
s_mov_b32 s18, 524288
s_mov_b32 s19, 0x20000
s_add_u32 s20, s64, s40
s_addc_u32 s21, s65, 0
s_and_b32 s21, s21, 0xffff
s_mov_b32 s22, 524288
s_mov_b32 s23, 0x20000
s_lshl_b32 s40, s48, 5
s_add_u32 s40, s40, s49
s_mul_i32 s40, s40, 20480
s_add_u32 s40, s40, 5242880
s_add_u32 s24, s50, s40
s_addc_u32 s25, s51, 0
s_and_b32 s25, s25, 0xffff
s_mov_b32 s26, 40960
s_mov_b32 s27, 0x20000
s_lshr_b32 s52, s3, 1
s_and_b32 s53, s3, 1
s_mov_b32 s28, 0x3e0293ee
s_mov_b32 s29, 0x41c00000
s_add_u32 s32, s47, s46
s_lshl_b32 s33, s53, 12
s_lshl_b32 s40, s52, 18
s_add_u32 s33, s33, s40
s_lshl_b32 s37, s52, 16
s_lshl_b32 s40, s53, 12
s_add_u32 s37, s37, s40
s_mov_b32 s34, 0
v_lshrrev_b32 v170, 5, v210
v_and_b32 v171, 31, v210
v_lshlrev_b32 v172, 2, v170
v_xor_b32 v172, v172, v171
v_lshlrev_b32 v172, 4, v172
v_lshlrev_b32 v173, 13, v170
v_add_u32 v172, v172, v173
v_add_u32 v152, 0, v172
v_lshlrev_b32 v172, 2, v170
v_add_u32 v172, 8, v172
v_xor_b32 v172, v172, v171
v_lshlrev_b32 v172, 4, v172
v_lshlrev_b32 v173, 13, v170
v_add_u32 v172, v172, v173
v_add_u32 v153, 15360, v172
v_lshlrev_b32 v172, 2, v170
v_xor_b32 v172, v172, v171
v_lshlrev_b32 v172, 4, v172
v_lshlrev_b32 v173, 13, v170
v_add_u32 v172, v172, v173
v_add_u32 v154, 30720, v172
v_lshlrev_b32 v172, 2, v170
v_add_u32 v172, 8, v172
v_xor_b32 v172, v172, v171
v_lshlrev_b32 v172, 4, v172
v_lshlrev_b32 v173, 13, v170
v_add_u32 v172, v172, v173
v_add_u32 v155, 46080, v172
v_lshrrev_b32 v170, 3, v210
v_mul_u32_u24 v170, 1152, v170
v_lshrrev_b32 v171, 4, v210
s_add_u32 s40, s3, 0
s_and_b32 s40, s40, 1
s_lshl_b32 s40, s40, 2
v_add_u32 v172, s40, v171
v_xor_b32 v172, v172, v210
v_and_b32 v172, 7, v172
v_lshlrev_b32 v172, 4, v172
v_add_u32 v156, v170, v172
s_add_u32 s40, s3, 1
s_and_b32 s40, s40, 1
s_lshl_b32 s40, s40, 2
v_add_u32 v172, s40, v171
v_xor_b32 v172, v172, v210
v_and_b32 v172, 7, v172
v_lshlrev_b32 v172, 4, v172
v_add_u32 v161, v170, v172
s_mov_b32 s44, 0
s_mov_b32 s45, 0
s_lshl_b32 s57, s3, 16
s_mul_i32 s58, s3, 9216
s_lshl_b32 s59, s3, 12
s_mov_b32 s54, 0
s_mov_b32 s55, 0
v_lshrrev_b32 v212, 4, v210
v_and_b32 v213, 15, v210
v_xor_b32 v214, v212, v213
v_lshlrev_b32 v215, 8, v212
v_xor_b32 v216, 0, v214
v_lshlrev_b32 v216, 4, v216
v_add_u32 v203, v215, v216
v_xor_b32 v216, 4, v214
v_lshlrev_b32 v216, 4, v216
v_add_u32 v204, v215, v216
v_xor_b32 v216, 8, v214
v_lshlrev_b32 v216, 4, v216
v_add_u32 v205, v215, v216
v_xor_b32 v216, 12, v214
v_lshlrev_b32 v216, 4, v216
v_add_u32 v206, v215, v216
v_lshlrev_b32 v216, 1, v212
v_add_u32 v216, 0, v216
v_xor_b32 v216, v216, v213
v_lshlrev_b32 v216, 4, v216
v_add_u32 v207, v215, v216
v_lshlrev_b32 v216, 1, v212
v_add_u32 v216, 8, v216
v_xor_b32 v216, v216, v213
v_lshlrev_b32 v216, 4, v216
v_add_u32 v208, v215, v216
v_lshrrev_b32 v170, 4, v210
v_bfe_u32 v171, v210, 2, 2
v_and_b32 v172, 3, v210
v_lshlrev_b32 v173, 3, v170
v_add_u32 v173, v173, v171
v_lshlrev_b32 v173, 9, v173
s_lshl_b32 s40, s3, 3
s_add_u32 s40, s40, 0
v_add_u32 v175, s40, v172
v_lshlrev_b32 v176, 2, v171
v_xor_b32 v175, v175, v176
v_lshlrev_b32 v175, 4, v175
v_add_u32 v157, v175, v173
v_add_u32 v159, 65536, v157
s_lshl_b32 s40, s3, 3
s_add_u32 s40, s40, 4
v_add_u32 v175, s40, v172
v_lshlrev_b32 v176, 2, v171
v_xor_b32 v175, v175, v176
v_lshlrev_b32 v175, 4, v175
v_add_u32 v158, v175, v173
v_add_u32 v160, 65536, v158
v_and_b32 v171, 15, v210
v_lshrrev_b32 v172, 1, v171
v_lshlrev_b32 v171, 7, v171
v_add_u32 v173, 0, v170
v_xor_b32 v173, v173, v172
v_lshlrev_b32 v173, 4, v173
v_add_u32 v173, v173, v171
v_add_u32 v162, 131072, v173
v_mov_b32 v167, v162
v_add_u32 v173, 4, v170
v_xor_b32 v173, v173, v172
v_lshlrev_b32 v173, 4, v173
v_add_u32 v173, v173, v171
v_add_u32 v163, 131072, v173
v_mov_b32 v168, v163
v_mov_b32 v0, 0
v_mov_b32 v1, 0
v_mov_b32 v2, 0
v_mov_b32 v3, 0
v_mov_b32 v4, 0
v_mov_b32 v5, 0
v_mov_b32 v6, 0
v_mov_b32 v7, 0
v_mov_b32 v8, 0
v_mov_b32 v9, 0
v_mov_b32 v10, 0
v_mov_b32 v11, 0
v_mov_b32 v12, 0
v_mov_b32 v13, 0
v_mov_b32 v14, 0
v_mov_b32 v15, 0
v_mov_b32 v16, 0
v_mov_b32 v17, 0
v_mov_b32 v18, 0
v_mov_b32 v19, 0
v_mov_b32 v20, 0
v_mov_b32 v21, 0
v_mov_b32 v22, 0
v_mov_b32 v23, 0
v_mov_b32 v24, 0
v_mov_b32 v25, 0
v_mov_b32 v26, 0
v_mov_b32 v27, 0
v_mov_b32 v28, 0
v_mov_b32 v29, 0
v_mov_b32 v30, 0
v_mov_b32 v31, 0
v_mov_b32 v32, 0
v_mov_b32 v33, 0
v_mov_b32 v34, 0
v_mov_b32 v35, 0
v_mov_b32 v36, 0
v_mov_b32 v37, 0
v_mov_b32 v38, 0
v_mov_b32 v39, 0
v_mov_b32 v40, 0
v_mov_b32 v41, 0
v_mov_b32 v42, 0
v_mov_b32 v43, 0
v_mov_b32 v44, 0
v_mov_b32 v45, 0
v_mov_b32 v46, 0
v_mov_b32 v47, 0
v_mov_b32 v48, 0
v_mov_b32 v49, 0
v_mov_b32 v50, 0
v_mov_b32 v51, 0
v_mov_b32 v52, 0
v_mov_b32 v53, 0
v_mov_b32 v54, 0
v_mov_b32 v55, 0
v_mov_b32 v56, 0
v_mov_b32 v57, 0
v_mov_b32 v58, 0
v_mov_b32 v59, 0
v_mov_b32 v60, 0
v_mov_b32 v61, 0
v_mov_b32 v62, 0
v_mov_b32 v63, 0
v_mov_b32 v64, 0
v_mov_b32 v65, 0
v_mov_b32 v66, 0
v_mov_b32 v67, 0
v_mov_b32 v68, 0
v_mov_b32 v69, 0
v_mov_b32 v70, 0
v_mov_b32 v71, 0
v_mov_b32 v72, 0
v_mov_b32 v73, 0
v_mov_b32 v74, 0
v_mov_b32 v75, 0
v_mov_b32 v76, 0
v_mov_b32 v77, 0
v_mov_b32 v78, 0
v_mov_b32 v79, 0
v_lshrrev_b32 v212, 4, v210
v_and_b32 v213, 15, v210
s_lshl_b32 s43, s52, 16
v_lshlrev_b32 v215, 8, v213
v_add_u32 v215, s43, v215
v_add_u32 v216, 0, v212
v_xor_b32 v216, v216, v213
v_lshlrev_b32 v216, 4, v216
v_add_u32 v191, v215, v216
v_add_u32 v216, 4, v212
v_xor_b32 v216, v216, v213
v_lshlrev_b32 v216, 4, v216
v_add_u32 v192, v215, v216
v_add_u32 v216, 8, v212
v_xor_b32 v216, v216, v213
v_lshlrev_b32 v216, 4, v216
v_add_u32 v193, v215, v216
v_add_u32 v216, 12, v212
v_xor_b32 v216, v216, v213
v_lshlrev_b32 v216, 4, v216
v_add_u32 v194, v215, v216
v_lshrrev_b32 v214, 2, v210
v_lshlrev_b32 v215, 8, v214
v_add_u32 v215, s43, v215
v_and_b32 v216, 3, v210
v_lshlrev_b32 v216, 3, v216
v_add_u32 v215, v215, v216
v_and_b32 v214, 7, v214
s_mov_b32 s41, 0
s_add_u32 s40, s41, 0
s_and_b32 s40, s40, 7
v_xor_b32 v216, s40, v214
v_lshlrev_b32 v216, 5, v216
v_add_u32 v195, v215, v216
s_add_u32 s40, s41, 1
s_and_b32 s40, s40, 7
v_xor_b32 v216, s40, v214
v_lshlrev_b32 v216, 5, v216
v_add_u32 v196, v215, v216
s_add_u32 s40, s41, 2
s_and_b32 s40, s40, 7
v_xor_b32 v216, s40, v214
v_lshlrev_b32 v216, 5, v216
v_add_u32 v197, v215, v216
s_add_u32 s40, s41, 3
s_and_b32 s40, s40, 7
v_xor_b32 v216, s40, v214
v_lshlrev_b32 v216, 5, v216
v_add_u32 v198, v215, v216
s_add_u32 s40, s41, 4
s_and_b32 s40, s40, 7
v_xor_b32 v216, s40, v214
v_lshlrev_b32 v216, 5, v216
v_add_u32 v199, v215, v216
s_add_u32 s40, s41, 5
s_and_b32 s40, s40, 7
v_xor_b32 v216, s40, v214
v_lshlrev_b32 v216, 5, v216
v_add_u32 v200, v215, v216
s_add_u32 s40, s41, 6
s_and_b32 s40, s40, 7
v_xor_b32 v216, s40, v214
v_lshlrev_b32 v216, 5, v216
v_add_u32 v201, v215, v216
s_add_u32 s40, s41, 7
s_and_b32 s40, s40, 7
v_xor_b32 v216, s40, v214
v_lshlrev_b32 v216, 5, v216
v_add_u32 v202, v215, v216
v_mov_b32 v216, 0x3f803f80
v_accvgpr_write_b32 a244, v216
v_accvgpr_write_b32 a245, v216
v_accvgpr_write_b32 a246, v216
v_accvgpr_write_b32 a247, v216
v_lshrrev_b32 v214, 2, v213
v_and_b32 v215, 3, v210
v_cmp_eq_u32 vcc, v214, v212
s_nop 1
v_cndmask_b32 v217, 7, v215
v_mov_b32 v218, 0
v_mov_b32 v219, 0
v_mov_b32 v220, 0x3f80
v_mov_b32 v221, 0x3f800000
v_cmp_eq_u32 vcc, 0, v217
s_nop 1
v_cndmask_b32 v218, v218, v220
v_cmp_eq_u32 vcc, 1, v217
s_nop 1
v_cndmask_b32 v218, v218, v221
v_cmp_eq_u32 vcc, 2, v217
s_nop 1
v_cndmask_b32 v219, v219, v220
v_cmp_eq_u32 vcc, 3, v217
s_nop 1
v_cndmask_b32 v219, v219, v221
v_mov_b32 v220, 0
v_accvgpr_write_b32 a248, v218
v_accvgpr_write_b32 a249, v219
v_accvgpr_write_b32 a250, v220
v_accvgpr_write_b32 a251, v220
v_accvgpr_write_b32 a252, v220
v_accvgpr_write_b32 a253, v220
v_accvgpr_write_b32 a254, v218
v_accvgpr_write_b32 a255, v219
s_load_dwordx2 s[98:99], s[0:1], 72
s_load_dwordx4 s[64:67], s[0:1], 80
s_waitcnt lgkmcnt(0)
s_mov_b32 s68, s66
s_mov_b32 s69, s67
s_mov_b32 s40, s64
s_mov_b32 s41, s65
s_mov_b32 s64, s40
s_and_b32 s65, s41, 0xffff
s_mov_b32 s66, 1474560
s_mov_b32 s67, 0x20000
s_mov_b32 s100, s98
s_mov_b32 s101, s99
s_lshl_b32 s40, s48, 0
s_add_u32 s40, s40, 8
s_mov_b32 s56, s40
s_mul_i32 s40, s56, 1507328
s_lshr_b32 s41, s49, 1
s_mul_i32 s41, s41, 94208
s_add_u32 s40, s40, s41
s_add_u32 s24, s50, s40
s_addc_u32 s25, s51, 0
s_and_b32 s25, s25, 0xffff
s_mov_b32 s26, 94208
s_mov_b32 s27, 0x20000
v_lshrrev_b32 v240, 3, v210
v_mul_u32_u24 v240, 1152, v240
v_lshrrev_b32 v241, 4, v210
v_lshlrev_b32 v241, 1, v241
v_xor_b32 v241, v241, v210
v_and_b32 v241, 7, v241
v_lshlrev_b32 v241, 4, v241
v_add_u32 v221, v240, v241
v_lshrrev_b32 v240, 2, v210
v_lshlrev_b32 v241, 7, v240
v_and_b32 v242, 3, v210
v_lshlrev_b32 v242, 3, v242
v_add_u32 v241, v241, v242
v_bfe_u32 v240, v240, 1, 2
s_add_u32 s40, s3, 0
s_and_b32 s41, s40, 3
s_lshr_b32 s40, s40, 2
s_lshl_b32 s42, s3, 1
s_add_u32 s40, s40, s42
s_lshl_b32 s40, s40, 12
s_add_u32 s40, s40, 40960
v_xor_b32 v243, s41, v240
v_lshlrev_b32 v243, 5, v243
v_add_u32 v243, v243, v241
v_add_u32 v219, s40, v243
s_add_u32 s40, s3, 1
s_and_b32 s41, s40, 3
s_lshr_b32 s40, s40, 2
s_lshl_b32 s42, s3, 1
s_add_u32 s40, s40, s42
s_lshl_b32 s40, s40, 12
s_add_u32 s40, s40, 40960
v_xor_b32 v243, s41, v240
v_lshlrev_b32 v243, 5, v243
v_add_u32 v243, v243, v241
v_add_u32 v220, s40, v243
s_add_u32 s40, s3, 2
s_and_b32 s41, s40, 3
s_lshr_b32 s40, s40, 2
s_lshl_b32 s42, s3, 1
s_add_u32 s40, s40, s42
s_lshl_b32 s40, s40, 12
s_add_u32 s40, s40, 40960
v_xor_b32 v243, s41, v240
v_lshlrev_b32 v243, 5, v243
v_add_u32 v243, v243, v241
v_add_u32 v224, s40, v243
s_add_u32 s40, s3, 3
s_and_b32 s41, s40, 3
s_lshr_b32 s40, s40, 2
s_lshl_b32 s42, s3, 1
s_add_u32 s40, s40, s42
s_lshl_b32 s40, s40, 12
s_add_u32 s40, s40, 40960
v_xor_b32 v243, s41, v240
v_lshlrev_b32 v243, 5, v243
v_add_u32 v243, v243, v241
v_add_u32 v225, s40, v243
s_mul_i32 s40, s49, 147456
s_add_u32 s60, s100, s40
s_addc_u32 s61, s101, 0
s_and_b32 s61, s61, 0xffff
s_mov_b32 s62, 294912
s_mov_b32 s63, 0x20000
s_mov_b32 s96, 1
s_mov_b32 s97, s56
s_mul_i32 s40, s97, 1507328
s_add_u32 s92, s50, s40
s_addc_u32 s93, s51, 0
s_and_b32 s93, s93, 0xffff
s_mov_b32 s94, 1507328
s_mov_b32 s95, 0x20000
s_lshr_b32 s40, s49, 1
s_or_b32 s40, s40, s3
s_cmp_lg_u32 s40, 0
s_cbranch_scc1 finit_3
s_mul_i32 s40, s97, 4352
s_add_u32 s40, s40, 33554432
v_mov_b32 v226, s40
v_mov_b32 v227, 0
s_mov_b64 s[42:43], exec
s_mov_b64 exec, 1
global_store_dword v226, v227, s[50:51] sc1
s_mov_b64 exec, s[42:43]
finit_3:
s_cmp_eq_u32 s3, 0
s_cbranch_scc0 qr1_2
s_lshr_b32 s41, s59, 2
s_add_u32 s41, s41, s54
s_add_u32 m0, s41, 131072
s_add_u32 s40, s44, s58
buffer_load_dwordx4 v156, s[8:11], s40 offen lds
s_add_u32 m0, s54, 135168
s_add_u32 s40, s44, 36864
buffer_load_dwordx4 v156, s[8:11], s40 offen lds
s_add_u32 m0, s59, 32768
s_add_u32 s40, s45, s57
buffer_load_dwordx4 v152, s[12:15], s40 offen lds
buffer_load_dwordx4 v153, s[12:15], s40 offen offset:1024 lds
buffer_load_dwordx4 v154, s[12:15], s40 offen offset:2048 lds
buffer_load_dwordx4 v155, s[12:15], s40 offen offset:3072 lds
s_lshr_b32 s41, s59, 2
s_add_u32 s41, s41, s54
s_add_u32 m0, s41, 136192
s_add_u32 s40, s44, s58
s_add_u32 s40, s40, 46080
buffer_load_dwordx4 v161, s[8:11], s40 offen lds
s_add_u32 m0, s54, 140288
s_add_u32 s40, s44, 82944
buffer_load_dwordx4 v161, s[8:11], s40 offen lds
s_add_u32 s45, s45, 262144
s_add_u32 m0, s59, 49152
s_add_u32 s40, s45, s57
buffer_load_dwordx4 v152, s[12:15], s40 offen lds
buffer_load_dwordx4 v153, s[12:15], s40 offen offset:1024 lds
buffer_load_dwordx4 v154, s[12:15], s40 offen offset:2048 lds
buffer_load_dwordx4 v155, s[12:15], s40 offen offset:3072 lds
s_add_u32 s44, s44, 128
s_add_u32 s54, s54, 10240
s_cmp_eq_u32 s54, 30720
s_cselect_b32 s54, 0, s54
s_lshr_b32 s41, s59, 2
s_add_u32 s41, s41, s54
s_add_u32 m0, s41, 131072
s_add_u32 s40, s44, s58
buffer_load_dwordx4 v156, s[8:11], s40 offen lds
s_add_u32 m0, s54, 135168
s_add_u32 s40, s44, 36864
buffer_load_dwordx4 v156, s[8:11], s40 offen lds
s_add_u32 s45, s45, 262144
s_add_u32 m0, s59, 98304
s_add_u32 s40, s45, s57
buffer_load_dwordx4 v152, s[12:15], s40 offen lds
buffer_load_dwordx4 v153, s[12:15], s40 offen offset:1024 lds
buffer_load_dwordx4 v154, s[12:15], s40 offen offset:2048 lds
buffer_load_dwordx4 v155, s[12:15], s40 offen offset:3072 lds
s_lshr_b32 s41, s59, 2
s_add_u32 s41, s41, s54
s_add_u32 m0, s41, 136192
s_add_u32 s40, s44, s58
s_add_u32 s40, s40, 46080
buffer_load_dwordx4 v161, s[8:11], s40 offen lds
s_add_u32 m0, s54, 140288
s_add_u32 s40, s44, 82944
buffer_load_dwordx4 v161, s[8:11], s40 offen lds
s_add_u32 s45, s45, 262144
s_waitcnt vmcnt(12)
s_barrier
s_add_u32 m0, s59, 114688
s_add_u32 s40, s45, s57
buffer_load_dwordx4 v152, s[12:15], s40 offen lds
buffer_load_dwordx4 v153, s[12:15], s40 offen offset:1024 lds
buffer_load_dwordx4 v154, s[12:15], s40 offen offset:2048 lds
buffer_load_dwordx4 v155, s[12:15], s40 offen offset:3072 lds
s_add_u32 s44, s44, 128
s_add_u32 s54, s54, 10240
s_cmp_eq_u32 s54, 30720
s_cselect_b32 s54, 0, s54
s_lshr_b32 s41, s59, 2
s_add_u32 s41, s41, s54
s_add_u32 m0, s41, 131072
s_add_u32 s40, s44, s58
buffer_load_dwordx4 v156, s[8:11], s40 offen lds
s_add_u32 m0, s54, 135168
s_add_u32 s40, s44, 36864
buffer_load_dwordx4 v156, s[8:11], s40 offen lds
s_add_u32 s45, s45, 262144
ds_read_b64_tr_b16 v[80:81], v157 offset:32768
ds_read_b64_tr_b16 v[82:83], v157 offset:34816
ds_read_b64_tr_b16 v[84:85], v157 offset:32776
ds_read_b64_tr_b16 v[86:87], v157 offset:34824
ds_read_b64_tr_b16 v[88:89], v158 offset:32768
ds_read_b64_tr_b16 v[90:91], v158 offset:34816
ds_read_b64_tr_b16 v[92:93], v158 offset:32776
ds_read_b64_tr_b16 v[94:95], v158 offset:34824
ds_read_b128 v[112:115], v167
ds_read_b128 v[116:119], v167 offset:2048
ds_read_b128 v[120:123], v167 offset:4096
ds_read_b128 v[124:127], v167 offset:6144
ds_read_b128 v[128:131], v167 offset:8192
s_waitcnt lgkmcnt(0)
s_mov_b32 s38, 0
qloop_4:
s_waitcnt vmcnt(12)
s_barrier
v_mfma_f32_16x16x32_bf16 v[0:3], v[80:83], v[112:115], v[0:3]
ds_read_b64_tr_b16 v[96:97], v157 offset:49152
ds_read_b64_tr_b16 v[98:99], v157 offset:51200
v_mfma_f32_16x16x32_bf16 v[20:23], v[84:87], v[112:115], v[20:23]
ds_read_b64_tr_b16 v[100:101], v157 offset:49160
s_add_u32 m0, s59, 32768
s_add_u32 s40, s45, s57
buffer_load_dwordx4 v152, s[12:15], s40 offen lds
v_mfma_f32_16x16x32_bf16 v[40:43], v[88:91], v[112:115], v[40:43]
ds_read_b64_tr_b16 v[102:103], v157 offset:51208
v_mfma_f32_16x16x32_bf16 v[60:63], v[92:95], v[112:115], v[60:63]
ds_read_b64_tr_b16 v[104:105], v158 offset:49152
ds_read_b64_tr_b16 v[106:107], v158 offset:51200
buffer_load_dwordx4 v153, s[12:15], s40 offen offset:1024 lds
v_mfma_f32_16x16x32_bf16 v[4:7], v[80:83], v[116:119], v[4:7]
ds_read_b64_tr_b16 v[108:109], v158 offset:49160
v_mfma_f32_16x16x32_bf16 v[24:27], v[84:87], v[116:119], v[24:27]
ds_read_b64_tr_b16 v[110:111], v158 offset:51208
buffer_load_dwordx4 v154, s[12:15], s40 offen offset:2048 lds
v_mfma_f32_16x16x32_bf16 v[44:47], v[88:91], v[116:119], v[44:47]
ds_read_b128 v[132:135], v168
ds_read_b128 v[136:139], v168 offset:2048
v_mfma_f32_16x16x32_bf16 v[64:67], v[92:95], v[116:119], v[64:67]
ds_read_b128 v[140:143], v168 offset:4096
buffer_load_dwordx4 v155, s[12:15], s40 offen offset:3072 lds
v_mfma_f32_16x16x32_bf16 v[8:11], v[80:83], v[120:123], v[8:11]
ds_read_b128 v[144:147], v168 offset:6144
v_mfma_f32_16x16x32_bf16 v[28:31], v[84:87], v[120:123], v[28:31]
ds_read_b128 v[148:151], v168 offset:8192
s_lshr_b32 s41, s59, 2
s_add_u32 s41, s41, s54
s_add_u32 m0, s41, 136192
s_add_u32 s40, s44, s58
s_add_u32 s40, s40, 46080
buffer_load_dwordx4 v161, s[8:11], s40 offen lds
v_mfma_f32_16x16x32_bf16 v[48:51], v[88:91], v[120:123], v[48:51]
v_mfma_f32_16x16x32_bf16 v[68:71], v[92:95], v[120:123], v[68:71]
s_add_u32 m0, s54, 140288
s_add_u32 s40, s44, 82944
buffer_load_dwordx4 v161, s[8:11], s40 offen lds
s_add_u32 s45, s45, 262144
v_mfma_f32_16x16x32_bf16 v[12:15], v[80:83], v[124:127], v[12:15]
v_mfma_f32_16x16x32_bf16 v[32:35], v[84:87], v[124:127], v[32:35]
v_mfma_f32_16x16x32_bf16 v[52:55], v[88:91], v[124:127], v[52:55]
v_mfma_f32_16x16x32_bf16 v[72:75], v[92:95], v[124:127], v[72:75]
v_mfma_f32_16x16x32_bf16 v[16:19], v[80:83], v[128:131], v[16:19]
v_mfma_f32_16x16x32_bf16 v[36:39], v[84:87], v[128:131], v[36:39]
v_mfma_f32_16x16x32_bf16 v[56:59], v[88:91], v[128:131], v[56:59]
v_mfma_f32_16x16x32_bf16 v[76:79], v[92:95], v[128:131], v[76:79]
s_waitcnt lgkmcnt(0)
s_waitcnt vmcnt(12)
s_barrier
v_mfma_f32_16x16x32_bf16 v[0:3], v[96:99], v[132:135], v[0:3]
s_add_u32 s55, s55, 10240
s_cmp_eq_u32 s55, 30720
s_cselect_b32 s55, 0, s55
v_add_u32 v167, s55, v162
v_add_u32 v168, s55, v163
ds_read_b64_tr_b16 v[80:81], v159 offset:32768
v_mfma_f32_16x16x32_bf16 v[20:23], v[100:103], v[132:135], v[20:23]
ds_read_b64_tr_b16 v[82:83], v159 offset:34816
s_add_u32 m0, s59, 49152
s_add_u32 s40, s45, s57
buffer_load_dwordx4 v152, s[12:15], s40 offen lds
v_mfma_f32_16x16x32_bf16 v[40:43], v[104:107], v[132:135], v[40:43]
ds_read_b64_tr_b16 v[84:85], v159 offset:32776
ds_read_b64_tr_b16 v[86:87], v159 offset:34824
v_mfma_f32_16x16x32_bf16 v[60:63], v[108:111], v[132:135], v[60:63]
ds_read_b64_tr_b16 v[88:89], v160 offset:32768
buffer_load_dwordx4 v153, s[12:15], s40 offen offset:1024 lds
v_mfma_f32_16x16x32_bf16 v[4:7], v[96:99], v[136:139], v[4:7]
ds_read_b64_tr_b16 v[90:91], v160 offset:34816
v_mfma_f32_16x16x32_bf16 v[24:27], v[100:103], v[136:139], v[24:27]
ds_read_b64_tr_b16 v[92:93], v160 offset:32776
ds_read_b64_tr_b16 v[94:95], v160 offset:34824
buffer_load_dwordx4 v154, s[12:15], s40 offen offset:2048 lds
v_mfma_f32_16x16x32_bf16 v[44:47], v[104:107], v[136:139], v[44:47]
ds_read_b128 v[112:115], v167
v_mfma_f32_16x16x32_bf16 v[64:67], v[108:111], v[136:139], v[64:67]
ds_read_b128 v[116:119], v167 offset:2048
ds_read_b128 v[120:123], v167 offset:4096
buffer_load_dwordx4 v155, s[12:15], s40 offen offset:3072 lds
v_mfma_f32_16x16x32_bf16 v[8:11], v[96:99], v[140:143], v[8:11]
ds_read_b128 v[124:127], v167 offset:6144
v_mfma_f32_16x16x32_bf16 v[28:31], v[100:103], v[140:143], v[28:31]
ds_read_b128 v[128:131], v167 offset:8192
s_add_u32 s44, s44, 128
s_add_u32 s54, s54, 10240
s_cmp_eq_u32 s54, 30720
s_cselect_b32 s54, 0, s54
s_lshr_b32 s41, s59, 2
s_add_u32 s41, s41, s54
s_add_u32 m0, s41, 131072
s_add_u32 s40, s44, s58
buffer_load_dwordx4 v156, s[8:11], s40 offen lds
v_mfma_f32_16x16x32_bf16 v[48:51], v[104:107], v[140:143], v[48:51]
v_mfma_f32_16x16x32_bf16 v[68:71], v[108:111], v[140:143], v[68:71]
s_add_u32 m0, s54, 135168
s_add_u32 s40, s44, 36864
buffer_load_dwordx4 v156, s[8:11], s40 offen lds
s_add_u32 s45, s45, 262144
v_mfma_f32_16x16x32_bf16 v[12:15], v[96:99], v[144:147], v[12:15]
v_mfma_f32_16x16x32_bf16 v[32:35], v[100:103], v[144:147], v[32:35]
v_mfma_f32_16x16x32_bf16 v[52:55], v[104:107], v[144:147], v[52:55]
v_mfma_f32_16x16x32_bf16 v[72:75], v[108:111], v[144:147], v[72:75]
v_mfma_f32_16x16x32_bf16 v[16:19], v[96:99], v[148:151], v[16:19]
v_mfma_f32_16x16x32_bf16 v[36:39], v[100:103], v[148:151], v[36:39]
v_mfma_f32_16x16x32_bf16 v[56:59], v[104:107], v[148:151], v[56:59]
v_mfma_f32_16x16x32_bf16 v[76:79], v[108:111], v[148:151], v[76:79]
s_waitcnt lgkmcnt(0)
s_waitcnt vmcnt(12)
s_barrier
v_mfma_f32_16x16x32_bf16 v[0:3], v[80:83], v[112:115], v[0:3]
ds_read_b64_tr_b16 v[96:97], v159 offset:49152
ds_read_b64_tr_b16 v[98:99], v159 offset:51200
v_mfma_f32_16x16x32_bf16 v[20:23], v[84:87], v[112:115], v[20:23]
ds_read_b64_tr_b16 v[100:101], v159 offset:49160
s_add_u32 m0, s59, 98304
s_add_u32 s40, s45, s57
buffer_load_dwordx4 v152, s[12:15], s40 offen lds
v_mfma_f32_16x16x32_bf16 v[40:43], v[88:91], v[112:115], v[40:43]
ds_read_b64_tr_b16 v[102:103], v159 offset:51208
v_mfma_f32_16x16x32_bf16 v[60:63], v[92:95], v[112:115], v[60:63]
ds_read_b64_tr_b16 v[104:105], v160 offset:49152
ds_read_b64_tr_b16 v[106:107], v160 offset:51200
buffer_load_dwordx4 v153, s[12:15], s40 offen offset:1024 lds
v_mfma_f32_16x16x32_bf16 v[4:7], v[80:83], v[116:119], v[4:7]
ds_read_b64_tr_b16 v[108:109], v160 offset:49160
v_mfma_f32_16x16x32_bf16 v[24:27], v[84:87], v[116:119], v[24:27]
ds_read_b64_tr_b16 v[110:111], v160 offset:51208
buffer_load_dwordx4 v154, s[12:15], s40 offen offset:2048 lds
v_mfma_f32_16x16x32_bf16 v[44:47], v[88:91], v[116:119], v[44:47]
ds_read_b128 v[132:135], v168
ds_read_b128 v[136:139], v168 offset:2048
v_mfma_f32_16x16x32_bf16 v[64:67], v[92:95], v[116:119], v[64:67]
ds_read_b128 v[140:143], v168 offset:4096
buffer_load_dwordx4 v155, s[12:15], s40 offen offset:3072 lds
v_mfma_f32_16x16x32_bf16 v[8:11], v[80:83], v[120:123], v[8:11]
ds_read_b128 v[144:147], v168 offset:6144
v_mfma_f32_16x16x32_bf16 v[28:31], v[84:87], v[120:123], v[28:31]
ds_read_b128 v[148:151], v168 offset:8192
s_lshr_b32 s41, s59, 2
s_add_u32 s41, s41, s54
s_add_u32 m0, s41, 136192
s_add_u32 s40, s44, s58
s_add_u32 s40, s40, 46080
buffer_load_dwordx4 v161, s[8:11], s40 offen lds
v_mfma_f32_16x16x32_bf16 v[48:51], v[88:91], v[120:123], v[48:51]
v_mfma_f32_16x16x32_bf16 v[68:71], v[92:95], v[120:123], v[68:71]
s_add_u32 m0, s54, 140288
s_add_u32 s40, s44, 82944
buffer_load_dwordx4 v161, s[8:11], s40 offen lds
s_add_u32 s45, s45, 262144
v_mfma_f32_16x16x32_bf16 v[12:15], v[80:83], v[124:127], v[12:15]
v_mfma_f32_16x16x32_bf16 v[32:35], v[84:87], v[124:127], v[32:35]
v_mfma_f32_16x16x32_bf16 v[52:55], v[88:91], v[124:127], v[52:55]
v_mfma_f32_16x16x32_bf16 v[72:75], v[92:95], v[124:127], v[72:75]
v_mfma_f32_16x16x32_bf16 v[16:19], v[80:83], v[128:131], v[16:19]
v_mfma_f32_16x16x32_bf16 v[36:39], v[84:87], v[128:131], v[36:39]
v_mfma_f32_16x16x32_bf16 v[56:59], v[88:91], v[128:131], v[56:59]
v_mfma_f32_16x16x32_bf16 v[76:79], v[92:95], v[128:131], v[76:79]
s_waitcnt lgkmcnt(0)
s_waitcnt vmcnt(12)
s_barrier
v_mfma_f32_16x16x32_bf16 v[0:3], v[96:99], v[132:135], v[0:3]
s_add_u32 s55, s55, 10240
s_cmp_eq_u32 s55, 30720
s_cselect_b32 s55, 0, s55
v_add_u32 v167, s55, v162
v_add_u32 v168, s55, v163
ds_read_b64_tr_b16 v[80:81], v157 offset:32768
v_mfma_f32_16x16x32_bf16 v[20:23], v[100:103], v[132:135], v[20:23]
ds_read_b64_tr_b16 v[82:83], v157 offset:34816
s_add_u32 m0, s59, 114688
s_add_u32 s40, s45, s57
buffer_load_dwordx4 v152, s[12:15], s40 offen lds
v_mfma_f32_16x16x32_bf16 v[40:43], v[104:107], v[132:135], v[40:43]
ds_read_b64_tr_b16 v[84:85], v157 offset:32776
ds_read_b64_tr_b16 v[86:87], v157 offset:34824
v_mfma_f32_16x16x32_bf16 v[60:63], v[108:111], v[132:135], v[60:63]
ds_read_b64_tr_b16 v[88:89], v158 offset:32768
buffer_load_dwordx4 v153, s[12:15], s40 offen offset:1024 lds
v_mfma_f32_16x16x32_bf16 v[4:7], v[96:99], v[136:139], v[4:7]
ds_read_b64_tr_b16 v[90:91], v158 offset:34816
v_mfma_f32_16x16x32_bf16 v[24:27], v[100:103], v[136:139], v[24:27]
ds_read_b64_tr_b16 v[92:93], v158 offset:32776
ds_read_b64_tr_b16 v[94:95], v158 offset:34824
buffer_load_dwordx4 v154, s[12:15], s40 offen offset:2048 lds
v_mfma_f32_16x16x32_bf16 v[44:47], v[104:107], v[136:139], v[44:47]
ds_read_b128 v[112:115], v167
v_mfma_f32_16x16x32_bf16 v[64:67], v[108:111], v[136:139], v[64:67]
ds_read_b128 v[116:119], v167 offset:2048
ds_read_b128 v[120:123], v167 offset:4096
buffer_load_dwordx4 v155, s[12:15], s40 offen offset:3072 lds
v_mfma_f32_16x16x32_bf16 v[8:11], v[96:99], v[140:143], v[8:11]
ds_read_b128 v[124:127], v167 offset:6144
v_mfma_f32_16x16x32_bf16 v[28:31], v[100:103], v[140:143], v[28:31]
ds_read_b128 v[128:131], v167 offset:8192
s_add_u32 s44, s44, 128
s_add_u32 s54, s54, 10240
s_cmp_eq_u32 s54, 30720
s_cselect_b32 s54, 0, s54
s_lshr_b32 s41, s59, 2
s_add_u32 s41, s41, s54
s_add_u32 m0, s41, 131072
s_add_u32 s40, s44, s58
buffer_load_dwordx4 v156, s[8:11], s40 offen lds
v_mfma_f32_16x16x32_bf16 v[48:51], v[104:107], v[140:143], v[48:51]
v_mfma_f32_16x16x32_bf16 v[68:71], v[108:111], v[140:143], v[68:71]
s_add_u32 m0, s54, 135168
s_add_u32 s40, s44, 36864
buffer_load_dwordx4 v156, s[8:11], s40 offen lds
s_add_u32 s45, s45, 262144
v_mfma_f32_16x16x32_bf16 v[12:15], v[96:99], v[144:147], v[12:15]
v_mfma_f32_16x16x32_bf16 v[32:35], v[100:103], v[144:147], v[32:35]
v_mfma_f32_16x16x32_bf16 v[52:55], v[104:107], v[144:147], v[52:55]
v_mfma_f32_16x16x32_bf16 v[72:75], v[108:111], v[144:147], v[72:75]
v_mfma_f32_16x16x32_bf16 v[16:19], v[96:99], v[148:151], v[16:19]
v_mfma_f32_16x16x32_bf16 v[36:39], v[100:103], v[148:151], v[36:39]
v_mfma_f32_16x16x32_bf16 v[56:59], v[104:107], v[148:151], v[56:59]
v_mfma_f32_16x16x32_bf16 v[76:79], v[108:111], v[148:151], v[76:79]
s_waitcnt lgkmcnt(0)
s_add_u32 s38, s38, 1
s_cmp_lt_u32 s38, 3
s_cbranch_scc1 qloop_4
s_lshr_b32 s40, s49, 1
s_or_b32 s40, s40, s3
s_cmp_lg_u32 s40, 0
s_cbranch_scc1 fpub_5
s_lshl_b32 s40, s97, 2
v_mov_b32 v226, s40
v_mov_b32 v227, 1
s_mov_b64 s[42:43], exec
s_mov_b64 exec, 1
global_atomic_add v226, v227, s[68:69] sc1
s_mov_b64 exec, s[42:43]
fpub_5:
s_waitcnt vmcnt(12)
s_barrier
v_mfma_f32_16x16x32_bf16 v[0:3], v[80:83], v[112:115], v[0:3]
ds_read_b64_tr_b16 v[96:97], v157 offset:49152
ds_read_b64_tr_b16 v[98:99], v157 offset:51200
v_mfma_f32_16x16x32_bf16 v[20:23], v[84:87], v[112:115], v[20:23]
ds_read_b64_tr_b16 v[100:101], v157 offset:49160
s_add_u32 m0, s59, 32768
s_add_u32 s40, s45, s57
buffer_load_dwordx4 v152, s[12:15], s40 offen lds
v_mfma_f32_16x16x32_bf16 v[40:43], v[88:91], v[112:115], v[40:43]
ds_read_b64_tr_b16 v[102:103], v157 offset:51208
v_mfma_f32_16x16x32_bf16 v[60:63], v[92:95], v[112:115], v[60:63]
ds_read_b64_tr_b16 v[104:105], v158 offset:49152
ds_read_b64_tr_b16 v[106:107], v158 offset:51200
buffer_load_dwordx4 v153, s[12:15], s40 offen offset:1024 lds
v_mfma_f32_16x16x32_bf16 v[4:7], v[80:83], v[116:119], v[4:7]
ds_read_b64_tr_b16 v[108:109], v158 offset:49160
v_mfma_f32_16x16x32_bf16 v[24:27], v[84:87], v[116:119], v[24:27]
ds_read_b64_tr_b16 v[110:111], v158 offset:51208
buffer_load_dwordx4 v154, s[12:15], s40 offen offset:2048 lds
v_mfma_f32_16x16x32_bf16 v[44:47], v[88:91], v[116:119], v[44:47]
ds_read_b128 v[132:135], v168
ds_read_b128 v[136:139], v168 offset:2048
v_mfma_f32_16x16x32_bf16 v[64:67], v[92:95], v[116:119], v[64:67]
ds_read_b128 v[140:143], v168 offset:4096
buffer_load_dwordx4 v155, s[12:15], s40 offen offset:3072 lds
v_mfma_f32_16x16x32_bf16 v[8:11], v[80:83], v[120:123], v[8:11]
ds_read_b128 v[144:147], v168 offset:6144
v_mfma_f32_16x16x32_bf16 v[28:31], v[84:87], v[120:123], v[28:31]
ds_read_b128 v[148:151], v168 offset:8192
s_lshr_b32 s41, s59, 2
s_add_u32 s41, s41, s54
s_add_u32 m0, s41, 136192
s_add_u32 s40, s44, s58
s_add_u32 s40, s40, 46080
buffer_load_dwordx4 v161, s[8:11], s40 offen lds
v_mfma_f32_16x16x32_bf16 v[48:51], v[88:91], v[120:123], v[48:51]
v_mfma_f32_16x16x32_bf16 v[68:71], v[92:95], v[120:123], v[68:71]
s_add_u32 m0, s54, 140288
s_add_u32 s40, s44, 82944
buffer_load_dwordx4 v161, s[8:11], s40 offen lds
s_add_u32 s45, s45, 262144
v_mfma_f32_16x16x32_bf16 v[12:15], v[80:83], v[124:127], v[12:15]
v_mfma_f32_16x16x32_bf16 v[32:35], v[84:87], v[124:127], v[32:35]
v_mfma_f32_16x16x32_bf16 v[52:55], v[88:91], v[124:127], v[52:55]
v_mfma_f32_16x16x32_bf16 v[72:75], v[92:95], v[124:127], v[72:75]
v_mfma_f32_16x16x32_bf16 v[16:19], v[80:83], v[128:131], v[16:19]
v_mfma_f32_16x16x32_bf16 v[36:39], v[84:87], v[128:131], v[36:39]
v_mfma_f32_16x16x32_bf16 v[56:59], v[88:91], v[128:131], v[56:59]
v_mfma_f32_16x16x32_bf16 v[76:79], v[92:95], v[128:131], v[76:79]
s_waitcnt lgkmcnt(0)
s_waitcnt vmcnt(12)
s_barrier
v_mfma_f32_16x16x32_bf16 v[0:3], v[96:99], v[132:135], v[0:3]
s_add_u32 s55, s55, 10240
s_cmp_eq_u32 s55, 30720
s_cselect_b32 s55, 0, s55
v_add_u32 v167, s55, v162
v_add_u32 v168, s55, v163
ds_read_b64_tr_b16 v[80:81], v159 offset:32768
v_mfma_f32_16x16x32_bf16 v[20:23], v[100:103], v[132:135], v[20:23]
ds_read_b64_tr_b16 v[82:83], v159 offset:34816
s_add_u32 m0, s59, 49152
s_add_u32 s40, s45, s57
buffer_load_dwordx4 v152, s[12:15], s40 offen lds
v_mfma_f32_16x16x32_bf16 v[40:43], v[104:107], v[132:135], v[40:43]
ds_read_b64_tr_b16 v[84:85], v159 offset:32776
ds_read_b64_tr_b16 v[86:87], v159 offset:34824
v_mfma_f32_16x16x32_bf16 v[60:63], v[108:111], v[132:135], v[60:63]
ds_read_b64_tr_b16 v[88:89], v160 offset:32768
buffer_load_dwordx4 v153, s[12:15], s40 offen offset:1024 lds
v_mfma_f32_16x16x32_bf16 v[4:7], v[96:99], v[136:139], v[4:7]
ds_read_b64_tr_b16 v[90:91], v160 offset:34816
v_mfma_f32_16x16x32_bf16 v[24:27], v[100:103], v[136:139], v[24:27]
ds_read_b64_tr_b16 v[92:93], v160 offset:32776
ds_read_b64_tr_b16 v[94:95], v160 offset:34824
buffer_load_dwordx4 v154, s[12:15], s40 offen offset:2048 lds
v_mfma_f32_16x16x32_bf16 v[44:47], v[104:107], v[136:139], v[44:47]
ds_read_b128 v[112:115], v167
v_mfma_f32_16x16x32_bf16 v[64:67], v[108:111], v[136:139], v[64:67]
ds_read_b128 v[116:119], v167 offset:2048
ds_read_b128 v[120:123], v167 offset:4096
buffer_load_dwordx4 v155, s[12:15], s40 offen offset:3072 lds
v_mfma_f32_16x16x32_bf16 v[8:11], v[96:99], v[140:143], v[8:11]
ds_read_b128 v[124:127], v167 offset:6144
v_mfma_f32_16x16x32_bf16 v[28:31], v[100:103], v[140:143], v[28:31]
ds_read_b128 v[128:131], v167 offset:8192
s_add_u32 s44, s44, 128
s_add_u32 s54, s54, 10240
s_cmp_eq_u32 s54, 30720
s_cselect_b32 s54, 0, s54
s_lshr_b32 s41, s59, 2
s_add_u32 s41, s41, s54
s_add_u32 m0, s41, 131072
s_add_u32 s40, s44, s58
buffer_load_dwordx4 v156, s[8:11], s40 offen lds
v_mfma_f32_16x16x32_bf16 v[48:51], v[104:107], v[140:143], v[48:51]
v_mfma_f32_16x16x32_bf16 v[68:71], v[108:111], v[140:143], v[68:71]
s_add_u32 m0, s54, 135168
s_add_u32 s40, s44, 36864
buffer_load_dwordx4 v156, s[8:11], s40 offen lds
s_add_u32 s45, s45, 262144
v_mfma_f32_16x16x32_bf16 v[12:15], v[96:99], v[144:147], v[12:15]
v_mfma_f32_16x16x32_bf16 v[32:35], v[100:103], v[144:147], v[32:35]
v_mfma_f32_16x16x32_bf16 v[52:55], v[104:107], v[144:147], v[52:55]
v_mfma_f32_16x16x32_bf16 v[72:75], v[108:111], v[144:147], v[72:75]
v_mfma_f32_16x16x32_bf16 v[16:19], v[96:99], v[148:151], v[16:19]
v_mfma_f32_16x16x32_bf16 v[36:39], v[100:103], v[148:151], v[36:39]
v_mfma_f32_16x16x32_bf16 v[56:59], v[104:107], v[148:151], v[56:59]
v_mfma_f32_16x16x32_bf16 v[76:79], v[108:111], v[148:151], v[76:79]
s_waitcnt lgkmcnt(0)
s_mov_b32 s34, 0
s_waitcnt vmcnt(12)
s_barrier
v_mfma_f32_16x16x32_bf16 v[0:3], v[80:83], v[112:115], v[0:3]
ds_read_b64_tr_b16 v[96:97], v159 offset:49152
ds_read_b64_tr_b16 v[98:99], v159 offset:51200
v_mfma_f32_16x16x32_bf16 v[20:23], v[84:87], v[112:115], v[20:23]
ds_read_b64_tr_b16 v[100:101], v159 offset:49160
s_add_u32 s40, s34, s32
s_and_b32 s40, s40, 31
s_lshl_b32 s40, s40, 13
s_lshr_b32 s41, s34, 5
s_lshl_b32 s41, s41, 19
s_add_u32 s40, s40, s41
s_add_u32 s35, s40, s33
s_add_u32 s34, s34, 1
s_add_u32 m0, s37, 0
s_nop 0
buffer_load_dwordx4 v203, s[16:19], s35 offen nt lds
v_mfma_f32_16x16x32_bf16 v[40:43], v[88:91], v[112:115], v[40:43]
ds_read_b64_tr_b16 v[102:103], v159 offset:51208
buffer_load_dwordx4 v204, s[16:19], s35 offen offset:1024 nt lds
v_mfma_f32_16x16x32_bf16 v[60:63], v[92:95], v[112:115], v[60:63]
ds_read_b64_tr_b16 v[104:105], v160 offset:49152
ds_read_b64_tr_b16 v[106:107], v160 offset:51200
v_mfma_f32_16x16x32_bf16 v[4:7], v[80:83], v[116:119], v[4:7]
ds_read_b64_tr_b16 v[108:109], v160 offset:49160
buffer_load_dwordx4 v205, s[16:19], s35 offen offset:2048 nt lds
v_mfma_f32_16x16x32_bf16 v[24:27], v[84:87], v[116:119], v[24:27]
ds_read_b64_tr_b16 v[110:111], v160 offset:51208
buffer_load_dwordx4 v206, s[16:19], s35 offen offset:3072 nt lds
v_mfma_f32_16x16x32_bf16 v[44:47], v[88:91], v[116:119], v[44:47]
ds_read_b128 v[132:135], v168
ds_read_b128 v[136:139], v168 offset:2048
v_mfma_f32_16x16x32_bf16 v[64:67], v[92:95], v[116:119], v[64:67]
ds_read_b128 v[140:143], v168 offset:4096
s_add_u32 m0, s37, 8192
s_nop 0
buffer_load_dwordx4 v207, s[20:23], s35 offen nt lds
v_mfma_f32_16x16x32_bf16 v[8:11], v[80:83], v[120:123], v[8:11]
ds_read_b128 v[144:147], v168 offset:6144
buffer_load_dwordx4 v208, s[20:23], s35 offen offset:1024 nt lds
v_mfma_f32_16x16x32_bf16 v[28:31], v[84:87], v[120:123], v[28:31]
ds_read_b128 v[148:151], v168 offset:8192
v_mfma_f32_16x16x32_bf16 v[48:51], v[88:91], v[120:123], v[48:51]
buffer_load_dwordx4 v207, s[20:23], s35 offen offset:2048 nt lds
v_mfma_f32_16x16x32_bf16 v[68:71], v[92:95], v[120:123], v[68:71]
buffer_load_dwordx4 v208, s[20:23], s35 offen offset:3072 nt lds
v_mfma_f32_16x16x32_bf16 v[12:15], v[80:83], v[124:127], v[12:15]
v_mfma_f32_16x16x32_bf16 v[32:35], v[84:87], v[124:127], v[32:35]
v_mfma_f32_16x16x32_bf16 v[52:55], v[88:91], v[124:127], v[52:55]
v_mfma_f32_16x16x32_bf16 v[72:75], v[92:95], v[124:127], v[72:75]
v_mfma_f32_16x16x32_bf16 v[16:19], v[80:83], v[128:131], v[16:19]
v_mfma_f32_16x16x32_bf16 v[36:39], v[84:87], v[128:131], v[36:39]
v_mfma_f32_16x16x32_bf16 v[56:59], v[88:91], v[128:131], v[56:59]
v_mfma_f32_16x16x32_bf16 v[76:79], v[92:95], v[128:131], v[76:79]
s_waitcnt lgkmcnt(0)
s_waitcnt vmcnt(14)
s_barrier
v_mfma_f32_16x16x32_bf16 v[0:3], v[96:99], v[132:135], v[0:3]
s_add_u32 s55, s55, 10240
s_cmp_eq_u32 s55, 30720
s_cselect_b32 s55, 0, s55
v_add_u32 v167, s55, v162
v_add_u32 v168, s55, v163
ds_read_b64_tr_b16 v[80:81], v157 offset:32768
v_mfma_f32_16x16x32_bf16 v[20:23], v[100:103], v[132:135], v[20:23]
ds_read_b64_tr_b16 v[82:83], v157 offset:34816
s_add_u32 s40, s34, s32
s_and_b32 s40, s40, 31
s_lshl_b32 s40, s40, 13
s_lshr_b32 s41, s34, 5
s_lshl_b32 s41, s41, 19
s_add_u32 s40, s40, s41
s_add_u32 s35, s40, s33
s_add_u32 s34, s34, 1
s_add_u32 m0, s37, 16384
s_nop 0
buffer_load_dwordx4 v203, s[16:19], s35 offen nt lds
v_mfma_f32_16x16x32_bf16 v[40:43], v[104:107], v[132:135], v[40:43]
ds_read_b64_tr_b16 v[84:85], v157 offset:32776
ds_read_b64_tr_b16 v[86:87], v157 offset:34824
buffer_load_dwordx4 v204, s[16:19], s35 offen offset:1024 nt lds
v_mfma_f32_16x16x32_bf16 v[60:63], v[108:111], v[132:135], v[60:63]
ds_read_b64_tr_b16 v[88:89], v158 offset:32768
v_mfma_f32_16x16x32_bf16 v[4:7], v[96:99], v[136:139], v[4:7]
ds_read_b64_tr_b16 v[90:91], v158 offset:34816
buffer_load_dwordx4 v205, s[16:19], s35 offen offset:2048 nt lds
v_mfma_f32_16x16x32_bf16 v[24:27], v[100:103], v[136:139], v[24:27]
ds_read_b64_tr_b16 v[92:93], v158 offset:32776
ds_read_b64_tr_b16 v[94:95], v158 offset:34824
buffer_load_dwordx4 v206, s[16:19], s35 offen offset:3072 nt lds
v_mfma_f32_16x16x32_bf16 v[44:47], v[104:107], v[136:139], v[44:47]
ds_read_b128 v[112:115], v167
v_mfma_f32_16x16x32_bf16 v[64:67], v[108:111], v[136:139], v[64:67]
ds_read_b128 v[116:119], v167 offset:2048
ds_read_b128 v[120:123], v167 offset:4096
s_add_u32 m0, s37, 24576
s_nop 0
buffer_load_dwordx4 v207, s[20:23], s35 offen nt lds
v_mfma_f32_16x16x32_bf16 v[8:11], v[96:99], v[140:143], v[8:11]
ds_read_b128 v[124:127], v167 offset:6144
buffer_load_dwordx4 v208, s[20:23], s35 offen offset:1024 nt lds
v_mfma_f32_16x16x32_bf16 v[28:31], v[100:103], v[140:143], v[28:31]
ds_read_b128 v[128:131], v167 offset:8192
v_mfma_f32_16x16x32_bf16 v[48:51], v[104:107], v[140:143], v[48:51]
buffer_load_dwordx4 v207, s[20:23], s35 offen offset:2048 nt lds
v_mfma_f32_16x16x32_bf16 v[68:71], v[108:111], v[140:143], v[68:71]
buffer_load_dwordx4 v208, s[20:23], s35 offen offset:3072 nt lds
v_mfma_f32_16x16x32_bf16 v[12:15], v[96:99], v[144:147], v[12:15]
v_mfma_f32_16x16x32_bf16 v[32:35], v[100:103], v[144:147], v[32:35]
v_mfma_f32_16x16x32_bf16 v[52:55], v[104:107], v[144:147], v[52:55]
v_mfma_f32_16x16x32_bf16 v[72:75], v[108:111], v[144:147], v[72:75]
v_mfma_f32_16x16x32_bf16 v[16:19], v[96:99], v[148:151], v[16:19]
v_mfma_f32_16x16x32_bf16 v[36:39], v[100:103], v[148:151], v[36:39]
v_mfma_f32_16x16x32_bf16 v[56:59], v[104:107], v[148:151], v[56:59]
v_mfma_f32_16x16x32_bf16 v[76:79], v[108:111], v[148:151], v[76:79]
s_waitcnt lgkmcnt(0)
s_waitcnt vmcnt(16)
s_barrier
v_mfma_f32_16x16x32_bf16 v[0:3], v[80:83], v[112:115], v[0:3]
ds_read_b64_tr_b16 v[96:97], v157 offset:49152
ds_read_b64_tr_b16 v[98:99], v157 offset:51200
v_mfma_f32_16x16x32_bf16 v[20:23], v[84:87], v[112:115], v[20:23]
ds_read_b64_tr_b16 v[100:101], v157 offset:49160
v_mfma_f32_16x16x32_bf16 v[40:43], v[88:91], v[112:115], v[40:43]
ds_read_b64_tr_b16 v[102:103], v157 offset:51208
v_mfma_f32_16x16x32_bf16 v[60:63], v[92:95], v[112:115], v[60:63]
ds_read_b64_tr_b16 v[104:105], v158 offset:49152
ds_read_b64_tr_b16 v[106:107], v158 offset:51200
v_mfma_f32_16x16x32_bf16 v[4:7], v[80:83], v[116:119], v[4:7]
ds_read_b64_tr_b16 v[108:109], v158 offset:49160
v_mfma_f32_16x16x32_bf16 v[24:27], v[84:87], v[116:119], v[24:27]
ds_read_b64_tr_b16 v[110:111], v158 offset:51208
v_mfma_f32_16x16x32_bf16 v[44:47], v[88:91], v[116:119], v[44:47]
ds_read_b128 v[132:135], v168
ds_read_b128 v[136:139], v168 offset:2048
v_mfma_f32_16x16x32_bf16 v[64:67], v[92:95], v[116:119], v[64:67]
ds_read_b128 v[140:143], v168 offset:4096
v_mfma_f32_16x16x32_bf16 v[8:11], v[80:83], v[120:123], v[8:11]
ds_read_b128 v[144:147], v168 offset:6144
v_mfma_f32_16x16x32_bf16 v[28:31], v[84:87], v[120:123], v[28:31]
ds_read_b128 v[148:151], v168 offset:8192
v_mfma_f32_16x16x32_bf16 v[48:51], v[88:91], v[120:123], v[48:51]
v_mfma_f32_16x16x32_bf16 v[68:71], v[92:95], v[120:123], v[68:71]
v_mfma_f32_16x16x32_bf16 v[12:15], v[80:83], v[124:127], v[12:15]
v_mfma_f32_16x16x32_bf16 v[32:35], v[84:87], v[124:127], v[32:35]
v_mfma_f32_16x16x32_bf16 v[52:55], v[88:91], v[124:127], v[52:55]
v_mfma_f32_16x16x32_bf16 v[72:75], v[92:95], v[124:127], v[72:75]
v_mfma_f32_16x16x32_bf16 v[16:19], v[80:83], v[128:131], v[16:19]
v_mfma_f32_16x16x32_bf16 v[36:39], v[84:87], v[128:131], v[36:39]
v_mfma_f32_16x16x32_bf16 v[56:59], v[88:91], v[128:131], v[56:59]
v_mfma_f32_16x16x32_bf16 v[76:79], v[92:95], v[128:131], v[76:79]
s_waitcnt lgkmcnt(0)
v_mfma_f32_16x16x32_bf16 v[0:3], v[96:99], v[132:135], v[0:3]
v_mfma_f32_16x16x32_bf16 v[20:23], v[100:103], v[132:135], v[20:23]
v_mfma_f32_16x16x32_bf16 v[40:43], v[104:107], v[132:135], v[40:43]
v_mfma_f32_16x16x32_bf16 v[60:63], v[108:111], v[132:135], v[60:63]
v_mfma_f32_16x16x32_bf16 v[4:7], v[96:99], v[136:139], v[4:7]
v_mfma_f32_16x16x32_bf16 v[24:27], v[100:103], v[136:139], v[24:27]
v_mfma_f32_16x16x32_bf16 v[44:47], v[104:107], v[136:139], v[44:47]
v_mfma_f32_16x16x32_bf16 v[64:67], v[108:111], v[136:139], v[64:67]
v_mfma_f32_16x16x32_bf16 v[8:11], v[96:99], v[140:143], v[8:11]
v_mfma_f32_16x16x32_bf16 v[28:31], v[100:103], v[140:143], v[28:31]
v_mfma_f32_16x16x32_bf16 v[48:51], v[104:107], v[140:143], v[48:51]
v_mfma_f32_16x16x32_bf16 v[68:71], v[108:111], v[140:143], v[68:71]
v_mfma_f32_16x16x32_bf16 v[12:15], v[96:99], v[144:147], v[12:15]
v_mfma_f32_16x16x32_bf16 v[32:35], v[100:103], v[144:147], v[32:35]
v_mfma_f32_16x16x32_bf16 v[52:55], v[104:107], v[144:147], v[52:55]
v_mfma_f32_16x16x32_bf16 v[72:75], v[108:111], v[144:147], v[72:75]
v_mfma_f32_16x16x32_bf16 v[16:19], v[96:99], v[148:151], v[16:19]
v_mfma_f32_16x16x32_bf16 v[36:39], v[100:103], v[148:151], v[36:39]
v_mfma_f32_16x16x32_bf16 v[56:59], v[104:107], v[148:151], v[56:59]
v_mfma_f32_16x16x32_bf16 v[76:79], v[108:111], v[148:151], v[76:79]
s_branch qdone_1
qr1_2:
s_lshr_b32 s41, s59, 2
s_add_u32 s41, s41, s54
s_add_u32 m0, s41, 131072
s_add_u32 s40, s44, s58
buffer_load_dwordx4 v156, s[8:11], s40 offen lds
s_add_u32 m0, s59, 32768
s_add_u32 s40, s45, s57
buffer_load_dwordx4 v152, s[12:15], s40 offen lds
buffer_load_dwordx4 v153, s[12:15], s40 offen offset:1024 lds
buffer_load_dwordx4 v154, s[12:15], s40 offen offset:2048 lds
buffer_load_dwordx4 v155, s[12:15], s40 offen offset:3072 lds
s_lshr_b32 s41, s59, 2
s_add_u32 s41, s41, s54
s_add_u32 m0, s41, 136192
s_add_u32 s40, s44, s58
s_add_u32 s40, s40, 46080
buffer_load_dwordx4 v161, s[8:11], s40 offen lds
s_add_u32 s45, s45, 262144
s_add_u32 m0, s59, 49152
s_add_u32 s40, s45, s57
buffer_load_dwordx4 v152, s[12:15], s40 offen lds
buffer_load_dwordx4 v153, s[12:15], s40 offen offset:1024 lds
buffer_load_dwordx4 v154, s[12:15], s40 offen offset:2048 lds
buffer_load_dwordx4 v155, s[12:15], s40 offen offset:3072 lds
s_add_u32 s44, s44, 128
s_add_u32 s54, s54, 10240
s_cmp_eq_u32 s54, 30720
s_cselect_b32 s54, 0, s54
s_lshr_b32 s41, s59, 2
s_add_u32 s41, s41, s54
s_add_u32 m0, s41, 131072
s_add_u32 s40, s44, s58
buffer_load_dwordx4 v156, s[8:11], s40 offen lds
s_add_u32 s45, s45, 262144
s_add_u32 m0, s59, 98304
s_add_u32 s40, s45, s57
buffer_load_dwordx4 v152, s[12:15], s40 offen lds
buffer_load_dwordx4 v153, s[12:15], s40 offen offset:1024 lds
buffer_load_dwordx4 v154, s[12:15], s40 offen offset:2048 lds
buffer_load_dwordx4 v155, s[12:15], s40 offen offset:3072 lds
s_lshr_b32 s41, s59, 2
s_add_u32 s41, s41, s54
s_add_u32 m0, s41, 136192
s_add_u32 s40, s44, s58
s_add_u32 s40, s40, 46080
buffer_load_dwordx4 v161, s[8:11], s40 offen lds
s_add_u32 s45, s45, 262144
s_waitcnt vmcnt(10)
s_barrier
s_add_u32 m0, s59, 114688
s_add_u32 s40, s45, s57
buffer_load_dwordx4 v152, s[12:15], s40 offen lds
buffer_load_dwordx4 v153, s[12:15], s40 offen offset:1024 lds
buffer_load_dwordx4 v154, s[12:15], s40 offen offset:2048 lds
buffer_load_dwordx4 v155, s[12:15], s40 offen offset:3072 lds
s_add_u32 s44, s44, 128
s_add_u32 s54, s54, 10240
s_cmp_eq_u32 s54, 30720
s_cselect_b32 s54, 0, s54
s_lshr_b32 s41, s59, 2
s_add_u32 s41, s41, s54
s_add_u32 m0, s41, 131072
s_add_u32 s40, s44, s58
buffer_load_dwordx4 v156, s[8:11], s40 offen lds
s_add_u32 s45, s45, 262144
ds_read_b64_tr_b16 v[80:81], v157 offset:32768
ds_read_b64_tr_b16 v[82:83], v157 offset:34816
ds_read_b64_tr_b16 v[84:85], v157 offset:32776
ds_read_b64_tr_b16 v[86:87], v157 offset:34824
ds_read_b64_tr_b16 v[88:89], v158 offset:32768
ds_read_b64_tr_b16 v[90:91], v158 offset:34816
ds_read_b64_tr_b16 v[92:93], v158 offset:32776
ds_read_b64_tr_b16 v[94:95], v158 offset:34824
ds_read_b128 v[112:115], v167
ds_read_b128 v[116:119], v167 offset:2048
ds_read_b128 v[120:123], v167 offset:4096
ds_read_b128 v[124:127], v167 offset:6144
ds_read_b128 v[128:131], v167 offset:8192
s_waitcnt lgkmcnt(0)
s_mov_b32 s38, 0
qloop_6:
s_waitcnt vmcnt(10)
s_barrier
v_mfma_f32_16x16x32_bf16 v[0:3], v[80:83], v[112:115], v[0:3]
ds_read_b64_tr_b16 v[96:97], v157 offset:49152
ds_read_b64_tr_b16 v[98:99], v157 offset:51200
v_mfma_f32_16x16x32_bf16 v[20:23], v[84:87], v[112:115], v[20:23]
ds_read_b64_tr_b16 v[100:101], v157 offset:49160
s_add_u32 m0, s59, 32768
s_add_u32 s40, s45, s57
buffer_load_dwordx4 v152, s[12:15], s40 offen lds
v_mfma_f32_16x16x32_bf16 v[40:43], v[88:91], v[112:115], v[40:43]
ds_read_b64_tr_b16 v[102:103], v157 offset:51208
v_mfma_f32_16x16x32_bf16 v[60:63], v[92:95], v[112:115], v[60:63]
ds_read_b64_tr_b16 v[104:105], v158 offset:49152
ds_read_b64_tr_b16 v[106:107], v158 offset:51200
buffer_load_dwordx4 v153, s[12:15], s40 offen offset:1024 lds
v_mfma_f32_16x16x32_bf16 v[4:7], v[80:83], v[116:119], v[4:7]
ds_read_b64_tr_b16 v[108:109], v158 offset:49160
v_mfma_f32_16x16x32_bf16 v[24:27], v[84:87], v[116:119], v[24:27]
ds_read_b64_tr_b16 v[110:111], v158 offset:51208
buffer_load_dwordx4 v154, s[12:15], s40 offen offset:2048 lds
v_mfma_f32_16x16x32_bf16 v[44:47], v[88:91], v[116:119], v[44:47]
ds_read_b128 v[132:135], v168
ds_read_b128 v[136:139], v168 offset:2048
v_mfma_f32_16x16x32_bf16 v[64:67], v[92:95], v[116:119], v[64:67]
ds_read_b128 v[140:143], v168 offset:4096
v_mfma_f32_16x16x32_bf16 v[8:11], v[80:83], v[120:123], v[8:11]
ds_read_b128 v[144:147], v168 offset:6144
buffer_load_dwordx4 v155, s[12:15], s40 offen offset:3072 lds
v_mfma_f32_16x16x32_bf16 v[28:31], v[84:87], v[120:123], v[28:31]
ds_read_b128 v[148:151], v168 offset:8192
v_mfma_f32_16x16x32_bf16 v[48:51], v[88:91], v[120:123], v[48:51]
s_lshr_b32 s41, s59, 2
s_add_u32 s41, s41, s54
s_add_u32 m0, s41, 136192
s_add_u32 s40, s44, s58
s_add_u32 s40, s40, 46080
buffer_load_dwordx4 v161, s[8:11], s40 offen lds
s_add_u32 s45, s45, 262144
v_mfma_f32_16x16x32_bf16 v[68:71], v[92:95], v[120:123], v[68:71]
v_mfma_f32_16x16x32_bf16 v[12:15], v[80:83], v[124:127], v[12:15]
v_mfma_f32_16x16x32_bf16 v[32:35], v[84:87], v[124:127], v[32:35]
v_mfma_f32_16x16x32_bf16 v[52:55], v[88:91], v[124:127], v[52:55]
v_mfma_f32_16x16x32_bf16 v[72:75], v[92:95], v[124:127], v[72:75]
v_mfma_f32_16x16x32_bf16 v[16:19], v[80:83], v[128:131], v[16:19]
v_mfma_f32_16x16x32_bf16 v[36:39], v[84:87], v[128:131], v[36:39]
v_mfma_f32_16x16x32_bf16 v[56:59], v[88:91], v[128:131], v[56:59]
v_mfma_f32_16x16x32_bf16 v[76:79], v[92:95], v[128:131], v[76:79]
s_waitcnt lgkmcnt(0)
s_waitcnt vmcnt(10)
s_barrier
v_mfma_f32_16x16x32_bf16 v[0:3], v[96:99], v[132:135], v[0:3]
s_add_u32 s55, s55, 10240
s_cmp_eq_u32 s55, 30720
s_cselect_b32 s55, 0, s55
v_add_u32 v167, s55, v162
v_add_u32 v168, s55, v163
ds_read_b64_tr_b16 v[80:81], v159 offset:32768
v_mfma_f32_16x16x32_bf16 v[20:23], v[100:103], v[132:135], v[20:23]
ds_read_b64_tr_b16 v[82:83], v159 offset:34816
s_add_u32 m0, s59, 49152
s_add_u32 s40, s45, s57
buffer_load_dwordx4 v152, s[12:15], s40 offen lds
v_mfma_f32_16x16x32_bf16 v[40:43], v[104:107], v[132:135], v[40:43]
ds_read_b64_tr_b16 v[84:85], v159 offset:32776
ds_read_b64_tr_b16 v[86:87], v159 offset:34824
v_mfma_f32_16x16x32_bf16 v[60:63], v[108:111], v[132:135], v[60:63]
ds_read_b64_tr_b16 v[88:89], v160 offset:32768
buffer_load_dwordx4 v153, s[12:15], s40 offen offset:1024 lds
v_mfma_f32_16x16x32_bf16 v[4:7], v[96:99], v[136:139], v[4:7]
ds_read_b64_tr_b16 v[90:91], v160 offset:34816
v_mfma_f32_16x16x32_bf16 v[24:27], v[100:103], v[136:139], v[24:27]
ds_read_b64_tr_b16 v[92:93], v160 offset:32776
ds_read_b64_tr_b16 v[94:95], v160 offset:34824
buffer_load_dwordx4 v154, s[12:15], s40 offen offset:2048 lds
v_mfma_f32_16x16x32_bf16 v[44:47], v[104:107], v[136:139], v[44:47]
ds_read_b128 v[112:115], v167
v_mfma_f32_16x16x32_bf16 v[64:67], v[108:111], v[136:139], v[64:67]
ds_read_b128 v[116:119], v167 offset:2048
ds_read_b128 v[120:123], v167 offset:4096
v_mfma_f32_16x16x32_bf16 v[8:11], v[96:99], v[140:143], v[8:11]
ds_read_b128 v[124:127], v167 offset:6144
buffer_load_dwordx4 v155, s[12:15], s40 offen offset:3072 lds
v_mfma_f32_16x16x32_bf16 v[28:31], v[100:103], v[140:143], v[28:31]
ds_read_b128 v[128:131], v167 offset:8192
v_mfma_f32_16x16x32_bf16 v[48:51], v[104:107], v[140:143], v[48:51]
s_add_u32 s44, s44, 128
s_add_u32 s54, s54, 10240
s_cmp_eq_u32 s54, 30720
s_cselect_b32 s54, 0, s54
s_lshr_b32 s41, s59, 2
s_add_u32 s41, s41, s54
s_add_u32 m0, s41, 131072
s_add_u32 s40, s44, s58
buffer_load_dwordx4 v156, s[8:11], s40 offen lds
s_add_u32 s45, s45, 262144
v_mfma_f32_16x16x32_bf16 v[68:71], v[108:111], v[140:143], v[68:71]
v_mfma_f32_16x16x32_bf16 v[12:15], v[96:99], v[144:147], v[12:15]
v_mfma_f32_16x16x32_bf16 v[32:35], v[100:103], v[144:147], v[32:35]
v_mfma_f32_16x16x32_bf16 v[52:55], v[104:107], v[144:147], v[52:55]
v_mfma_f32_16x16x32_bf16 v[72:75], v[108:111], v[144:147], v[72:75]
v_mfma_f32_16x16x32_bf16 v[16:19], v[96:99], v[148:151], v[16:19]
v_mfma_f32_16x16x32_bf16 v[36:39], v[100:103], v[148:151], v[36:39]
v_mfma_f32_16x16x32_bf16 v[56:59], v[104:107], v[148:151], v[56:59]
v_mfma_f32_16x16x32_bf16 v[76:79], v[108:111], v[148:151], v[76:79]
s_waitcnt lgkmcnt(0)
s_waitcnt vmcnt(10)
s_barrier
v_mfma_f32_16x16x32_bf16 v[0:3], v[80:83], v[112:115], v[0:3]
ds_read_b64_tr_b16 v[96:97], v159 offset:49152
ds_read_b64_tr_b16 v[98:99], v159 offset:51200
v_mfma_f32_16x16x32_bf16 v[20:23], v[84:87], v[112:115], v[20:23]
ds_read_b64_tr_b16 v[100:101], v159 offset:49160
s_add_u32 m0, s59, 98304
s_add_u32 s40, s45, s57
buffer_load_dwordx4 v152, s[12:15], s40 offen lds
v_mfma_f32_16x16x32_bf16 v[40:43], v[88:91], v[112:115], v[40:43]
ds_read_b64_tr_b16 v[102:103], v159 offset:51208
v_mfma_f32_16x16x32_bf16 v[60:63], v[92:95], v[112:115], v[60:63]
ds_read_b64_tr_b16 v[104:105], v160 offset:49152
ds_read_b64_tr_b16 v[106:107], v160 offset:51200
buffer_load_dwordx4 v153, s[12:15], s40 offen offset:1024 lds
v_mfma_f32_16x16x32_bf16 v[4:7], v[80:83], v[116:119], v[4:7]
ds_read_b64_tr_b16 v[108:109], v160 offset:49160
v_mfma_f32_16x16x32_bf16 v[24:27], v[84:87], v[116:119], v[24:27]
ds_read_b64_tr_b16 v[110:111], v160 offset:51208
buffer_load_dwordx4 v154, s[12:15], s40 offen offset:2048 lds
v_mfma_f32_16x16x32_bf16 v[44:47], v[88:91], v[116:119], v[44:47]
ds_read_b128 v[132:135], v168
ds_read_b128 v[136:139], v168 offset:2048
v_mfma_f32_16x16x32_bf16 v[64:67], v[92:95], v[116:119], v[64:67]
ds_read_b128 v[140:143], v168 offset:4096
v_mfma_f32_16x16x32_bf16 v[8:11], v[80:83], v[120:123], v[8:11]
ds_read_b128 v[144:147], v168 offset:6144
buffer_load_dwordx4 v155, s[12:15], s40 offen offset:3072 lds
v_mfma_f32_16x16x32_bf16 v[28:31], v[84:87], v[120:123], v[28:31]
ds_read_b128 v[148:151], v168 offset:8192
v_mfma_f32_16x16x32_bf16 v[48:51], v[88:91], v[120:123], v[48:51]
s_lshr_b32 s41, s59, 2
s_add_u32 s41, s41, s54
s_add_u32 m0, s41, 136192
s_add_u32 s40, s44, s58
s_add_u32 s40, s40, 46080
buffer_load_dwordx4 v161, s[8:11], s40 offen lds
s_add_u32 s45, s45, 262144
v_mfma_f32_16x16x32_bf16 v[68:71], v[92:95], v[120:123], v[68:71]
v_mfma_f32_16x16x32_bf16 v[12:15], v[80:83], v[124:127], v[12:15]
v_mfma_f32_16x16x32_bf16 v[32:35], v[84:87], v[124:127], v[32:35]
v_mfma_f32_16x16x32_bf16 v[52:55], v[88:91], v[124:127], v[52:55]
v_mfma_f32_16x16x32_bf16 v[72:75], v[92:95], v[124:127], v[72:75]
v_mfma_f32_16x16x32_bf16 v[16:19], v[80:83], v[128:131], v[16:19]
v_mfma_f32_16x16x32_bf16 v[36:39], v[84:87], v[128:131], v[36:39]
v_mfma_f32_16x16x32_bf16 v[56:59], v[88:91], v[128:131], v[56:59]
v_mfma_f32_16x16x32_bf16 v[76:79], v[92:95], v[128:131], v[76:79]
s_waitcnt lgkmcnt(0)
s_waitcnt vmcnt(10)
s_barrier
v_mfma_f32_16x16x32_bf16 v[0:3], v[96:99], v[132:135], v[0:3]
s_add_u32 s55, s55, 10240
s_cmp_eq_u32 s55, 30720
s_cselect_b32 s55, 0, s55
v_add_u32 v167, s55, v162
v_add_u32 v168, s55, v163
ds_read_b64_tr_b16 v[80:81], v157 offset:32768
v_mfma_f32_16x16x32_bf16 v[20:23], v[100:103], v[132:135], v[20:23]
ds_read_b64_tr_b16 v[82:83], v157 offset:34816
s_add_u32 m0, s59, 114688
s_add_u32 s40, s45, s57
buffer_load_dwordx4 v152, s[12:15], s40 offen lds
v_mfma_f32_16x16x32_bf16 v[40:43], v[104:107], v[132:135], v[40:43]
ds_read_b64_tr_b16 v[84:85], v157 offset:32776
ds_read_b64_tr_b16 v[86:87], v157 offset:34824
v_mfma_f32_16x16x32_bf16 v[60:63], v[108:111], v[132:135], v[60:63]
ds_read_b64_tr_b16 v[88:89], v158 offset:32768
buffer_load_dwordx4 v153, s[12:15], s40 offen offset:1024 lds
v_mfma_f32_16x16x32_bf16 v[4:7], v[96:99], v[136:139], v[4:7]
ds_read_b64_tr_b16 v[90:91], v158 offset:34816
v_mfma_f32_16x16x32_bf16 v[24:27], v[100:103], v[136:139], v[24:27]
ds_read_b64_tr_b16 v[92:93], v158 offset:32776
ds_read_b64_tr_b16 v[94:95], v158 offset:34824
buffer_load_dwordx4 v154, s[12:15], s40 offen offset:2048 lds
v_mfma_f32_16x16x32_bf16 v[44:47], v[104:107], v[136:139], v[44:47]
ds_read_b128 v[112:115], v167
v_mfma_f32_16x16x32_bf16 v[64:67], v[108:111], v[136:139], v[64:67]
ds_read_b128 v[116:119], v167 offset:2048
ds_read_b128 v[120:123], v167 offset:4096
v_mfma_f32_16x16x32_bf16 v[8:11], v[96:99], v[140:143], v[8:11]
ds_read_b128 v[124:127], v167 offset:6144
buffer_load_dwordx4 v155, s[12:15], s40 offen offset:3072 lds
v_mfma_f32_16x16x32_bf16 v[28:31], v[100:103], v[140:143], v[28:31]
ds_read_b128 v[128:131], v167 offset:8192
v_mfma_f32_16x16x32_bf16 v[48:51], v[104:107], v[140:143], v[48:51]
s_add_u32 s44, s44, 128
s_add_u32 s54, s54, 10240
s_cmp_eq_u32 s54, 30720
s_cselect_b32 s54, 0, s54
s_lshr_b32 s41, s59, 2
s_add_u32 s41, s41, s54
s_add_u32 m0, s41, 131072
s_add_u32 s40, s44, s58
buffer_load_dwordx4 v156, s[8:11], s40 offen lds
s_add_u32 s45, s45, 262144
v_mfma_f32_16x16x32_bf16 v[68:71], v[108:111], v[140:143], v[68:71]
v_mfma_f32_16x16x32_bf16 v[12:15], v[96:99], v[144:147], v[12:15]
v_mfma_f32_16x16x32_bf16 v[32:35], v[100:103], v[144:147], v[32:35]
v_mfma_f32_16x16x32_bf16 v[52:55], v[104:107], v[144:147], v[52:55]
v_mfma_f32_16x16x32_bf16 v[72:75], v[108:111], v[144:147], v[72:75]
v_mfma_f32_16x16x32_bf16 v[16:19], v[96:99], v[148:151], v[16:19]
v_mfma_f32_16x16x32_bf16 v[36:39], v[100:103], v[148:151], v[36:39]
v_mfma_f32_16x16x32_bf16 v[56:59], v[104:107], v[148:151], v[56:59]
v_mfma_f32_16x16x32_bf16 v[76:79], v[108:111], v[148:151], v[76:79]
s_waitcnt lgkmcnt(0)
s_add_u32 s38, s38, 1
s_cmp_lt_u32 s38, 3
s_cbranch_scc1 qloop_6
s_lshr_b32 s40, s49, 1
s_or_b32 s40, s40, s3
s_cmp_lg_u32 s40, 0
s_cbranch_scc1 fpub_7
s_lshl_b32 s40, s97, 2
v_mov_b32 v226, s40
v_mov_b32 v227, 1
s_mov_b64 s[42:43], exec
s_mov_b64 exec, 1
global_atomic_add v226, v227, s[68:69] sc1
s_mov_b64 exec, s[42:43]
fpub_7:
s_waitcnt vmcnt(10)
s_barrier
v_mfma_f32_16x16x32_bf16 v[0:3], v[80:83], v[112:115], v[0:3]
ds_read_b64_tr_b16 v[96:97], v157 offset:49152
ds_read_b64_tr_b16 v[98:99], v157 offset:51200
v_mfma_f32_16x16x32_bf16 v[20:23], v[84:87], v[112:115], v[20:23]
ds_read_b64_tr_b16 v[100:101], v157 offset:49160
s_add_u32 m0, s59, 32768
s_add_u32 s40, s45, s57
buffer_load_dwordx4 v152, s[12:15], s40 offen lds
v_mfma_f32_16x16x32_bf16 v[40:43], v[88:91], v[112:115], v[40:43]
ds_read_b64_tr_b16 v[102:103], v157 offset:51208
v_mfma_f32_16x16x32_bf16 v[60:63], v[92:95], v[112:115], v[60:63]
ds_read_b64_tr_b16 v[104:105], v158 offset:49152
ds_read_b64_tr_b16 v[106:107], v158 offset:51200
buffer_load_dwordx4 v153, s[12:15], s40 offen offset:1024 lds
v_mfma_f32_16x16x32_bf16 v[4:7], v[80:83], v[116:119], v[4:7]
ds_read_b64_tr_b16 v[108:109], v158 offset:49160
v_mfma_f32_16x16x32_bf16 v[24:27], v[84:87], v[116:119], v[24:27]
ds_read_b64_tr_b16 v[110:111], v158 offset:51208
buffer_load_dwordx4 v154, s[12:15], s40 offen offset:2048 lds
v_mfma_f32_16x16x32_bf16 v[44:47], v[88:91], v[116:119], v[44:47]
ds_read_b128 v[132:135], v168
ds_read_b128 v[136:139], v168 offset:2048
v_mfma_f32_16x16x32_bf16 v[64:67], v[92:95], v[116:119], v[64:67]
ds_read_b128 v[140:143], v168 offset:4096
v_mfma_f32_16x16x32_bf16 v[8:11], v[80:83], v[120:123], v[8:11]
ds_read_b128 v[144:147], v168 offset:6144
buffer_load_dwordx4 v155, s[12:15], s40 offen offset:3072 lds
v_mfma_f32_16x16x32_bf16 v[28:31], v[84:87], v[120:123], v[28:31]
ds_read_b128 v[148:151], v168 offset:8192
v_mfma_f32_16x16x32_bf16 v[48:51], v[88:91], v[120:123], v[48:51]
s_lshr_b32 s41, s59, 2
s_add_u32 s41, s41, s54
s_add_u32 m0, s41, 136192
s_add_u32 s40, s44, s58
s_add_u32 s40, s40, 46080
buffer_load_dwordx4 v161, s[8:11], s40 offen lds
s_add_u32 s45, s45, 262144
v_mfma_f32_16x16x32_bf16 v[68:71], v[92:95], v[120:123], v[68:71]
v_mfma_f32_16x16x32_bf16 v[12:15], v[80:83], v[124:127], v[12:15]
v_mfma_f32_16x16x32_bf16 v[32:35], v[84:87], v[124:127], v[32:35]
v_mfma_f32_16x16x32_bf16 v[52:55], v[88:91], v[124:127], v[52:55]
v_mfma_f32_16x16x32_bf16 v[72:75], v[92:95], v[124:127], v[72:75]
v_mfma_f32_16x16x32_bf16 v[16:19], v[80:83], v[128:131], v[16:19]
v_mfma_f32_16x16x32_bf16 v[36:39], v[84:87], v[128:131], v[36:39]
v_mfma_f32_16x16x32_bf16 v[56:59], v[88:91], v[128:131], v[56:59]
v_mfma_f32_16x16x32_bf16 v[76:79], v[92:95], v[128:131], v[76:79]
s_waitcnt lgkmcnt(0)
s_waitcnt vmcnt(10)
s_barrier
v_mfma_f32_16x16x32_bf16 v[0:3], v[96:99], v[132:135], v[0:3]
s_add_u32 s55, s55, 10240
s_cmp_eq_u32 s55, 30720
s_cselect_b32 s55, 0, s55
v_add_u32 v167, s55, v162
v_add_u32 v168, s55, v163
ds_read_b64_tr_b16 v[80:81], v159 offset:32768
v_mfma_f32_16x16x32_bf16 v[20:23], v[100:103], v[132:135], v[20:23]
ds_read_b64_tr_b16 v[82:83], v159 offset:34816
s_add_u32 m0, s59, 49152
s_add_u32 s40, s45, s57
buffer_load_dwordx4 v152, s[12:15], s40 offen lds
v_mfma_f32_16x16x32_bf16 v[40:43], v[104:107], v[132:135], v[40:43]
ds_read_b64_tr_b16 v[84:85], v159 offset:32776
ds_read_b64_tr_b16 v[86:87], v159 offset:34824
v_mfma_f32_16x16x32_bf16 v[60:63], v[108:111], v[132:135], v[60:63]
ds_read_b64_tr_b16 v[88:89], v160 offset:32768
buffer_load_dwordx4 v153, s[12:15], s40 offen offset:1024 lds
v_mfma_f32_16x16x32_bf16 v[4:7], v[96:99], v[136:139], v[4:7]
ds_read_b64_tr_b16 v[90:91], v160 offset:34816
v_mfma_f32_16x16x32_bf16 v[24:27], v[100:103], v[136:139], v[24:27]
ds_read_b64_tr_b16 v[92:93], v160 offset:32776
ds_read_b64_tr_b16 v[94:95], v160 offset:34824
buffer_load_dwordx4 v154, s[12:15], s40 offen offset:2048 lds
v_mfma_f32_16x16x32_bf16 v[44:47], v[104:107], v[136:139], v[44:47]
ds_read_b128 v[112:115], v167
v_mfma_f32_16x16x32_bf16 v[64:67], v[108:111], v[136:139], v[64:67]
ds_read_b128 v[116:119], v167 offset:2048
ds_read_b128 v[120:123], v167 offset:4096
v_mfma_f32_16x16x32_bf16 v[8:11], v[96:99], v[140:143], v[8:11]
ds_read_b128 v[124:127], v167 offset:6144
buffer_load_dwordx4 v155, s[12:15], s40 offen offset:3072 lds
v_mfma_f32_16x16x32_bf16 v[28:31], v[100:103], v[140:143], v[28:31]
ds_read_b128 v[128:131], v167 offset:8192
v_mfma_f32_16x16x32_bf16 v[48:51], v[104:107], v[140:143], v[48:51]
s_add_u32 s44, s44, 128
s_add_u32 s54, s54, 10240
s_cmp_eq_u32 s54, 30720
s_cselect_b32 s54, 0, s54
s_lshr_b32 s41, s59, 2
s_add_u32 s41, s41, s54
s_add_u32 m0, s41, 131072
s_add_u32 s40, s44, s58
buffer_load_dwordx4 v156, s[8:11], s40 offen lds
s_add_u32 s45, s45, 262144
v_mfma_f32_16x16x32_bf16 v[68:71], v[108:111], v[140:143], v[68:71]
v_mfma_f32_16x16x32_bf16 v[12:15], v[96:99], v[144:147], v[12:15]
v_mfma_f32_16x16x32_bf16 v[32:35], v[100:103], v[144:147], v[32:35]
v_mfma_f32_16x16x32_bf16 v[52:55], v[104:107], v[144:147], v[52:55]
v_mfma_f32_16x16x32_bf16 v[72:75], v[108:111], v[144:147], v[72:75]
v_mfma_f32_16x16x32_bf16 v[16:19], v[96:99], v[148:151], v[16:19]
v_mfma_f32_16x16x32_bf16 v[36:39], v[100:103], v[148:151], v[36:39]
v_mfma_f32_16x16x32_bf16 v[56:59], v[104:107], v[148:151], v[56:59]
v_mfma_f32_16x16x32_bf16 v[76:79], v[108:111], v[148:151], v[76:79]
s_waitcnt lgkmcnt(0)
s_mov_b32 s34, 0
s_waitcnt vmcnt(10)
s_barrier
v_mfma_f32_16x16x32_bf16 v[0:3], v[80:83], v[112:115], v[0:3]
ds_read_b64_tr_b16 v[96:97], v159 offset:49152
ds_read_b64_tr_b16 v[98:99], v159 offset:51200
v_mfma_f32_16x16x32_bf16 v[20:23], v[84:87], v[112:115], v[20:23]
ds_read_b64_tr_b16 v[100:101], v159 offset:49160
s_add_u32 s40, s34, s32
s_and_b32 s40, s40, 31
s_lshl_b32 s40, s40, 13
s_lshr_b32 s41, s34, 5
s_lshl_b32 s41, s41, 19
s_add_u32 s40, s40, s41
s_add_u32 s35, s40, s33
s_add_u32 s34, s34, 1
s_add_u32 m0, s37, 0
s_nop 0
buffer_load_dwordx4 v203, s[16:19], s35 offen nt lds
v_mfma_f32_16x16x32_bf16 v[40:43], v[88:91], v[112:115], v[40:43]
ds_read_b64_tr_b16 v[102:103], v159 offset:51208
buffer_load_dwordx4 v204, s[16:19], s35 offen offset:1024 nt lds
v_mfma_f32_16x16x32_bf16 v[60:63], v[92:95], v[112:115], v[60:63]
ds_read_b64_tr_b16 v[104:105], v160 offset:49152
ds_read_b64_tr_b16 v[106:107], v160 offset:51200
v_mfma_f32_16x16x32_bf16 v[4:7], v[80:83], v[116:119], v[4:7]
ds_read_b64_tr_b16 v[108:109], v160 offset:49160
buffer_load_dwordx4 v205, s[16:19], s35 offen offset:2048 nt lds
v_mfma_f32_16x16x32_bf16 v[24:27], v[84:87], v[116:119], v[24:27]
ds_read_b64_tr_b16 v[110:111], v160 offset:51208
buffer_load_dwordx4 v206, s[16:19], s35 offen offset:3072 nt lds
v_mfma_f32_16x16x32_bf16 v[44:47], v[88:91], v[116:119], v[44:47]
ds_read_b128 v[132:135], v168
ds_read_b128 v[136:139], v168 offset:2048
v_mfma_f32_16x16x32_bf16 v[64:67], v[92:95], v[116:119], v[64:67]
ds_read_b128 v[140:143], v168 offset:4096
s_add_u32 m0, s37, 8192
s_nop 0
buffer_load_dwordx4 v207, s[20:23], s35 offen nt lds
v_mfma_f32_16x16x32_bf16 v[8:11], v[80:83], v[120:123], v[8:11]
ds_read_b128 v[144:147], v168 offset:6144
buffer_load_dwordx4 v208, s[20:23], s35 offen offset:1024 nt lds
v_mfma_f32_16x16x32_bf16 v[28:31], v[84:87], v[120:123], v[28:31]
ds_read_b128 v[148:151], v168 offset:8192
v_mfma_f32_16x16x32_bf16 v[48:51], v[88:91], v[120:123], v[48:51]
buffer_load_dwordx4 v207, s[20:23], s35 offen offset:2048 nt lds
v_mfma_f32_16x16x32_bf16 v[68:71], v[92:95], v[120:123], v[68:71]
buffer_load_dwordx4 v208, s[20:23], s35 offen offset:3072 nt lds
v_mfma_f32_16x16x32_bf16 v[12:15], v[80:83], v[124:127], v[12:15]
v_mfma_f32_16x16x32_bf16 v[32:35], v[84:87], v[124:127], v[32:35]
v_mfma_f32_16x16x32_bf16 v[52:55], v[88:91], v[124:127], v[52:55]
v_mfma_f32_16x16x32_bf16 v[72:75], v[92:95], v[124:127], v[72:75]
v_mfma_f32_16x16x32_bf16 v[16:19], v[80:83], v[128:131], v[16:19]
v_mfma_f32_16x16x32_bf16 v[36:39], v[84:87], v[128:131], v[36:39]
v_mfma_f32_16x16x32_bf16 v[56:59], v[88:91], v[128:131], v[56:59]
v_mfma_f32_16x16x32_bf16 v[76:79], v[92:95], v[128:131], v[76:79]
s_waitcnt lgkmcnt(0)
s_waitcnt vmcnt(13)
s_barrier
v_mfma_f32_16x16x32_bf16 v[0:3], v[96:99], v[132:135], v[0:3]
s_add_u32 s55, s55, 10240
s_cmp_eq_u32 s55, 30720
s_cselect_b32 s55, 0, s55
v_add_u32 v167, s55, v162
v_add_u32 v168, s55, v163
ds_read_b64_tr_b16 v[80:81], v157 offset:32768
v_mfma_f32_16x16x32_bf16 v[20:23], v[100:103], v[132:135], v[20:23]
ds_read_b64_tr_b16 v[82:83], v157 offset:34816
s_add_u32 s40, s34, s32
s_and_b32 s40, s40, 31
s_lshl_b32 s40, s40, 13
s_lshr_b32 s41, s34, 5
s_lshl_b32 s41, s41, 19
s_add_u32 s40, s40, s41
s_add_u32 s35, s40, s33
s_add_u32 s34, s34, 1
s_add_u32 m0, s37, 16384
s_nop 0
buffer_load_dwordx4 v203, s[16:19], s35 offen nt lds
v_mfma_f32_16x16x32_bf16 v[40:43], v[104:107], v[132:135], v[40:43]
ds_read_b64_tr_b16 v[84:85], v157 offset:32776
ds_read_b64_tr_b16 v[86:87], v157 offset:34824
buffer_load_dwordx4 v204, s[16:19], s35 offen offset:1024 nt lds
v_mfma_f32_16x16x32_bf16 v[60:63], v[108:111], v[132:135], v[60:63]
ds_read_b64_tr_b16 v[88:89], v158 offset:32768
v_mfma_f32_16x16x32_bf16 v[4:7], v[96:99], v[136:139], v[4:7]
ds_read_b64_tr_b16 v[90:91], v158 offset:34816
buffer_load_dwordx4 v205, s[16:19], s35 offen offset:2048 nt lds
v_mfma_f32_16x16x32_bf16 v[24:27], v[100:103], v[136:139], v[24:27]
ds_read_b64_tr_b16 v[92:93], v158 offset:32776
ds_read_b64_tr_b16 v[94:95], v158 offset:34824
buffer_load_dwordx4 v206, s[16:19], s35 offen offset:3072 nt lds
v_mfma_f32_16x16x32_bf16 v[44:47], v[104:107], v[136:139], v[44:47]
ds_read_b128 v[112:115], v167
v_mfma_f32_16x16x32_bf16 v[64:67], v[108:111], v[136:139], v[64:67]
ds_read_b128 v[116:119], v167 offset:2048
ds_read_b128 v[120:123], v167 offset:4096
s_add_u32 m0, s37, 24576
s_nop 0
buffer_load_dwordx4 v207, s[20:23], s35 offen nt lds
v_mfma_f32_16x16x32_bf16 v[8:11], v[96:99], v[140:143], v[8:11]
ds_read_b128 v[124:127], v167 offset:6144
buffer_load_dwordx4 v208, s[20:23], s35 offen offset:1024 nt lds
v_mfma_f32_16x16x32_bf16 v[28:31], v[100:103], v[140:143], v[28:31]
ds_read_b128 v[128:131], v167 offset:8192
v_mfma_f32_16x16x32_bf16 v[48:51], v[104:107], v[140:143], v[48:51]
buffer_load_dwordx4 v207, s[20:23], s35 offen offset:2048 nt lds
v_mfma_f32_16x16x32_bf16 v[68:71], v[108:111], v[140:143], v[68:71]
buffer_load_dwordx4 v208, s[20:23], s35 offen offset:3072 nt lds
v_mfma_f32_16x16x32_bf16 v[12:15], v[96:99], v[144:147], v[12:15]
v_mfma_f32_16x16x32_bf16 v[32:35], v[100:103], v[144:147], v[32:35]
v_mfma_f32_16x16x32_bf16 v[52:55], v[104:107], v[144:147], v[52:55]
v_mfma_f32_16x16x32_bf16 v[72:75], v[108:111], v[144:147], v[72:75]
v_mfma_f32_16x16x32_bf16 v[16:19], v[96:99], v[148:151], v[16:19]
v_mfma_f32_16x16x32_bf16 v[36:39], v[100:103], v[148:151], v[36:39]
v_mfma_f32_16x16x32_bf16 v[56:59], v[104:107], v[148:151], v[56:59]
v_mfma_f32_16x16x32_bf16 v[76:79], v[108:111], v[148:151], v[76:79]
s_waitcnt lgkmcnt(0)
s_waitcnt vmcnt(16)
s_barrier
v_mfma_f32_16x16x32_bf16 v[0:3], v[80:83], v[112:115], v[0:3]
ds_read_b64_tr_b16 v[96:97], v157 offset:49152
ds_read_b64_tr_b16 v[98:99], v157 offset:51200
v_mfma_f32_16x16x32_bf16 v[20:23], v[84:87], v[112:115], v[20:23]
ds_read_b64_tr_b16 v[100:101], v157 offset:49160
v_mfma_f32_16x16x32_bf16 v[40:43], v[88:91], v[112:115], v[40:43]
ds_read_b64_tr_b16 v[102:103], v157 offset:51208
v_mfma_f32_16x16x32_bf16 v[60:63], v[92:95], v[112:115], v[60:63]
ds_read_b64_tr_b16 v[104:105], v158 offset:49152
ds_read_b64_tr_b16 v[106:107], v158 offset:51200
v_mfma_f32_16x16x32_bf16 v[4:7], v[80:83], v[116:119], v[4:7]
ds_read_b64_tr_b16 v[108:109], v158 offset:49160
v_mfma_f32_16x16x32_bf16 v[24:27], v[84:87], v[116:119], v[24:27]
ds_read_b64_tr_b16 v[110:111], v158 offset:51208
v_mfma_f32_16x16x32_bf16 v[44:47], v[88:91], v[116:119], v[44:47]
ds_read_b128 v[132:135], v168
ds_read_b128 v[136:139], v168 offset:2048
v_mfma_f32_16x16x32_bf16 v[64:67], v[92:95], v[116:119], v[64:67]
ds_read_b128 v[140:143], v168 offset:4096
v_mfma_f32_16x16x32_bf16 v[8:11], v[80:83], v[120:123], v[8:11]
ds_read_b128 v[144:147], v168 offset:6144
v_mfma_f32_16x16x32_bf16 v[28:31], v[84:87], v[120:123], v[28:31]
ds_read_b128 v[148:151], v168 offset:8192
v_mfma_f32_16x16x32_bf16 v[48:51], v[88:91], v[120:123], v[48:51]
v_mfma_f32_16x16x32_bf16 v[68:71], v[92:95], v[120:123], v[68:71]
v_mfma_f32_16x16x32_bf16 v[12:15], v[80:83], v[124:127], v[12:15]
v_mfma_f32_16x16x32_bf16 v[32:35], v[84:87], v[124:127], v[32:35]
v_mfma_f32_16x16x32_bf16 v[52:55], v[88:91], v[124:127], v[52:55]
v_mfma_f32_16x16x32_bf16 v[72:75], v[92:95], v[124:127], v[72:75]
v_mfma_f32_16x16x32_bf16 v[16:19], v[80:83], v[128:131], v[16:19]
v_mfma_f32_16x16x32_bf16 v[36:39], v[84:87], v[128:131], v[36:39]
v_mfma_f32_16x16x32_bf16 v[56:59], v[88:91], v[128:131], v[56:59]
v_mfma_f32_16x16x32_bf16 v[76:79], v[92:95], v[128:131], v[76:79]
s_waitcnt lgkmcnt(0)
v_mfma_f32_16x16x32_bf16 v[0:3], v[96:99], v[132:135], v[0:3]
v_mfma_f32_16x16x32_bf16 v[20:23], v[100:103], v[132:135], v[20:23]
v_mfma_f32_16x16x32_bf16 v[40:43], v[104:107], v[132:135], v[40:43]
v_mfma_f32_16x16x32_bf16 v[60:63], v[108:111], v[132:135], v[60:63]
v_mfma_f32_16x16x32_bf16 v[4:7], v[96:99], v[136:139], v[4:7]
v_mfma_f32_16x16x32_bf16 v[24:27], v[100:103], v[136:139], v[24:27]
v_mfma_f32_16x16x32_bf16 v[44:47], v[104:107], v[136:139], v[44:47]
v_mfma_f32_16x16x32_bf16 v[64:67], v[108:111], v[136:139], v[64:67]
v_mfma_f32_16x16x32_bf16 v[8:11], v[96:99], v[140:143], v[8:11]
v_mfma_f32_16x16x32_bf16 v[28:31], v[100:103], v[140:143], v[28:31]
v_mfma_f32_16x16x32_bf16 v[48:51], v[104:107], v[140:143], v[48:51]
v_mfma_f32_16x16x32_bf16 v[68:71], v[108:111], v[140:143], v[68:71]
v_mfma_f32_16x16x32_bf16 v[12:15], v[96:99], v[144:147], v[12:15]
v_mfma_f32_16x16x32_bf16 v[32:35], v[100:103], v[144:147], v[32:35]
v_mfma_f32_16x16x32_bf16 v[52:55], v[104:107], v[144:147], v[52:55]
v_mfma_f32_16x16x32_bf16 v[72:75], v[108:111], v[144:147], v[72:75]
v_mfma_f32_16x16x32_bf16 v[16:19], v[96:99], v[148:151], v[16:19]
v_mfma_f32_16x16x32_bf16 v[36:39], v[100:103], v[148:151], v[36:39]
v_mfma_f32_16x16x32_bf16 v[56:59], v[104:107], v[148:151], v[56:59]
v_mfma_f32_16x16x32_bf16 v[76:79], v[108:111], v[148:151], v[76:79]
qdone_1:
s_barrier
v_cvt_pk_bf16_f32 v80, v0, v1
v_cvt_pk_bf16_f32 v81, v2, v3
v_cvt_pk_bf16_f32 v82, v20, v21
v_cvt_pk_bf16_f32 v83, v22, v23
v_cvt_pk_bf16_f32 v84, v4, v5
v_cvt_pk_bf16_f32 v85, v6, v7
v_cvt_pk_bf16_f32 v86, v24, v25
v_cvt_pk_bf16_f32 v87, v26, v27
v_cvt_pk_bf16_f32 v88, v8, v9
v_cvt_pk_bf16_f32 v89, v10, v11
v_cvt_pk_bf16_f32 v90, v28, v29
v_cvt_pk_bf16_f32 v91, v30, v31
v_cvt_pk_bf16_f32 v92, v12, v13
v_cvt_pk_bf16_f32 v93, v14, v15
v_cvt_pk_bf16_f32 v94, v32, v33
v_cvt_pk_bf16_f32 v95, v34, v35
v_cvt_pk_bf16_f32 v96, v16, v17
v_cvt_pk_bf16_f32 v97, v18, v19
v_cvt_pk_bf16_f32 v98, v36, v37
v_cvt_pk_bf16_f32 v99, v38, v39
v_cvt_pk_bf16_f32 v100, v40, v41
v_cvt_pk_bf16_f32 v101, v42, v43
v_cvt_pk_bf16_f32 v102, v60, v61
v_cvt_pk_bf16_f32 v103, v62, v63
v_cvt_pk_bf16_f32 v104, v44, v45
v_cvt_pk_bf16_f32 v105, v46, v47
v_cvt_pk_bf16_f32 v106, v64, v65
v_cvt_pk_bf16_f32 v107, v66, v67
v_cvt_pk_bf16_f32 v108, v48, v49
v_cvt_pk_bf16_f32 v109, v50, v51
v_cvt_pk_bf16_f32 v110, v68, v69
v_cvt_pk_bf16_f32 v111, v70, v71
v_cvt_pk_bf16_f32 v112, v52, v53
v_cvt_pk_bf16_f32 v113, v54, v55
v_cvt_pk_bf16_f32 v114, v72, v73
v_cvt_pk_bf16_f32 v115, v74, v75
v_cvt_pk_bf16_f32 v116, v56, v57
v_cvt_pk_bf16_f32 v117, v58, v59
v_cvt_pk_bf16_f32 v118, v76, v77
v_cvt_pk_bf16_f32 v119, v78, v79
s_lshr_b32 s40, s3, 1
s_lshl_b32 s40, s40, 16
s_and_b32 s41, s3, 1
s_lshl_b32 s41, s41, 13
s_add_u32 s40, s40, s41
s_add_u32 s40, s40, 49152
v_add_u32 v164, s40, v209
s_lshl_b32 s41, s3, 11
s_add_u32 s41, s41, 131072
v_add_u32 v165, s41, v209
ds_write_b128 v164, v[80:83]
ds_write_b128 v164, v[84:87] offset:1024
ds_write_b128 v164, v[88:91] offset:2048
ds_write_b128 v164, v[92:95] offset:3072
ds_write_b128 v164, v[96:99] offset:4096
ds_write_b128 v164, v[100:103] offset:5120
ds_write_b128 v164, v[104:107] offset:6144
ds_write_b128 v164, v[108:111] offset:7168
ds_write_b128 v165, v[112:115]
ds_write_b128 v165, v[116:119] offset:1024
s_waitcnt lgkmcnt(0)
s_barrier
s_cmp_eq_u32 s53, 1
s_cbranch_scc1 qs_h1_8
s_lshl_b32 s40, s52, 16
v_add_u32 v164, s40, v209
s_lshl_b32 s40, s52, 12
s_add_u32 s40, s40, 131072
v_add_u32 v165, s40, v209
ds_read_b128 a[0:3], v164 offset:49152
ds_read_b128 a[4:7], v164 offset:50176
ds_read_b128 a[8:11], v164 offset:51200
ds_read_b128 a[20:23], v164 offset:54272
ds_read_b128 a[24:27], v164 offset:55296
ds_read_b128 a[28:31], v164 offset:56320
ds_read_b128 a[40:43], v164 offset:57344
ds_read_b128 a[44:47], v164 offset:58368
ds_read_b128 a[48:51], v164 offset:59392
ds_read_b128 a[60:63], v164 offset:62464
ds_read_b128 a[64:67], v164 offset:63488
ds_read_b128 a[68:71], v164 offset:64512
s_waitcnt lgkmcnt(0)
s_barrier
s_add_u32 s40, s34, s32
s_and_b32 s40, s40, 31
s_lshl_b32 s40, s40, 13
s_lshr_b32 s41, s34, 5
s_lshl_b32 s41, s41, 19
s_add_u32 s40, s40, s41
s_add_u32 s35, s40, s33
s_add_u32 s34, s34, 1
s_add_u32 m0, s37, 32768
s_nop 0
buffer_load_dwordx4 v203, s[16:19], s35 offen nt lds
buffer_load_dwordx4 v204, s[16:19], s35 offen offset:1024 nt lds
buffer_load_dwordx4 v205, s[16:19], s35 offen offset:2048 nt lds
buffer_load_dwordx4 v206, s[16:19], s35 offen offset:3072 nt lds
s_add_u32 m0, s37, 40960
s_nop 0
buffer_load_dwordx4 v207, s[20:23], s35 offen nt lds
buffer_load_dwordx4 v208, s[20:23], s35 offen offset:1024 nt lds
buffer_load_dwordx4 v207, s[20:23], s35 offen offset:2048 nt lds
buffer_load_dwordx4 v208, s[20:23], s35 offen offset:3072 nt lds
s_waitcnt vmcnt(20)
s_barrier
ds_read_b128 a[160:163], v191
ds_read_b128 a[176:179], v191 offset:4096
ds_read_b128 a[164:167], v192
ds_read_b128 a[180:183], v192 offset:4096
ds_read_b128 a[168:171], v193
ds_read_b128 a[184:187], v193 offset:4096
ds_read_b128 a[172:175], v194
ds_read_b128 a[188:191], v194 offset:4096
v_mov_b32 v64, 0
v_mov_b32 v65, 0
v_mov_b32 v66, 0
v_mov_b32 v67, 0
v_mov_b32 v68, 0
v_mov_b32 v69, 0
v_mov_b32 v70, 0
v_mov_b32 v71, 0
v_mov_b32 v72, 0
v_mov_b32 v73, 0
v_mov_b32 v74, 0
v_mov_b32 v75, 0
v_mov_b32 v76, 0
v_mov_b32 v77, 0
v_mov_b32 v78, 0
v_mov_b32 v79, 0
v_mov_b32 v80, 0
v_mov_b32 v81, 0
v_mov_b32 v82, 0
v_mov_b32 v83, 0
v_mov_b32 v84, 0
v_mov_b32 v85, 0
v_mov_b32 v86, 0
v_mov_b32 v87, 0
v_mov_b32 v88, 0
v_mov_b32 v89, 0
v_mov_b32 v90, 0
v_mov_b32 v91, 0
v_mov_b32 v92, 0
v_mov_b32 v93, 0
v_mov_b32 v94, 0
v_mov_b32 v95, 0
v_mov_b32 v189, 0
v_accvgpr_write_b32 a232, v189
v_accvgpr_write_b32 a233, v189
v_accvgpr_write_b32 a234, v189
v_accvgpr_write_b32 a235, v189
s_waitcnt lgkmcnt(0)
v_mfma_f32_16x16x32_bf16 v[160:163], a[160:163], a[0:3], 0
v_mfma_f32_16x16x32_bf16 v[164:167], a[176:179], a[0:3], 0
v_mfma_f32_16x16x32_bf16 v[160:163], a[164:167], a[20:23], v[160:163]
v_mfma_f32_16x16x32_bf16 v[164:167], a[180:183], a[20:23], v[164:167]
v_mfma_f32_16x16x32_bf16 v[160:163], a[168:171], a[40:43], v[160:163]
v_mfma_f32_16x16x32_bf16 v[164:167], a[184:187], a[40:43], v[164:167]
v_mfma_f32_16x16x32_bf16 v[160:163], a[172:175], a[60:63], v[160:163]
v_mfma_f32_16x16x32_bf16 v[164:167], a[188:191], a[60:63], v[164:167]
v_mfma_f32_16x16x32_bf16 v[168:171], a[160:163], a[4:7], 0
s_nop 5
v_max3_f32 v189, v160, v161, v162
v_max3_f32 v190, v163, v164, v165
v_max3_f32 v189, v189, v166, v167
v_max_f32 v189, v189, v190
v_mfma_f32_16x16x32_bf16 v[172:175], a[176:179], a[4:7], 0
v_mov_b32 v190, v189
s_nop 1
v_permlane32_swap_b32 v189, v190
v_max_f32 v189, v189, v190
v_mov_b32 v190, v189
v_mfma_f32_16x16x32_bf16 v[168:171], a[164:167], a[24:27], v[168:171]
s_nop 0
v_permlane16_swap_b32 v189, v190
v_max_f32 v189, v189, v190
v_mul_f32 v184, s28, v189
v_fma_f32 v160, v160, s28, -v184
v_fma_f32 v161, v161, s28, -v184
v_mfma_f32_16x16x32_bf16 v[172:175], a[180:183], a[24:27], v[172:175]
v_fma_f32 v162, v162, s28, -v184
v_fma_f32 v163, v163, s28, -v184
v_fma_f32 v164, v164, s28, -v184
v_fma_f32 v165, v165, s28, -v184
v_mfma_f32_16x16x32_bf16 v[168:171], a[168:171], a[44:47], v[168:171]
v_fma_f32 v166, v166, s28, -v184
v_fma_f32 v167, v167, s28, -v184
v_exp_f32 v160, v160
v_mfma_f32_16x16x32_bf16 v[172:175], a[184:187], a[44:47], v[172:175]
v_exp_f32 v161, v161
v_exp_f32 v162, v162
v_mfma_f32_16x16x32_bf16 v[168:171], a[172:175], a[64:67], v[168:171]
v_exp_f32 v163, v163
v_exp_f32 v164, v164
v_mfma_f32_16x16x32_bf16 v[172:175], a[188:191], a[64:67], v[172:175]
v_exp_f32 v165, v165
v_exp_f32 v166, v166
s_waitcnt vmcnt(16)
s_waitcnt vmcnt(12)
s_barrier
v_exp_f32 v167, v167
ds_read_b64_tr_b16 a[192:193], v195 offset:8192
ds_read_b64_tr_b16 a[194:195], v195 offset:12288
s_add_u32 s40, s34, s32
s_and_b32 s40, s40, 31
s_lshl_b32 s40, s40, 13
s_lshr_b32 s41, s34, 5
s_lshl_b32 s41, s41, 19
s_add_u32 s40, s40, s41
s_add_u32 s35, s40, s33
s_add_u32 s34, s34, 1
s_add_u32 m0, s37, 49152
s_nop 0
buffer_load_dwordx4 v203, s[16:19], s35 offen nt lds
ds_read_b64_tr_b16 a[196:197], v196 offset:8192
ds_read_b64_tr_b16 a[198:199], v196 offset:12288
ds_read_b64_tr_b16 a[200:201], v197 offset:8192
ds_read_b64_tr_b16 a[202:203], v197 offset:12288
buffer_load_dwordx4 v204, s[16:19], s35 offen offset:1024 nt lds
ds_read_b64_tr_b16 a[204:205], v198 offset:8192
ds_read_b64_tr_b16 a[206:207], v198 offset:12288
ds_read_b64_tr_b16 a[208:209], v199 offset:8192
ds_read_b64_tr_b16 a[210:211], v199 offset:12288
buffer_load_dwordx4 v205, s[16:19], s35 offen offset:2048 nt lds
ds_read_b64_tr_b16 a[212:213], v200 offset:8192
ds_read_b64_tr_b16 a[214:215], v200 offset:12288
v_cvt_pk_bf16_f32 v176, v160, v161
ds_read_b64_tr_b16 a[216:217], v201 offset:8192
ds_read_b64_tr_b16 a[218:219], v201 offset:12288
buffer_load_dwordx4 v206, s[16:19], s35 offen offset:3072 nt lds
v_cvt_pk_bf16_f32 v177, v162, v163
ds_read_b64_tr_b16 a[220:221], v202 offset:8192
ds_read_b64_tr_b16 a[222:223], v202 offset:12288
v_cvt_pk_bf16_f32 v178, v164, v165
v_cvt_pk_bf16_f32 v179, v166, v167
v_mfma_f32_16x16x32_bf16 v[160:163], a[160:163], a[8:11], 0
ds_read_b128 a[160:163], v191 offset:16384
v_max3_f32 v189, v168, v169, v170
v_max3_f32 v190, v171, v172, v173
v_mfma_f32_16x16x32_bf16 v[164:167], a[176:179], a[8:11], 0
ds_read_b128 a[176:179], v191 offset:20480
v_max3_f32 v189, v189, v174, v175
v_max_f32 v189, v189, v190
v_mfma_f32_16x16x32_bf16 v[160:163], a[164:167], a[28:31], v[160:163]
ds_read_b128 a[164:167], v192 offset:16384
s_add_u32 m0, s37, 57344
s_nop 0
buffer_load_dwordx4 v207, s[20:23], s35 offen nt lds
v_mfma_f32_16x16x32_bf16 v[164:167], a[180:183], a[28:31], v[164:167]
ds_read_b128 a[180:183], v192 offset:20480
v_mov_b32 v190, v189
s_nop 1
v_permlane32_swap_b32 v189, v190
v_mfma_f32_16x16x32_bf16 v[160:163], a[168:171], a[48:51], v[160:163]
ds_read_b128 a[168:171], v193 offset:16384
v_max_f32 v189, v189, v190
v_mov_b32 v190, v189
v_mfma_f32_16x16x32_bf16 v[164:167], a[184:187], a[48:51], v[164:167]
ds_read_b128 a[184:187], v193 offset:20480
v_permlane16_swap_b32 v189, v190
v_max_f32 v189, v189, v190
v_mfma_f32_16x16x32_bf16 v[160:163], a[172:175], a[68:71], v[160:163]
ds_read_b128 a[172:175], v194 offset:16384
buffer_load_dwordx4 v208, s[20:23], s35 offen offset:1024 nt lds
v_mul_f32 v185, s28, v189
v_mfma_f32_16x16x32_bf16 v[164:167], a[188:191], a[68:71], v[164:167]
ds_read_b128 a[188:191], v194 offset:20480
v_fma_f32 v168, v168, s28, -v185
v_fma_f32 v169, v169, s28, -v185
s_waitcnt lgkmcnt(8)
v_mfma_f32_16x16x32_bf16 v[0:3], a[192:195], v[176:179], 0
v_fma_f32 v170, v170, s28, -v185
v_fma_f32 v171, v171, s28, -v185
v_fma_f32 v172, v172, s28, -v185
v_mfma_f32_16x16x32_bf16 v[4:7], a[196:199], v[176:179], 0
v_fma_f32 v173, v173, s28, -v185
v_fma_f32 v174, v174, s28, -v185
v_fma_f32 v175, v175, s28, -v185
v_mfma_f32_16x16x32_bf16 v[8:11], a[200:203], v[176:179], 0
buffer_load_dwordx4 v207, s[20:23], s35 offen offset:2048 nt lds
v_exp_f32 v168, v168
v_mfma_f32_16x16x32_bf16 v[12:15], a[204:207], v[176:179], 0
v_exp_f32 v169, v169
v_exp_f32 v170, v170
v_mfma_f32_16x16x32_bf16 v[16:19], a[208:211], v[176:179], 0
v_exp_f32 v171, v171
v_mfma_f32_16x16x32_bf16 v[20:23], a[212:215], v[176:179], 0
v_exp_f32 v172, v172
v_exp_f32 v173, v173
v_mfma_f32_16x16x32_bf16 v[24:27], a[216:219], v[176:179], 0
buffer_load_dwordx4 v208, s[20:23], s35 offen offset:3072 nt lds
v_exp_f32 v174, v174
v_mfma_f32_16x16x32_bf16 v[28:31], a[220:223], v[176:179], 0
v_exp_f32 v175, v175
v_cvt_pk_bf16_f32 v180, v168, v169
v_mfma_f32_16x16x32_bf16 a[224:227], a[244:247], v[176:179], 0
v_cvt_pk_bf16_f32 v181, v170, v171
v_cvt_pk_bf16_f32 v182, v172, v173
v_cvt_pk_bf16_f32 v183, v174, v175
s_waitcnt lgkmcnt(0)
v_mfma_f32_16x16x32_bf16 v[168:171], a[160:163], a[0:3], 0
v_max3_f32 v189, v160, v161, v162
v_mfma_f32_16x16x32_bf16 v[172:175], a[176:179], a[0:3], 0
v_max3_f32 v190, v163, v164, v165
v_max3_f32 v189, v189, v166, v167
v_max_f32 v189, v189, v190
v_mfma_f32_16x16x32_bf16 v[168:171], a[164:167], a[20:23], v[168:171]
v_mov_b32 v190, v189
s_nop 1
v_permlane32_swap_b32 v189, v190
v_mfma_f32_16x16x32_bf16 v[172:175], a[180:183], a[20:23], v[172:175]
v_max_f32 v189, v189, v190
v_mov_b32 v190, v189
v_mfma_f32_16x16x32_bf16 v[168:171], a[168:171], a[40:43], v[168:171]
s_nop 0
v_permlane16_swap_b32 v189, v190
v_max_f32 v189, v189, v190
v_mul_f32 v186, s28, v189
v_mfma_f32_16x16x32_bf16 v[172:175], a[184:187], a[40:43], v[172:175]
v_fma_f32 v160, v160, s28, -v186
v_fma_f32 v161, v161, s28, -v186
v_mfma_f32_16x16x32_bf16 v[168:171], a[172:175], a[60:63], v[168:171]
v_fma_f32 v162, v162, s28, -v186
v_fma_f32 v163, v163, s28, -v186
v_mfma_f32_16x16x32_bf16 v[172:175], a[188:191], a[60:63], v[172:175]
v_fma_f32 v164, v164, s28, -v186
v_fma_f32 v165, v165, s28, -v186
v_fma_f32 v166, v166, s28, -v186
v_mfma_f32_16x16x32_bf16 v[32:35], a[192:195], v[180:183], 0
v_fma_f32 v167, v167, s28, -v186
v_exp_f32 v160, v160
v_mfma_f32_16x16x32_bf16 v[36:39], a[196:199], v[180:183], 0
v_exp_f32 v161, v161
v_mfma_f32_16x16x32_bf16 v[40:43], a[200:203], v[180:183], 0
v_exp_f32 v162, v162
v_mfma_f32_16x16x32_bf16 v[44:47], a[204:207], v[180:183], 0
v_exp_f32 v163, v163
v_mfma_f32_16x16x32_bf16 v[48:51], a[208:211], v[180:183], 0
v_exp_f32 v164, v164
v_mfma_f32_16x16x32_bf16 v[52:55], a[212:215], v[180:183], 0
v_exp_f32 v165, v165
v_mfma_f32_16x16x32_bf16 v[56:59], a[216:219], v[180:183], 0
v_exp_f32 v166, v166
v_exp_f32 v167, v167
v_mfma_f32_16x16x32_bf16 v[60:63], a[220:223], v[180:183], 0
v_cvt_pk_bf16_f32 v176, v160, v161
v_cvt_pk_bf16_f32 v177, v162, v163
v_mfma_f32_16x16x32_bf16 a[228:231], a[244:247], v[180:183], 0
v_cvt_pk_bf16_f32 v178, v164, v165
v_cvt_pk_bf16_f32 v179, v166, v167
s_mov_b32 s38, 0
loop_9:
v_mfma_f32_16x16x32_bf16 v[160:163], a[160:163], a[4:7], 0
v_fma_f32 v168, v168, s28, -v184
v_fma_f32 v169, v169, s28, -v184
v_fma_f32 v170, v170, s28, -v184
v_fma_f32 v171, v171, s28, -v184
v_mfma_f32_16x16x32_bf16 v[164:167], a[176:179], a[4:7], 0
v_fma_f32 v172, v172, s28, -v184
v_fma_f32 v173, v173, s28, -v184
v_fma_f32 v174, v174, s28, -v184
v_fma_f32 v175, v175, s28, -v184
v_mfma_f32_16x16x32_bf16 v[160:163], a[164:167], a[24:27], v[160:163]
v_max3_f32 v189, v168, v169, v170
v_max3_f32 v190, v171, v172, v173
v_max3_f32 v189, v189, v174, v175
v_max_f32 v189, v189, v190
v_mfma_f32_16x16x32_bf16 v[164:167], a[180:183], a[24:27], v[164:167]
v_cmp_lt_f32 vcc, 0x41000000, v189
s_cbranch_vccnz stub_10
back_11:
v_exp_f32 v168, v168
v_mfma_f32_16x16x32_bf16 v[160:163], a[168:171], a[44:47], v[160:163]
v_exp_f32 v169, v169
v_exp_f32 v170, v170
v_mfma_f32_16x16x32_bf16 v[164:167], a[184:187], a[44:47], v[164:167]
v_exp_f32 v171, v171
v_exp_f32 v172, v172
v_mfma_f32_16x16x32_bf16 v[160:163], a[172:175], a[64:67], v[160:163]
v_exp_f32 v173, v173
v_exp_f32 v174, v174
v_mfma_f32_16x16x32_bf16 v[164:167], a[188:191], a[64:67], v[164:167]
v_exp_f32 v175, v175
v_cvt_pk_bf16_f32 v180, v168, v169
v_cvt_pk_bf16_f32 v181, v170, v171
s_waitcnt vmcnt(16)
s_waitcnt vmcnt(12)
s_barrier
v_mfma_f32_16x16x32_bf16 v[64:67], a[192:195], v[176:179], v[64:67]
ds_read_b64_tr_b16 a[192:193], v195 offset:24576
ds_read_b64_tr_b16 a[194:195], v195 offset:28672
v_mfma_f32_16x16x32_bf16 v[68:71], a[196:199], v[176:179], v[68:71]
ds_read_b64_tr_b16 a[196:197], v196 offset:24576
ds_read_b64_tr_b16 a[198:199], v196 offset:28672
s_add_u32 s40, s34, s32
s_and_b32 s40, s40, 31
s_lshl_b32 s40, s40, 13
s_lshr_b32 s41, s34, 5
s_lshl_b32 s41, s41, 19
s_add_u32 s40, s40, s41
s_add_u32 s35, s40, s33
s_add_u32 s34, s34, 1
s_add_u32 m0, s37, 0
s_nop 0
buffer_load_dwordx4 v203, s[16:19], s35 offen nt lds
v_mfma_f32_16x16x32_bf16 v[72:75], a[200:203], v[176:179], v[72:75]
ds_read_b64_tr_b16 a[200:201], v197 offset:24576
ds_read_b64_tr_b16 a[202:203], v197 offset:28672
v_mfma_f32_16x16x32_bf16 v[76:79], a[204:207], v[176:179], v[76:79]
ds_read_b64_tr_b16 a[204:205], v198 offset:24576
ds_read_b64_tr_b16 a[206:207], v198 offset:28672
buffer_load_dwordx4 v204, s[16:19], s35 offen offset:1024 nt lds
v_mfma_f32_16x16x32_bf16 v[80:83], a[208:211], v[176:179], v[80:83]
ds_read_b64_tr_b16 a[208:209], v199 offset:24576
ds_read_b64_tr_b16 a[210:211], v199 offset:28672
v_mfma_f32_16x16x32_bf16 v[84:87], a[212:215], v[176:179], v[84:87]
ds_read_b64_tr_b16 a[212:213], v200 offset:24576
ds_read_b64_tr_b16 a[214:215], v200 offset:28672
buffer_load_dwordx4 v205, s[16:19], s35 offen offset:2048 nt lds
v_mfma_f32_16x16x32_bf16 v[88:91], a[216:219], v[176:179], v[88:91]
ds_read_b64_tr_b16 a[216:217], v201 offset:24576
ds_read_b64_tr_b16 a[218:219], v201 offset:28672
v_mfma_f32_16x16x32_bf16 v[92:95], a[220:223], v[176:179], v[92:95]
ds_read_b64_tr_b16 a[220:221], v202 offset:24576
ds_read_b64_tr_b16 a[222:223], v202 offset:28672
buffer_load_dwordx4 v206, s[16:19], s35 offen offset:3072 nt lds
v_mfma_f32_16x16x32_bf16 a[232:235], a[244:247], v[176:179], a[232:235]
v_cvt_pk_bf16_f32 v182, v172, v173
v_cvt_pk_bf16_f32 v183, v174, v175
v_mfma_f32_16x16x32_bf16 v[168:171], a[160:163], a[8:11], 0
ds_read_b128 a[160:163], v191 offset:32768
v_fma_f32 v160, v160, s28, -v185
v_fma_f32 v161, v161, s28, -v185
v_mfma_f32_16x16x32_bf16 v[172:175], a[176:179], a[8:11], 0
ds_read_b128 a[176:179], v191 offset:36864
v_fma_f32 v162, v162, s28, -v185
v_fma_f32 v163, v163, s28, -v185
v_mfma_f32_16x16x32_bf16 v[168:171], a[164:167], a[28:31], v[168:171]
ds_read_b128 a[164:167], v192 offset:32768
s_add_u32 m0, s37, 8192
s_nop 0
buffer_load_dwordx4 v207, s[20:23], s35 offen nt lds
v_mfma_f32_16x16x32_bf16 v[172:175], a[180:183], a[28:31], v[172:175]
ds_read_b128 a[180:183], v192 offset:36864
v_fma_f32 v164, v164, s28, -v185
v_mfma_f32_16x16x32_bf16 v[168:171], a[168:171], a[48:51], v[168:171]
ds_read_b128 a[168:171], v193 offset:32768
v_fma_f32 v165, v165, s28, -v185
v_mfma_f32_16x16x32_bf16 v[172:175], a[184:187], a[48:51], v[172:175]
ds_read_b128 a[184:187], v193 offset:36864
v_fma_f32 v166, v166, s28, -v185
v_fma_f32 v167, v167, s28, -v185
v_mfma_f32_16x16x32_bf16 v[168:171], a[172:175], a[68:71], v[168:171]
ds_read_b128 a[172:175], v194 offset:32768
buffer_load_dwordx4 v208, s[20:23], s35 offen offset:1024 nt lds
v_max3_f32 v189, v160, v161, v162
v_mfma_f32_16x16x32_bf16 v[172:175], a[188:191], a[68:71], v[172:175]
ds_read_b128 a[188:191], v194 offset:36864
v_max3_f32 v190, v163, v164, v165
v_max3_f32 v189, v189, v166, v167
s_waitcnt lgkmcnt(8)
v_mfma_f32_16x16x32_bf16 v[0:3], a[192:195], v[180:183], v[0:3]
v_max_f32 v189, v189, v190
v_cmp_lt_f32 vcc, 0x41000000, v189
v_mfma_f32_16x16x32_bf16 v[4:7], a[196:199], v[180:183], v[4:7]
s_cbranch_vccnz stub_12
back_13:
v_exp_f32 v160, v160
v_mfma_f32_16x16x32_bf16 v[8:11], a[200:203], v[180:183], v[8:11]
buffer_load_dwordx4 v207, s[20:23], s35 offen offset:2048 nt lds
v_exp_f32 v161, v161
v_mfma_f32_16x16x32_bf16 v[12:15], a[204:207], v[180:183], v[12:15]
v_exp_f32 v162, v162
v_mfma_f32_16x16x32_bf16 v[16:19], a[208:211], v[180:183], v[16:19]
v_exp_f32 v163, v163
v_exp_f32 v164, v164
v_mfma_f32_16x16x32_bf16 v[20:23], a[212:215], v[180:183], v[20:23]
v_exp_f32 v165, v165
v_mfma_f32_16x16x32_bf16 v[24:27], a[216:219], v[180:183], v[24:27]
buffer_load_dwordx4 v208, s[20:23], s35 offen offset:3072 nt lds
v_exp_f32 v166, v166
v_mfma_f32_16x16x32_bf16 v[28:31], a[220:223], v[180:183], v[28:31]
v_exp_f32 v167, v167
v_cvt_pk_bf16_f32 v176, v160, v161
v_mfma_f32_16x16x32_bf16 a[224:227], a[244:247], v[180:183], a[224:227]
v_cvt_pk_bf16_f32 v177, v162, v163
v_cvt_pk_bf16_f32 v178, v164, v165
v_cvt_pk_bf16_f32 v179, v166, v167
s_waitcnt lgkmcnt(0)
v_mfma_f32_16x16x32_bf16 v[160:163], a[160:163], a[0:3], 0
v_fma_f32 v168, v168, s28, -v186
v_mfma_f32_16x16x32_bf16 v[164:167], a[176:179], a[0:3], 0
v_fma_f32 v169, v169, s28, -v186
v_fma_f32 v170, v170, s28, -v186
v_mfma_f32_16x16x32_bf16 v[160:163], a[164:167], a[20:23], v[160:163]
v_fma_f32 v171, v171, s28, -v186
v_fma_f32 v172, v172, s28, -v186
v_mfma_f32_16x16x32_bf16 v[164:167], a[180:183], a[20:23], v[164:167]
v_fma_f32 v173, v173, s28, -v186
v_fma_f32 v174, v174, s28, -v186
v_mfma_f32_16x16x32_bf16 v[160:163], a[168:171], a[40:43], v[160:163]
v_fma_f32 v175, v175, s28, -v186
v_max3_f32 v189, v168, v169, v170
v_mfma_f32_16x16x32_bf16 v[164:167], a[184:187], a[40:43], v[164:167]
v_max3_f32 v190, v171, v172, v173
v_max3_f32 v189, v189, v174, v175
v_mfma_f32_16x16x32_bf16 v[160:163], a[172:175], a[60:63], v[160:163]
v_max_f32 v189, v189, v190
v_cmp_lt_f32 vcc, 0x41000000, v189
v_mfma_f32_16x16x32_bf16 v[164:167], a[188:191], a[60:63], v[164:167]
s_cbranch_vccnz stub_14
back_15:
v_exp_f32 v168, v168
v_mfma_f32_16x16x32_bf16 v[32:35], a[192:195], v[176:179], v[32:35]
v_exp_f32 v169, v169
v_mfma_f32_16x16x32_bf16 v[36:39], a[196:199], v[176:179], v[36:39]
v_exp_f32 v170, v170
v_mfma_f32_16x16x32_bf16 v[40:43], a[200:203], v[176:179], v[40:43]
v_exp_f32 v171, v171
v_mfma_f32_16x16x32_bf16 v[44:47], a[204:207], v[176:179], v[44:47]
v_exp_f32 v172, v172
v_mfma_f32_16x16x32_bf16 v[48:51], a[208:211], v[176:179], v[48:51]
v_exp_f32 v173, v173
v_mfma_f32_16x16x32_bf16 v[52:55], a[212:215], v[176:179], v[52:55]
v_exp_f32 v174, v174
v_mfma_f32_16x16x32_bf16 v[56:59], a[216:219], v[176:179], v[56:59]
v_exp_f32 v175, v175
v_mfma_f32_16x16x32_bf16 v[60:63], a[220:223], v[176:179], v[60:63]
v_cvt_pk_bf16_f32 v180, v168, v169
v_cvt_pk_bf16_f32 v181, v170, v171
v_mfma_f32_16x16x32_bf16 a[228:231], a[244:247], v[176:179], a[228:231]
v_cvt_pk_bf16_f32 v182, v172, v173
v_cvt_pk_bf16_f32 v183, v174, v175
v_mfma_f32_16x16x32_bf16 v[168:171], a[160:163], a[4:7], 0
v_fma_f32 v160, v160, s28, -v184
v_fma_f32 v161, v161, s28, -v184
v_fma_f32 v162, v162, s28, -v184
v_fma_f32 v163, v163, s28, -v184
v_mfma_f32_16x16x32_bf16 v[172:175], a[176:179], a[4:7], 0
v_fma_f32 v164, v164, s28, -v184
v_fma_f32 v165, v165, s28, -v184
v_fma_f32 v166, v166, s28, -v184
v_fma_f32 v167, v167, s28, -v184
v_mfma_f32_16x16x32_bf16 v[168:171], a[164:167], a[24:27], v[168:171]
v_max3_f32 v189, v160, v161, v162
v_max3_f32 v190, v163, v164, v165
v_max3_f32 v189, v189, v166, v167
v_max_f32 v189, v189, v190
v_mfma_f32_16x16x32_bf16 v[172:175], a[180:183], a[24:27], v[172:175]
v_cmp_lt_f32 vcc, 0x41000000, v189
s_cbranch_vccnz stub_16
back_17:
v_exp_f32 v160, v160
v_mfma_f32_16x16x32_bf16 v[168:171], a[168:171], a[44:47], v[168:171]
v_exp_f32 v161, v161
v_exp_f32 v162, v162
v_mfma_f32_16x16x32_bf16 v[172:175], a[184:187], a[44:47], v[172:175]
v_exp_f32 v163, v163
v_exp_f32 v164, v164
v_mfma_f32_16x16x32_bf16 v[168:171], a[172:175], a[64:67], v[168:171]
v_exp_f32 v165, v165
v_exp_f32 v166, v166
v_mfma_f32_16x16x32_bf16 v[172:175], a[188:191], a[64:67], v[172:175]
v_exp_f32 v167, v167
v_cvt_pk_bf16_f32 v176, v160, v161
v_cvt_pk_bf16_f32 v177, v162, v163
s_waitcnt vmcnt(16)
s_waitcnt vmcnt(12)
s_barrier
v_mfma_f32_16x16x32_bf16 v[64:67], a[192:195], v[180:183], v[64:67]
ds_read_b64_tr_b16 a[192:193], v195 offset:40960
ds_read_b64_tr_b16 a[194:195], v195 offset:45056
v_mfma_f32_16x16x32_bf16 v[68:71], a[196:199], v[180:183], v[68:71]
ds_read_b64_tr_b16 a[196:197], v196 offset:40960
ds_read_b64_tr_b16 a[198:199], v196 offset:45056
s_add_u32 s40, s34, s32
s_and_b32 s40, s40, 31
s_lshl_b32 s40, s40, 13
s_lshr_b32 s41, s34, 5
s_lshl_b32 s41, s41, 19
s_add_u32 s40, s40, s41
s_add_u32 s35, s40, s33
s_add_u32 s34, s34, 1
s_add_u32 m0, s37, 16384
s_nop 0
buffer_load_dwordx4 v203, s[16:19], s35 offen nt lds
v_mfma_f32_16x16x32_bf16 v[72:75], a[200:203], v[180:183], v[72:75]
ds_read_b64_tr_b16 a[200:201], v197 offset:40960
ds_read_b64_tr_b16 a[202:203], v197 offset:45056
v_mfma_f32_16x16x32_bf16 v[76:79], a[204:207], v[180:183], v[76:79]
ds_read_b64_tr_b16 a[204:205], v198 offset:40960
ds_read_b64_tr_b16 a[206:207], v198 offset:45056
buffer_load_dwordx4 v204, s[16:19], s35 offen offset:1024 nt lds
v_mfma_f32_16x16x32_bf16 v[80:83], a[208:211], v[180:183], v[80:83]
ds_read_b64_tr_b16 a[208:209], v199 offset:40960
ds_read_b64_tr_b16 a[210:211], v199 offset:45056
v_mfma_f32_16x16x32_bf16 v[84:87], a[212:215], v[180:183], v[84:87]
ds_read_b64_tr_b16 a[212:213], v200 offset:40960
ds_read_b64_tr_b16 a[214:215], v200 offset:45056
buffer_load_dwordx4 v205, s[16:19], s35 offen offset:2048 nt lds
v_mfma_f32_16x16x32_bf16 v[88:91], a[216:219], v[180:183], v[88:91]
ds_read_b64_tr_b16 a[216:217], v201 offset:40960
ds_read_b64_tr_b16 a[218:219], v201 offset:45056
v_mfma_f32_16x16x32_bf16 v[92:95], a[220:223], v[180:183], v[92:95]
ds_read_b64_tr_b16 a[220:221], v202 offset:40960
ds_read_b64_tr_b16 a[222:223], v202 offset:45056
buffer_load_dwordx4 v206, s[16:19], s35 offen offset:3072 nt lds
v_mfma_f32_16x16x32_bf16 a[232:235], a[244:247], v[180:183], a[232:235]
v_cvt_pk_bf16_f32 v178, v164, v165
v_cvt_pk_bf16_f32 v179, v166, v167
v_mfma_f32_16x16x32_bf16 v[160:163], a[160:163], a[8:11], 0
ds_read_b128 a[160:163], v191 offset:49152
v_fma_f32 v168, v168, s28, -v185
v_fma_f32 v169, v169, s28, -v185
v_mfma_f32_16x16x32_bf16 v[164:167], a[176:179], a[8:11], 0
ds_read_b128 a[176:179], v191 offset:53248
v_fma_f32 v170, v170, s28, -v185
v_fma_f32 v171, v171, s28, -v185
v_mfma_f32_16x16x32_bf16 v[160:163], a[164:167], a[28:31], v[160:163]
ds_read_b128 a[164:167], v192 offset:49152
s_add_u32 m0, s37, 24576
s_nop 0
buffer_load_dwordx4 v207, s[20:23], s35 offen nt lds
v_mfma_f32_16x16x32_bf16 v[164:167], a[180:183], a[28:31], v[164:167]
ds_read_b128 a[180:183], v192 offset:53248
v_fma_f32 v172, v172, s28, -v185
v_mfma_f32_16x16x32_bf16 v[160:163], a[168:171], a[48:51], v[160:163]
ds_read_b128 a[168:171], v193 offset:49152
v_fma_f32 v173, v173, s28, -v185
v_mfma_f32_16x16x32_bf16 v[164:167], a[184:187], a[48:51], v[164:167]
ds_read_b128 a[184:187], v193 offset:53248
v_fma_f32 v174, v174, s28, -v185
v_fma_f32 v175, v175, s28, -v185
v_mfma_f32_16x16x32_bf16 v[160:163], a[172:175], a[68:71], v[160:163]
ds_read_b128 a[172:175], v194 offset:49152
buffer_load_dwordx4 v208, s[20:23], s35 offen offset:1024 nt lds
v_max3_f32 v189, v168, v169, v170
v_mfma_f32_16x16x32_bf16 v[164:167], a[188:191], a[68:71], v[164:167]
ds_read_b128 a[188:191], v194 offset:53248
v_max3_f32 v190, v171, v172, v173
v_max3_f32 v189, v189, v174, v175
s_waitcnt lgkmcnt(8)
v_mfma_f32_16x16x32_bf16 v[0:3], a[192:195], v[176:179], v[0:3]
v_max_f32 v189, v189, v190
v_cmp_lt_f32 vcc, 0x41000000, v189
v_mfma_f32_16x16x32_bf16 v[4:7], a[196:199], v[176:179], v[4:7]
s_cbranch_vccnz stub_18
back_19:
v_exp_f32 v168, v168
v_mfma_f32_16x16x32_bf16 v[8:11], a[200:203], v[176:179], v[8:11]
buffer_load_dwordx4 v207, s[20:23], s35 offen offset:2048 nt lds
v_exp_f32 v169, v169
v_mfma_f32_16x16x32_bf16 v[12:15], a[204:207], v[176:179], v[12:15]
v_exp_f32 v170, v170
v_mfma_f32_16x16x32_bf16 v[16:19], a[208:211], v[176:179], v[16:19]
v_exp_f32 v171, v171
v_exp_f32 v172, v172
v_mfma_f32_16x16x32_bf16 v[20:23], a[212:215], v[176:179], v[20:23]
v_exp_f32 v173, v173
v_mfma_f32_16x16x32_bf16 v[24:27], a[216:219], v[176:179], v[24:27]
buffer_load_dwordx4 v208, s[20:23], s35 offen offset:3072 nt lds
v_exp_f32 v174, v174
v_mfma_f32_16x16x32_bf16 v[28:31], a[220:223], v[176:179], v[28:31]
v_exp_f32 v175, v175
v_cvt_pk_bf16_f32 v180, v168, v169
v_mfma_f32_16x16x32_bf16 a[224:227], a[244:247], v[176:179], a[224:227]
v_cvt_pk_bf16_f32 v181, v170, v171
v_cvt_pk_bf16_f32 v182, v172, v173
v_cvt_pk_bf16_f32 v183, v174, v175
s_waitcnt lgkmcnt(0)
v_mfma_f32_16x16x32_bf16 v[168:171], a[160:163], a[0:3], 0
v_fma_f32 v160, v160, s28, -v186
v_mfma_f32_16x16x32_bf16 v[172:175], a[176:179], a[0:3], 0
v_fma_f32 v161, v161, s28, -v186
v_fma_f32 v162, v162, s28, -v186
v_mfma_f32_16x16x32_bf16 v[168:171], a[164:167], a[20:23], v[168:171]
v_fma_f32 v163, v163, s28, -v186
v_fma_f32 v164, v164, s28, -v186
v_mfma_f32_16x16x32_bf16 v[172:175], a[180:183], a[20:23], v[172:175]
v_fma_f32 v165, v165, s28, -v186
v_fma_f32 v166, v166, s28, -v186
v_mfma_f32_16x16x32_bf16 v[168:171], a[168:171], a[40:43], v[168:171]
v_fma_f32 v167, v167, s28, -v186
v_max3_f32 v189, v160, v161, v162
v_mfma_f32_16x16x32_bf16 v[172:175], a[184:187], a[40:43], v[172:175]
v_max3_f32 v190, v163, v164, v165
v_max3_f32 v189, v189, v166, v167
v_mfma_f32_16x16x32_bf16 v[168:171], a[172:175], a[60:63], v[168:171]
v_max_f32 v189, v189, v190
v_cmp_lt_f32 vcc, 0x41000000, v189
v_mfma_f32_16x16x32_bf16 v[172:175], a[188:191], a[60:63], v[172:175]
s_cbranch_vccnz stub_20
back_21:
v_exp_f32 v160, v160
v_mfma_f32_16x16x32_bf16 v[32:35], a[192:195], v[180:183], v[32:35]
v_exp_f32 v161, v161
v_mfma_f32_16x16x32_bf16 v[36:39], a[196:199], v[180:183], v[36:39]
v_exp_f32 v162, v162
v_mfma_f32_16x16x32_bf16 v[40:43], a[200:203], v[180:183], v[40:43]
v_exp_f32 v163, v163
v_mfma_f32_16x16x32_bf16 v[44:47], a[204:207], v[180:183], v[44:47]
v_exp_f32 v164, v164
v_mfma_f32_16x16x32_bf16 v[48:51], a[208:211], v[180:183], v[48:51]
v_exp_f32 v165, v165
v_mfma_f32_16x16x32_bf16 v[52:55], a[212:215], v[180:183], v[52:55]
v_exp_f32 v166, v166
v_mfma_f32_16x16x32_bf16 v[56:59], a[216:219], v[180:183], v[56:59]
v_exp_f32 v167, v167
v_mfma_f32_16x16x32_bf16 v[60:63], a[220:223], v[180:183], v[60:63]
v_cvt_pk_bf16_f32 v176, v160, v161
v_cvt_pk_bf16_f32 v177, v162, v163
v_mfma_f32_16x16x32_bf16 a[228:231], a[244:247], v[180:183], a[228:231]
v_cvt_pk_bf16_f32 v178, v164, v165
v_cvt_pk_bf16_f32 v179, v166, v167
v_mfma_f32_16x16x32_bf16 v[160:163], a[160:163], a[4:7], 0
v_fma_f32 v168, v168, s28, -v184
v_fma_f32 v169, v169, s28, -v184
v_fma_f32 v170, v170, s28, -v184
v_fma_f32 v171, v171, s28, -v184
v_mfma_f32_16x16x32_bf16 v[164:167], a[176:179], a[4:7], 0
v_fma_f32 v172, v172, s28, -v184
v_fma_f32 v173, v173, s28, -v184
v_fma_f32 v174, v174, s28, -v184
v_fma_f32 v175, v175, s28, -v184
v_mfma_f32_16x16x32_bf16 v[160:163], a[164:167], a[24:27], v[160:163]
v_max3_f32 v189, v168, v169, v170
v_max3_f32 v190, v171, v172, v173
v_max3_f32 v189, v189, v174, v175
v_max_f32 v189, v189, v190
v_mfma_f32_16x16x32_bf16 v[164:167], a[180:183], a[24:27], v[164:167]
v_cmp_lt_f32 vcc, 0x41000000, v189
s_cbranch_vccnz stub_22
back_23:
v_exp_f32 v168, v168
v_mfma_f32_16x16x32_bf16 v[160:163], a[168:171], a[44:47], v[160:163]
v_exp_f32 v169, v169
v_exp_f32 v170, v170
v_mfma_f32_16x16x32_bf16 v[164:167], a[184:187], a[44:47], v[164:167]
v_exp_f32 v171, v171
v_exp_f32 v172, v172
v_mfma_f32_16x16x32_bf16 v[160:163], a[172:175], a[64:67], v[160:163]
v_exp_f32 v173, v173
v_exp_f32 v174, v174
v_mfma_f32_16x16x32_bf16 v[164:167], a[188:191], a[64:67], v[164:167]
v_exp_f32 v175, v175
v_cvt_pk_bf16_f32 v180, v168, v169
v_cvt_pk_bf16_f32 v181, v170, v171
s_waitcnt vmcnt(16)
s_waitcnt vmcnt(12)
s_barrier
v_mfma_f32_16x16x32_bf16 v[64:67], a[192:195], v[176:179], v[64:67]
ds_read_b64_tr_b16 a[192:193], v195 offset:57344
ds_read_b64_tr_b16 a[194:195], v195 offset:61440
v_mfma_f32_16x16x32_bf16 v[68:71], a[196:199], v[176:179], v[68:71]
ds_read_b64_tr_b16 a[196:197], v196 offset:57344
ds_read_b64_tr_b16 a[198:199], v196 offset:61440
s_add_u32 s40, s34, s32
s_and_b32 s40, s40, 31
s_lshl_b32 s40, s40, 13
s_lshr_b32 s41, s34, 5
s_lshl_b32 s41, s41, 19
s_add_u32 s40, s40, s41
s_add_u32 s35, s40, s33
s_add_u32 s34, s34, 1
s_add_u32 m0, s37, 32768
s_nop 0
buffer_load_dwordx4 v203, s[16:19], s35 offen nt lds
v_mfma_f32_16x16x32_bf16 v[72:75], a[200:203], v[176:179], v[72:75]
ds_read_b64_tr_b16 a[200:201], v197 offset:57344
ds_read_b64_tr_b16 a[202:203], v197 offset:61440
v_mfma_f32_16x16x32_bf16 v[76:79], a[204:207], v[176:179], v[76:79]
ds_read_b64_tr_b16 a[204:205], v198 offset:57344
ds_read_b64_tr_b16 a[206:207], v198 offset:61440
buffer_load_dwordx4 v204, s[16:19], s35 offen offset:1024 nt lds
v_mfma_f32_16x16x32_bf16 v[80:83], a[208:211], v[176:179], v[80:83]
ds_read_b64_tr_b16 a[208:209], v199 offset:57344
ds_read_b64_tr_b16 a[210:211], v199 offset:61440
v_mfma_f32_16x16x32_bf16 v[84:87], a[212:215], v[176:179], v[84:87]
ds_read_b64_tr_b16 a[212:213], v200 offset:57344
ds_read_b64_tr_b16 a[214:215], v200 offset:61440
buffer_load_dwordx4 v205, s[16:19], s35 offen offset:2048 nt lds
v_mfma_f32_16x16x32_bf16 v[88:91], a[216:219], v[176:179], v[88:91]
ds_read_b64_tr_b16 a[216:217], v201 offset:57344
ds_read_b64_tr_b16 a[218:219], v201 offset:61440
v_mfma_f32_16x16x32_bf16 v[92:95], a[220:223], v[176:179], v[92:95]
ds_read_b64_tr_b16 a[220:221], v202 offset:57344
ds_read_b64_tr_b16 a[222:223], v202 offset:61440
buffer_load_dwordx4 v206, s[16:19], s35 offen offset:3072 nt lds
v_mfma_f32_16x16x32_bf16 a[232:235], a[244:247], v[176:179], a[232:235]
v_cvt_pk_bf16_f32 v182, v172, v173
v_cvt_pk_bf16_f32 v183, v174, v175
v_mfma_f32_16x16x32_bf16 v[168:171], a[160:163], a[8:11], 0
ds_read_b128 a[160:163], v191
v_fma_f32 v160, v160, s28, -v185
v_fma_f32 v161, v161, s28, -v185
v_mfma_f32_16x16x32_bf16 v[172:175], a[176:179], a[8:11], 0
ds_read_b128 a[176:179], v191 offset:4096
v_fma_f32 v162, v162, s28, -v185
v_fma_f32 v163, v163, s28, -v185
v_mfma_f32_16x16x32_bf16 v[168:171], a[164:167], a[28:31], v[168:171]
ds_read_b128 a[164:167], v192
s_add_u32 m0, s37, 40960
s_nop 0
buffer_load_dwordx4 v207, s[20:23], s35 offen nt lds
v_mfma_f32_16x16x32_bf16 v[172:175], a[180:183], a[28:31], v[172:175]
ds_read_b128 a[180:183], v192 offset:4096
v_fma_f32 v164, v164, s28, -v185
v_mfma_f32_16x16x32_bf16 v[168:171], a[168:171], a[48:51], v[168:171]
ds_read_b128 a[168:171], v193
v_fma_f32 v165, v165, s28, -v185
v_mfma_f32_16x16x32_bf16 v[172:175], a[184:187], a[48:51], v[172:175]
ds_read_b128 a[184:187], v193 offset:4096
v_fma_f32 v166, v166, s28, -v185
v_fma_f32 v167, v167, s28, -v185
v_mfma_f32_16x16x32_bf16 v[168:171], a[172:175], a[68:71], v[168:171]
ds_read_b128 a[172:175], v194
buffer_load_dwordx4 v208, s[20:23], s35 offen offset:1024 nt lds
v_max3_f32 v189, v160, v161, v162
v_mfma_f32_16x16x32_bf16 v[172:175], a[188:191], a[68:71], v[172:175]
ds_read_b128 a[188:191], v194 offset:4096
v_max3_f32 v190, v163, v164, v165
v_max3_f32 v189, v189, v166, v167
s_waitcnt lgkmcnt(8)
v_mfma_f32_16x16x32_bf16 v[0:3], a[192:195], v[180:183], v[0:3]
v_max_f32 v189, v189, v190
v_cmp_lt_f32 vcc, 0x41000000, v189
v_mfma_f32_16x16x32_bf16 v[4:7], a[196:199], v[180:183], v[4:7]
s_cbranch_vccnz stub_24
back_25:
v_exp_f32 v160, v160
v_mfma_f32_16x16x32_bf16 v[8:11], a[200:203], v[180:183], v[8:11]
buffer_load_dwordx4 v207, s[20:23], s35 offen offset:2048 nt lds
v_exp_f32 v161, v161
v_mfma_f32_16x16x32_bf16 v[12:15], a[204:207], v[180:183], v[12:15]
v_exp_f32 v162, v162
v_mfma_f32_16x16x32_bf16 v[16:19], a[208:211], v[180:183], v[16:19]
v_exp_f32 v163, v163
v_exp_f32 v164, v164
v_mfma_f32_16x16x32_bf16 v[20:23], a[212:215], v[180:183], v[20:23]
v_exp_f32 v165, v165
v_mfma_f32_16x16x32_bf16 v[24:27], a[216:219], v[180:183], v[24:27]
buffer_load_dwordx4 v208, s[20:23], s35 offen offset:3072 nt lds
v_exp_f32 v166, v166
v_mfma_f32_16x16x32_bf16 v[28:31], a[220:223], v[180:183], v[28:31]
v_exp_f32 v167, v167
v_cvt_pk_bf16_f32 v176, v160, v161
v_mfma_f32_16x16x32_bf16 a[224:227], a[244:247], v[180:183], a[224:227]
v_cvt_pk_bf16_f32 v177, v162, v163
v_cvt_pk_bf16_f32 v178, v164, v165
v_cvt_pk_bf16_f32 v179, v166, v167
s_waitcnt lgkmcnt(0)
v_mfma_f32_16x16x32_bf16 v[160:163], a[160:163], a[0:3], 0
v_fma_f32 v168, v168, s28, -v186
v_mfma_f32_16x16x32_bf16 v[164:167], a[176:179], a[0:3], 0
v_fma_f32 v169, v169, s28, -v186
v_fma_f32 v170, v170, s28, -v186
v_mfma_f32_16x16x32_bf16 v[160:163], a[164:167], a[20:23], v[160:163]
v_fma_f32 v171, v171, s28, -v186
v_fma_f32 v172, v172, s28, -v186
v_mfma_f32_16x16x32_bf16 v[164:167], a[180:183], a[20:23], v[164:167]
v_fma_f32 v173, v173, s28, -v186
v_fma_f32 v174, v174, s28, -v186
v_mfma_f32_16x16x32_bf16 v[160:163], a[168:171], a[40:43], v[160:163]
v_fma_f32 v175, v175, s28, -v186
v_max3_f32 v189, v168, v169, v170
v_mfma_f32_16x16x32_bf16 v[164:167], a[184:187], a[40:43], v[164:167]
v_max3_f32 v190, v171, v172, v173
v_max3_f32 v189, v189, v174, v175
v_mfma_f32_16x16x32_bf16 v[160:163], a[172:175], a[60:63], v[160:163]
v_max_f32 v189, v189, v190
v_cmp_lt_f32 vcc, 0x41000000, v189
v_mfma_f32_16x16x32_bf16 v[164:167], a[188:191], a[60:63], v[164:167]
s_cbranch_vccnz stub_26
back_27:
v_exp_f32 v168, v168
v_mfma_f32_16x16x32_bf16 v[32:35], a[192:195], v[176:179], v[32:35]
v_exp_f32 v169, v169
v_mfma_f32_16x16x32_bf16 v[36:39], a[196:199], v[176:179], v[36:39]
v_exp_f32 v170, v170
v_mfma_f32_16x16x32_bf16 v[40:43], a[200:203], v[176:179], v[40:43]
v_exp_f32 v171, v171
v_mfma_f32_16x16x32_bf16 v[44:47], a[204:207], v[176:179], v[44:47]
v_exp_f32 v172, v172
v_mfma_f32_16x16x32_bf16 v[48:51], a[208:211], v[176:179], v[48:51]
v_exp_f32 v173, v173
v_mfma_f32_16x16x32_bf16 v[52:55], a[212:215], v[176:179], v[52:55]
v_exp_f32 v174, v174
v_mfma_f32_16x16x32_bf16 v[56:59], a[216:219], v[176:179], v[56:59]
v_exp_f32 v175, v175
v_mfma_f32_16x16x32_bf16 v[60:63], a[220:223], v[176:179], v[60:63]
v_cvt_pk_bf16_f32 v180, v168, v169
v_cvt_pk_bf16_f32 v181, v170, v171
v_mfma_f32_16x16x32_bf16 a[228:231], a[244:247], v[176:179], a[228:231]
v_cvt_pk_bf16_f32 v182, v172, v173
v_cvt_pk_bf16_f32 v183, v174, v175
v_mfma_f32_16x16x32_bf16 v[168:171], a[160:163], a[4:7], 0
v_fma_f32 v160, v160, s28, -v184
v_fma_f32 v161, v161, s28, -v184
v_fma_f32 v162, v162, s28, -v184
v_fma_f32 v163, v163, s28, -v184
v_mfma_f32_16x16x32_bf16 v[172:175], a[176:179], a[4:7], 0
v_fma_f32 v164, v164, s28, -v184
v_fma_f32 v165, v165, s28, -v184
v_fma_f32 v166, v166, s28, -v184
v_fma_f32 v167, v167, s28, -v184
v_mfma_f32_16x16x32_bf16 v[168:171], a[164:167], a[24:27], v[168:171]
v_max3_f32 v189, v160, v161, v162
v_max3_f32 v190, v163, v164, v165
v_max3_f32 v189, v189, v166, v167
v_max_f32 v189, v189, v190
v_mfma_f32_16x16x32_bf16 v[172:175], a[180:183], a[24:27], v[172:175]
v_cmp_lt_f32 vcc, 0x41000000, v189
s_cbranch_vccnz stub_28
back_29:
v_exp_f32 v160, v160
v_mfma_f32_16x16x32_bf16 v[168:171], a[168:171], a[44:47], v[168:171]
v_exp_f32 v161, v161
v_exp_f32 v162, v162
v_mfma_f32_16x16x32_bf16 v[172:175], a[184:187], a[44:47], v[172:175]
v_exp_f32 v163, v163
v_exp_f32 v164, v164
v_mfma_f32_16x16x32_bf16 v[168:171], a[172:175], a[64:67], v[168:171]
v_exp_f32 v165, v165
v_exp_f32 v166, v166
v_mfma_f32_16x16x32_bf16 v[172:175], a[188:191], a[64:67], v[172:175]
v_exp_f32 v167, v167
v_cvt_pk_bf16_f32 v176, v160, v161
v_cvt_pk_bf16_f32 v177, v162, v163
s_waitcnt vmcnt(16)
s_waitcnt vmcnt(12)
s_barrier
v_mfma_f32_16x16x32_bf16 v[64:67], a[192:195], v[180:183], v[64:67]
ds_read_b64_tr_b16 a[192:193], v195 offset:8192
ds_read_b64_tr_b16 a[194:195], v195 offset:12288
v_mfma_f32_16x16x32_bf16 v[68:71], a[196:199], v[180:183], v[68:71]
ds_read_b64_tr_b16 a[196:197], v196 offset:8192
ds_read_b64_tr_b16 a[198:199], v196 offset:12288
s_add_u32 s40, s34, s32
s_and_b32 s40, s40, 31
s_lshl_b32 s40, s40, 13
s_lshr_b32 s41, s34, 5
s_lshl_b32 s41, s41, 19
s_add_u32 s40, s40, s41
s_add_u32 s35, s40, s33
s_add_u32 s34, s34, 1
s_add_u32 m0, s37, 49152
s_nop 0
buffer_load_dwordx4 v203, s[16:19], s35 offen nt lds
v_mfma_f32_16x16x32_bf16 v[72:75], a[200:203], v[180:183], v[72:75]
ds_read_b64_tr_b16 a[200:201], v197 offset:8192
ds_read_b64_tr_b16 a[202:203], v197 offset:12288
v_mfma_f32_16x16x32_bf16 v[76:79], a[204:207], v[180:183], v[76:79]
ds_read_b64_tr_b16 a[204:205], v198 offset:8192
ds_read_b64_tr_b16 a[206:207], v198 offset:12288
buffer_load_dwordx4 v204, s[16:19], s35 offen offset:1024 nt lds
v_mfma_f32_16x16x32_bf16 v[80:83], a[208:211], v[180:183], v[80:83]
ds_read_b64_tr_b16 a[208:209], v199 offset:8192
ds_read_b64_tr_b16 a[210:211], v199 offset:12288
v_mfma_f32_16x16x32_bf16 v[84:87], a[212:215], v[180:183], v[84:87]
ds_read_b64_tr_b16 a[212:213], v200 offset:8192
ds_read_b64_tr_b16 a[214:215], v200 offset:12288
buffer_load_dwordx4 v205, s[16:19], s35 offen offset:2048 nt lds
v_mfma_f32_16x16x32_bf16 v[88:91], a[216:219], v[180:183], v[88:91]
ds_read_b64_tr_b16 a[216:217], v201 offset:8192
ds_read_b64_tr_b16 a[218:219], v201 offset:12288
v_mfma_f32_16x16x32_bf16 v[92:95], a[220:223], v[180:183], v[92:95]
ds_read_b64_tr_b16 a[220:221], v202 offset:8192
ds_read_b64_tr_b16 a[222:223], v202 offset:12288
buffer_load_dwordx4 v206, s[16:19], s35 offen offset:3072 nt lds
v_mfma_f32_16x16x32_bf16 a[232:235], a[244:247], v[180:183], a[232:235]
v_cvt_pk_bf16_f32 v178, v164, v165
v_cvt_pk_bf16_f32 v179, v166, v167
v_mfma_f32_16x16x32_bf16 v[160:163], a[160:163], a[8:11], 0
ds_read_b128 a[160:163], v191 offset:16384
v_fma_f32 v168, v168, s28, -v185
v_fma_f32 v169, v169, s28, -v185
v_mfma_f32_16x16x32_bf16 v[164:167], a[176:179], a[8:11], 0
ds_read_b128 a[176:179], v191 offset:20480
v_fma_f32 v170, v170, s28, -v185
v_fma_f32 v171, v171, s28, -v185
v_mfma_f32_16x16x32_bf16 v[160:163], a[164:167], a[28:31], v[160:163]
ds_read_b128 a[164:167], v192 offset:16384
s_add_u32 m0, s37, 57344
s_nop 0
buffer_load_dwordx4 v207, s[20:23], s35 offen nt lds
v_mfma_f32_16x16x32_bf16 v[164:167], a[180:183], a[28:31], v[164:167]
ds_read_b128 a[180:183], v192 offset:20480
v_fma_f32 v172, v172, s28, -v185
v_mfma_f32_16x16x32_bf16 v[160:163], a[168:171], a[48:51], v[160:163]
ds_read_b128 a[168:171], v193 offset:16384
v_fma_f32 v173, v173, s28, -v185
v_mfma_f32_16x16x32_bf16 v[164:167], a[184:187], a[48:51], v[164:167]
ds_read_b128 a[184:187], v193 offset:20480
v_fma_f32 v174, v174, s28, -v185
v_fma_f32 v175, v175, s28, -v185
v_mfma_f32_16x16x32_bf16 v[160:163], a[172:175], a[68:71], v[160:163]
ds_read_b128 a[172:175], v194 offset:16384
buffer_load_dwordx4 v208, s[20:23], s35 offen offset:1024 nt lds
v_max3_f32 v189, v168, v169, v170
v_mfma_f32_16x16x32_bf16 v[164:167], a[188:191], a[68:71], v[164:167]
ds_read_b128 a[188:191], v194 offset:20480
v_max3_f32 v190, v171, v172, v173
v_max3_f32 v189, v189, v174, v175
s_waitcnt lgkmcnt(8)
v_mfma_f32_16x16x32_bf16 v[0:3], a[192:195], v[176:179], v[0:3]
v_max_f32 v189, v189, v190
v_cmp_lt_f32 vcc, 0x41000000, v189
v_mfma_f32_16x16x32_bf16 v[4:7], a[196:199], v[176:179], v[4:7]
s_cbranch_vccnz stub_30
back_31:
v_exp_f32 v168, v168
v_mfma_f32_16x16x32_bf16 v[8:11], a[200:203], v[176:179], v[8:11]
buffer_load_dwordx4 v207, s[20:23], s35 offen offset:2048 nt lds
v_exp_f32 v169, v169
v_mfma_f32_16x16x32_bf16 v[12:15], a[204:207], v[176:179], v[12:15]
v_exp_f32 v170, v170
v_mfma_f32_16x16x32_bf16 v[16:19], a[208:211], v[176:179], v[16:19]
v_exp_f32 v171, v171
v_exp_f32 v172, v172
v_mfma_f32_16x16x32_bf16 v[20:23], a[212:215], v[176:179], v[20:23]
v_exp_f32 v173, v173
v_mfma_f32_16x16x32_bf16 v[24:27], a[216:219], v[176:179], v[24:27]
buffer_load_dwordx4 v208, s[20:23], s35 offen offset:3072 nt lds
v_exp_f32 v174, v174
v_mfma_f32_16x16x32_bf16 v[28:31], a[220:223], v[176:179], v[28:31]
v_exp_f32 v175, v175
v_cvt_pk_bf16_f32 v180, v168, v169
v_mfma_f32_16x16x32_bf16 a[224:227], a[244:247], v[176:179], a[224:227]
v_cvt_pk_bf16_f32 v181, v170, v171
v_cvt_pk_bf16_f32 v182, v172, v173
v_cvt_pk_bf16_f32 v183, v174, v175
s_waitcnt lgkmcnt(0)
v_mfma_f32_16x16x32_bf16 v[168:171], a[160:163], a[0:3], 0
v_fma_f32 v160, v160, s28, -v186
v_mfma_f32_16x16x32_bf16 v[172:175], a[176:179], a[0:3], 0
v_fma_f32 v161, v161, s28, -v186
v_fma_f32 v162, v162, s28, -v186
v_mfma_f32_16x16x32_bf16 v[168:171], a[164:167], a[20:23], v[168:171]
v_fma_f32 v163, v163, s28, -v186
v_fma_f32 v164, v164, s28, -v186
v_mfma_f32_16x16x32_bf16 v[172:175], a[180:183], a[20:23], v[172:175]
v_fma_f32 v165, v165, s28, -v186
v_fma_f32 v166, v166, s28, -v186
v_mfma_f32_16x16x32_bf16 v[168:171], a[168:171], a[40:43], v[168:171]
v_fma_f32 v167, v167, s28, -v186
v_max3_f32 v189, v160, v161, v162
v_mfma_f32_16x16x32_bf16 v[172:175], a[184:187], a[40:43], v[172:175]
v_max3_f32 v190, v163, v164, v165
v_max3_f32 v189, v189, v166, v167
v_mfma_f32_16x16x32_bf16 v[168:171], a[172:175], a[60:63], v[168:171]
v_max_f32 v189, v189, v190
v_cmp_lt_f32 vcc, 0x41000000, v189
v_mfma_f32_16x16x32_bf16 v[172:175], a[188:191], a[60:63], v[172:175]
s_cbranch_vccnz stub_32
back_33:
v_exp_f32 v160, v160
v_mfma_f32_16x16x32_bf16 v[32:35], a[192:195], v[180:183], v[32:35]
v_exp_f32 v161, v161
v_mfma_f32_16x16x32_bf16 v[36:39], a[196:199], v[180:183], v[36:39]
v_exp_f32 v162, v162
v_mfma_f32_16x16x32_bf16 v[40:43], a[200:203], v[180:183], v[40:43]
v_exp_f32 v163, v163
v_mfma_f32_16x16x32_bf16 v[44:47], a[204:207], v[180:183], v[44:47]
v_exp_f32 v164, v164
v_mfma_f32_16x16x32_bf16 v[48:51], a[208:211], v[180:183], v[48:51]
v_exp_f32 v165, v165
v_mfma_f32_16x16x32_bf16 v[52:55], a[212:215], v[180:183], v[52:55]
v_exp_f32 v166, v166
v_mfma_f32_16x16x32_bf16 v[56:59], a[216:219], v[180:183], v[56:59]
v_exp_f32 v167, v167
v_mfma_f32_16x16x32_bf16 v[60:63], a[220:223], v[180:183], v[60:63]
v_cvt_pk_bf16_f32 v176, v160, v161
v_cvt_pk_bf16_f32 v177, v162, v163
v_mfma_f32_16x16x32_bf16 a[228:231], a[244:247], v[180:183], a[228:231]
v_cvt_pk_bf16_f32 v178, v164, v165
v_cvt_pk_bf16_f32 v179, v166, v167
s_add_u32 s38, s38, 1
s_cmp_lt_u32 s38, 7
s_cbranch_scc1 loop_9
v_mfma_f32_16x16x32_bf16 v[160:163], a[160:163], a[4:7], 0
v_fma_f32 v168, v168, s28, -v184
v_fma_f32 v169, v169, s28, -v184
v_fma_f32 v170, v170, s28, -v184
v_fma_f32 v171, v171, s28, -v184
v_mfma_f32_16x16x32_bf16 v[164:167], a[176:179], a[4:7], 0
v_fma_f32 v172, v172, s28, -v184
v_fma_f32 v173, v173, s28, -v184
v_fma_f32 v174, v174, s28, -v184
v_fma_f32 v175, v175, s28, -v184
v_mfma_f32_16x16x32_bf16 v[160:163], a[164:167], a[24:27], v[160:163]
v_max3_f32 v189, v168, v169, v170
v_max3_f32 v190, v171, v172, v173
v_max3_f32 v189, v189, v174, v175
v_max_f32 v189, v189, v190
v_mfma_f32_16x16x32_bf16 v[164:167], a[180:183], a[24:27], v[164:167]
v_cmp_lt_f32 vcc, 0x41000000, v189
s_cbranch_vccnz stub_34
back_35:
v_exp_f32 v168, v168
v_mfma_f32_16x16x32_bf16 v[160:163], a[168:171], a[44:47], v[160:163]
v_exp_f32 v169, v169
v_exp_f32 v170, v170
v_mfma_f32_16x16x32_bf16 v[164:167], a[184:187], a[44:47], v[164:167]
v_exp_f32 v171, v171
v_exp_f32 v172, v172
v_mfma_f32_16x16x32_bf16 v[160:163], a[172:175], a[64:67], v[160:163]
v_exp_f32 v173, v173
v_exp_f32 v174, v174
v_mfma_f32_16x16x32_bf16 v[164:167], a[188:191], a[64:67], v[164:167]
v_exp_f32 v175, v175
v_cvt_pk_bf16_f32 v180, v168, v169
v_cvt_pk_bf16_f32 v181, v170, v171
s_waitcnt vmcnt(16)
s_waitcnt vmcnt(12)
s_barrier
v_mfma_f32_16x16x32_bf16 v[64:67], a[192:195], v[176:179], v[64:67]
ds_read_b64_tr_b16 a[192:193], v195 offset:24576
ds_read_b64_tr_b16 a[194:195], v195 offset:28672
v_mfma_f32_16x16x32_bf16 v[68:71], a[196:199], v[176:179], v[68:71]
ds_read_b64_tr_b16 a[196:197], v196 offset:24576
ds_read_b64_tr_b16 a[198:199], v196 offset:28672
s_add_u32 s40, s34, s32
s_and_b32 s40, s40, 31
s_lshl_b32 s40, s40, 13
s_lshr_b32 s41, s34, 5
s_lshl_b32 s41, s41, 19
s_add_u32 s40, s40, s41
s_add_u32 s35, s40, s33
s_add_u32 s34, s34, 1
s_add_u32 m0, s37, 0
s_nop 0
buffer_load_dwordx4 v203, s[16:19], s35 offen nt lds
v_mfma_f32_16x16x32_bf16 v[72:75], a[200:203], v[176:179], v[72:75]
ds_read_b64_tr_b16 a[200:201], v197 offset:24576
ds_read_b64_tr_b16 a[202:203], v197 offset:28672
v_mfma_f32_16x16x32_bf16 v[76:79], a[204:207], v[176:179], v[76:79]
ds_read_b64_tr_b16 a[204:205], v198 offset:24576
ds_read_b64_tr_b16 a[206:207], v198 offset:28672
buffer_load_dwordx4 v204, s[16:19], s35 offen offset:1024 nt lds
v_mfma_f32_16x16x32_bf16 v[80:83], a[208:211], v[176:179], v[80:83]
ds_read_b64_tr_b16 a[208:209], v199 offset:24576
ds_read_b64_tr_b16 a[210:211], v199 offset:28672
v_mfma_f32_16x16x32_bf16 v[84:87], a[212:215], v[176:179], v[84:87]
ds_read_b64_tr_b16 a[212:213], v200 offset:24576
ds_read_b64_tr_b16 a[214:215], v200 offset:28672
buffer_load_dwordx4 v205, s[16:19], s35 offen offset:2048 nt lds
v_mfma_f32_16x16x32_bf16 v[88:91], a[216:219], v[176:179], v[88:91]
ds_read_b64_tr_b16 a[216:217], v201 offset:24576
ds_read_b64_tr_b16 a[218:219], v201 offset:28672
v_mfma_f32_16x16x32_bf16 v[92:95], a[220:223], v[176:179], v[92:95]
ds_read_b64_tr_b16 a[220:221], v202 offset:24576
ds_read_b64_tr_b16 a[222:223], v202 offset:28672
buffer_load_dwordx4 v206, s[16:19], s35 offen offset:3072 nt lds
v_mfma_f32_16x16x32_bf16 a[232:235], a[244:247], v[176:179], a[232:235]
v_cvt_pk_bf16_f32 v182, v172, v173
v_cvt_pk_bf16_f32 v183, v174, v175
v_mfma_f32_16x16x32_bf16 v[168:171], a[160:163], a[8:11], 0
ds_read_b128 a[160:163], v191 offset:32768
v_fma_f32 v160, v160, s28, -v185
v_fma_f32 v161, v161, s28, -v185
v_mfma_f32_16x16x32_bf16 v[172:175], a[176:179], a[8:11], 0
ds_read_b128 a[176:179], v191 offset:36864
v_fma_f32 v162, v162, s28, -v185
v_fma_f32 v163, v163, s28, -v185
v_mfma_f32_16x16x32_bf16 v[168:171], a[164:167], a[28:31], v[168:171]
ds_read_b128 a[164:167], v192 offset:32768
s_add_u32 m0, s37, 8192
s_nop 0
buffer_load_dwordx4 v207, s[20:23], s35 offen nt lds
v_mfma_f32_16x16x32_bf16 v[172:175], a[180:183], a[28:31], v[172:175]
ds_read_b128 a[180:183], v192 offset:36864
v_fma_f32 v164, v164, s28, -v185
v_mfma_f32_16x16x32_bf16 v[168:171], a[168:171], a[48:51], v[168:171]
ds_read_b128 a[168:171], v193 offset:32768
v_fma_f32 v165, v165, s28, -v185
v_mfma_f32_16x16x32_bf16 v[172:175], a[184:187], a[48:51], v[172:175]
ds_read_b128 a[184:187], v193 offset:36864
v_fma_f32 v166, v166, s28, -v185
v_fma_f32 v167, v167, s28, -v185
v_mfma_f32_16x16x32_bf16 v[168:171], a[172:175], a[68:71], v[168:171]
ds_read_b128 a[172:175], v194 offset:32768
buffer_load_dwordx4 v208, s[20:23], s35 offen offset:1024 nt lds
v_max3_f32 v189, v160, v161, v162
v_mfma_f32_16x16x32_bf16 v[172:175], a[188:191], a[68:71], v[172:175]
ds_read_b128 a[188:191], v194 offset:36864
v_max3_f32 v190, v163, v164, v165
v_max3_f32 v189, v189, v166, v167
s_waitcnt lgkmcnt(8)
v_mfma_f32_16x16x32_bf16 v[0:3], a[192:195], v[180:183], v[0:3]
v_max_f32 v189, v189, v190
v_cmp_lt_f32 vcc, 0x41000000, v189
v_mfma_f32_16x16x32_bf16 v[4:7], a[196:199], v[180:183], v[4:7]
s_cbranch_vccnz stub_36
back_37:
v_exp_f32 v160, v160
v_mfma_f32_16x16x32_bf16 v[8:11], a[200:203], v[180:183], v[8:11]
buffer_load_dwordx4 v207, s[20:23], s35 offen offset:2048 nt lds
v_exp_f32 v161, v161
v_mfma_f32_16x16x32_bf16 v[12:15], a[204:207], v[180:183], v[12:15]
v_exp_f32 v162, v162
v_mfma_f32_16x16x32_bf16 v[16:19], a[208:211], v[180:183], v[16:19]
v_exp_f32 v163, v163
v_exp_f32 v164, v164
v_mfma_f32_16x16x32_bf16 v[20:23], a[212:215], v[180:183], v[20:23]
v_exp_f32 v165, v165
v_mfma_f32_16x16x32_bf16 v[24:27], a[216:219], v[180:183], v[24:27]
buffer_load_dwordx4 v208, s[20:23], s35 offen offset:3072 nt lds
v_exp_f32 v166, v166
v_mfma_f32_16x16x32_bf16 v[28:31], a[220:223], v[180:183], v[28:31]
v_exp_f32 v167, v167
v_cvt_pk_bf16_f32 v176, v160, v161
v_mfma_f32_16x16x32_bf16 a[224:227], a[244:247], v[180:183], a[224:227]
v_cvt_pk_bf16_f32 v177, v162, v163
v_cvt_pk_bf16_f32 v178, v164, v165
v_cvt_pk_bf16_f32 v179, v166, v167
s_waitcnt lgkmcnt(0)
v_mfma_f32_16x16x32_bf16 v[160:163], a[160:163], a[0:3], 0
v_fma_f32 v168, v168, s28, -v186
v_mfma_f32_16x16x32_bf16 v[164:167], a[176:179], a[0:3], 0
v_fma_f32 v169, v169, s28, -v186
v_fma_f32 v170, v170, s28, -v186
v_mfma_f32_16x16x32_bf16 v[160:163], a[164:167], a[20:23], v[160:163]
v_fma_f32 v171, v171, s28, -v186
v_fma_f32 v172, v172, s28, -v186
v_mfma_f32_16x16x32_bf16 v[164:167], a[180:183], a[20:23], v[164:167]
v_fma_f32 v173, v173, s28, -v186
v_fma_f32 v174, v174, s28, -v186
v_mfma_f32_16x16x32_bf16 v[160:163], a[168:171], a[40:43], v[160:163]
v_fma_f32 v175, v175, s28, -v186
v_max3_f32 v189, v168, v169, v170
v_mfma_f32_16x16x32_bf16 v[164:167], a[184:187], a[40:43], v[164:167]
v_max3_f32 v190, v171, v172, v173
v_max3_f32 v189, v189, v174, v175
v_mfma_f32_16x16x32_bf16 v[160:163], a[172:175], a[60:63], v[160:163]
v_max_f32 v189, v189, v190
v_cmp_lt_f32 vcc, 0x41000000, v189
v_mfma_f32_16x16x32_bf16 v[164:167], a[188:191], a[60:63], v[164:167]
s_cbranch_vccnz stub_38
back_39:
v_exp_f32 v168, v168
v_mfma_f32_16x16x32_bf16 v[32:35], a[192:195], v[176:179], v[32:35]
v_exp_f32 v169, v169
v_mfma_f32_16x16x32_bf16 v[36:39], a[196:199], v[176:179], v[36:39]
v_exp_f32 v170, v170
v_mfma_f32_16x16x32_bf16 v[40:43], a[200:203], v[176:179], v[40:43]
v_exp_f32 v171, v171
v_mfma_f32_16x16x32_bf16 v[44:47], a[204:207], v[176:179], v[44:47]
v_exp_f32 v172, v172
v_mfma_f32_16x16x32_bf16 v[48:51], a[208:211], v[176:179], v[48:51]
v_exp_f32 v173, v173
v_mfma_f32_16x16x32_bf16 v[52:55], a[212:215], v[176:179], v[52:55]
v_exp_f32 v174, v174
v_mfma_f32_16x16x32_bf16 v[56:59], a[216:219], v[176:179], v[56:59]
v_exp_f32 v175, v175
v_mfma_f32_16x16x32_bf16 v[60:63], a[220:223], v[176:179], v[60:63]
v_cvt_pk_bf16_f32 v180, v168, v169
v_cvt_pk_bf16_f32 v181, v170, v171
v_mfma_f32_16x16x32_bf16 a[228:231], a[244:247], v[176:179], a[228:231]
v_cvt_pk_bf16_f32 v182, v172, v173
v_cvt_pk_bf16_f32 v183, v174, v175
v_mfma_f32_16x16x32_bf16 v[168:171], a[160:163], a[4:7], 0
v_fma_f32 v160, v160, s28, -v184
v_fma_f32 v161, v161, s28, -v184
v_fma_f32 v162, v162, s28, -v184
v_fma_f32 v163, v163, s28, -v184
v_mfma_f32_16x16x32_bf16 v[172:175], a[176:179], a[4:7], 0
v_fma_f32 v164, v164, s28, -v184
v_fma_f32 v165, v165, s28, -v184
v_fma_f32 v166, v166, s28, -v184
v_fma_f32 v167, v167, s28, -v184
v_mfma_f32_16x16x32_bf16 v[168:171], a[164:167], a[24:27], v[168:171]
v_max3_f32 v189, v160, v161, v162
v_max3_f32 v190, v163, v164, v165
v_max3_f32 v189, v189, v166, v167
v_max_f32 v189, v189, v190
v_mfma_f32_16x16x32_bf16 v[172:175], a[180:183], a[24:27], v[172:175]
v_cmp_lt_f32 vcc, 0x41000000, v189
s_cbranch_vccnz stub_40
back_41:
v_exp_f32 v160, v160
v_mfma_f32_16x16x32_bf16 v[168:171], a[168:171], a[44:47], v[168:171]
v_exp_f32 v161, v161
v_exp_f32 v162, v162
v_mfma_f32_16x16x32_bf16 v[172:175], a[184:187], a[44:47], v[172:175]
v_exp_f32 v163, v163
v_exp_f32 v164, v164
v_mfma_f32_16x16x32_bf16 v[168:171], a[172:175], a[64:67], v[168:171]
v_exp_f32 v165, v165
v_exp_f32 v166, v166
v_mfma_f32_16x16x32_bf16 v[172:175], a[188:191], a[64:67], v[172:175]
v_exp_f32 v167, v167
v_cvt_pk_bf16_f32 v176, v160, v161
v_cvt_pk_bf16_f32 v177, v162, v163
s_waitcnt vmcnt(16)
s_waitcnt vmcnt(12)
s_barrier
v_mfma_f32_16x16x32_bf16 v[64:67], a[192:195], v[180:183], v[64:67]
ds_read_b64_tr_b16 a[192:193], v195 offset:40960
ds_read_b64_tr_b16 a[194:195], v195 offset:45056
v_mfma_f32_16x16x32_bf16 v[68:71], a[196:199], v[180:183], v[68:71]
ds_read_b64_tr_b16 a[196:197], v196 offset:40960
ds_read_b64_tr_b16 a[198:199], v196 offset:45056
s_add_u32 s40, s34, s32
s_and_b32 s40, s40, 31
s_lshl_b32 s40, s40, 13
s_lshr_b32 s41, s34, 5
s_lshl_b32 s41, s41, 19
s_add_u32 s40, s40, s41
s_add_u32 s35, s40, s33
s_add_u32 s34, s34, 1
s_add_u32 m0, s37, 16384
s_nop 0
buffer_load_dwordx4 v203, s[16:19], s35 offen nt lds
v_mfma_f32_16x16x32_bf16 v[72:75], a[200:203], v[180:183], v[72:75]
ds_read_b64_tr_b16 a[200:201], v197 offset:40960
ds_read_b64_tr_b16 a[202:203], v197 offset:45056
v_mfma_f32_16x16x32_bf16 v[76:79], a[204:207], v[180:183], v[76:79]
ds_read_b64_tr_b16 a[204:205], v198 offset:40960
ds_read_b64_tr_b16 a[206:207], v198 offset:45056
buffer_load_dwordx4 v204, s[16:19], s35 offen offset:1024 nt lds
v_mfma_f32_16x16x32_bf16 v[80:83], a[208:211], v[180:183], v[80:83]
ds_read_b64_tr_b16 a[208:209], v199 offset:40960
ds_read_b64_tr_b16 a[210:211], v199 offset:45056
v_mfma_f32_16x16x32_bf16 v[84:87], a[212:215], v[180:183], v[84:87]
ds_read_b64_tr_b16 a[212:213], v200 offset:40960
ds_read_b64_tr_b16 a[214:215], v200 offset:45056
buffer_load_dwordx4 v205, s[16:19], s35 offen offset:2048 nt lds
v_mfma_f32_16x16x32_bf16 v[88:91], a[216:219], v[180:183], v[88:91]
ds_read_b64_tr_b16 a[216:217], v201 offset:40960
ds_read_b64_tr_b16 a[218:219], v201 offset:45056
v_mfma_f32_16x16x32_bf16 v[92:95], a[220:223], v[180:183], v[92:95]
ds_read_b64_tr_b16 a[220:221], v202 offset:40960
ds_read_b64_tr_b16 a[222:223], v202 offset:45056
buffer_load_dwordx4 v206, s[16:19], s35 offen offset:3072 nt lds
v_mfma_f32_16x16x32_bf16 a[232:235], a[244:247], v[180:183], a[232:235]
v_cvt_pk_bf16_f32 v178, v164, v165
v_cvt_pk_bf16_f32 v179, v166, v167
v_mfma_f32_16x16x32_bf16 v[160:163], a[160:163], a[8:11], 0
ds_read_b128 a[160:163], v191 offset:49152
v_fma_f32 v168, v168, s28, -v185
v_fma_f32 v169, v169, s28, -v185
v_mfma_f32_16x16x32_bf16 v[164:167], a[176:179], a[8:11], 0
ds_read_b128 a[176:179], v191 offset:53248
v_fma_f32 v170, v170, s28, -v185
v_fma_f32 v171, v171, s28, -v185
v_mfma_f32_16x16x32_bf16 v[160:163], a[164:167], a[28:31], v[160:163]
ds_read_b128 a[164:167], v192 offset:49152
s_add_u32 m0, s37, 24576
s_nop 0
buffer_load_dwordx4 v207, s[20:23], s35 offen nt lds
v_mfma_f32_16x16x32_bf16 v[164:167], a[180:183], a[28:31], v[164:167]
ds_read_b128 a[180:183], v192 offset:53248
v_fma_f32 v172, v172, s28, -v185
v_mfma_f32_16x16x32_bf16 v[160:163], a[168:171], a[48:51], v[160:163]
ds_read_b128 a[168:171], v193 offset:49152
v_fma_f32 v173, v173, s28, -v185
v_mfma_f32_16x16x32_bf16 v[164:167], a[184:187], a[48:51], v[164:167]
ds_read_b128 a[184:187], v193 offset:53248
v_fma_f32 v174, v174, s28, -v185
v_fma_f32 v175, v175, s28, -v185
v_mfma_f32_16x16x32_bf16 v[160:163], a[172:175], a[68:71], v[160:163]
ds_read_b128 a[172:175], v194 offset:49152
buffer_load_dwordx4 v208, s[20:23], s35 offen offset:1024 nt lds
v_max3_f32 v189, v168, v169, v170
v_mfma_f32_16x16x32_bf16 v[164:167], a[188:191], a[68:71], v[164:167]
ds_read_b128 a[188:191], v194 offset:53248
v_max3_f32 v190, v171, v172, v173
v_max3_f32 v189, v189, v174, v175
s_waitcnt lgkmcnt(8)
v_mfma_f32_16x16x32_bf16 v[0:3], a[192:195], v[176:179], v[0:3]
v_max_f32 v189, v189, v190
v_cmp_lt_f32 vcc, 0x41000000, v189
v_mfma_f32_16x16x32_bf16 v[4:7], a[196:199], v[176:179], v[4:7]
s_cbranch_vccnz stub_42
back_43:
v_exp_f32 v168, v168
v_mfma_f32_16x16x32_bf16 v[8:11], a[200:203], v[176:179], v[8:11]
buffer_load_dwordx4 v207, s[20:23], s35 offen offset:2048 nt lds
v_exp_f32 v169, v169
v_mfma_f32_16x16x32_bf16 v[12:15], a[204:207], v[176:179], v[12:15]
v_exp_f32 v170, v170
v_mfma_f32_16x16x32_bf16 v[16:19], a[208:211], v[176:179], v[16:19]
v_exp_f32 v171, v171
v_exp_f32 v172, v172
v_mfma_f32_16x16x32_bf16 v[20:23], a[212:215], v[176:179], v[20:23]
v_exp_f32 v173, v173
v_mfma_f32_16x16x32_bf16 v[24:27], a[216:219], v[176:179], v[24:27]
buffer_load_dwordx4 v208, s[20:23], s35 offen offset:3072 nt lds
v_exp_f32 v174, v174
v_mfma_f32_16x16x32_bf16 v[28:31], a[220:223], v[176:179], v[28:31]
v_exp_f32 v175, v175
v_cvt_pk_bf16_f32 v180, v168, v169
v_mfma_f32_16x16x32_bf16 a[224:227], a[244:247], v[176:179], a[224:227]
v_cvt_pk_bf16_f32 v181, v170, v171
v_cvt_pk_bf16_f32 v182, v172, v173
v_cvt_pk_bf16_f32 v183, v174, v175
s_waitcnt lgkmcnt(0)
v_mfma_f32_16x16x32_bf16 v[168:171], a[160:163], a[0:3], 0
v_fma_f32 v160, v160, s28, -v186
v_mfma_f32_16x16x32_bf16 v[172:175], a[176:179], a[0:3], 0
v_fma_f32 v161, v161, s28, -v186
v_fma_f32 v162, v162, s28, -v186
v_mfma_f32_16x16x32_bf16 v[168:171], a[164:167], a[20:23], v[168:171]
v_fma_f32 v163, v163, s28, -v186
v_fma_f32 v164, v164, s28, -v186
v_mfma_f32_16x16x32_bf16 v[172:175], a[180:183], a[20:23], v[172:175]
v_fma_f32 v165, v165, s28, -v186
v_fma_f32 v166, v166, s28, -v186
v_mfma_f32_16x16x32_bf16 v[168:171], a[168:171], a[40:43], v[168:171]
v_fma_f32 v167, v167, s28, -v186
v_max3_f32 v189, v160, v161, v162
v_mfma_f32_16x16x32_bf16 v[172:175], a[184:187], a[40:43], v[172:175]
v_max3_f32 v190, v163, v164, v165
v_max3_f32 v189, v189, v166, v167
v_mfma_f32_16x16x32_bf16 v[168:171], a[172:175], a[60:63], v[168:171]
v_max_f32 v189, v189, v190
v_cmp_lt_f32 vcc, 0x41000000, v189
v_mfma_f32_16x16x32_bf16 v[172:175], a[188:191], a[60:63], v[172:175]
s_cbranch_vccnz stub_44
back_45:
v_exp_f32 v160, v160
v_mfma_f32_16x16x32_bf16 v[32:35], a[192:195], v[180:183], v[32:35]
v_exp_f32 v161, v161
v_mfma_f32_16x16x32_bf16 v[36:39], a[196:199], v[180:183], v[36:39]
v_exp_f32 v162, v162
v_mfma_f32_16x16x32_bf16 v[40:43], a[200:203], v[180:183], v[40:43]
v_exp_f32 v163, v163
v_mfma_f32_16x16x32_bf16 v[44:47], a[204:207], v[180:183], v[44:47]
v_exp_f32 v164, v164
v_mfma_f32_16x16x32_bf16 v[48:51], a[208:211], v[180:183], v[48:51]
v_exp_f32 v165, v165
v_mfma_f32_16x16x32_bf16 v[52:55], a[212:215], v[180:183], v[52:55]
v_exp_f32 v166, v166
v_mfma_f32_16x16x32_bf16 v[56:59], a[216:219], v[180:183], v[56:59]
v_exp_f32 v167, v167
v_mfma_f32_16x16x32_bf16 v[60:63], a[220:223], v[180:183], v[60:63]
v_cvt_pk_bf16_f32 v176, v160, v161
v_cvt_pk_bf16_f32 v177, v162, v163
v_mfma_f32_16x16x32_bf16 a[228:231], a[244:247], v[180:183], a[228:231]
v_cvt_pk_bf16_f32 v178, v164, v165
v_cvt_pk_bf16_f32 v179, v166, v167
s_mul_i32 s43, s48, 36864
s_mul_i32 s42, s3, 9216
s_add_u32 s43, s43, s42
buffer_load_dwordx4 a[0:3], v209, s[60:63], s43 offen
s_add_u32 s43, s43, 1024
buffer_load_dwordx4 a[0:3], v209, s[60:63], s43 offen
s_add_u32 s43, s43, 1024
buffer_load_dwordx4 a[0:3], v209, s[60:63], s43 offen
s_add_u32 s43, s43, 1024
buffer_load_dwordx4 a[0:3], v209, s[60:63], s43 offen
s_add_u32 s43, s43, 1024
buffer_load_dwordx4 a[0:3], v209, s[60:63], s43 offen
s_add_u32 s43, s43, 1024
buffer_load_dwordx4 a[0:3], v209, s[60:63], s43 offen
s_add_u32 s43, s43, 1024
buffer_load_dwordx4 a[0:3], v209, s[60:63], s43 offen
s_add_u32 s43, s43, 1024
buffer_load_dwordx4 a[0:3], v209, s[60:63], s43 offen
s_add_u32 s43, s43, 1024
buffer_load_dwordx4 a[0:3], v209, s[60:63], s43 offen
s_add_u32 s43, s43, 1024
v_mfma_f32_16x16x32_bf16 v[160:163], a[160:163], a[4:7], 0
v_fma_f32 v168, v168, s28, -v184
v_fma_f32 v169, v169, s28, -v184
v_fma_f32 v170, v170, s28, -v184
v_fma_f32 v171, v171, s28, -v184
v_mfma_f32_16x16x32_bf16 v[164:167], a[176:179], a[4:7], 0
v_fma_f32 v172, v172, s28, -v184
v_fma_f32 v173, v173, s28, -v184
v_fma_f32 v174, v174, s28, -v184
v_fma_f32 v175, v175, s28, -v184
v_mfma_f32_16x16x32_bf16 v[160:163], a[164:167], a[24:27], v[160:163]
v_max3_f32 v189, v168, v169, v170
v_max3_f32 v190, v171, v172, v173
v_max3_f32 v189, v189, v174, v175
v_max_f32 v189, v189, v190
v_mfma_f32_16x16x32_bf16 v[164:167], a[180:183], a[24:27], v[164:167]
v_cmp_lt_f32 vcc, 0x41000000, v189
s_cbranch_vccnz stub_46
back_47:
v_exp_f32 v168, v168
v_mfma_f32_16x16x32_bf16 v[160:163], a[168:171], a[44:47], v[160:163]
v_exp_f32 v169, v169
v_exp_f32 v170, v170
v_mfma_f32_16x16x32_bf16 v[164:167], a[184:187], a[44:47], v[164:167]
v_exp_f32 v171, v171
v_exp_f32 v172, v172
v_mfma_f32_16x16x32_bf16 v[160:163], a[172:175], a[64:67], v[160:163]
v_exp_f32 v173, v173
v_exp_f32 v174, v174
v_mfma_f32_16x16x32_bf16 v[164:167], a[188:191], a[64:67], v[164:167]
v_exp_f32 v175, v175
v_cvt_pk_bf16_f32 v180, v168, v169
v_cvt_pk_bf16_f32 v181, v170, v171
s_waitcnt vmcnt(25)
s_waitcnt vmcnt(21)
s_barrier
v_mfma_f32_16x16x32_bf16 v[64:67], a[192:195], v[176:179], v[64:67]
ds_read_b64_tr_b16 a[192:193], v195 offset:57344
ds_read_b64_tr_b16 a[194:195], v195 offset:61440
v_mfma_f32_16x16x32_bf16 v[68:71], a[196:199], v[176:179], v[68:71]
ds_read_b64_tr_b16 a[196:197], v196 offset:57344
ds_read_b64_tr_b16 a[198:199], v196 offset:61440
s_add_u32 s40, s34, s32
s_and_b32 s40, s40, 31
s_lshl_b32 s40, s40, 13
s_lshr_b32 s41, s34, 5
s_lshl_b32 s41, s41, 19
s_add_u32 s40, s40, s41
s_add_u32 s35, s40, s33
s_add_u32 s34, s34, 1
s_add_u32 m0, s37, 32768
s_nop 0
buffer_load_dwordx4 v203, s[16:19], s35 offen nt lds
v_mfma_f32_16x16x32_bf16 v[72:75], a[200:203], v[176:179], v[72:75]
ds_read_b64_tr_b16 a[200:201], v197 offset:57344
ds_read_b64_tr_b16 a[202:203], v197 offset:61440
v_mfma_f32_16x16x32_bf16 v[76:79], a[204:207], v[176:179], v[76:79]
ds_read_b64_tr_b16 a[204:205], v198 offset:57344
ds_read_b64_tr_b16 a[206:207], v198 offset:61440
buffer_load_dwordx4 v204, s[16:19], s35 offen offset:1024 nt lds
v_mfma_f32_16x16x32_bf16 v[80:83], a[208:211], v[176:179], v[80:83]
ds_read_b64_tr_b16 a[208:209], v199 offset:57344
ds_read_b64_tr_b16 a[210:211], v199 offset:61440
v_mfma_f32_16x16x32_bf16 v[84:87], a[212:215], v[176:179], v[84:87]
ds_read_b64_tr_b16 a[212:213], v200 offset:57344
ds_read_b64_tr_b16 a[214:215], v200 offset:61440
buffer_load_dwordx4 v205, s[16:19], s35 offen offset:2048 nt lds
v_mfma_f32_16x16x32_bf16 v[88:91], a[216:219], v[176:179], v[88:91]
ds_read_b64_tr_b16 a[216:217], v201 offset:57344
ds_read_b64_tr_b16 a[218:219], v201 offset:61440
v_mfma_f32_16x16x32_bf16 v[92:95], a[220:223], v[176:179], v[92:95]
ds_read_b64_tr_b16 a[220:221], v202 offset:57344
ds_read_b64_tr_b16 a[222:223], v202 offset:61440
buffer_load_dwordx4 v206, s[16:19], s35 offen offset:3072 nt lds
v_mfma_f32_16x16x32_bf16 a[232:235], a[244:247], v[176:179], a[232:235]
v_cvt_pk_bf16_f32 v182, v172, v173
v_cvt_pk_bf16_f32 v183, v174, v175
v_mfma_f32_16x16x32_bf16 v[168:171], a[160:163], a[8:11], 0
ds_read_b128 a[160:163], v191
v_fma_f32 v160, v160, s28, -v185
v_fma_f32 v161, v161, s28, -v185
v_mfma_f32_16x16x32_bf16 v[172:175], a[176:179], a[8:11], 0
ds_read_b128 a[176:179], v191 offset:4096
v_fma_f32 v162, v162, s28, -v185
v_fma_f32 v163, v163, s28, -v185
v_mfma_f32_16x16x32_bf16 v[168:171], a[164:167], a[28:31], v[168:171]
ds_read_b128 a[164:167], v192
s_add_u32 m0, s37, 40960
s_nop 0
buffer_load_dwordx4 v207, s[20:23], s35 offen nt lds
v_mfma_f32_16x16x32_bf16 v[172:175], a[180:183], a[28:31], v[172:175]
ds_read_b128 a[180:183], v192 offset:4096
v_fma_f32 v164, v164, s28, -v185
v_mfma_f32_16x16x32_bf16 v[168:171], a[168:171], a[48:51], v[168:171]
ds_read_b128 a[168:171], v193
v_fma_f32 v165, v165, s28, -v185
v_mfma_f32_16x16x32_bf16 v[172:175], a[184:187], a[48:51], v[172:175]
ds_read_b128 a[184:187], v193 offset:4096
v_fma_f32 v166, v166, s28, -v185
v_fma_f32 v167, v167, s28, -v185
v_mfma_f32_16x16x32_bf16 v[168:171], a[172:175], a[68:71], v[168:171]
ds_read_b128 a[172:175], v194
buffer_load_dwordx4 v208, s[20:23], s35 offen offset:1024 nt lds
v_max3_f32 v189, v160, v161, v162
v_mfma_f32_16x16x32_bf16 v[172:175], a[188:191], a[68:71], v[172:175]
ds_read_b128 a[188:191], v194 offset:4096
v_max3_f32 v190, v163, v164, v165
v_max3_f32 v189, v189, v166, v167
s_waitcnt lgkmcnt(8)
v_mfma_f32_16x16x32_bf16 v[0:3], a[192:195], v[180:183], v[0:3]
v_max_f32 v189, v189, v190
v_cmp_lt_f32 vcc, 0x41000000, v189
v_mfma_f32_16x16x32_bf16 v[4:7], a[196:199], v[180:183], v[4:7]
s_cbranch_vccnz stub_48
back_49:
v_exp_f32 v160, v160
v_mfma_f32_16x16x32_bf16 v[8:11], a[200:203], v[180:183], v[8:11]
buffer_load_dwordx4 v207, s[20:23], s35 offen offset:2048 nt lds
v_exp_f32 v161, v161
v_mfma_f32_16x16x32_bf16 v[12:15], a[204:207], v[180:183], v[12:15]
v_exp_f32 v162, v162
v_mfma_f32_16x16x32_bf16 v[16:19], a[208:211], v[180:183], v[16:19]
v_exp_f32 v163, v163
v_exp_f32 v164, v164
v_mfma_f32_16x16x32_bf16 v[20:23], a[212:215], v[180:183], v[20:23]
v_exp_f32 v165, v165
v_mfma_f32_16x16x32_bf16 v[24:27], a[216:219], v[180:183], v[24:27]
buffer_load_dwordx4 v208, s[20:23], s35 offen offset:3072 nt lds
v_exp_f32 v166, v166
v_mfma_f32_16x16x32_bf16 v[28:31], a[220:223], v[180:183], v[28:31]
v_exp_f32 v167, v167
v_cvt_pk_bf16_f32 v176, v160, v161
v_mfma_f32_16x16x32_bf16 a[224:227], a[244:247], v[180:183], a[224:227]
v_cvt_pk_bf16_f32 v177, v162, v163
v_cvt_pk_bf16_f32 v178, v164, v165
v_cvt_pk_bf16_f32 v179, v166, v167
s_waitcnt lgkmcnt(0)
v_fma_f32 v168, v168, s28, -v186
v_fma_f32 v169, v169, s28, -v186
v_fma_f32 v170, v170, s28, -v186
v_mfma_f32_16x16x32_bf16 v[32:35], a[192:195], v[176:179], v[32:35]
v_fma_f32 v171, v171, s28, -v186
v_fma_f32 v172, v172, s28, -v186
v_fma_f32 v173, v173, s28, -v186
v_mfma_f32_16x16x32_bf16 v[36:39], a[196:199], v[176:179], v[36:39]
v_fma_f32 v174, v174, s28, -v186
v_fma_f32 v175, v175, s28, -v186
v_max3_f32 v189, v168, v169, v170
v_max3_f32 v190, v171, v172, v173
v_mfma_f32_16x16x32_bf16 v[40:43], a[200:203], v[176:179], v[40:43]
v_max3_f32 v189, v189, v174, v175
v_max_f32 v189, v189, v190
v_cmp_lt_f32 vcc, 0x41000000, v189
v_mfma_f32_16x16x32_bf16 v[44:47], a[204:207], v[176:179], v[44:47]
s_cbranch_vccnz stub_50
back_51:
v_exp_f32 v168, v168
v_mfma_f32_16x16x32_bf16 v[48:51], a[208:211], v[176:179], v[48:51]
v_exp_f32 v169, v169
v_exp_f32 v170, v170
v_mfma_f32_16x16x32_bf16 v[52:55], a[212:215], v[176:179], v[52:55]
v_exp_f32 v171, v171
v_exp_f32 v172, v172
v_mfma_f32_16x16x32_bf16 v[56:59], a[216:219], v[176:179], v[56:59]
v_exp_f32 v173, v173
v_exp_f32 v174, v174
v_mfma_f32_16x16x32_bf16 v[60:63], a[220:223], v[176:179], v[60:63]
v_exp_f32 v175, v175
v_cvt_pk_bf16_f32 v180, v168, v169
v_mfma_f32_16x16x32_bf16 a[228:231], a[244:247], v[176:179], a[228:231]
v_cvt_pk_bf16_f32 v181, v170, v171
v_cvt_pk_bf16_f32 v182, v172, v173
v_cvt_pk_bf16_f32 v183, v174, v175
s_nop 1
v_mfma_f32_16x16x32_bf16 v[64:67], a[192:195], v[180:183], v[64:67]
v_mfma_f32_16x16x32_bf16 v[68:71], a[196:199], v[180:183], v[68:71]
v_mfma_f32_16x16x32_bf16 v[72:75], a[200:203], v[180:183], v[72:75]
v_mfma_f32_16x16x32_bf16 v[76:79], a[204:207], v[180:183], v[76:79]
v_mfma_f32_16x16x32_bf16 v[80:83], a[208:211], v[180:183], v[80:83]
v_mfma_f32_16x16x32_bf16 v[84:87], a[212:215], v[180:183], v[84:87]
v_mfma_f32_16x16x32_bf16 v[88:91], a[216:219], v[180:183], v[88:91]
v_mfma_f32_16x16x32_bf16 v[92:95], a[220:223], v[180:183], v[92:95]
v_mfma_f32_16x16x32_bf16 a[232:235], a[244:247], v[180:183], a[232:235]
s_branch att_epi0
qs_h1_8:
s_lshl_b32 s40, s52, 16
v_add_u32 v164, s40, v209
s_lshl_b32 s40, s52, 12
s_add_u32 s40, s40, 131072
v_add_u32 v165, s40, v209
ds_read_b128 a[0:3], v164 offset:52224
ds_read_b128 a[4:7], v164 offset:53248
ds_read_b128 a[20:23], v165
ds_read_b128 a[24:27], v165 offset:1024
ds_read_b128 a[40:43], v164 offset:60416
ds_read_b128 a[44:47], v164 offset:61440
ds_read_b128 a[60:63], v165 offset:2048
ds_read_b128 a[64:67], v165 offset:3072
s_waitcnt lgkmcnt(0)
s_barrier
s_add_u32 s40, s34, s32
s_and_b32 s40, s40, 31
s_lshl_b32 s40, s40, 13
s_lshr_b32 s41, s34, 5
s_lshl_b32 s41, s41, 19
s_add_u32 s40, s40, s41
s_add_u32 s35, s40, s33
s_add_u32 s34, s34, 1
s_add_u32 m0, s37, 32768
s_nop 0
buffer_load_dwordx4 v203, s[16:19], s35 offen nt lds
buffer_load_dwordx4 v204, s[16:19], s35 offen offset:1024 nt lds
buffer_load_dwordx4 v205, s[16:19], s35 offen offset:2048 nt lds
buffer_load_dwordx4 v206, s[16:19], s35 offen offset:3072 nt lds
s_add_u32 m0, s37, 40960
s_nop 0
buffer_load_dwordx4 v207, s[20:23], s35 offen nt lds
buffer_load_dwordx4 v208, s[20:23], s35 offen offset:1024 nt lds
buffer_load_dwordx4 v207, s[20:23], s35 offen offset:2048 nt lds
buffer_load_dwordx4 v208, s[20:23], s35 offen offset:3072 nt lds
s_waitcnt vmcnt(20)
s_barrier
ds_read_b128 a[160:163], v191
ds_read_b128 a[176:179], v191 offset:4096
ds_read_b128 a[164:167], v192
ds_read_b128 a[180:183], v192 offset:4096
ds_read_b128 a[168:171], v193
ds_read_b128 a[184:187], v193 offset:4096
ds_read_b128 a[172:175], v194
ds_read_b128 a[188:191], v194 offset:4096
v_mov_b32 v32, 0
v_mov_b32 v33, 0
v_mov_b32 v34, 0
v_mov_b32 v35, 0
v_mov_b32 v36, 0
v_mov_b32 v37, 0
v_mov_b32 v38, 0
v_mov_b32 v39, 0
v_mov_b32 v40, 0
v_mov_b32 v41, 0
v_mov_b32 v42, 0
v_mov_b32 v43, 0
v_mov_b32 v44, 0
v_mov_b32 v45, 0
v_mov_b32 v46, 0
v_mov_b32 v47, 0
v_mov_b32 v48, 0
v_mov_b32 v49, 0
v_mov_b32 v50, 0
v_mov_b32 v51, 0
v_mov_b32 v52, 0
v_mov_b32 v53, 0
v_mov_b32 v54, 0
v_mov_b32 v55, 0
v_mov_b32 v56, 0
v_mov_b32 v57, 0
v_mov_b32 v58, 0
v_mov_b32 v59, 0
v_mov_b32 v60, 0
v_mov_b32 v61, 0
v_mov_b32 v62, 0
v_mov_b32 v63, 0
v_mov_b32 v189, 0
v_accvgpr_write_b32 a228, v189
v_accvgpr_write_b32 a229, v189
v_accvgpr_write_b32 a230, v189
v_accvgpr_write_b32 a231, v189
s_waitcnt lgkmcnt(0)
v_mfma_f32_16x16x32_bf16 v[160:163], a[160:163], a[0:3], 0
v_mfma_f32_16x16x32_bf16 v[164:167], a[176:179], a[0:3], 0
v_mfma_f32_16x16x32_bf16 v[160:163], a[164:167], a[20:23], v[160:163]
v_mfma_f32_16x16x32_bf16 v[164:167], a[180:183], a[20:23], v[164:167]
v_mfma_f32_16x16x32_bf16 v[160:163], a[168:171], a[40:43], v[160:163]
v_mfma_f32_16x16x32_bf16 v[164:167], a[184:187], a[40:43], v[164:167]
v_mfma_f32_16x16x32_bf16 v[160:163], a[172:175], a[60:63], v[160:163]
v_mfma_f32_16x16x32_bf16 v[164:167], a[188:191], a[60:63], v[164:167]
s_waitcnt vmcnt(16)
s_waitcnt vmcnt(12)
s_barrier
s_nop 3
v_max3_f32 v189, v160, v161, v162
v_max3_f32 v190, v163, v164, v165
ds_read_b64_tr_b16 a[192:193], v195 offset:8192
ds_read_b64_tr_b16 a[194:195], v195 offset:12288
s_add_u32 s40, s34, s32
s_and_b32 s40, s40, 31
s_lshl_b32 s40, s40, 13
s_lshr_b32 s41, s34, 5
s_lshl_b32 s41, s41, 19
s_add_u32 s40, s40, s41
s_add_u32 s35, s40, s33
s_add_u32 s34, s34, 1
s_add_u32 m0, s37, 49152
s_nop 0
buffer_load_dwordx4 v203, s[16:19], s35 offen nt lds
ds_read_b64_tr_b16 a[196:197], v196 offset:8192
ds_read_b64_tr_b16 a[198:199], v196 offset:12288
ds_read_b64_tr_b16 a[200:201], v197 offset:8192
ds_read_b64_tr_b16 a[202:203], v197 offset:12288
buffer_load_dwordx4 v204, s[16:19], s35 offen offset:1024 nt lds
ds_read_b64_tr_b16 a[204:205], v198 offset:8192
ds_read_b64_tr_b16 a[206:207], v198 offset:12288
ds_read_b64_tr_b16 a[208:209], v199 offset:8192
ds_read_b64_tr_b16 a[210:211], v199 offset:12288
buffer_load_dwordx4 v205, s[16:19], s35 offen offset:2048 nt lds
v_max3_f32 v189, v189, v166, v167
v_max_f32 v189, v189, v190
ds_read_b64_tr_b16 a[212:213], v200 offset:8192
ds_read_b64_tr_b16 a[214:215], v200 offset:12288
v_mov_b32 v190, v189
s_nop 1
v_permlane32_swap_b32 v189, v190
v_max_f32 v189, v189, v190
ds_read_b64_tr_b16 a[216:217], v201 offset:8192
ds_read_b64_tr_b16 a[218:219], v201 offset:12288
buffer_load_dwordx4 v206, s[16:19], s35 offen offset:3072 nt lds
v_mov_b32 v190, v189
s_nop 1
v_permlane16_swap_b32 v189, v190
ds_read_b64_tr_b16 a[220:221], v202 offset:8192
ds_read_b64_tr_b16 a[222:223], v202 offset:12288
v_max_f32 v189, v189, v190
v_mul_f32 v184, s28, v189
v_fma_f32 v160, v160, s28, -v184
v_fma_f32 v161, v161, s28, -v184
v_mfma_f32_16x16x32_bf16 v[168:171], a[160:163], a[4:7], 0
ds_read_b128 a[160:163], v191 offset:16384
v_fma_f32 v162, v162, s28, -v184
v_fma_f32 v163, v163, s28, -v184
v_fma_f32 v164, v164, s28, -v184
v_fma_f32 v165, v165, s28, -v184
v_mfma_f32_16x16x32_bf16 v[172:175], a[176:179], a[4:7], 0
ds_read_b128 a[176:179], v191 offset:20480
s_add_u32 m0, s37, 57344
s_nop 0
buffer_load_dwordx4 v207, s[20:23], s35 offen nt lds
v_fma_f32 v166, v166, s28, -v184
v_mfma_f32_16x16x32_bf16 v[168:171], a[164:167], a[24:27], v[168:171]
ds_read_b128 a[164:167], v192 offset:16384
v_fma_f32 v167, v167, s28, -v184
v_exp_f32 v160, v160
v_mfma_f32_16x16x32_bf16 v[172:175], a[180:183], a[24:27], v[172:175]
ds_read_b128 a[180:183], v192 offset:20480
buffer_load_dwordx4 v208, s[20:23], s35 offen offset:1024 nt lds
v_exp_f32 v161, v161
v_exp_f32 v162, v162
v_mfma_f32_16x16x32_bf16 v[168:171], a[168:171], a[44:47], v[168:171]
ds_read_b128 a[168:171], v193 offset:16384
v_exp_f32 v163, v163
v_exp_f32 v164, v164
v_mfma_f32_16x16x32_bf16 v[172:175], a[184:187], a[44:47], v[172:175]
ds_read_b128 a[184:187], v193 offset:20480
buffer_load_dwordx4 v207, s[20:23], s35 offen offset:2048 nt lds
v_exp_f32 v165, v165
v_mfma_f32_16x16x32_bf16 v[168:171], a[172:175], a[64:67], v[168:171]
ds_read_b128 a[172:175], v194 offset:16384
v_exp_f32 v166, v166
v_exp_f32 v167, v167
v_cvt_pk_bf16_f32 v176, v160, v161
v_mfma_f32_16x16x32_bf16 v[172:175], a[188:191], a[64:67], v[172:175]
ds_read_b128 a[188:191], v194 offset:20480
buffer_load_dwordx4 v208, s[20:23], s35 offen offset:3072 nt lds
v_cvt_pk_bf16_f32 v177, v162, v163
v_cvt_pk_bf16_f32 v178, v164, v165
v_cvt_pk_bf16_f32 v179, v166, v167
s_waitcnt lgkmcnt(0)
v_mfma_f32_16x16x32_bf16 v[160:163], a[160:163], a[0:3], 0
v_max3_f32 v189, v168, v169, v170
v_mfma_f32_16x16x32_bf16 v[164:167], a[176:179], a[0:3], 0
v_max3_f32 v190, v171, v172, v173
v_max3_f32 v189, v189, v174, v175
v_max_f32 v189, v189, v190
v_mfma_f32_16x16x32_bf16 v[160:163], a[164:167], a[20:23], v[160:163]
v_mov_b32 v190, v189
s_nop 1
v_permlane32_swap_b32 v189, v190
v_mfma_f32_16x16x32_bf16 v[164:167], a[180:183], a[20:23], v[164:167]
v_max_f32 v189, v189, v190
v_mov_b32 v190, v189
v_mfma_f32_16x16x32_bf16 v[160:163], a[168:171], a[40:43], v[160:163]
s_nop 0
v_permlane16_swap_b32 v189, v190
v_max_f32 v189, v189, v190
v_mul_f32 v185, s28, v189
v_mfma_f32_16x16x32_bf16 v[164:167], a[184:187], a[40:43], v[164:167]
v_fma_f32 v168, v168, s28, -v185
v_fma_f32 v169, v169, s28, -v185
v_mfma_f32_16x16x32_bf16 v[160:163], a[172:175], a[60:63], v[160:163]
v_fma_f32 v170, v170, s28, -v185
v_fma_f32 v171, v171, s28, -v185
v_mfma_f32_16x16x32_bf16 v[164:167], a[188:191], a[60:63], v[164:167]
v_fma_f32 v172, v172, s28, -v185
v_fma_f32 v173, v173, s28, -v185
v_fma_f32 v174, v174, s28, -v185
v_mfma_f32_16x16x32_bf16 v[0:3], a[192:195], v[176:179], 0
v_fma_f32 v175, v175, s28, -v185
v_exp_f32 v168, v168
v_mfma_f32_16x16x32_bf16 v[4:7], a[196:199], v[176:179], 0
v_exp_f32 v169, v169
v_mfma_f32_16x16x32_bf16 v[8:11], a[200:203], v[176:179], 0
v_exp_f32 v170, v170
v_mfma_f32_16x16x32_bf16 v[12:15], a[204:207], v[176:179], 0
v_exp_f32 v171, v171
v_mfma_f32_16x16x32_bf16 v[16:19], a[208:211], v[176:179], 0
v_exp_f32 v172, v172
v_mfma_f32_16x16x32_bf16 v[20:23], a[212:215], v[176:179], 0
v_exp_f32 v173, v173
v_mfma_f32_16x16x32_bf16 v[24:27], a[216:219], v[176:179], 0
v_exp_f32 v174, v174
v_exp_f32 v175, v175
v_mfma_f32_16x16x32_bf16 v[28:31], a[220:223], v[176:179], 0
v_cvt_pk_bf16_f32 v180, v168, v169
v_cvt_pk_bf16_f32 v181, v170, v171
v_mfma_f32_16x16x32_bf16 a[224:227], a[244:247], v[176:179], 0
v_cvt_pk_bf16_f32 v182, v172, v173
v_cvt_pk_bf16_f32 v183, v174, v175
s_mov_b32 s38, 0
loop_52:
s_waitcnt vmcnt(16)
s_waitcnt vmcnt(12)
s_barrier
v_mfma_f32_16x16x32_bf16 v[32:35], a[192:195], v[180:183], v[32:35]
ds_read_b64_tr_b16 a[192:193], v195 offset:24576
ds_read_b64_tr_b16 a[194:195], v195 offset:28672
v_mfma_f32_16x16x32_bf16 v[36:39], a[196:199], v[180:183], v[36:39]
ds_read_b64_tr_b16 a[196:197], v196 offset:24576
ds_read_b64_tr_b16 a[198:199], v196 offset:28672
s_add_u32 s40, s34, s32
s_and_b32 s40, s40, 31
s_lshl_b32 s40, s40, 13
s_lshr_b32 s41, s34, 5
s_lshl_b32 s41, s41, 19
s_add_u32 s40, s40, s41
s_add_u32 s35, s40, s33
s_add_u32 s34, s34, 1
s_add_u32 m0, s37, 0
s_nop 0
buffer_load_dwordx4 v203, s[16:19], s35 offen nt lds
v_mfma_f32_16x16x32_bf16 v[40:43], a[200:203], v[180:183], v[40:43]
ds_read_b64_tr_b16 a[200:201], v197 offset:24576
ds_read_b64_tr_b16 a[202:203], v197 offset:28672
v_mfma_f32_16x16x32_bf16 v[44:47], a[204:207], v[180:183], v[44:47]
ds_read_b64_tr_b16 a[204:205], v198 offset:24576
ds_read_b64_tr_b16 a[206:207], v198 offset:28672
buffer_load_dwordx4 v204, s[16:19], s35 offen offset:1024 nt lds
v_mfma_f32_16x16x32_bf16 v[48:51], a[208:211], v[180:183], v[48:51]
ds_read_b64_tr_b16 a[208:209], v199 offset:24576
ds_read_b64_tr_b16 a[210:211], v199 offset:28672
v_mfma_f32_16x16x32_bf16 v[52:55], a[212:215], v[180:183], v[52:55]
ds_read_b64_tr_b16 a[212:213], v200 offset:24576
ds_read_b64_tr_b16 a[214:215], v200 offset:28672
buffer_load_dwordx4 v205, s[16:19], s35 offen offset:2048 nt lds
v_fma_f32 v160, v160, s28, -v184
v_mfma_f32_16x16x32_bf16 v[56:59], a[216:219], v[180:183], v[56:59]
ds_read_b64_tr_b16 a[216:217], v201 offset:24576
ds_read_b64_tr_b16 a[218:219], v201 offset:28672
v_fma_f32 v161, v161, s28, -v184
v_fma_f32 v162, v162, s28, -v184
v_mfma_f32_16x16x32_bf16 v[60:63], a[220:223], v[180:183], v[60:63]
ds_read_b64_tr_b16 a[220:221], v202 offset:24576
ds_read_b64_tr_b16 a[222:223], v202 offset:28672
buffer_load_dwordx4 v206, s[16:19], s35 offen offset:3072 nt lds
v_fma_f32 v163, v163, s28, -v184
v_fma_f32 v164, v164, s28, -v184
v_mfma_f32_16x16x32_bf16 a[228:231], a[244:247], v[180:183], a[228:231]
v_fma_f32 v165, v165, s28, -v184
v_fma_f32 v166, v166, s28, -v184
v_fma_f32 v167, v167, s28, -v184
v_max3_f32 v189, v160, v161, v162
v_max3_f32 v190, v163, v164, v165
v_mfma_f32_16x16x32_bf16 v[168:171], a[160:163], a[4:7], 0
ds_read_b128 a[160:163], v191 offset:32768
v_max3_f32 v189, v189, v166, v167
v_max_f32 v189, v189, v190
v_cmp_lt_f32 vcc, 0x41000000, v189
s_cbranch_vccnz stub_53
back_54:
v_mfma_f32_16x16x32_bf16 v[172:175], a[176:179], a[4:7], 0
ds_read_b128 a[176:179], v191 offset:36864
s_add_u32 m0, s37, 8192
s_nop 0
buffer_load_dwordx4 v207, s[20:23], s35 offen nt lds
v_mfma_f32_16x16x32_bf16 v[168:171], a[164:167], a[24:27], v[168:171]
ds_read_b128 a[164:167], v192 offset:32768
v_exp_f32 v160, v160
v_exp_f32 v161, v161
v_mfma_f32_16x16x32_bf16 v[172:175], a[180:183], a[24:27], v[172:175]
ds_read_b128 a[180:183], v192 offset:36864
buffer_load_dwordx4 v208, s[20:23], s35 offen offset:1024 nt lds
v_exp_f32 v162, v162
v_mfma_f32_16x16x32_bf16 v[168:171], a[168:171], a[44:47], v[168:171]
ds_read_b128 a[168:171], v193 offset:32768
v_exp_f32 v163, v163
v_exp_f32 v164, v164
v_mfma_f32_16x16x32_bf16 v[172:175], a[184:187], a[44:47], v[172:175]
ds_read_b128 a[184:187], v193 offset:36864
buffer_load_dwordx4 v207, s[20:23], s35 offen offset:2048 nt lds
v_exp_f32 v165, v165
v_exp_f32 v166, v166
v_mfma_f32_16x16x32_bf16 v[168:171], a[172:175], a[64:67], v[168:171]
ds_read_b128 a[172:175], v194 offset:32768
v_exp_f32 v167, v167
v_cvt_pk_bf16_f32 v176, v160, v161
v_mfma_f32_16x16x32_bf16 v[172:175], a[188:191], a[64:67], v[172:175]
ds_read_b128 a[188:191], v194 offset:36864
buffer_load_dwordx4 v208, s[20:23], s35 offen offset:3072 nt lds
v_cvt_pk_bf16_f32 v177, v162, v163
v_cvt_pk_bf16_f32 v178, v164, v165
v_cvt_pk_bf16_f32 v179, v166, v167
s_waitcnt lgkmcnt(0)
v_mfma_f32_16x16x32_bf16 v[160:163], a[160:163], a[0:3], 0
v_fma_f32 v168, v168, s28, -v185
v_mfma_f32_16x16x32_bf16 v[164:167], a[176:179], a[0:3], 0
v_fma_f32 v169, v169, s28, -v185
v_fma_f32 v170, v170, s28, -v185
v_mfma_f32_16x16x32_bf16 v[160:163], a[164:167], a[20:23], v[160:163]
v_fma_f32 v171, v171, s28, -v185
v_fma_f32 v172, v172, s28, -v185
v_mfma_f32_16x16x32_bf16 v[164:167], a[180:183], a[20:23], v[164:167]
v_fma_f32 v173, v173, s28, -v185
v_fma_f32 v174, v174, s28, -v185
v_mfma_f32_16x16x32_bf16 v[160:163], a[168:171], a[40:43], v[160:163]
v_fma_f32 v175, v175, s28, -v185
v_max3_f32 v189, v168, v169, v170
v_mfma_f32_16x16x32_bf16 v[164:167], a[184:187], a[40:43], v[164:167]
v_max3_f32 v190, v171, v172, v173
v_max3_f32 v189, v189, v174, v175
v_mfma_f32_16x16x32_bf16 v[160:163], a[172:175], a[60:63], v[160:163]
v_max_f32 v189, v189, v190
v_cmp_lt_f32 vcc, 0x41000000, v189
v_mfma_f32_16x16x32_bf16 v[164:167], a[188:191], a[60:63], v[164:167]
s_cbranch_vccnz stub_55
back_56:
v_exp_f32 v168, v168
v_mfma_f32_16x16x32_bf16 v[0:3], a[192:195], v[176:179], v[0:3]
v_exp_f32 v169, v169
v_mfma_f32_16x16x32_bf16 v[4:7], a[196:199], v[176:179], v[4:7]
v_exp_f32 v170, v170
v_mfma_f32_16x16x32_bf16 v[8:11], a[200:203], v[176:179], v[8:11]
v_exp_f32 v171, v171
v_mfma_f32_16x16x32_bf16 v[12:15], a[204:207], v[176:179], v[12:15]
v_exp_f32 v172, v172
v_mfma_f32_16x16x32_bf16 v[16:19], a[208:211], v[176:179], v[16:19]
v_exp_f32 v173, v173
v_mfma_f32_16x16x32_bf16 v[20:23], a[212:215], v[176:179], v[20:23]
v_exp_f32 v174, v174
v_mfma_f32_16x16x32_bf16 v[24:27], a[216:219], v[176:179], v[24:27]
v_exp_f32 v175, v175
v_mfma_f32_16x16x32_bf16 v[28:31], a[220:223], v[176:179], v[28:31]
v_cvt_pk_bf16_f32 v180, v168, v169
v_cvt_pk_bf16_f32 v181, v170, v171
v_mfma_f32_16x16x32_bf16 a[224:227], a[244:247], v[176:179], a[224:227]
v_cvt_pk_bf16_f32 v182, v172, v173
v_cvt_pk_bf16_f32 v183, v174, v175
s_waitcnt vmcnt(16)
s_waitcnt vmcnt(12)
s_barrier
v_mfma_f32_16x16x32_bf16 v[32:35], a[192:195], v[180:183], v[32:35]
ds_read_b64_tr_b16 a[192:193], v195 offset:40960
ds_read_b64_tr_b16 a[194:195], v195 offset:45056
v_mfma_f32_16x16x32_bf16 v[36:39], a[196:199], v[180:183], v[36:39]
ds_read_b64_tr_b16 a[196:197], v196 offset:40960
ds_read_b64_tr_b16 a[198:199], v196 offset:45056
s_add_u32 s40, s34, s32
s_and_b32 s40, s40, 31
s_lshl_b32 s40, s40, 13
s_lshr_b32 s41, s34, 5
s_lshl_b32 s41, s41, 19
s_add_u32 s40, s40, s41
s_add_u32 s35, s40, s33
s_add_u32 s34, s34, 1
s_add_u32 m0, s37, 16384
s_nop 0
buffer_load_dwordx4 v203, s[16:19], s35 offen nt lds
v_mfma_f32_16x16x32_bf16 v[40:43], a[200:203], v[180:183], v[40:43]
ds_read_b64_tr_b16 a[200:201], v197 offset:40960
ds_read_b64_tr_b16 a[202:203], v197 offset:45056
v_mfma_f32_16x16x32_bf16 v[44:47], a[204:207], v[180:183], v[44:47]
ds_read_b64_tr_b16 a[204:205], v198 offset:40960
ds_read_b64_tr_b16 a[206:207], v198 offset:45056
buffer_load_dwordx4 v204, s[16:19], s35 offen offset:1024 nt lds
v_mfma_f32_16x16x32_bf16 v[48:51], a[208:211], v[180:183], v[48:51]
ds_read_b64_tr_b16 a[208:209], v199 offset:40960
ds_read_b64_tr_b16 a[210:211], v199 offset:45056
v_mfma_f32_16x16x32_bf16 v[52:55], a[212:215], v[180:183], v[52:55]
ds_read_b64_tr_b16 a[212:213], v200 offset:40960
ds_read_b64_tr_b16 a[214:215], v200 offset:45056
buffer_load_dwordx4 v205, s[16:19], s35 offen offset:2048 nt lds
v_fma_f32 v160, v160, s28, -v184
v_mfma_f32_16x16x32_bf16 v[56:59], a[216:219], v[180:183], v[56:59]
ds_read_b64_tr_b16 a[216:217], v201 offset:40960
ds_read_b64_tr_b16 a[218:219], v201 offset:45056
v_fma_f32 v161, v161, s28, -v184
v_fma_f32 v162, v162, s28, -v184
v_mfma_f32_16x16x32_bf16 v[60:63], a[220:223], v[180:183], v[60:63]
ds_read_b64_tr_b16 a[220:221], v202 offset:40960
ds_read_b64_tr_b16 a[222:223], v202 offset:45056
buffer_load_dwordx4 v206, s[16:19], s35 offen offset:3072 nt lds
v_fma_f32 v163, v163, s28, -v184
v_fma_f32 v164, v164, s28, -v184
v_mfma_f32_16x16x32_bf16 a[228:231], a[244:247], v[180:183], a[228:231]
v_fma_f32 v165, v165, s28, -v184
v_fma_f32 v166, v166, s28, -v184
v_fma_f32 v167, v167, s28, -v184
v_max3_f32 v189, v160, v161, v162
v_max3_f32 v190, v163, v164, v165
v_mfma_f32_16x16x32_bf16 v[168:171], a[160:163], a[4:7], 0
ds_read_b128 a[160:163], v191 offset:49152
v_max3_f32 v189, v189, v166, v167
v_max_f32 v189, v189, v190
v_cmp_lt_f32 vcc, 0x41000000, v189
s_cbranch_vccnz stub_57
back_58:
v_mfma_f32_16x16x32_bf16 v[172:175], a[176:179], a[4:7], 0
ds_read_b128 a[176:179], v191 offset:53248
s_add_u32 m0, s37, 24576
s_nop 0
buffer_load_dwordx4 v207, s[20:23], s35 offen nt lds
v_mfma_f32_16x16x32_bf16 v[168:171], a[164:167], a[24:27], v[168:171]
ds_read_b128 a[164:167], v192 offset:49152
v_exp_f32 v160, v160
v_exp_f32 v161, v161
v_mfma_f32_16x16x32_bf16 v[172:175], a[180:183], a[24:27], v[172:175]
ds_read_b128 a[180:183], v192 offset:53248
buffer_load_dwordx4 v208, s[20:23], s35 offen offset:1024 nt lds
v_exp_f32 v162, v162
v_mfma_f32_16x16x32_bf16 v[168:171], a[168:171], a[44:47], v[168:171]
ds_read_b128 a[168:171], v193 offset:49152
v_exp_f32 v163, v163
v_exp_f32 v164, v164
v_mfma_f32_16x16x32_bf16 v[172:175], a[184:187], a[44:47], v[172:175]
ds_read_b128 a[184:187], v193 offset:53248
buffer_load_dwordx4 v207, s[20:23], s35 offen offset:2048 nt lds
v_exp_f32 v165, v165
v_exp_f32 v166, v166
v_mfma_f32_16x16x32_bf16 v[168:171], a[172:175], a[64:67], v[168:171]
ds_read_b128 a[172:175], v194 offset:49152
v_exp_f32 v167, v167
v_cvt_pk_bf16_f32 v176, v160, v161
v_mfma_f32_16x16x32_bf16 v[172:175], a[188:191], a[64:67], v[172:175]
ds_read_b128 a[188:191], v194 offset:53248
buffer_load_dwordx4 v208, s[20:23], s35 offen offset:3072 nt lds
v_cvt_pk_bf16_f32 v177, v162, v163
v_cvt_pk_bf16_f32 v178, v164, v165
v_cvt_pk_bf16_f32 v179, v166, v167
s_waitcnt lgkmcnt(0)
v_mfma_f32_16x16x32_bf16 v[160:163], a[160:163], a[0:3], 0
v_fma_f32 v168, v168, s28, -v185
v_mfma_f32_16x16x32_bf16 v[164:167], a[176:179], a[0:3], 0
v_fma_f32 v169, v169, s28, -v185
v_fma_f32 v170, v170, s28, -v185
v_mfma_f32_16x16x32_bf16 v[160:163], a[164:167], a[20:23], v[160:163]
v_fma_f32 v171, v171, s28, -v185
v_fma_f32 v172, v172, s28, -v185
v_mfma_f32_16x16x32_bf16 v[164:167], a[180:183], a[20:23], v[164:167]
v_fma_f32 v173, v173, s28, -v185
v_fma_f32 v174, v174, s28, -v185
v_mfma_f32_16x16x32_bf16 v[160:163], a[168:171], a[40:43], v[160:163]
v_fma_f32 v175, v175, s28, -v185
v_max3_f32 v189, v168, v169, v170
v_mfma_f32_16x16x32_bf16 v[164:167], a[184:187], a[40:43], v[164:167]
v_max3_f32 v190, v171, v172, v173
v_max3_f32 v189, v189, v174, v175
v_mfma_f32_16x16x32_bf16 v[160:163], a[172:175], a[60:63], v[160:163]
v_max_f32 v189, v189, v190
v_cmp_lt_f32 vcc, 0x41000000, v189
v_mfma_f32_16x16x32_bf16 v[164:167], a[188:191], a[60:63], v[164:167]
s_cbranch_vccnz stub_59
back_60:
v_exp_f32 v168, v168
v_mfma_f32_16x16x32_bf16 v[0:3], a[192:195], v[176:179], v[0:3]
v_exp_f32 v169, v169
v_mfma_f32_16x16x32_bf16 v[4:7], a[196:199], v[176:179], v[4:7]
v_exp_f32 v170, v170
v_mfma_f32_16x16x32_bf16 v[8:11], a[200:203], v[176:179], v[8:11]
v_exp_f32 v171, v171
v_mfma_f32_16x16x32_bf16 v[12:15], a[204:207], v[176:179], v[12:15]
v_exp_f32 v172, v172
v_mfma_f32_16x16x32_bf16 v[16:19], a[208:211], v[176:179], v[16:19]
v_exp_f32 v173, v173
v_mfma_f32_16x16x32_bf16 v[20:23], a[212:215], v[176:179], v[20:23]
v_exp_f32 v174, v174
v_mfma_f32_16x16x32_bf16 v[24:27], a[216:219], v[176:179], v[24:27]
v_exp_f32 v175, v175
v_mfma_f32_16x16x32_bf16 v[28:31], a[220:223], v[176:179], v[28:31]
v_cvt_pk_bf16_f32 v180, v168, v169
v_cvt_pk_bf16_f32 v181, v170, v171
v_mfma_f32_16x16x32_bf16 a[224:227], a[244:247], v[176:179], a[224:227]
v_cvt_pk_bf16_f32 v182, v172, v173
v_cvt_pk_bf16_f32 v183, v174, v175
s_waitcnt vmcnt(16)
s_waitcnt vmcnt(12)
s_barrier
v_mfma_f32_16x16x32_bf16 v[32:35], a[192:195], v[180:183], v[32:35]
ds_read_b64_tr_b16 a[192:193], v195 offset:57344
ds_read_b64_tr_b16 a[194:195], v195 offset:61440
v_mfma_f32_16x16x32_bf16 v[36:39], a[196:199], v[180:183], v[36:39]
ds_read_b64_tr_b16 a[196:197], v196 offset:57344
ds_read_b64_tr_b16 a[198:199], v196 offset:61440
s_add_u32 s40, s34, s32
s_and_b32 s40, s40, 31
s_lshl_b32 s40, s40, 13
s_lshr_b32 s41, s34, 5
s_lshl_b32 s41, s41, 19
s_add_u32 s40, s40, s41
s_add_u32 s35, s40, s33
s_add_u32 s34, s34, 1
s_add_u32 m0, s37, 32768
s_nop 0
buffer_load_dwordx4 v203, s[16:19], s35 offen nt lds
v_mfma_f32_16x16x32_bf16 v[40:43], a[200:203], v[180:183], v[40:43]
ds_read_b64_tr_b16 a[200:201], v197 offset:57344
ds_read_b64_tr_b16 a[202:203], v197 offset:61440
v_mfma_f32_16x16x32_bf16 v[44:47], a[204:207], v[180:183], v[44:47]
ds_read_b64_tr_b16 a[204:205], v198 offset:57344
ds_read_b64_tr_b16 a[206:207], v198 offset:61440
buffer_load_dwordx4 v204, s[16:19], s35 offen offset:1024 nt lds
v_mfma_f32_16x16x32_bf16 v[48:51], a[208:211], v[180:183], v[48:51]
ds_read_b64_tr_b16 a[208:209], v199 offset:57344
ds_read_b64_tr_b16 a[210:211], v199 offset:61440
v_mfma_f32_16x16x32_bf16 v[52:55], a[212:215], v[180:183], v[52:55]
ds_read_b64_tr_b16 a[212:213], v200 offset:57344
ds_read_b64_tr_b16 a[214:215], v200 offset:61440
buffer_load_dwordx4 v205, s[16:19], s35 offen offset:2048 nt lds
v_fma_f32 v160, v160, s28, -v184
v_mfma_f32_16x16x32_bf16 v[56:59], a[216:219], v[180:183], v[56:59]
ds_read_b64_tr_b16 a[216:217], v201 offset:57344
ds_read_b64_tr_b16 a[218:219], v201 offset:61440
v_fma_f32 v161, v161, s28, -v184
v_fma_f32 v162, v162, s28, -v184
v_mfma_f32_16x16x32_bf16 v[60:63], a[220:223], v[180:183], v[60:63]
ds_read_b64_tr_b16 a[220:221], v202 offset:57344
ds_read_b64_tr_b16 a[222:223], v202 offset:61440
buffer_load_dwordx4 v206, s[16:19], s35 offen offset:3072 nt lds
v_fma_f32 v163, v163, s28, -v184
v_fma_f32 v164, v164, s28, -v184
v_mfma_f32_16x16x32_bf16 a[228:231], a[244:247], v[180:183], a[228:231]
v_fma_f32 v165, v165, s28, -v184
v_fma_f32 v166, v166, s28, -v184
v_fma_f32 v167, v167, s28, -v184
v_max3_f32 v189, v160, v161, v162
v_max3_f32 v190, v163, v164, v165
v_mfma_f32_16x16x32_bf16 v[168:171], a[160:163], a[4:7], 0
ds_read_b128 a[160:163], v191
v_max3_f32 v189, v189, v166, v167
v_max_f32 v189, v189, v190
v_cmp_lt_f32 vcc, 0x41000000, v189
s_cbranch_vccnz stub_61
back_62:
v_mfma_f32_16x16x32_bf16 v[172:175], a[176:179], a[4:7], 0
ds_read_b128 a[176:179], v191 offset:4096
s_add_u32 m0, s37, 40960
s_nop 0
buffer_load_dwordx4 v207, s[20:23], s35 offen nt lds
v_mfma_f32_16x16x32_bf16 v[168:171], a[164:167], a[24:27], v[168:171]
ds_read_b128 a[164:167], v192
v_exp_f32 v160, v160
v_exp_f32 v161, v161
v_mfma_f32_16x16x32_bf16 v[172:175], a[180:183], a[24:27], v[172:175]
ds_read_b128 a[180:183], v192 offset:4096
buffer_load_dwordx4 v208, s[20:23], s35 offen offset:1024 nt lds
v_exp_f32 v162, v162
v_mfma_f32_16x16x32_bf16 v[168:171], a[168:171], a[44:47], v[168:171]
ds_read_b128 a[168:171], v193
v_exp_f32 v163, v163
v_exp_f32 v164, v164
v_mfma_f32_16x16x32_bf16 v[172:175], a[184:187], a[44:47], v[172:175]
ds_read_b128 a[184:187], v193 offset:4096
buffer_load_dwordx4 v207, s[20:23], s35 offen offset:2048 nt lds
v_exp_f32 v165, v165
v_exp_f32 v166, v166
v_mfma_f32_16x16x32_bf16 v[168:171], a[172:175], a[64:67], v[168:171]
ds_read_b128 a[172:175], v194
v_exp_f32 v167, v167
v_cvt_pk_bf16_f32 v176, v160, v161
v_mfma_f32_16x16x32_bf16 v[172:175], a[188:191], a[64:67], v[172:175]
ds_read_b128 a[188:191], v194 offset:4096
buffer_load_dwordx4 v208, s[20:23], s35 offen offset:3072 nt lds
v_cvt_pk_bf16_f32 v177, v162, v163
v_cvt_pk_bf16_f32 v178, v164, v165
v_cvt_pk_bf16_f32 v179, v166, v167
s_waitcnt lgkmcnt(0)
v_mfma_f32_16x16x32_bf16 v[160:163], a[160:163], a[0:3], 0
v_fma_f32 v168, v168, s28, -v185
v_mfma_f32_16x16x32_bf16 v[164:167], a[176:179], a[0:3], 0
v_fma_f32 v169, v169, s28, -v185
v_fma_f32 v170, v170, s28, -v185
v_mfma_f32_16x16x32_bf16 v[160:163], a[164:167], a[20:23], v[160:163]
v_fma_f32 v171, v171, s28, -v185
v_fma_f32 v172, v172, s28, -v185
v_mfma_f32_16x16x32_bf16 v[164:167], a[180:183], a[20:23], v[164:167]
v_fma_f32 v173, v173, s28, -v185
v_fma_f32 v174, v174, s28, -v185
v_mfma_f32_16x16x32_bf16 v[160:163], a[168:171], a[40:43], v[160:163]
v_fma_f32 v175, v175, s28, -v185
v_max3_f32 v189, v168, v169, v170
v_mfma_f32_16x16x32_bf16 v[164:167], a[184:187], a[40:43], v[164:167]
v_max3_f32 v190, v171, v172, v173
v_max3_f32 v189, v189, v174, v175
v_mfma_f32_16x16x32_bf16 v[160:163], a[172:175], a[60:63], v[160:163]
v_max_f32 v189, v189, v190
v_cmp_lt_f32 vcc, 0x41000000, v189
v_mfma_f32_16x16x32_bf16 v[164:167], a[188:191], a[60:63], v[164:167]
s_cbranch_vccnz stub_63
back_64:
v_exp_f32 v168, v168
v_mfma_f32_16x16x32_bf16 v[0:3], a[192:195], v[176:179], v[0:3]
v_exp_f32 v169, v169
v_mfma_f32_16x16x32_bf16 v[4:7], a[196:199], v[176:179], v[4:7]
v_exp_f32 v170, v170
v_mfma_f32_16x16x32_bf16 v[8:11], a[200:203], v[176:179], v[8:11]
v_exp_f32 v171, v171
v_mfma_f32_16x16x32_bf16 v[12:15], a[204:207], v[176:179], v[12:15]
v_exp_f32 v172, v172
v_mfma_f32_16x16x32_bf16 v[16:19], a[208:211], v[176:179], v[16:19]
v_exp_f32 v173, v173
v_mfma_f32_16x16x32_bf16 v[20:23], a[212:215], v[176:179], v[20:23]
v_exp_f32 v174, v174
v_mfma_f32_16x16x32_bf16 v[24:27], a[216:219], v[176:179], v[24:27]
v_exp_f32 v175, v175
v_mfma_f32_16x16x32_bf16 v[28:31], a[220:223], v[176:179], v[28:31]
v_cvt_pk_bf16_f32 v180, v168, v169
v_cvt_pk_bf16_f32 v181, v170, v171
v_mfma_f32_16x16x32_bf16 a[224:227], a[244:247], v[176:179], a[224:227]
v_cvt_pk_bf16_f32 v182, v172, v173
v_cvt_pk_bf16_f32 v183, v174, v175
s_waitcnt vmcnt(16)
s_waitcnt vmcnt(12)
s_barrier
v_mfma_f32_16x16x32_bf16 v[32:35], a[192:195], v[180:183], v[32:35]
ds_read_b64_tr_b16 a[192:193], v195 offset:8192
ds_read_b64_tr_b16 a[194:195], v195 offset:12288
v_mfma_f32_16x16x32_bf16 v[36:39], a[196:199], v[180:183], v[36:39]
ds_read_b64_tr_b16 a[196:197], v196 offset:8192
ds_read_b64_tr_b16 a[198:199], v196 offset:12288
s_add_u32 s40, s34, s32
s_and_b32 s40, s40, 31
s_lshl_b32 s40, s40, 13
s_lshr_b32 s41, s34, 5
s_lshl_b32 s41, s41, 19
s_add_u32 s40, s40, s41
s_add_u32 s35, s40, s33
s_add_u32 s34, s34, 1
s_add_u32 m0, s37, 49152
s_nop 0
buffer_load_dwordx4 v203, s[16:19], s35 offen nt lds
v_mfma_f32_16x16x32_bf16 v[40:43], a[200:203], v[180:183], v[40:43]
ds_read_b64_tr_b16 a[200:201], v197 offset:8192
ds_read_b64_tr_b16 a[202:203], v197 offset:12288
v_mfma_f32_16x16x32_bf16 v[44:47], a[204:207], v[180:183], v[44:47]
ds_read_b64_tr_b16 a[204:205], v198 offset:8192
ds_read_b64_tr_b16 a[206:207], v198 offset:12288
buffer_load_dwordx4 v204, s[16:19], s35 offen offset:1024 nt lds
v_mfma_f32_16x16x32_bf16 v[48:51], a[208:211], v[180:183], v[48:51]
ds_read_b64_tr_b16 a[208:209], v199 offset:8192
ds_read_b64_tr_b16 a[210:211], v199 offset:12288
v_mfma_f32_16x16x32_bf16 v[52:55], a[212:215], v[180:183], v[52:55]
ds_read_b64_tr_b16 a[212:213], v200 offset:8192
ds_read_b64_tr_b16 a[214:215], v200 offset:12288
buffer_load_dwordx4 v205, s[16:19], s35 offen offset:2048 nt lds
v_fma_f32 v160, v160, s28, -v184
v_mfma_f32_16x16x32_bf16 v[56:59], a[216:219], v[180:183], v[56:59]
ds_read_b64_tr_b16 a[216:217], v201 offset:8192
ds_read_b64_tr_b16 a[218:219], v201 offset:12288
v_fma_f32 v161, v161, s28, -v184
v_fma_f32 v162, v162, s28, -v184
v_mfma_f32_16x16x32_bf16 v[60:63], a[220:223], v[180:183], v[60:63]
ds_read_b64_tr_b16 a[220:221], v202 offset:8192
ds_read_b64_tr_b16 a[222:223], v202 offset:12288
buffer_load_dwordx4 v206, s[16:19], s35 offen offset:3072 nt lds
v_fma_f32 v163, v163, s28, -v184
v_fma_f32 v164, v164, s28, -v184
v_mfma_f32_16x16x32_bf16 a[228:231], a[244:247], v[180:183], a[228:231]
v_fma_f32 v165, v165, s28, -v184
v_fma_f32 v166, v166, s28, -v184
v_fma_f32 v167, v167, s28, -v184
v_max3_f32 v189, v160, v161, v162
v_max3_f32 v190, v163, v164, v165
v_mfma_f32_16x16x32_bf16 v[168:171], a[160:163], a[4:7], 0
ds_read_b128 a[160:163], v191 offset:16384
v_max3_f32 v189, v189, v166, v167
v_max_f32 v189, v189, v190
v_cmp_lt_f32 vcc, 0x41000000, v189
s_cbranch_vccnz stub_65
back_66:
v_mfma_f32_16x16x32_bf16 v[172:175], a[176:179], a[4:7], 0
ds_read_b128 a[176:179], v191 offset:20480
s_add_u32 m0, s37, 57344
s_nop 0
buffer_load_dwordx4 v207, s[20:23], s35 offen nt lds
v_mfma_f32_16x16x32_bf16 v[168:171], a[164:167], a[24:27], v[168:171]
ds_read_b128 a[164:167], v192 offset:16384
v_exp_f32 v160, v160
v_exp_f32 v161, v161
v_mfma_f32_16x16x32_bf16 v[172:175], a[180:183], a[24:27], v[172:175]
ds_read_b128 a[180:183], v192 offset:20480
buffer_load_dwordx4 v208, s[20:23], s35 offen offset:1024 nt lds
v_exp_f32 v162, v162
v_mfma_f32_16x16x32_bf16 v[168:171], a[168:171], a[44:47], v[168:171]
ds_read_b128 a[168:171], v193 offset:16384
v_exp_f32 v163, v163
v_exp_f32 v164, v164
v_mfma_f32_16x16x32_bf16 v[172:175], a[184:187], a[44:47], v[172:175]
ds_read_b128 a[184:187], v193 offset:20480
buffer_load_dwordx4 v207, s[20:23], s35 offen offset:2048 nt lds
v_exp_f32 v165, v165
v_exp_f32 v166, v166
v_mfma_f32_16x16x32_bf16 v[168:171], a[172:175], a[64:67], v[168:171]
ds_read_b128 a[172:175], v194 offset:16384
v_exp_f32 v167, v167
v_cvt_pk_bf16_f32 v176, v160, v161
v_mfma_f32_16x16x32_bf16 v[172:175], a[188:191], a[64:67], v[172:175]
ds_read_b128 a[188:191], v194 offset:20480
buffer_load_dwordx4 v208, s[20:23], s35 offen offset:3072 nt lds
v_cvt_pk_bf16_f32 v177, v162, v163
v_cvt_pk_bf16_f32 v178, v164, v165
v_cvt_pk_bf16_f32 v179, v166, v167
s_waitcnt lgkmcnt(0)
v_mfma_f32_16x16x32_bf16 v[160:163], a[160:163], a[0:3], 0
v_fma_f32 v168, v168, s28, -v185
v_mfma_f32_16x16x32_bf16 v[164:167], a[176:179], a[0:3], 0
v_fma_f32 v169, v169, s28, -v185
v_fma_f32 v170, v170, s28, -v185
v_mfma_f32_16x16x32_bf16 v[160:163], a[164:167], a[20:23], v[160:163]
v_fma_f32 v171, v171, s28, -v185
v_fma_f32 v172, v172, s28, -v185
v_mfma_f32_16x16x32_bf16 v[164:167], a[180:183], a[20:23], v[164:167]
v_fma_f32 v173, v173, s28, -v185
v_fma_f32 v174, v174, s28, -v185
v_mfma_f32_16x16x32_bf16 v[160:163], a[168:171], a[40:43], v[160:163]
v_fma_f32 v175, v175, s28, -v185
v_max3_f32 v189, v168, v169, v170
v_mfma_f32_16x16x32_bf16 v[164:167], a[184:187], a[40:43], v[164:167]
v_max3_f32 v190, v171, v172, v173
v_max3_f32 v189, v189, v174, v175
v_mfma_f32_16x16x32_bf16 v[160:163], a[172:175], a[60:63], v[160:163]
v_max_f32 v189, v189, v190
v_cmp_lt_f32 vcc, 0x41000000, v189
v_mfma_f32_16x16x32_bf16 v[164:167], a[188:191], a[60:63], v[164:167]
s_cbranch_vccnz stub_67
back_68:
v_exp_f32 v168, v168
v_mfma_f32_16x16x32_bf16 v[0:3], a[192:195], v[176:179], v[0:3]
v_exp_f32 v169, v169
v_mfma_f32_16x16x32_bf16 v[4:7], a[196:199], v[176:179], v[4:7]
v_exp_f32 v170, v170
v_mfma_f32_16x16x32_bf16 v[8:11], a[200:203], v[176:179], v[8:11]
v_exp_f32 v171, v171
v_mfma_f32_16x16x32_bf16 v[12:15], a[204:207], v[176:179], v[12:15]
v_exp_f32 v172, v172
v_mfma_f32_16x16x32_bf16 v[16:19], a[208:211], v[176:179], v[16:19]
v_exp_f32 v173, v173
v_mfma_f32_16x16x32_bf16 v[20:23], a[212:215], v[176:179], v[20:23]
v_exp_f32 v174, v174
v_mfma_f32_16x16x32_bf16 v[24:27], a[216:219], v[176:179], v[24:27]
v_exp_f32 v175, v175
v_mfma_f32_16x16x32_bf16 v[28:31], a[220:223], v[176:179], v[28:31]
v_cvt_pk_bf16_f32 v180, v168, v169
v_cvt_pk_bf16_f32 v181, v170, v171
v_mfma_f32_16x16x32_bf16 a[224:227], a[244:247], v[176:179], a[224:227]
v_cvt_pk_bf16_f32 v182, v172, v173
v_cvt_pk_bf16_f32 v183, v174, v175
s_add_u32 s38, s38, 1
s_cmp_lt_u32 s38, 7
s_cbranch_scc1 loop_52
s_waitcnt vmcnt(16)
s_waitcnt vmcnt(12)
s_barrier
v_mfma_f32_16x16x32_bf16 v[32:35], a[192:195], v[180:183], v[32:35]
ds_read_b64_tr_b16 a[192:193], v195 offset:24576
ds_read_b64_tr_b16 a[194:195], v195 offset:28672
v_mfma_f32_16x16x32_bf16 v[36:39], a[196:199], v[180:183], v[36:39]
ds_read_b64_tr_b16 a[196:197], v196 offset:24576
ds_read_b64_tr_b16 a[198:199], v196 offset:28672
s_add_u32 s40, s34, s32
s_and_b32 s40, s40, 31
s_lshl_b32 s40, s40, 13
s_lshr_b32 s41, s34, 5
s_lshl_b32 s41, s41, 19
s_add_u32 s40, s40, s41
s_add_u32 s35, s40, s33
s_add_u32 s34, s34, 1
s_add_u32 m0, s37, 0
s_nop 0
buffer_load_dwordx4 v203, s[16:19], s35 offen nt lds
v_mfma_f32_16x16x32_bf16 v[40:43], a[200:203], v[180:183], v[40:43]
ds_read_b64_tr_b16 a[200:201], v197 offset:24576
ds_read_b64_tr_b16 a[202:203], v197 offset:28672
v_mfma_f32_16x16x32_bf16 v[44:47], a[204:207], v[180:183], v[44:47]
ds_read_b64_tr_b16 a[204:205], v198 offset:24576
ds_read_b64_tr_b16 a[206:207], v198 offset:28672
buffer_load_dwordx4 v204, s[16:19], s35 offen offset:1024 nt lds
v_mfma_f32_16x16x32_bf16 v[48:51], a[208:211], v[180:183], v[48:51]
ds_read_b64_tr_b16 a[208:209], v199 offset:24576
ds_read_b64_tr_b16 a[210:211], v199 offset:28672
v_mfma_f32_16x16x32_bf16 v[52:55], a[212:215], v[180:183], v[52:55]
ds_read_b64_tr_b16 a[212:213], v200 offset:24576
ds_read_b64_tr_b16 a[214:215], v200 offset:28672
buffer_load_dwordx4 v205, s[16:19], s35 offen offset:2048 nt lds
v_fma_f32 v160, v160, s28, -v184
v_mfma_f32_16x16x32_bf16 v[56:59], a[216:219], v[180:183], v[56:59]
ds_read_b64_tr_b16 a[216:217], v201 offset:24576
ds_read_b64_tr_b16 a[218:219], v201 offset:28672
v_fma_f32 v161, v161, s28, -v184
v_fma_f32 v162, v162, s28, -v184
v_mfma_f32_16x16x32_bf16 v[60:63], a[220:223], v[180:183], v[60:63]
ds_read_b64_tr_b16 a[220:221], v202 offset:24576
ds_read_b64_tr_b16 a[222:223], v202 offset:28672
buffer_load_dwordx4 v206, s[16:19], s35 offen offset:3072 nt lds
v_fma_f32 v163, v163, s28, -v184
v_fma_f32 v164, v164, s28, -v184
v_mfma_f32_16x16x32_bf16 a[228:231], a[244:247], v[180:183], a[228:231]
v_fma_f32 v165, v165, s28, -v184
v_fma_f32 v166, v166, s28, -v184
v_fma_f32 v167, v167, s28, -v184
v_max3_f32 v189, v160, v161, v162
v_max3_f32 v190, v163, v164, v165
v_mfma_f32_16x16x32_bf16 v[168:171], a[160:163], a[4:7], 0
ds_read_b128 a[160:163], v191 offset:32768
v_max3_f32 v189, v189, v166, v167
v_max_f32 v189, v189, v190
v_cmp_lt_f32 vcc, 0x41000000, v189
s_cbranch_vccnz stub_69
back_70:
v_mfma_f32_16x16x32_bf16 v[172:175], a[176:179], a[4:7], 0
ds_read_b128 a[176:179], v191 offset:36864
s_add_u32 m0, s37, 8192
s_nop 0
buffer_load_dwordx4 v207, s[20:23], s35 offen nt lds
v_mfma_f32_16x16x32_bf16 v[168:171], a[164:167], a[24:27], v[168:171]
ds_read_b128 a[164:167], v192 offset:32768
v_exp_f32 v160, v160
v_exp_f32 v161, v161
v_mfma_f32_16x16x32_bf16 v[172:175], a[180:183], a[24:27], v[172:175]
ds_read_b128 a[180:183], v192 offset:36864
buffer_load_dwordx4 v208, s[20:23], s35 offen offset:1024 nt lds
v_exp_f32 v162, v162
v_mfma_f32_16x16x32_bf16 v[168:171], a[168:171], a[44:47], v[168:171]
ds_read_b128 a[168:171], v193 offset:32768
v_exp_f32 v163, v163
v_exp_f32 v164, v164
v_mfma_f32_16x16x32_bf16 v[172:175], a[184:187], a[44:47], v[172:175]
ds_read_b128 a[184:187], v193 offset:36864
buffer_load_dwordx4 v207, s[20:23], s35 offen offset:2048 nt lds
v_exp_f32 v165, v165
v_exp_f32 v166, v166
v_mfma_f32_16x16x32_bf16 v[168:171], a[172:175], a[64:67], v[168:171]
ds_read_b128 a[172:175], v194 offset:32768
v_exp_f32 v167, v167
v_cvt_pk_bf16_f32 v176, v160, v161
v_mfma_f32_16x16x32_bf16 v[172:175], a[188:191], a[64:67], v[172:175]
ds_read_b128 a[188:191], v194 offset:36864
buffer_load_dwordx4 v208, s[20:23], s35 offen offset:3072 nt lds
v_cvt_pk_bf16_f32 v177, v162, v163
v_cvt_pk_bf16_f32 v178, v164, v165
v_cvt_pk_bf16_f32 v179, v166, v167
s_waitcnt lgkmcnt(0)
v_mfma_f32_16x16x32_bf16 v[160:163], a[160:163], a[0:3], 0
v_fma_f32 v168, v168, s28, -v185
v_mfma_f32_16x16x32_bf16 v[164:167], a[176:179], a[0:3], 0
v_fma_f32 v169, v169, s28, -v185
v_fma_f32 v170, v170, s28, -v185
v_mfma_f32_16x16x32_bf16 v[160:163], a[164:167], a[20:23], v[160:163]
v_fma_f32 v171, v171, s28, -v185
v_fma_f32 v172, v172, s28, -v185
v_mfma_f32_16x16x32_bf16 v[164:167], a[180:183], a[20:23], v[164:167]
v_fma_f32 v173, v173, s28, -v185
v_fma_f32 v174, v174, s28, -v185
v_mfma_f32_16x16x32_bf16 v[160:163], a[168:171], a[40:43], v[160:163]
v_fma_f32 v175, v175, s28, -v185
v_max3_f32 v189, v168, v169, v170
v_mfma_f32_16x16x32_bf16 v[164:167], a[184:187], a[40:43], v[164:167]
v_max3_f32 v190, v171, v172, v173
v_max3_f32 v189, v189, v174, v175
v_mfma_f32_16x16x32_bf16 v[160:163], a[172:175], a[60:63], v[160:163]
v_max_f32 v189, v189, v190
v_cmp_lt_f32 vcc, 0x41000000, v189
v_mfma_f32_16x16x32_bf16 v[164:167], a[188:191], a[60:63], v[164:167]
s_cbranch_vccnz stub_71
back_72:
v_exp_f32 v168, v168
v_mfma_f32_16x16x32_bf16 v[0:3], a[192:195], v[176:179], v[0:3]
v_exp_f32 v169, v169
v_mfma_f32_16x16x32_bf16 v[4:7], a[196:199], v[176:179], v[4:7]
v_exp_f32 v170, v170
v_mfma_f32_16x16x32_bf16 v[8:11], a[200:203], v[176:179], v[8:11]
v_exp_f32 v171, v171
v_mfma_f32_16x16x32_bf16 v[12:15], a[204:207], v[176:179], v[12:15]
v_exp_f32 v172, v172
v_mfma_f32_16x16x32_bf16 v[16:19], a[208:211], v[176:179], v[16:19]
v_exp_f32 v173, v173
v_mfma_f32_16x16x32_bf16 v[20:23], a[212:215], v[176:179], v[20:23]
v_exp_f32 v174, v174
v_mfma_f32_16x16x32_bf16 v[24:27], a[216:219], v[176:179], v[24:27]
v_exp_f32 v175, v175
v_mfma_f32_16x16x32_bf16 v[28:31], a[220:223], v[176:179], v[28:31]
v_cvt_pk_bf16_f32 v180, v168, v169
v_cvt_pk_bf16_f32 v181, v170, v171
v_mfma_f32_16x16x32_bf16 a[224:227], a[244:247], v[176:179], a[224:227]
v_cvt_pk_bf16_f32 v182, v172, v173
v_cvt_pk_bf16_f32 v183, v174, v175
s_waitcnt vmcnt(16)
s_waitcnt vmcnt(12)
s_barrier
v_mfma_f32_16x16x32_bf16 v[32:35], a[192:195], v[180:183], v[32:35]
ds_read_b64_tr_b16 a[192:193], v195 offset:40960
ds_read_b64_tr_b16 a[194:195], v195 offset:45056
v_mfma_f32_16x16x32_bf16 v[36:39], a[196:199], v[180:183], v[36:39]
ds_read_b64_tr_b16 a[196:197], v196 offset:40960
ds_read_b64_tr_b16 a[198:199], v196 offset:45056
s_add_u32 s40, s34, s32
s_and_b32 s40, s40, 31
s_lshl_b32 s40, s40, 13
s_lshr_b32 s41, s34, 5
s_lshl_b32 s41, s41, 19
s_add_u32 s40, s40, s41
s_add_u32 s35, s40, s33
s_add_u32 s34, s34, 1
s_add_u32 m0, s37, 16384
s_nop 0
buffer_load_dwordx4 v203, s[16:19], s35 offen nt lds
v_mfma_f32_16x16x32_bf16 v[40:43], a[200:203], v[180:183], v[40:43]
ds_read_b64_tr_b16 a[200:201], v197 offset:40960
ds_read_b64_tr_b16 a[202:203], v197 offset:45056
v_mfma_f32_16x16x32_bf16 v[44:47], a[204:207], v[180:183], v[44:47]
ds_read_b64_tr_b16 a[204:205], v198 offset:40960
ds_read_b64_tr_b16 a[206:207], v198 offset:45056
buffer_load_dwordx4 v204, s[16:19], s35 offen offset:1024 nt lds
v_mfma_f32_16x16x32_bf16 v[48:51], a[208:211], v[180:183], v[48:51]
ds_read_b64_tr_b16 a[208:209], v199 offset:40960
ds_read_b64_tr_b16 a[210:211], v199 offset:45056
v_mfma_f32_16x16x32_bf16 v[52:55], a[212:215], v[180:183], v[52:55]
ds_read_b64_tr_b16 a[212:213], v200 offset:40960
ds_read_b64_tr_b16 a[214:215], v200 offset:45056
buffer_load_dwordx4 v205, s[16:19], s35 offen offset:2048 nt lds
v_fma_f32 v160, v160, s28, -v184
v_mfma_f32_16x16x32_bf16 v[56:59], a[216:219], v[180:183], v[56:59]
ds_read_b64_tr_b16 a[216:217], v201 offset:40960
ds_read_b64_tr_b16 a[218:219], v201 offset:45056
v_fma_f32 v161, v161, s28, -v184
v_fma_f32 v162, v162, s28, -v184
v_mfma_f32_16x16x32_bf16 v[60:63], a[220:223], v[180:183], v[60:63]
ds_read_b64_tr_b16 a[220:221], v202 offset:40960
ds_read_b64_tr_b16 a[222:223], v202 offset:45056
buffer_load_dwordx4 v206, s[16:19], s35 offen offset:3072 nt lds
v_fma_f32 v163, v163, s28, -v184
v_fma_f32 v164, v164, s28, -v184
v_mfma_f32_16x16x32_bf16 a[228:231], a[244:247], v[180:183], a[228:231]
v_fma_f32 v165, v165, s28, -v184
v_fma_f32 v166, v166, s28, -v184
v_fma_f32 v167, v167, s28, -v184
v_max3_f32 v189, v160, v161, v162
v_max3_f32 v190, v163, v164, v165
v_mfma_f32_16x16x32_bf16 v[168:171], a[160:163], a[4:7], 0
ds_read_b128 a[160:163], v191 offset:49152
v_max3_f32 v189, v189, v166, v167
v_max_f32 v189, v189, v190
v_cmp_lt_f32 vcc, 0x41000000, v189
s_cbranch_vccnz stub_73
back_74:
v_mfma_f32_16x16x32_bf16 v[172:175], a[176:179], a[4:7], 0
ds_read_b128 a[176:179], v191 offset:53248
s_add_u32 m0, s37, 24576
s_nop 0
buffer_load_dwordx4 v207, s[20:23], s35 offen nt lds
v_mfma_f32_16x16x32_bf16 v[168:171], a[164:167], a[24:27], v[168:171]
ds_read_b128 a[164:167], v192 offset:49152
v_exp_f32 v160, v160
v_exp_f32 v161, v161
v_mfma_f32_16x16x32_bf16 v[172:175], a[180:183], a[24:27], v[172:175]
ds_read_b128 a[180:183], v192 offset:53248
buffer_load_dwordx4 v208, s[20:23], s35 offen offset:1024 nt lds
v_exp_f32 v162, v162
v_mfma_f32_16x16x32_bf16 v[168:171], a[168:171], a[44:47], v[168:171]
ds_read_b128 a[168:171], v193 offset:49152
v_exp_f32 v163, v163
v_exp_f32 v164, v164
v_mfma_f32_16x16x32_bf16 v[172:175], a[184:187], a[44:47], v[172:175]
ds_read_b128 a[184:187], v193 offset:53248
buffer_load_dwordx4 v207, s[20:23], s35 offen offset:2048 nt lds
v_exp_f32 v165, v165
v_exp_f32 v166, v166
v_mfma_f32_16x16x32_bf16 v[168:171], a[172:175], a[64:67], v[168:171]
ds_read_b128 a[172:175], v194 offset:49152
v_exp_f32 v167, v167
v_cvt_pk_bf16_f32 v176, v160, v161
v_mfma_f32_16x16x32_bf16 v[172:175], a[188:191], a[64:67], v[172:175]
ds_read_b128 a[188:191], v194 offset:53248
buffer_load_dwordx4 v208, s[20:23], s35 offen offset:3072 nt lds
v_cvt_pk_bf16_f32 v177, v162, v163
v_cvt_pk_bf16_f32 v178, v164, v165
v_cvt_pk_bf16_f32 v179, v166, v167
s_waitcnt lgkmcnt(0)
v_mfma_f32_16x16x32_bf16 v[160:163], a[160:163], a[0:3], 0
v_fma_f32 v168, v168, s28, -v185
v_mfma_f32_16x16x32_bf16 v[164:167], a[176:179], a[0:3], 0
v_fma_f32 v169, v169, s28, -v185
v_fma_f32 v170, v170, s28, -v185
v_mfma_f32_16x16x32_bf16 v[160:163], a[164:167], a[20:23], v[160:163]
v_fma_f32 v171, v171, s28, -v185
v_fma_f32 v172, v172, s28, -v185
v_mfma_f32_16x16x32_bf16 v[164:167], a[180:183], a[20:23], v[164:167]
v_fma_f32 v173, v173, s28, -v185
v_fma_f32 v174, v174, s28, -v185
v_mfma_f32_16x16x32_bf16 v[160:163], a[168:171], a[40:43], v[160:163]
v_fma_f32 v175, v175, s28, -v185
v_max3_f32 v189, v168, v169, v170
v_mfma_f32_16x16x32_bf16 v[164:167], a[184:187], a[40:43], v[164:167]
v_max3_f32 v190, v171, v172, v173
v_max3_f32 v189, v189, v174, v175
v_mfma_f32_16x16x32_bf16 v[160:163], a[172:175], a[60:63], v[160:163]
v_max_f32 v189, v189, v190
v_cmp_lt_f32 vcc, 0x41000000, v189
v_mfma_f32_16x16x32_bf16 v[164:167], a[188:191], a[60:63], v[164:167]
s_cbranch_vccnz stub_75
back_76:
v_exp_f32 v168, v168
v_mfma_f32_16x16x32_bf16 v[0:3], a[192:195], v[176:179], v[0:3]
v_exp_f32 v169, v169
v_mfma_f32_16x16x32_bf16 v[4:7], a[196:199], v[176:179], v[4:7]
v_exp_f32 v170, v170
v_mfma_f32_16x16x32_bf16 v[8:11], a[200:203], v[176:179], v[8:11]
v_exp_f32 v171, v171
v_mfma_f32_16x16x32_bf16 v[12:15], a[204:207], v[176:179], v[12:15]
v_exp_f32 v172, v172
v_mfma_f32_16x16x32_bf16 v[16:19], a[208:211], v[176:179], v[16:19]
v_exp_f32 v173, v173
v_mfma_f32_16x16x32_bf16 v[20:23], a[212:215], v[176:179], v[20:23]
v_exp_f32 v174, v174
v_mfma_f32_16x16x32_bf16 v[24:27], a[216:219], v[176:179], v[24:27]
v_exp_f32 v175, v175
v_mfma_f32_16x16x32_bf16 v[28:31], a[220:223], v[176:179], v[28:31]
v_cvt_pk_bf16_f32 v180, v168, v169
v_cvt_pk_bf16_f32 v181, v170, v171
v_mfma_f32_16x16x32_bf16 a[224:227], a[244:247], v[176:179], a[224:227]
v_cvt_pk_bf16_f32 v182, v172, v173
v_cvt_pk_bf16_f32 v183, v174, v175
s_mul_i32 s43, s48, 36864
s_mul_i32 s42, s3, 9216
s_add_u32 s43, s43, s42
buffer_load_dwordx4 a[0:3], v209, s[60:63], s43 offen
s_add_u32 s43, s43, 1024
buffer_load_dwordx4 a[0:3], v209, s[60:63], s43 offen
s_add_u32 s43, s43, 1024
buffer_load_dwordx4 a[0:3], v209, s[60:63], s43 offen
s_add_u32 s43, s43, 1024
buffer_load_dwordx4 a[0:3], v209, s[60:63], s43 offen
s_add_u32 s43, s43, 1024
buffer_load_dwordx4 a[0:3], v209, s[60:63], s43 offen
s_add_u32 s43, s43, 1024
buffer_load_dwordx4 a[0:3], v209, s[60:63], s43 offen
s_add_u32 s43, s43, 1024
buffer_load_dwordx4 a[0:3], v209, s[60:63], s43 offen
s_add_u32 s43, s43, 1024
buffer_load_dwordx4 a[0:3], v209, s[60:63], s43 offen
s_add_u32 s43, s43, 1024
buffer_load_dwordx4 a[0:3], v209, s[60:63], s43 offen
s_add_u32 s43, s43, 1024
s_waitcnt vmcnt(25)
s_waitcnt vmcnt(21)
s_barrier
v_mfma_f32_16x16x32_bf16 v[32:35], a[192:195], v[180:183], v[32:35]
ds_read_b64_tr_b16 a[192:193], v195 offset:57344
ds_read_b64_tr_b16 a[194:195], v195 offset:61440
v_mfma_f32_16x16x32_bf16 v[36:39], a[196:199], v[180:183], v[36:39]
ds_read_b64_tr_b16 a[196:197], v196 offset:57344
ds_read_b64_tr_b16 a[198:199], v196 offset:61440
s_add_u32 s40, s34, s32
s_and_b32 s40, s40, 31
s_lshl_b32 s40, s40, 13
s_lshr_b32 s41, s34, 5
s_lshl_b32 s41, s41, 19
s_add_u32 s40, s40, s41
s_add_u32 s35, s40, s33
s_add_u32 s34, s34, 1
s_add_u32 m0, s37, 32768
s_nop 0
buffer_load_dwordx4 v203, s[16:19], s35 offen nt lds
v_mfma_f32_16x16x32_bf16 v[40:43], a[200:203], v[180:183], v[40:43]
ds_read_b64_tr_b16 a[200:201], v197 offset:57344
ds_read_b64_tr_b16 a[202:203], v197 offset:61440
v_mfma_f32_16x16x32_bf16 v[44:47], a[204:207], v[180:183], v[44:47]
ds_read_b64_tr_b16 a[204:205], v198 offset:57344
ds_read_b64_tr_b16 a[206:207], v198 offset:61440
buffer_load_dwordx4 v204, s[16:19], s35 offen offset:1024 nt lds
v_mfma_f32_16x16x32_bf16 v[48:51], a[208:211], v[180:183], v[48:51]
ds_read_b64_tr_b16 a[208:209], v199 offset:57344
ds_read_b64_tr_b16 a[210:211], v199 offset:61440
v_mfma_f32_16x16x32_bf16 v[52:55], a[212:215], v[180:183], v[52:55]
ds_read_b64_tr_b16 a[212:213], v200 offset:57344
ds_read_b64_tr_b16 a[214:215], v200 offset:61440
buffer_load_dwordx4 v205, s[16:19], s35 offen offset:2048 nt lds
v_fma_f32 v160, v160, s28, -v184
v_mfma_f32_16x16x32_bf16 v[56:59], a[216:219], v[180:183], v[56:59]
ds_read_b64_tr_b16 a[216:217], v201 offset:57344
ds_read_b64_tr_b16 a[218:219], v201 offset:61440
v_fma_f32 v161, v161, s28, -v184
v_fma_f32 v162, v162, s28, -v184
v_mfma_f32_16x16x32_bf16 v[60:63], a[220:223], v[180:183], v[60:63]
ds_read_b64_tr_b16 a[220:221], v202 offset:57344
ds_read_b64_tr_b16 a[222:223], v202 offset:61440
buffer_load_dwordx4 v206, s[16:19], s35 offen offset:3072 nt lds
v_fma_f32 v163, v163, s28, -v184
v_fma_f32 v164, v164, s28, -v184
v_mfma_f32_16x16x32_bf16 a[228:231], a[244:247], v[180:183], a[228:231]
v_fma_f32 v165, v165, s28, -v184
v_fma_f32 v166, v166, s28, -v184
v_fma_f32 v167, v167, s28, -v184
v_max3_f32 v189, v160, v161, v162
v_max3_f32 v190, v163, v164, v165
v_mfma_f32_16x16x32_bf16 v[168:171], a[160:163], a[4:7], 0
ds_read_b128 a[160:163], v191
v_max3_f32 v189, v189, v166, v167
v_max_f32 v189, v189, v190
v_cmp_lt_f32 vcc, 0x41000000, v189
s_cbranch_vccnz stub_77
back_78:
v_mfma_f32_16x16x32_bf16 v[172:175], a[176:179], a[4:7], 0
ds_read_b128 a[176:179], v191 offset:4096
s_add_u32 m0, s37, 40960
s_nop 0
buffer_load_dwordx4 v207, s[20:23], s35 offen nt lds
v_mfma_f32_16x16x32_bf16 v[168:171], a[164:167], a[24:27], v[168:171]
ds_read_b128 a[164:167], v192
v_exp_f32 v160, v160
v_exp_f32 v161, v161
v_mfma_f32_16x16x32_bf16 v[172:175], a[180:183], a[24:27], v[172:175]
ds_read_b128 a[180:183], v192 offset:4096
buffer_load_dwordx4 v208, s[20:23], s35 offen offset:1024 nt lds
v_exp_f32 v162, v162
v_mfma_f32_16x16x32_bf16 v[168:171], a[168:171], a[44:47], v[168:171]
ds_read_b128 a[168:171], v193
v_exp_f32 v163, v163
v_exp_f32 v164, v164
v_mfma_f32_16x16x32_bf16 v[172:175], a[184:187], a[44:47], v[172:175]
ds_read_b128 a[184:187], v193 offset:4096
buffer_load_dwordx4 v207, s[20:23], s35 offen offset:2048 nt lds
v_exp_f32 v165, v165
v_exp_f32 v166, v166
v_mfma_f32_16x16x32_bf16 v[168:171], a[172:175], a[64:67], v[168:171]
ds_read_b128 a[172:175], v194
v_exp_f32 v167, v167
v_cvt_pk_bf16_f32 v176, v160, v161
v_mfma_f32_16x16x32_bf16 v[172:175], a[188:191], a[64:67], v[172:175]
ds_read_b128 a[188:191], v194 offset:4096
buffer_load_dwordx4 v208, s[20:23], s35 offen offset:3072 nt lds
v_cvt_pk_bf16_f32 v177, v162, v163
v_cvt_pk_bf16_f32 v178, v164, v165
v_cvt_pk_bf16_f32 v179, v166, v167
s_waitcnt lgkmcnt(0)
v_fma_f32 v168, v168, s28, -v185
v_fma_f32 v169, v169, s28, -v185
v_fma_f32 v170, v170, s28, -v185
v_mfma_f32_16x16x32_bf16 v[0:3], a[192:195], v[176:179], v[0:3]
v_fma_f32 v171, v171, s28, -v185
v_fma_f32 v172, v172, s28, -v185
v_fma_f32 v173, v173, s28, -v185
v_mfma_f32_16x16x32_bf16 v[4:7], a[196:199], v[176:179], v[4:7]
v_fma_f32 v174, v174, s28, -v185
v_fma_f32 v175, v175, s28, -v185
v_max3_f32 v189, v168, v169, v170
v_max3_f32 v190, v171, v172, v173
v_mfma_f32_16x16x32_bf16 v[8:11], a[200:203], v[176:179], v[8:11]
v_max3_f32 v189, v189, v174, v175
v_max_f32 v189, v189, v190
v_cmp_lt_f32 vcc, 0x41000000, v189
v_mfma_f32_16x16x32_bf16 v[12:15], a[204:207], v[176:179], v[12:15]
s_cbranch_vccnz stub_79
back_80:
v_exp_f32 v168, v168
v_mfma_f32_16x16x32_bf16 v[16:19], a[208:211], v[176:179], v[16:19]
v_exp_f32 v169, v169
v_exp_f32 v170, v170
v_mfma_f32_16x16x32_bf16 v[20:23], a[212:215], v[176:179], v[20:23]
v_exp_f32 v171, v171
v_exp_f32 v172, v172
v_mfma_f32_16x16x32_bf16 v[24:27], a[216:219], v[176:179], v[24:27]
v_exp_f32 v173, v173
v_exp_f32 v174, v174
v_mfma_f32_16x16x32_bf16 v[28:31], a[220:223], v[176:179], v[28:31]
v_exp_f32 v175, v175
v_cvt_pk_bf16_f32 v180, v168, v169
v_mfma_f32_16x16x32_bf16 a[224:227], a[244:247], v[176:179], a[224:227]
v_cvt_pk_bf16_f32 v181, v170, v171
v_cvt_pk_bf16_f32 v182, v172, v173
v_cvt_pk_bf16_f32 v183, v174, v175
s_nop 1
v_mfma_f32_16x16x32_bf16 v[32:35], a[192:195], v[180:183], v[32:35]
v_mfma_f32_16x16x32_bf16 v[36:39], a[196:199], v[180:183], v[36:39]
v_mfma_f32_16x16x32_bf16 v[40:43], a[200:203], v[180:183], v[40:43]
v_mfma_f32_16x16x32_bf16 v[44:47], a[204:207], v[180:183], v[44:47]
v_mfma_f32_16x16x32_bf16 v[48:51], a[208:211], v[180:183], v[48:51]
v_mfma_f32_16x16x32_bf16 v[52:55], a[212:215], v[180:183], v[52:55]
v_mfma_f32_16x16x32_bf16 v[56:59], a[216:219], v[180:183], v[56:59]
v_mfma_f32_16x16x32_bf16 v[60:63], a[220:223], v[180:183], v[60:63]
v_mfma_f32_16x16x32_bf16 a[228:231], a[244:247], v[180:183], a[228:231]
s_branch att_epi1
s_branch att_fin
att_A:
s_load_dwordx4 s[60:63], s[0:1], 0
s_load_dwordx4 s[64:67], s[0:1], 16
s_load_dwordx2 s[50:51], s[0:1], 96
s_waitcnt lgkmcnt(0)
s_mul_i32 s40, s48, 92160
s_add_u32 s8, s60, s40
s_addc_u32 s9, s61, 0
s_and_b32 s9, s9, 0xffff
s_mov_b32 s10, 92160
s_mov_b32 s11, 0x20000
s_lshl_b32 s40, s49, 8
s_add_u32 s12, s66, s40
s_addc_u32 s13, s67, 0
s_and_b32 s13, s13, 0xffff
s_mov_b32 s14, 0
s_mov_b32 s15, 0x20000
s_sub_u32 s14, 4718592, s40
s_lshl_b32 s40, s48, 4
s_lshr_b32 s41, s49, 1
s_add_u32 s40, s40, s41
s_lshl_b32 s40, s40, 18
s_add_u32 s16, s62, s40
s_addc_u32 s17, s63, 0
s_and_b32 s17, s17, 0xffff
s_mov_b32 s18, 262144
s_mov_b32 s19, 0x20000
s_add_u32 s20, s64, s40
s_addc_u32 s21, s65, 0
s_and_b32 s21, s21, 0xffff
s_mov_b32 s22, 262144
s_mov_b32 s23, 0x20000
s_lshl_b32 s40, s48, 5
s_add_u32 s40, s40, s49
s_mul_i32 s40, s40, 20480
s_add_u32 s24, s50, s40
s_addc_u32 s25, s51, 0
s_and_b32 s25, s25, 0xffff
s_mov_b32 s26, 40960
s_mov_b32 s27, 0x20000
s_lshr_b32 s52, s3, 1
s_and_b32 s53, s3, 1
s_mov_b32 s28, 0x3e0293ee
s_mov_b32 s29, 0x41c00000
s_add_u32 s32, s47, s46
s_lshl_b32 s33, s3, 11
s_lshl_b32 s37, s3, 11
s_mov_b32 s34, 0
v_lshrrev_b32 v170, 5, v210
v_and_b32 v171, 31, v210
v_lshlrev_b32 v172, 2, v170
v_xor_b32 v172, v172, v171
v_lshlrev_b32 v172, 4, v172
v_lshlrev_b32 v173, 13, v170
v_add_u32 v172, v172, v173
v_add_u32 v152, 0, v172
v_lshlrev_b32 v172, 2, v170
v_add_u32 v172, 8, v172
v_xor_b32 v172, v172, v171
v_lshlrev_b32 v172, 4, v172
v_lshlrev_b32 v173, 13, v170
v_add_u32 v172, v172, v173
v_add_u32 v153, 15360, v172
v_lshlrev_b32 v172, 2, v170
v_xor_b32 v172, v172, v171
v_lshlrev_b32 v172, 4, v172
v_lshlrev_b32 v173, 13, v170
v_add_u32 v172, v172, v173
v_add_u32 v154, 30720, v172
v_lshlrev_b32 v172, 2, v170
v_add_u32 v172, 8, v172
v_xor_b32 v172, v172, v171
v_lshlrev_b32 v172, 4, v172
v_lshlrev_b32 v173, 13, v170
v_add_u32 v172, v172, v173
v_add_u32 v155, 46080, v172
v_lshrrev_b32 v170, 3, v210
v_mul_u32_u24 v170, 1152, v170
v_lshrrev_b32 v171, 4, v210
s_add_u32 s40, s3, 0
s_and_b32 s40, s40, 1
s_lshl_b32 s40, s40, 2
v_add_u32 v172, s40, v171
v_xor_b32 v172, v172, v210
v_and_b32 v172, 7, v172
v_lshlrev_b32 v172, 4, v172
v_add_u32 v156, v170, v172
s_add_u32 s40, s3, 1
s_and_b32 s40, s40, 1
s_lshl_b32 s40, s40, 2
v_add_u32 v172, s40, v171
v_xor_b32 v172, v172, v210
v_and_b32 v172, 7, v172
v_lshlrev_b32 v172, 4, v172
v_add_u32 v161, v170, v172
s_mov_b32 s44, 0
s_mov_b32 s45, 0
s_lshl_b32 s57, s3, 16
s_mul_i32 s58, s3, 9216
s_lshl_b32 s59, s3, 12
s_mov_b32 s54, 0
s_mov_b32 s55, 0
v_lshrrev_b32 v212, 4, v210
v_and_b32 v213, 15, v210
v_xor_b32 v214, v212, v213
v_lshlrev_b32 v215, 8, v212
s_lshl_b32 s40, s3, 1
s_add_u32 s40, s40, 0
s_and_b32 s40, s40, 3
s_lshl_b32 s40, s40, 2
v_xor_b32 v216, s40, v214
v_lshlrev_b32 v216, 4, v216
v_add_u32 v203, v215, v216
s_lshl_b32 s40, s3, 1
s_add_u32 s40, s40, 1
s_and_b32 s40, s40, 3
s_lshl_b32 s40, s40, 2
v_xor_b32 v216, s40, v214
v_lshlrev_b32 v216, 4, v216
v_add_u32 v204, v215, v216
v_lshlrev_b32 v216, 1, v212
v_add_u32 v216, 0, v216
v_xor_b32 v216, v216, v213
v_lshlrev_b32 v216, 4, v216
v_add_u32 v207, v215, v216
v_lshlrev_b32 v216, 1, v212
v_add_u32 v216, 8, v216
v_xor_b32 v216, v216, v213
v_lshlrev_b32 v216, 4, v216
v_add_u32 v208, v215, v216
v_lshrrev_b32 v170, 4, v210
v_bfe_u32 v171, v210, 2, 2
v_and_b32 v172, 3, v210
v_lshlrev_b32 v173, 3, v170
v_add_u32 v173, v173, v171
v_lshlrev_b32 v173, 9, v173
s_lshl_b32 s40, s3, 3
s_add_u32 s40, s40, 0
v_add_u32 v175, s40, v172
v_lshlrev_b32 v176, 2, v171
v_xor_b32 v175, v175, v176
v_lshlrev_b32 v175, 4, v175
v_add_u32 v157, v175, v173
v_add_u32 v159, 65536, v157
s_lshl_b32 s40, s3, 3
s_add_u32 s40, s40, 4
v_add_u32 v175, s40, v172
v_lshlrev_b32 v176, 2, v171
v_xor_b32 v175, v175, v176
v_lshlrev_b32 v175, 4, v175
v_add_u32 v158, v175, v173
v_add_u32 v160, 65536, v158
v_and_b32 v171, 15, v210
v_lshrrev_b32 v172, 1, v171
v_lshlrev_b32 v171, 7, v171
v_add_u32 v173, 0, v170
v_xor_b32 v173, v173, v172
v_lshlrev_b32 v173, 4, v173
v_add_u32 v173, v173, v171
v_add_u32 v162, 131072, v173
v_mov_b32 v167, v162
v_add_u32 v173, 4, v170
v_xor_b32 v173, v173, v172
v_lshlrev_b32 v173, 4, v173
v_add_u32 v173, v173, v171
v_add_u32 v163, 131072, v173
v_mov_b32 v168, v163
v_mov_b32 v0, 0
v_mov_b32 v1, 0
v_mov_b32 v2, 0
v_mov_b32 v3, 0
v_mov_b32 v4, 0
v_mov_b32 v5, 0
v_mov_b32 v6, 0
v_mov_b32 v7, 0
v_mov_b32 v8, 0
v_mov_b32 v9, 0
v_mov_b32 v10, 0
v_mov_b32 v11, 0
v_mov_b32 v12, 0
v_mov_b32 v13, 0
v_mov_b32 v14, 0
v_mov_b32 v15, 0
v_mov_b32 v16, 0
v_mov_b32 v17, 0
v_mov_b32 v18, 0
v_mov_b32 v19, 0
v_mov_b32 v20, 0
v_mov_b32 v21, 0
v_mov_b32 v22, 0
v_mov_b32 v23, 0
v_mov_b32 v24, 0
v_mov_b32 v25, 0
v_mov_b32 v26, 0
v_mov_b32 v27, 0
v_mov_b32 v28, 0
v_mov_b32 v29, 0
v_mov_b32 v30, 0
v_mov_b32 v31, 0
v_mov_b32 v32, 0
v_mov_b32 v33, 0
v_mov_b32 v34, 0
v_mov_b32 v35, 0
v_mov_b32 v36, 0
v_mov_b32 v37, 0
v_mov_b32 v38, 0
v_mov_b32 v39, 0
v_mov_b32 v40, 0
v_mov_b32 v41, 0
v_mov_b32 v42, 0
v_mov_b32 v43, 0
v_mov_b32 v44, 0
v_mov_b32 v45, 0
v_mov_b32 v46, 0
v_mov_b32 v47, 0
v_mov_b32 v48, 0
v_mov_b32 v49, 0
v_mov_b32 v50, 0
v_mov_b32 v51, 0
v_mov_b32 v52, 0
v_mov_b32 v53, 0
v_mov_b32 v54, 0
v_mov_b32 v55, 0
v_mov_b32 v56, 0
v_mov_b32 v57, 0
v_mov_b32 v58, 0
v_mov_b32 v59, 0
v_mov_b32 v60, 0
v_mov_b32 v61, 0
v_mov_b32 v62, 0
v_mov_b32 v63, 0
v_mov_b32 v64, 0
v_mov_b32 v65, 0
v_mov_b32 v66, 0
v_mov_b32 v67, 0
v_mov_b32 v68, 0
v_mov_b32 v69, 0
v_mov_b32 v70, 0
v_mov_b32 v71, 0
v_mov_b32 v72, 0
v_mov_b32 v73, 0
v_mov_b32 v74, 0
v_mov_b32 v75, 0
v_mov_b32 v76, 0
v_mov_b32 v77, 0
v_mov_b32 v78, 0
v_mov_b32 v79, 0
v_lshrrev_b32 v212, 4, v210
v_and_b32 v213, 15, v210
s_mov_b32 s43, 0
v_lshlrev_b32 v215, 8, v213
v_add_u32 v215, s43, v215
v_add_u32 v216, 0, v212
v_xor_b32 v216, v216, v213
v_lshlrev_b32 v216, 4, v216
v_add_u32 v191, v215, v216
v_add_u32 v216, 4, v212
v_xor_b32 v216, v216, v213
v_lshlrev_b32 v216, 4, v216
v_add_u32 v192, v215, v216
v_add_u32 v216, 8, v212
v_xor_b32 v216, v216, v213
v_lshlrev_b32 v216, 4, v216
v_add_u32 v193, v215, v216
v_add_u32 v216, 12, v212
v_xor_b32 v216, v216, v213
v_lshlrev_b32 v216, 4, v216
v_add_u32 v194, v215, v216
v_lshrrev_b32 v214, 2, v210
v_lshlrev_b32 v215, 8, v214
v_add_u32 v215, s43, v215
v_and_b32 v216, 3, v210
v_lshlrev_b32 v216, 3, v216
v_add_u32 v215, v215, v216
v_and_b32 v214, 7, v214
s_mov_b32 s41, 0
s_add_u32 s40, s41, 0
s_and_b32 s40, s40, 7
v_xor_b32 v216, s40, v214
v_lshlrev_b32 v216, 5, v216
v_add_u32 v195, v215, v216
s_add_u32 s40, s41, 1
s_and_b32 s40, s40, 7
v_xor_b32 v216, s40, v214
v_lshlrev_b32 v216, 5, v216
v_add_u32 v196, v215, v216
s_add_u32 s40, s41, 2
s_and_b32 s40, s40, 7
v_xor_b32 v216, s40, v214
v_lshlrev_b32 v216, 5, v216
v_add_u32 v197, v215, v216
s_add_u32 s40, s41, 3
s_and_b32 s40, s40, 7
v_xor_b32 v216, s40, v214
v_lshlrev_b32 v216, 5, v216
v_add_u32 v198, v215, v216
s_add_u32 s40, s41, 4
s_and_b32 s40, s40, 7
v_xor_b32 v216, s40, v214
v_lshlrev_b32 v216, 5, v216
v_add_u32 v199, v215, v216
s_add_u32 s40, s41, 5
s_and_b32 s40, s40, 7
v_xor_b32 v216, s40, v214
v_lshlrev_b32 v216, 5, v216
v_add_u32 v200, v215, v216
s_add_u32 s40, s41, 6
s_and_b32 s40, s40, 7
v_xor_b32 v216, s40, v214
v_lshlrev_b32 v216, 5, v216
v_add_u32 v201, v215, v216
s_add_u32 s40, s41, 7
s_and_b32 s40, s40, 7
v_xor_b32 v216, s40, v214
v_lshlrev_b32 v216, 5, v216
v_add_u32 v202, v215, v216
v_mov_b32 v216, 0x3f803f80
v_accvgpr_write_b32 a244, v216
v_accvgpr_write_b32 a245, v216
v_accvgpr_write_b32 a246, v216
v_accvgpr_write_b32 a247, v216
v_lshrrev_b32 v214, 2, v213
v_and_b32 v215, 3, v210
v_cmp_eq_u32 vcc, v214, v212
s_nop 1
v_cndmask_b32 v217, 7, v215
v_mov_b32 v218, 0
v_mov_b32 v219, 0
v_mov_b32 v220, 0x3f80
v_mov_b32 v221, 0x3f800000
v_cmp_eq_u32 vcc, 0, v217
s_nop 1
v_cndmask_b32 v218, v218, v220
v_cmp_eq_u32 vcc, 1, v217
s_nop 1
v_cndmask_b32 v218, v218, v221
v_cmp_eq_u32 vcc, 2, v217
s_nop 1
v_cndmask_b32 v219, v219, v220
v_cmp_eq_u32 vcc, 3, v217
s_nop 1
v_cndmask_b32 v219, v219, v221
v_mov_b32 v220, 0
v_accvgpr_write_b32 a248, v218
v_accvgpr_write_b32 a249, v219
v_accvgpr_write_b32 a250, v220
v_accvgpr_write_b32 a251, v220
v_accvgpr_write_b32 a252, v220
v_accvgpr_write_b32 a253, v220
v_accvgpr_write_b32 a254, v218
v_accvgpr_write_b32 a255, v219
s_load_dwordx2 s[98:99], s[0:1], 32
s_load_dwordx4 s[64:67], s[0:1], 80
s_waitcnt lgkmcnt(0)
s_mov_b32 s68, s66
s_mov_b32 s69, s67
s_mov_b32 s40, s64
s_mov_b32 s41, s65
s_mov_b32 s64, s40
s_and_b32 s65, s41, 0xffff
s_mov_b32 s66, 1474560
s_mov_b32 s67, 0x20000
s_mov_b32 s100, s98
s_mov_b32 s101, s99
s_lshl_b32 s40, s48, 0
s_add_u32 s40, s40, 0
s_mov_b32 s56, s40
s_mul_i32 s40, s56, 1507328
s_lshr_b32 s41, s49, 1
s_mul_i32 s41, s41, 94208
s_add_u32 s40, s40, s41
s_add_u32 s24, s50, s40
s_addc_u32 s25, s51, 0
s_and_b32 s25, s25, 0xffff
s_mov_b32 s26, 94208
s_mov_b32 s27, 0x20000
v_lshrrev_b32 v240, 3, v210
v_mul_u32_u24 v240, 1152, v240
v_lshrrev_b32 v241, 4, v210
v_lshlrev_b32 v241, 1, v241
v_xor_b32 v241, v241, v210
v_and_b32 v241, 7, v241
v_lshlrev_b32 v241, 4, v241
v_add_u32 v221, v240, v241
v_lshrrev_b32 v240, 2, v210
v_lshlrev_b32 v241, 7, v240
v_and_b32 v242, 3, v210
v_lshlrev_b32 v242, 3, v242
v_add_u32 v241, v241, v242
v_bfe_u32 v240, v240, 1, 2
s_add_u32 s40, s3, 0
s_and_b32 s41, s40, 3
s_lshr_b32 s40, s40, 2
s_lshl_b32 s42, s3, 1
s_add_u32 s40, s40, s42
s_lshl_b32 s40, s40, 12
s_add_u32 s40, s40, 40960
v_xor_b32 v243, s41, v240
v_lshlrev_b32 v243, 5, v243
v_add_u32 v243, v243, v241
v_add_u32 v219, s40, v243
s_add_u32 s40, s3, 1
s_and_b32 s41, s40, 3
s_lshr_b32 s40, s40, 2
s_lshl_b32 s42, s3, 1
s_add_u32 s40, s40, s42
s_lshl_b32 s40, s40, 12
s_add_u32 s40, s40, 40960
v_xor_b32 v243, s41, v240
v_lshlrev_b32 v243, 5, v243
v_add_u32 v243, v243, v241
v_add_u32 v220, s40, v243
s_add_u32 s40, s3, 2
s_and_b32 s41, s40, 3
s_lshr_b32 s40, s40, 2
s_lshl_b32 s42, s3, 1
s_add_u32 s40, s40, s42
s_lshl_b32 s40, s40, 12
s_add_u32 s40, s40, 40960
v_xor_b32 v243, s41, v240
v_lshlrev_b32 v243, 5, v243
v_add_u32 v243, v243, v241
v_add_u32 v224, s40, v243
s_add_u32 s40, s3, 3
s_and_b32 s41, s40, 3
s_lshr_b32 s40, s40, 2
s_lshl_b32 s42, s3, 1
s_add_u32 s40, s40, s42
s_lshl_b32 s40, s40, 12
s_add_u32 s40, s40, 40960
v_xor_b32 v243, s41, v240
v_lshlrev_b32 v243, 5, v243
v_add_u32 v243, v243, v241
v_add_u32 v225, s40, v243
v_lshlrev_b32 v169, 7, v210
s_sub_u32 s43, s47, 16
s_load_dwordx2 s[60:61], s[0:1], 0
s_load_dwordx2 s[62:63], s[0:1], 24
s_waitcnt lgkmcnt(0)
s_mov_b32 s92, s60
s_and_b32 s93, s61, 0xffff
s_mov_b32 s94, 737280
s_mov_b32 s95, 0x20000
s_lshl_b32 s40, s46, 10
s_add_u32 s96, s62, s40
s_addc_u32 s97, s63, 0
s_and_b32 s97, s97, 0xffff
s_mov_b32 s98, 0
s_mov_b32 s99, 0x20000
s_sub_u32 s98, 4718592, s40
s_mul_i32 s40, s43, 2
s_lshl_b32 s41, s3, 5
s_add_u32 s40, s40, s41
s_lshl_b32 s40, s40, 13
buffer_load_dwordx4 v[232:235], v209, s[96:99], s40 offen
s_add_u32 s41, s40, 8192
buffer_load_dwordx4 v[232:235], v209, s[96:99], s41 offen
s_add_u32 s40, s40, 1048576
buffer_load_dwordx4 v[232:235], v209, s[96:99], s40 offen
s_add_u32 s41, s40, 8192
buffer_load_dwordx4 v[232:235], v209, s[96:99], s41 offen
s_add_u32 s40, s40, 1048576
buffer_load_dwordx4 v[232:235], v209, s[96:99], s40 offen
s_add_u32 s41, s40, 8192
buffer_load_dwordx4 v[232:235], v209, s[96:99], s41 offen
s_add_u32 s40, s40, 1048576
buffer_load_dwordx4 v[232:235], v209, s[96:99], s40 offen
s_add_u32 s41, s40, 8192
buffer_load_dwordx4 v[232:235], v209, s[96:99], s41 offen
s_add_u32 s40, s40, 1048576
buffer_load_dwordx4 v[232:235], v209, s[96:99], s40 offen
s_add_u32 s41, s40, 8192
buffer_load_dwordx4 v[232:235], v209, s[96:99], s41 offen
s_add_u32 s40, s40, 1048576
s_lshl_b32 s40, s43, 2
s_add_u32 s40, s40, s3
s_mul_i32 s40, s40, 11520
buffer_load_dword v229, v169, s[92:95], s40 offen
s_add_u32 s40, s40, 8192
buffer_load_dword v229, v169, s[92:95], s40 offen
s_add_u32 s40, s40, 8192
s_mul_i32 s40, s49, 147456
s_add_u32 s60, s100, s40
s_addc_u32 s61, s101, 0
s_and_b32 s61, s61, 0xffff
s_mov_b32 s62, 294912
s_mov_b32 s63, 0x20000
s_mov_b32 s96, 0
s_mov_b32 s97, s56
s_mul_i32 s40, s97, 1507328
s_add_u32 s92, s50, s40
s_addc_u32 s93, s51, 0
s_and_b32 s93, s93, 0xffff
s_mov_b32 s94, 1507328
s_mov_b32 s95, 0x20000
s_lshr_b32 s40, s49, 1
s_or_b32 s40, s40, s3
s_cmp_lg_u32 s40, 0
s_cbranch_scc1 finit_83
s_mul_i32 s40, s97, 4352
s_add_u32 s40, s40, 33554432
v_mov_b32 v226, s40
v_mov_b32 v227, 0
s_mov_b64 s[42:43], exec
s_mov_b64 exec, 1
global_store_dword v226, v227, s[50:51] sc1
s_mov_b64 exec, s[42:43]
finit_83:
s_mov_b32 s34, 0
s_add_u32 s40, s34, s32
s_and_b32 s40, s40, 31
s_lshl_b32 s40, s40, 13
s_lshr_b32 s41, s34, 5
s_lshl_b32 s41, s41, 18
s_add_u32 s40, s40, s41
s_add_u32 s35, s40, s33
s_add_u32 s34, s34, 1
s_add_u32 m0, s37, 0
s_nop 0
buffer_load_dwordx4 v203, s[16:19], s35 offen nt lds
buffer_load_dwordx4 v204, s[16:19], s35 offen offset:1024 nt lds
s_add_u32 m0, s37, 8192
s_nop 0
buffer_load_dwordx4 v207, s[20:23], s35 offen nt lds
buffer_load_dwordx4 v208, s[20:23], s35 offen offset:1024 nt lds
s_add_u32 s40, s34, s32
s_and_b32 s40, s40, 31
s_lshl_b32 s40, s40, 13
s_lshr_b32 s41, s34, 5
s_lshl_b32 s41, s41, 18
s_add_u32 s40, s40, s41
s_add_u32 s35, s40, s33
s_add_u32 s34, s34, 1
s_add_u32 m0, s37, 16384
s_nop 0
buffer_load_dwordx4 v203, s[16:19], s35 offen nt lds
buffer_load_dwordx4 v204, s[16:19], s35 offen offset:1024 nt lds
s_add_u32 m0, s37, 24576
s_nop 0
buffer_load_dwordx4 v207, s[20:23], s35 offen nt lds
buffer_load_dwordx4 v208, s[20:23], s35 offen offset:1024 nt lds
s_add_u32 s40, s34, s32
s_and_b32 s40, s40, 31
s_lshl_b32 s40, s40, 13
s_lshr_b32 s41, s34, 5
s_lshl_b32 s41, s41, 18
s_add_u32 s40, s40, s41
s_add_u32 s35, s40, s33
s_add_u32 s34, s34, 1
s_add_u32 m0, s37, 32768
s_nop 0
buffer_load_dwordx4 v203, s[16:19], s35 offen nt lds
buffer_load_dwordx4 v204, s[16:19], s35 offen offset:1024 nt lds
s_add_u32 m0, s37, 40960
s_nop 0
buffer_load_dwordx4 v207, s[20:23], s35 offen nt lds
buffer_load_dwordx4 v208, s[20:23], s35 offen offset:1024 nt lds
s_mov_b32 s56, s34
s_add_u32 s40, s34, s32
s_and_b32 s40, s40, 31
s_lshl_b32 s40, s40, 13
s_lshr_b32 s41, s34, 5
s_lshl_b32 s41, s41, 18
s_add_u32 s40, s40, s41
s_add_u32 s35, s40, s33
s_add_u32 s34, s34, 1
buffer_load_dwordx4 v[232:235], v209, s[16:19], s35 offen
buffer_load_dwordx4 v[232:235], v209, s[16:19], s35 offen offset:1024
buffer_load_dwordx4 v[232:235], v209, s[20:23], s35 offen
buffer_load_dwordx4 v[232:235], v209, s[20:23], s35 offen offset:1024
s_add_u32 s40, s34, s32
s_and_b32 s40, s40, 31
s_lshl_b32 s40, s40, 13
s_lshr_b32 s41, s34, 5
s_lshl_b32 s41, s41, 18
s_add_u32 s40, s40, s41
s_add_u32 s35, s40, s33
s_add_u32 s34, s34, 1
buffer_load_dwordx4 v[232:235], v209, s[16:19], s35 offen
buffer_load_dwordx4 v[232:235], v209, s[16:19], s35 offen offset:1024
buffer_load_dwordx4 v[232:235], v209, s[20:23], s35 offen
buffer_load_dwordx4 v[232:235], v209, s[20:23], s35 offen offset:1024
s_add_u32 s40, s34, s32
s_and_b32 s40, s40, 31
s_lshl_b32 s40, s40, 13
s_lshr_b32 s41, s34, 5
s_lshl_b32 s41, s41, 18
s_add_u32 s40, s40, s41
s_add_u32 s35, s40, s33
s_add_u32 s34, s34, 1
buffer_load_dwordx4 v[232:235], v209, s[16:19], s35 offen
buffer_load_dwordx4 v[232:235], v209, s[16:19], s35 offen offset:1024
buffer_load_dwordx4 v[232:235], v209, s[20:23], s35 offen
buffer_load_dwordx4 v[232:235], v209, s[20:23], s35 offen offset:1024
s_add_u32 s40, s34, s32
s_and_b32 s40, s40, 31
s_lshl_b32 s40, s40, 13
s_lshr_b32 s41, s34, 5
s_lshl_b32 s41, s41, 18
s_add_u32 s40, s40, s41
s_add_u32 s35, s40, s33
s_add_u32 s34, s34, 1
buffer_load_dwordx4 v[232:235], v209, s[16:19], s35 offen
buffer_load_dwordx4 v[232:235], v209, s[16:19], s35 offen offset:1024
buffer_load_dwordx4 v[232:235], v209, s[20:23], s35 offen
buffer_load_dwordx4 v[232:235], v209, s[20:23], s35 offen offset:1024
s_add_u32 s40, s34, s32
s_and_b32 s40, s40, 31
s_lshl_b32 s40, s40, 13
s_lshr_b32 s41, s34, 5
s_lshl_b32 s41, s41, 18
s_add_u32 s40, s40, s41
s_add_u32 s35, s40, s33
s_add_u32 s34, s34, 1
buffer_load_dwordx4 v[232:235], v209, s[16:19], s35 offen
buffer_load_dwordx4 v[232:235], v209, s[16:19], s35 offen offset:1024
buffer_load_dwordx4 v[232:235], v209, s[20:23], s35 offen
buffer_load_dwordx4 v[232:235], v209, s[20:23], s35 offen offset:1024
s_add_u32 s40, s34, s32
s_and_b32 s40, s40, 31
s_lshl_b32 s40, s40, 13
s_lshr_b32 s41, s34, 5
s_lshl_b32 s41, s41, 18
s_add_u32 s40, s40, s41
s_add_u32 s35, s40, s33
s_add_u32 s34, s34, 1
buffer_load_dwordx4 v[232:235], v209, s[16:19], s35 offen
buffer_load_dwordx4 v[232:235], v209, s[16:19], s35 offen offset:1024
buffer_load_dwordx4 v[232:235], v209, s[20:23], s35 offen
buffer_load_dwordx4 v[232:235], v209, s[20:23], s35 offen offset:1024
s_mov_b32 s34, s56
s_waitcnt vmcnt(36)
s_cmp_eq_u32 s3, 0
s_cbranch_scc0 qr1_82
s_lshr_b32 s41, s59, 2
s_add_u32 s41, s41, s54
s_add_u32 m0, s41, 131072
s_add_u32 s40, s44, s58
buffer_load_dwordx4 v156, s[8:11], s40 offen lds
s_add_u32 m0, s54, 135168
s_add_u32 s40, s44, 36864
buffer_load_dwordx4 v156, s[8:11], s40 offen lds
s_add_u32 m0, s59, 65536
s_add_u32 s40, s45, s57
buffer_load_dwordx4 v152, s[12:15], s40 offen lds
buffer_load_dwordx4 v153, s[12:15], s40 offen offset:1024 lds
buffer_load_dwordx4 v154, s[12:15], s40 offen offset:2048 lds
buffer_load_dwordx4 v155, s[12:15], s40 offen offset:3072 lds
s_lshr_b32 s41, s59, 2
s_add_u32 s41, s41, s54
s_add_u32 m0, s41, 136192
s_add_u32 s40, s44, s58
s_add_u32 s40, s40, 46080
buffer_load_dwordx4 v161, s[8:11], s40 offen lds
s_add_u32 m0, s54, 140288
s_add_u32 s40, s44, 82944
buffer_load_dwordx4 v161, s[8:11], s40 offen lds
s_add_u32 s45, s45, 262144
s_add_u32 m0, s59, 81920
s_add_u32 s40, s45, s57
buffer_load_dwordx4 v152, s[12:15], s40 offen lds
buffer_load_dwordx4 v153, s[12:15], s40 offen offset:1024 lds
buffer_load_dwordx4 v154, s[12:15], s40 offen offset:2048 lds
buffer_load_dwordx4 v155, s[12:15], s40 offen offset:3072 lds
s_add_u32 s44, s44, 128
s_add_u32 s54, s54, 10240
s_cmp_eq_u32 s54, 30720
s_cselect_b32 s54, 0, s54
s_lshr_b32 s41, s59, 2
s_add_u32 s41, s41, s54
s_add_u32 m0, s41, 131072
s_add_u32 s40, s44, s58
buffer_load_dwordx4 v156, s[8:11], s40 offen lds
s_add_u32 m0, s54, 135168
s_add_u32 s40, s44, 36864
buffer_load_dwordx4 v156, s[8:11], s40 offen lds
s_add_u32 s45, s45, 262144
s_add_u32 m0, s59, 98304
s_add_u32 s40, s45, s57
buffer_load_dwordx4 v152, s[12:15], s40 offen lds
buffer_load_dwordx4 v153, s[12:15], s40 offen offset:1024 lds
buffer_load_dwordx4 v154, s[12:15], s40 offen offset:2048 lds
buffer_load_dwordx4 v155, s[12:15], s40 offen offset:3072 lds
s_lshr_b32 s41, s59, 2
s_add_u32 s41, s41, s54
s_add_u32 m0, s41, 136192
s_add_u32 s40, s44, s58
s_add_u32 s40, s40, 46080
buffer_load_dwordx4 v161, s[8:11], s40 offen lds
s_add_u32 m0, s54, 140288
s_add_u32 s40, s44, 82944
buffer_load_dwordx4 v161, s[8:11], s40 offen lds
s_add_u32 s45, s45, 262144
s_waitcnt vmcnt(12)
s_barrier
s_add_u32 m0, s59, 114688
s_add_u32 s40, s45, s57
buffer_load_dwordx4 v152, s[12:15], s40 offen lds
buffer_load_dwordx4 v153, s[12:15], s40 offen offset:1024 lds
buffer_load_dwordx4 v154, s[12:15], s40 offen offset:2048 lds
buffer_load_dwordx4 v155, s[12:15], s40 offen offset:3072 lds
s_add_u32 s44, s44, 128
s_add_u32 s54, s54, 10240
s_cmp_eq_u32 s54, 30720
s_cselect_b32 s54, 0, s54
s_lshr_b32 s41, s59, 2
s_add_u32 s41, s41, s54
s_add_u32 m0, s41, 131072
s_add_u32 s40, s44, s58
buffer_load_dwordx4 v156, s[8:11], s40 offen lds
s_add_u32 m0, s54, 135168
s_add_u32 s40, s44, 36864
buffer_load_dwordx4 v156, s[8:11], s40 offen lds
s_add_u32 s45, s45, 262144
ds_read_b64_tr_b16 v[80:81], v159
ds_read_b64_tr_b16 v[82:83], v159 offset:2048
ds_read_b64_tr_b16 v[84:85], v159 offset:8
ds_read_b64_tr_b16 v[86:87], v159 offset:2056
ds_read_b64_tr_b16 v[88:89], v160
ds_read_b64_tr_b16 v[90:91], v160 offset:2048
ds_read_b64_tr_b16 v[92:93], v160 offset:8
ds_read_b64_tr_b16 v[94:95], v160 offset:2056
ds_read_b128 v[112:115], v167
ds_read_b128 v[116:119], v167 offset:2048
ds_read_b128 v[120:123], v167 offset:4096
ds_read_b128 v[124:127], v167 offset:6144
ds_read_b128 v[128:131], v167 offset:8192
s_waitcnt lgkmcnt(0)
s_mov_b32 s38, 0
qloop_84:
s_waitcnt vmcnt(12)
s_barrier
v_mfma_f32_16x16x32_bf16 v[0:3], v[80:83], v[112:115], v[0:3]
ds_read_b64_tr_b16 v[96:97], v159 offset:16384
ds_read_b64_tr_b16 v[98:99], v159 offset:18432
v_mfma_f32_16x16x32_bf16 v[20:23], v[84:87], v[112:115], v[20:23]
ds_read_b64_tr_b16 v[100:101], v159 offset:16392
s_add_u32 m0, s59, 65536
s_add_u32 s40, s45, s57
buffer_load_dwordx4 v152, s[12:15], s40 offen lds
v_mfma_f32_16x16x32_bf16 v[40:43], v[88:91], v[112:115], v[40:43]
ds_read_b64_tr_b16 v[102:103], v159 offset:18440
v_mfma_f32_16x16x32_bf16 v[60:63], v[92:95], v[112:115], v[60:63]
ds_read_b64_tr_b16 v[104:105], v160 offset:16384
ds_read_b64_tr_b16 v[106:107], v160 offset:18432
buffer_load_dwordx4 v153, s[12:15], s40 offen offset:1024 lds
v_mfma_f32_16x16x32_bf16 v[4:7], v[80:83], v[116:119], v[4:7]
ds_read_b64_tr_b16 v[108:109], v160 offset:16392
v_mfma_f32_16x16x32_bf16 v[24:27], v[84:87], v[116:119], v[24:27]
ds_read_b64_tr_b16 v[110:111], v160 offset:18440
buffer_load_dwordx4 v154, s[12:15], s40 offen offset:2048 lds
v_mfma_f32_16x16x32_bf16 v[44:47], v[88:91], v[116:119], v[44:47]
ds_read_b128 v[132:135], v168
ds_read_b128 v[136:139], v168 offset:2048
v_mfma_f32_16x16x32_bf16 v[64:67], v[92:95], v[116:119], v[64:67]
ds_read_b128 v[140:143], v168 offset:4096
buffer_load_dwordx4 v155, s[12:15], s40 offen offset:3072 lds
v_mfma_f32_16x16x32_bf16 v[8:11], v[80:83], v[120:123], v[8:11]
ds_read_b128 v[144:147], v168 offset:6144
v_mfma_f32_16x16x32_bf16 v[28:31], v[84:87], v[120:123], v[28:31]
ds_read_b128 v[148:151], v168 offset:8192
s_lshr_b32 s41, s59, 2
s_add_u32 s41, s41, s54
s_add_u32 m0, s41, 136192
s_add_u32 s40, s44, s58
s_add_u32 s40, s40, 46080
buffer_load_dwordx4 v161, s[8:11], s40 offen lds
v_mfma_f32_16x16x32_bf16 v[48:51], v[88:91], v[120:123], v[48:51]
v_mfma_f32_16x16x32_bf16 v[68:71], v[92:95], v[120:123], v[68:71]
s_add_u32 m0, s54, 140288
s_add_u32 s40, s44, 82944
buffer_load_dwordx4 v161, s[8:11], s40 offen lds
s_add_u32 s45, s45, 262144
v_mfma_f32_16x16x32_bf16 v[12:15], v[80:83], v[124:127], v[12:15]
v_mfma_f32_16x16x32_bf16 v[32:35], v[84:87], v[124:127], v[32:35]
v_mfma_f32_16x16x32_bf16 v[52:55], v[88:91], v[124:127], v[52:55]
v_mfma_f32_16x16x32_bf16 v[72:75], v[92:95], v[124:127], v[72:75]
v_mfma_f32_16x16x32_bf16 v[16:19], v[80:83], v[128:131], v[16:19]
v_mfma_f32_16x16x32_bf16 v[36:39], v[84:87], v[128:131], v[36:39]
v_mfma_f32_16x16x32_bf16 v[56:59], v[88:91], v[128:131], v[56:59]
v_mfma_f32_16x16x32_bf16 v[76:79], v[92:95], v[128:131], v[76:79]
s_waitcnt lgkmcnt(0)
s_waitcnt vmcnt(12)
s_barrier
v_mfma_f32_16x16x32_bf16 v[0:3], v[96:99], v[132:135], v[0:3]
s_add_u32 s55, s55, 10240
s_cmp_eq_u32 s55, 30720
s_cselect_b32 s55, 0, s55
v_add_u32 v167, s55, v162
v_add_u32 v168, s55, v163
ds_read_b64_tr_b16 v[80:81], v159 offset:32768
v_mfma_f32_16x16x32_bf16 v[20:23], v[100:103], v[132:135], v[20:23]
ds_read_b64_tr_b16 v[82:83], v159 offset:34816
s_add_u32 m0, s59, 81920
s_add_u32 s40, s45, s57
buffer_load_dwordx4 v152, s[12:15], s40 offen lds
v_mfma_f32_16x16x32_bf16 v[40:43], v[104:107], v[132:135], v[40:43]
ds_read_b64_tr_b16 v[84:85], v159 offset:32776
ds_read_b64_tr_b16 v[86:87], v159 offset:34824
v_mfma_f32_16x16x32_bf16 v[60:63], v[108:111], v[132:135], v[60:63]
ds_read_b64_tr_b16 v[88:89], v160 offset:32768
buffer_load_dwordx4 v153, s[12:15], s40 offen offset:1024 lds
v_mfma_f32_16x16x32_bf16 v[4:7], v[96:99], v[136:139], v[4:7]
ds_read_b64_tr_b16 v[90:91], v160 offset:34816
v_mfma_f32_16x16x32_bf16 v[24:27], v[100:103], v[136:139], v[24:27]
ds_read_b64_tr_b16 v[92:93], v160 offset:32776
ds_read_b64_tr_b16 v[94:95], v160 offset:34824
buffer_load_dwordx4 v154, s[12:15], s40 offen offset:2048 lds
v_mfma_f32_16x16x32_bf16 v[44:47], v[104:107], v[136:139], v[44:47]
ds_read_b128 v[112:115], v167
v_mfma_f32_16x16x32_bf16 v[64:67], v[108:111], v[136:139], v[64:67]
ds_read_b128 v[116:119], v167 offset:2048
ds_read_b128 v[120:123], v167 offset:4096
buffer_load_dwordx4 v155, s[12:15], s40 offen offset:3072 lds
v_mfma_f32_16x16x32_bf16 v[8:11], v[96:99], v[140:143], v[8:11]
ds_read_b128 v[124:127], v167 offset:6144
v_mfma_f32_16x16x32_bf16 v[28:31], v[100:103], v[140:143], v[28:31]
ds_read_b128 v[128:131], v167 offset:8192
s_add_u32 s44, s44, 128
s_add_u32 s54, s54, 10240
s_cmp_eq_u32 s54, 30720
s_cselect_b32 s54, 0, s54
s_lshr_b32 s41, s59, 2
s_add_u32 s41, s41, s54
s_add_u32 m0, s41, 131072
s_add_u32 s40, s44, s58
buffer_load_dwordx4 v156, s[8:11], s40 offen lds
v_mfma_f32_16x16x32_bf16 v[48:51], v[104:107], v[140:143], v[48:51]
v_mfma_f32_16x16x32_bf16 v[68:71], v[108:111], v[140:143], v[68:71]
s_add_u32 m0, s54, 135168
s_add_u32 s40, s44, 36864
buffer_load_dwordx4 v156, s[8:11], s40 offen lds
s_add_u32 s45, s45, 262144
v_mfma_f32_16x16x32_bf16 v[12:15], v[96:99], v[144:147], v[12:15]
v_mfma_f32_16x16x32_bf16 v[32:35], v[100:103], v[144:147], v[32:35]
v_mfma_f32_16x16x32_bf16 v[52:55], v[104:107], v[144:147], v[52:55]
v_mfma_f32_16x16x32_bf16 v[72:75], v[108:111], v[144:147], v[72:75]
v_mfma_f32_16x16x32_bf16 v[16:19], v[96:99], v[148:151], v[16:19]
v_mfma_f32_16x16x32_bf16 v[36:39], v[100:103], v[148:151], v[36:39]
v_mfma_f32_16x16x32_bf16 v[56:59], v[104:107], v[148:151], v[56:59]
v_mfma_f32_16x16x32_bf16 v[76:79], v[108:111], v[148:151], v[76:79]
s_waitcnt lgkmcnt(0)
s_waitcnt vmcnt(12)
s_barrier
v_mfma_f32_16x16x32_bf16 v[0:3], v[80:83], v[112:115], v[0:3]
ds_read_b64_tr_b16 v[96:97], v159 offset:49152
ds_read_b64_tr_b16 v[98:99], v159 offset:51200
v_mfma_f32_16x16x32_bf16 v[20:23], v[84:87], v[112:115], v[20:23]
ds_read_b64_tr_b16 v[100:101], v159 offset:49160
s_add_u32 m0, s59, 98304
s_add_u32 s40, s45, s57
buffer_load_dwordx4 v152, s[12:15], s40 offen lds
v_mfma_f32_16x16x32_bf16 v[40:43], v[88:91], v[112:115], v[40:43]
ds_read_b64_tr_b16 v[102:103], v159 offset:51208
v_mfma_f32_16x16x32_bf16 v[60:63], v[92:95], v[112:115], v[60:63]
ds_read_b64_tr_b16 v[104:105], v160 offset:49152
ds_read_b64_tr_b16 v[106:107], v160 offset:51200
buffer_load_dwordx4 v153, s[12:15], s40 offen offset:1024 lds
v_mfma_f32_16x16x32_bf16 v[4:7], v[80:83], v[116:119], v[4:7]
ds_read_b64_tr_b16 v[108:109], v160 offset:49160
v_mfma_f32_16x16x32_bf16 v[24:27], v[84:87], v[116:119], v[24:27]
ds_read_b64_tr_b16 v[110:111], v160 offset:51208
buffer_load_dwordx4 v154, s[12:15], s40 offen offset:2048 lds
v_mfma_f32_16x16x32_bf16 v[44:47], v[88:91], v[116:119], v[44:47]
ds_read_b128 v[132:135], v168
ds_read_b128 v[136:139], v168 offset:2048
v_mfma_f32_16x16x32_bf16 v[64:67], v[92:95], v[116:119], v[64:67]
ds_read_b128 v[140:143], v168 offset:4096
buffer_load_dwordx4 v155, s[12:15], s40 offen offset:3072 lds
v_mfma_f32_16x16x32_bf16 v[8:11], v[80:83], v[120:123], v[8:11]
ds_read_b128 v[144:147], v168 offset:6144
v_mfma_f32_16x16x32_bf16 v[28:31], v[84:87], v[120:123], v[28:31]
ds_read_b128 v[148:151], v168 offset:8192
s_lshr_b32 s41, s59, 2
s_add_u32 s41, s41, s54
s_add_u32 m0, s41, 136192
s_add_u32 s40, s44, s58
s_add_u32 s40, s40, 46080
buffer_load_dwordx4 v161, s[8:11], s40 offen lds
v_mfma_f32_16x16x32_bf16 v[48:51], v[88:91], v[120:123], v[48:51]
v_mfma_f32_16x16x32_bf16 v[68:71], v[92:95], v[120:123], v[68:71]
s_add_u32 m0, s54, 140288
s_add_u32 s40, s44, 82944
buffer_load_dwordx4 v161, s[8:11], s40 offen lds
s_add_u32 s45, s45, 262144
v_mfma_f32_16x16x32_bf16 v[12:15], v[80:83], v[124:127], v[12:15]
v_mfma_f32_16x16x32_bf16 v[32:35], v[84:87], v[124:127], v[32:35]
v_mfma_f32_16x16x32_bf16 v[52:55], v[88:91], v[124:127], v[52:55]
v_mfma_f32_16x16x32_bf16 v[72:75], v[92:95], v[124:127], v[72:75]
v_mfma_f32_16x16x32_bf16 v[16:19], v[80:83], v[128:131], v[16:19]
v_mfma_f32_16x16x32_bf16 v[36:39], v[84:87], v[128:131], v[36:39]
v_mfma_f32_16x16x32_bf16 v[56:59], v[88:91], v[128:131], v[56:59]
v_mfma_f32_16x16x32_bf16 v[76:79], v[92:95], v[128:131], v[76:79]
s_waitcnt lgkmcnt(0)
s_waitcnt vmcnt(12)
s_barrier
v_mfma_f32_16x16x32_bf16 v[0:3], v[96:99], v[132:135], v[0:3]
s_add_u32 s55, s55, 10240
s_cmp_eq_u32 s55, 30720
s_cselect_b32 s55, 0, s55
v_add_u32 v167, s55, v162
v_add_u32 v168, s55, v163
ds_read_b64_tr_b16 v[80:81], v159
v_mfma_f32_16x16x32_bf16 v[20:23], v[100:103], v[132:135], v[20:23]
ds_read_b64_tr_b16 v[82:83], v159 offset:2048
s_add_u32 m0, s59, 114688
s_add_u32 s40, s45, s57
buffer_load_dwordx4 v152, s[12:15], s40 offen lds
v_mfma_f32_16x16x32_bf16 v[40:43], v[104:107], v[132:135], v[40:43]
ds_read_b64_tr_b16 v[84:85], v159 offset:8
ds_read_b64_tr_b16 v[86:87], v159 offset:2056
v_mfma_f32_16x16x32_bf16 v[60:63], v[108:111], v[132:135], v[60:63]
ds_read_b64_tr_b16 v[88:89], v160
buffer_load_dwordx4 v153, s[12:15], s40 offen offset:1024 lds
v_mfma_f32_16x16x32_bf16 v[4:7], v[96:99], v[136:139], v[4:7]
ds_read_b64_tr_b16 v[90:91], v160 offset:2048
v_mfma_f32_16x16x32_bf16 v[24:27], v[100:103], v[136:139], v[24:27]
ds_read_b64_tr_b16 v[92:93], v160 offset:8
ds_read_b64_tr_b16 v[94:95], v160 offset:2056
buffer_load_dwordx4 v154, s[12:15], s40 offen offset:2048 lds
v_mfma_f32_16x16x32_bf16 v[44:47], v[104:107], v[136:139], v[44:47]
ds_read_b128 v[112:115], v167
v_mfma_f32_16x16x32_bf16 v[64:67], v[108:111], v[136:139], v[64:67]
ds_read_b128 v[116:119], v167 offset:2048
ds_read_b128 v[120:123], v167 offset:4096
buffer_load_dwordx4 v155, s[12:15], s40 offen offset:3072 lds
v_mfma_f32_16x16x32_bf16 v[8:11], v[96:99], v[140:143], v[8:11]
ds_read_b128 v[124:127], v167 offset:6144
v_mfma_f32_16x16x32_bf16 v[28:31], v[100:103], v[140:143], v[28:31]
ds_read_b128 v[128:131], v167 offset:8192
s_add_u32 s44, s44, 128
s_add_u32 s54, s54, 10240
s_cmp_eq_u32 s54, 30720
s_cselect_b32 s54, 0, s54
s_lshr_b32 s41, s59, 2
s_add_u32 s41, s41, s54
s_add_u32 m0, s41, 131072
s_add_u32 s40, s44, s58
buffer_load_dwordx4 v156, s[8:11], s40 offen lds
v_mfma_f32_16x16x32_bf16 v[48:51], v[104:107], v[140:143], v[48:51]
v_mfma_f32_16x16x32_bf16 v[68:71], v[108:111], v[140:143], v[68:71]
s_add_u32 m0, s54, 135168
s_add_u32 s40, s44, 36864
buffer_load_dwordx4 v156, s[8:11], s40 offen lds
s_add_u32 s45, s45, 262144
v_mfma_f32_16x16x32_bf16 v[12:15], v[96:99], v[144:147], v[12:15]
v_mfma_f32_16x16x32_bf16 v[32:35], v[100:103], v[144:147], v[32:35]
v_mfma_f32_16x16x32_bf16 v[52:55], v[104:107], v[144:147], v[52:55]
v_mfma_f32_16x16x32_bf16 v[72:75], v[108:111], v[144:147], v[72:75]
v_mfma_f32_16x16x32_bf16 v[16:19], v[96:99], v[148:151], v[16:19]
v_mfma_f32_16x16x32_bf16 v[36:39], v[100:103], v[148:151], v[36:39]
v_mfma_f32_16x16x32_bf16 v[56:59], v[104:107], v[148:151], v[56:59]
v_mfma_f32_16x16x32_bf16 v[76:79], v[108:111], v[148:151], v[76:79]
s_waitcnt lgkmcnt(0)
s_add_u32 s38, s38, 1
s_cmp_lt_u32 s38, 3
s_cbranch_scc1 qloop_84
s_lshr_b32 s40, s49, 1
s_or_b32 s40, s40, s3
s_cmp_lg_u32 s40, 0
s_cbranch_scc1 fpub_85
s_lshl_b32 s40, s97, 2
v_mov_b32 v226, s40
v_mov_b32 v227, 1
s_mov_b64 s[42:43], exec
s_mov_b64 exec, 1
global_atomic_add v226, v227, s[68:69] sc1
s_mov_b64 exec, s[42:43]
fpub_85:
s_waitcnt vmcnt(12)
s_barrier
v_mfma_f32_16x16x32_bf16 v[0:3], v[80:83], v[112:115], v[0:3]
ds_read_b64_tr_b16 v[96:97], v159 offset:16384
ds_read_b64_tr_b16 v[98:99], v159 offset:18432
v_mfma_f32_16x16x32_bf16 v[20:23], v[84:87], v[112:115], v[20:23]
ds_read_b64_tr_b16 v[100:101], v159 offset:16392
s_add_u32 m0, s59, 65536
s_add_u32 s40, s45, s57
buffer_load_dwordx4 v152, s[12:15], s40 offen lds
v_mfma_f32_16x16x32_bf16 v[40:43], v[88:91], v[112:115], v[40:43]
ds_read_b64_tr_b16 v[102:103], v159 offset:18440
v_mfma_f32_16x16x32_bf16 v[60:63], v[92:95], v[112:115], v[60:63]
ds_read_b64_tr_b16 v[104:105], v160 offset:16384
ds_read_b64_tr_b16 v[106:107], v160 offset:18432
buffer_load_dwordx4 v153, s[12:15], s40 offen offset:1024 lds
v_mfma_f32_16x16x32_bf16 v[4:7], v[80:83], v[116:119], v[4:7]
ds_read_b64_tr_b16 v[108:109], v160 offset:16392
v_mfma_f32_16x16x32_bf16 v[24:27], v[84:87], v[116:119], v[24:27]
ds_read_b64_tr_b16 v[110:111], v160 offset:18440
buffer_load_dwordx4 v154, s[12:15], s40 offen offset:2048 lds
v_mfma_f32_16x16x32_bf16 v[44:47], v[88:91], v[116:119], v[44:47]
ds_read_b128 v[132:135], v168
ds_read_b128 v[136:139], v168 offset:2048
v_mfma_f32_16x16x32_bf16 v[64:67], v[92:95], v[116:119], v[64:67]
ds_read_b128 v[140:143], v168 offset:4096
buffer_load_dwordx4 v155, s[12:15], s40 offen offset:3072 lds
v_mfma_f32_16x16x32_bf16 v[8:11], v[80:83], v[120:123], v[8:11]
ds_read_b128 v[144:147], v168 offset:6144
v_mfma_f32_16x16x32_bf16 v[28:31], v[84:87], v[120:123], v[28:31]
ds_read_b128 v[148:151], v168 offset:8192
s_lshr_b32 s41, s59, 2
s_add_u32 s41, s41, s54
s_add_u32 m0, s41, 136192
s_add_u32 s40, s44, s58
s_add_u32 s40, s40, 46080
buffer_load_dwordx4 v161, s[8:11], s40 offen lds
v_mfma_f32_16x16x32_bf16 v[48:51], v[88:91], v[120:123], v[48:51]
v_mfma_f32_16x16x32_bf16 v[68:71], v[92:95], v[120:123], v[68:71]
s_add_u32 m0, s54, 140288
s_add_u32 s40, s44, 82944
buffer_load_dwordx4 v161, s[8:11], s40 offen lds
s_add_u32 s45, s45, 262144
v_mfma_f32_16x16x32_bf16 v[12:15], v[80:83], v[124:127], v[12:15]
v_mfma_f32_16x16x32_bf16 v[32:35], v[84:87], v[124:127], v[32:35]
v_mfma_f32_16x16x32_bf16 v[52:55], v[88:91], v[124:127], v[52:55]
v_mfma_f32_16x16x32_bf16 v[72:75], v[92:95], v[124:127], v[72:75]
v_mfma_f32_16x16x32_bf16 v[16:19], v[80:83], v[128:131], v[16:19]
v_mfma_f32_16x16x32_bf16 v[36:39], v[84:87], v[128:131], v[36:39]
v_mfma_f32_16x16x32_bf16 v[56:59], v[88:91], v[128:131], v[56:59]
v_mfma_f32_16x16x32_bf16 v[76:79], v[92:95], v[128:131], v[76:79]
s_waitcnt lgkmcnt(0)
s_waitcnt vmcnt(12)
s_barrier
v_mfma_f32_16x16x32_bf16 v[0:3], v[96:99], v[132:135], v[0:3]
s_add_u32 s55, s55, 10240
s_cmp_eq_u32 s55, 30720
s_cselect_b32 s55, 0, s55
v_add_u32 v167, s55, v162
v_add_u32 v168, s55, v163
ds_read_b64_tr_b16 v[80:81], v159 offset:32768
v_mfma_f32_16x16x32_bf16 v[20:23], v[100:103], v[132:135], v[20:23]
ds_read_b64_tr_b16 v[82:83], v159 offset:34816
s_add_u32 m0, s59, 81920
s_add_u32 s40, s45, s57
buffer_load_dwordx4 v152, s[12:15], s40 offen lds
v_mfma_f32_16x16x32_bf16 v[40:43], v[104:107], v[132:135], v[40:43]
ds_read_b64_tr_b16 v[84:85], v159 offset:32776
ds_read_b64_tr_b16 v[86:87], v159 offset:34824
v_mfma_f32_16x16x32_bf16 v[60:63], v[108:111], v[132:135], v[60:63]
ds_read_b64_tr_b16 v[88:89], v160 offset:32768
buffer_load_dwordx4 v153, s[12:15], s40 offen offset:1024 lds
v_mfma_f32_16x16x32_bf16 v[4:7], v[96:99], v[136:139], v[4:7]
ds_read_b64_tr_b16 v[90:91], v160 offset:34816
v_mfma_f32_16x16x32_bf16 v[24:27], v[100:103], v[136:139], v[24:27]
ds_read_b64_tr_b16 v[92:93], v160 offset:32776
ds_read_b64_tr_b16 v[94:95], v160 offset:34824
buffer_load_dwordx4 v154, s[12:15], s40 offen offset:2048 lds
v_mfma_f32_16x16x32_bf16 v[44:47], v[104:107], v[136:139], v[44:47]
ds_read_b128 v[112:115], v167
v_mfma_f32_16x16x32_bf16 v[64:67], v[108:111], v[136:139], v[64:67]
ds_read_b128 v[116:119], v167 offset:2048
ds_read_b128 v[120:123], v167 offset:4096
buffer_load_dwordx4 v155, s[12:15], s40 offen offset:3072 lds
v_mfma_f32_16x16x32_bf16 v[8:11], v[96:99], v[140:143], v[8:11]
ds_read_b128 v[124:127], v167 offset:6144
v_mfma_f32_16x16x32_bf16 v[28:31], v[100:103], v[140:143], v[28:31]
ds_read_b128 v[128:131], v167 offset:8192
s_add_u32 s44, s44, 128
s_add_u32 s54, s54, 10240
s_cmp_eq_u32 s54, 30720
s_cselect_b32 s54, 0, s54
s_lshr_b32 s41, s59, 2
s_add_u32 s41, s41, s54
s_add_u32 m0, s41, 131072
s_add_u32 s40, s44, s58
buffer_load_dwordx4 v156, s[8:11], s40 offen lds
v_mfma_f32_16x16x32_bf16 v[48:51], v[104:107], v[140:143], v[48:51]
v_mfma_f32_16x16x32_bf16 v[68:71], v[108:111], v[140:143], v[68:71]
s_add_u32 m0, s54, 135168
s_add_u32 s40, s44, 36864
buffer_load_dwordx4 v156, s[8:11], s40 offen lds
s_add_u32 s45, s45, 262144
v_mfma_f32_16x16x32_bf16 v[12:15], v[96:99], v[144:147], v[12:15]
v_mfma_f32_16x16x32_bf16 v[32:35], v[100:103], v[144:147], v[32:35]
v_mfma_f32_16x16x32_bf16 v[52:55], v[104:107], v[144:147], v[52:55]
v_mfma_f32_16x16x32_bf16 v[72:75], v[108:111], v[144:147], v[72:75]
v_mfma_f32_16x16x32_bf16 v[16:19], v[96:99], v[148:151], v[16:19]
v_mfma_f32_16x16x32_bf16 v[36:39], v[100:103], v[148:151], v[36:39]
v_mfma_f32_16x16x32_bf16 v[56:59], v[104:107], v[148:151], v[56:59]
v_mfma_f32_16x16x32_bf16 v[76:79], v[108:111], v[148:151], v[76:79]
s_waitcnt lgkmcnt(0)
s_waitcnt vmcnt(12)
s_barrier
v_mfma_f32_16x16x32_bf16 v[0:3], v[80:83], v[112:115], v[0:3]
ds_read_b64_tr_b16 v[96:97], v159 offset:49152
ds_read_b64_tr_b16 v[98:99], v159 offset:51200
v_mfma_f32_16x16x32_bf16 v[20:23], v[84:87], v[112:115], v[20:23]
ds_read_b64_tr_b16 v[100:101], v159 offset:49160
v_mfma_f32_16x16x32_bf16 v[40:43], v[88:91], v[112:115], v[40:43]
ds_read_b64_tr_b16 v[102:103], v159 offset:51208
v_mfma_f32_16x16x32_bf16 v[60:63], v[92:95], v[112:115], v[60:63]
ds_read_b64_tr_b16 v[104:105], v160 offset:49152
ds_read_b64_tr_b16 v[106:107], v160 offset:51200
v_mfma_f32_16x16x32_bf16 v[4:7], v[80:83], v[116:119], v[4:7]
ds_read_b64_tr_b16 v[108:109], v160 offset:49160
v_mfma_f32_16x16x32_bf16 v[24:27], v[84:87], v[116:119], v[24:27]
ds_read_b64_tr_b16 v[110:111], v160 offset:51208
v_mfma_f32_16x16x32_bf16 v[44:47], v[88:91], v[116:119], v[44:47]
ds_read_b128 v[132:135], v168
ds_read_b128 v[136:139], v168 offset:2048
v_mfma_f32_16x16x32_bf16 v[64:67], v[92:95], v[116:119], v[64:67]
ds_read_b128 v[140:143], v168 offset:4096
v_mfma_f32_16x16x32_bf16 v[8:11], v[80:83], v[120:123], v[8:11]
ds_read_b128 v[144:147], v168 offset:6144
v_mfma_f32_16x16x32_bf16 v[28:31], v[84:87], v[120:123], v[28:31]
ds_read_b128 v[148:151], v168 offset:8192
v_mfma_f32_16x16x32_bf16 v[48:51], v[88:91], v[120:123], v[48:51]
v_mfma_f32_16x16x32_bf16 v[68:71], v[92:95], v[120:123], v[68:71]
v_mfma_f32_16x16x32_bf16 v[12:15], v[80:83], v[124:127], v[12:15]
v_mfma_f32_16x16x32_bf16 v[32:35], v[84:87], v[124:127], v[32:35]
v_mfma_f32_16x16x32_bf16 v[52:55], v[88:91], v[124:127], v[52:55]
v_mfma_f32_16x16x32_bf16 v[72:75], v[92:95], v[124:127], v[72:75]
v_mfma_f32_16x16x32_bf16 v[16:19], v[80:83], v[128:131], v[16:19]
v_mfma_f32_16x16x32_bf16 v[36:39], v[84:87], v[128:131], v[36:39]
v_mfma_f32_16x16x32_bf16 v[56:59], v[88:91], v[128:131], v[56:59]
v_mfma_f32_16x16x32_bf16 v[76:79], v[92:95], v[128:131], v[76:79]
s_waitcnt lgkmcnt(0)
s_waitcnt vmcnt(6)
s_barrier
v_mfma_f32_16x16x32_bf16 v[0:3], v[96:99], v[132:135], v[0:3]
s_add_u32 s55, s55, 10240
s_cmp_eq_u32 s55, 30720
s_cselect_b32 s55, 0, s55
v_add_u32 v167, s55, v162
v_add_u32 v168, s55, v163
ds_read_b64_tr_b16 v[80:81], v159
v_mfma_f32_16x16x32_bf16 v[20:23], v[100:103], v[132:135], v[20:23]
ds_read_b64_tr_b16 v[82:83], v159 offset:2048
v_mfma_f32_16x16x32_bf16 v[40:43], v[104:107], v[132:135], v[40:43]
ds_read_b64_tr_b16 v[84:85], v159 offset:8
ds_read_b64_tr_b16 v[86:87], v159 offset:2056
v_mfma_f32_16x16x32_bf16 v[60:63], v[108:111], v[132:135], v[60:63]
ds_read_b64_tr_b16 v[88:89], v160
v_mfma_f32_16x16x32_bf16 v[4:7], v[96:99], v[136:139], v[4:7]
ds_read_b64_tr_b16 v[90:91], v160 offset:2048
v_mfma_f32_16x16x32_bf16 v[24:27], v[100:103], v[136:139], v[24:27]
ds_read_b64_tr_b16 v[92:93], v160 offset:8
ds_read_b64_tr_b16 v[94:95], v160 offset:2056
v_mfma_f32_16x16x32_bf16 v[44:47], v[104:107], v[136:139], v[44:47]
ds_read_b128 v[112:115], v167
v_mfma_f32_16x16x32_bf16 v[64:67], v[108:111], v[136:139], v[64:67]
ds_read_b128 v[116:119], v167 offset:2048
ds_read_b128 v[120:123], v167 offset:4096
v_mfma_f32_16x16x32_bf16 v[8:11], v[96:99], v[140:143], v[8:11]
ds_read_b128 v[124:127], v167 offset:6144
v_mfma_f32_16x16x32_bf16 v[28:31], v[100:103], v[140:143], v[28:31]
ds_read_b128 v[128:131], v167 offset:8192
v_mfma_f32_16x16x32_bf16 v[48:51], v[104:107], v[140:143], v[48:51]
v_mfma_f32_16x16x32_bf16 v[68:71], v[108:111], v[140:143], v[68:71]
v_mfma_f32_16x16x32_bf16 v[12:15], v[96:99], v[144:147], v[12:15]
v_mfma_f32_16x16x32_bf16 v[32:35], v[100:103], v[144:147], v[32:35]
v_mfma_f32_16x16x32_bf16 v[52:55], v[104:107], v[144:147], v[52:55]
v_mfma_f32_16x16x32_bf16 v[72:75], v[108:111], v[144:147], v[72:75]
v_mfma_f32_16x16x32_bf16 v[16:19], v[96:99], v[148:151], v[16:19]
v_mfma_f32_16x16x32_bf16 v[36:39], v[100:103], v[148:151], v[36:39]
v_mfma_f32_16x16x32_bf16 v[56:59], v[104:107], v[148:151], v[56:59]
v_mfma_f32_16x16x32_bf16 v[76:79], v[108:111], v[148:151], v[76:79]
s_waitcnt lgkmcnt(0)
s_waitcnt vmcnt(0)
s_barrier
v_mfma_f32_16x16x32_bf16 v[0:3], v[80:83], v[112:115], v[0:3]
ds_read_b64_tr_b16 v[96:97], v159 offset:16384
ds_read_b64_tr_b16 v[98:99], v159 offset:18432
v_mfma_f32_16x16x32_bf16 v[20:23], v[84:87], v[112:115], v[20:23]
ds_read_b64_tr_b16 v[100:101], v159 offset:16392
v_mfma_f32_16x16x32_bf16 v[40:43], v[88:91], v[112:115], v[40:43]
ds_read_b64_tr_b16 v[102:103], v159 offset:18440
v_mfma_f32_16x16x32_bf16 v[60:63], v[92:95], v[112:115], v[60:63]
ds_read_b64_tr_b16 v[104:105], v160 offset:16384
ds_read_b64_tr_b16 v[106:107], v160 offset:18432
v_mfma_f32_16x16x32_bf16 v[4:7], v[80:83], v[116:119], v[4:7]
ds_read_b64_tr_b16 v[108:109], v160 offset:16392
v_mfma_f32_16x16x32_bf16 v[24:27], v[84:87], v[116:119], v[24:27]
ds_read_b64_tr_b16 v[110:111], v160 offset:18440
v_mfma_f32_16x16x32_bf16 v[44:47], v[88:91], v[116:119], v[44:47]
ds_read_b128 v[132:135], v168
ds_read_b128 v[136:139], v168 offset:2048
v_mfma_f32_16x16x32_bf16 v[64:67], v[92:95], v[116:119], v[64:67]
ds_read_b128 v[140:143], v168 offset:4096
v_mfma_f32_16x16x32_bf16 v[8:11], v[80:83], v[120:123], v[8:11]
ds_read_b128 v[144:147], v168 offset:6144
v_mfma_f32_16x16x32_bf16 v[28:31], v[84:87], v[120:123], v[28:31]
ds_read_b128 v[148:151], v168 offset:8192
v_mfma_f32_16x16x32_bf16 v[48:51], v[88:91], v[120:123], v[48:51]
v_mfma_f32_16x16x32_bf16 v[68:71], v[92:95], v[120:123], v[68:71]
v_mfma_f32_16x16x32_bf16 v[12:15], v[80:83], v[124:127], v[12:15]
v_mfma_f32_16x16x32_bf16 v[32:35], v[84:87], v[124:127], v[32:35]
v_mfma_f32_16x16x32_bf16 v[52:55], v[88:91], v[124:127], v[52:55]
v_mfma_f32_16x16x32_bf16 v[72:75], v[92:95], v[124:127], v[72:75]
v_mfma_f32_16x16x32_bf16 v[16:19], v[80:83], v[128:131], v[16:19]
v_mfma_f32_16x16x32_bf16 v[36:39], v[84:87], v[128:131], v[36:39]
v_mfma_f32_16x16x32_bf16 v[56:59], v[88:91], v[128:131], v[56:59]
v_mfma_f32_16x16x32_bf16 v[76:79], v[92:95], v[128:131], v[76:79]
s_waitcnt lgkmcnt(0)
v_mfma_f32_16x16x32_bf16 v[0:3], v[96:99], v[132:135], v[0:3]
v_mfma_f32_16x16x32_bf16 v[20:23], v[100:103], v[132:135], v[20:23]
v_mfma_f32_16x16x32_bf16 v[40:43], v[104:107], v[132:135], v[40:43]
v_mfma_f32_16x16x32_bf16 v[60:63], v[108:111], v[132:135], v[60:63]
v_mfma_f32_16x16x32_bf16 v[4:7], v[96:99], v[136:139], v[4:7]
v_mfma_f32_16x16x32_bf16 v[24:27], v[100:103], v[136:139], v[24:27]
v_mfma_f32_16x16x32_bf16 v[44:47], v[104:107], v[136:139], v[44:47]
v_mfma_f32_16x16x32_bf16 v[64:67], v[108:111], v[136:139], v[64:67]
v_mfma_f32_16x16x32_bf16 v[8:11], v[96:99], v[140:143], v[8:11]
v_mfma_f32_16x16x32_bf16 v[28:31], v[100:103], v[140:143], v[28:31]
v_mfma_f32_16x16x32_bf16 v[48:51], v[104:107], v[140:143], v[48:51]
v_mfma_f32_16x16x32_bf16 v[68:71], v[108:111], v[140:143], v[68:71]
v_mfma_f32_16x16x32_bf16 v[12:15], v[96:99], v[144:147], v[12:15]
v_mfma_f32_16x16x32_bf16 v[32:35], v[100:103], v[144:147], v[32:35]
v_mfma_f32_16x16x32_bf16 v[52:55], v[104:107], v[144:147], v[52:55]
v_mfma_f32_16x16x32_bf16 v[72:75], v[108:111], v[144:147], v[72:75]
v_mfma_f32_16x16x32_bf16 v[16:19], v[96:99], v[148:151], v[16:19]
v_mfma_f32_16x16x32_bf16 v[36:39], v[100:103], v[148:151], v[36:39]
v_mfma_f32_16x16x32_bf16 v[56:59], v[104:107], v[148:151], v[56:59]
v_mfma_f32_16x16x32_bf16 v[76:79], v[108:111], v[148:151], v[76:79]
s_branch qdone_81
qr1_82:
s_lshr_b32 s41, s59, 2
s_add_u32 s41, s41, s54
s_add_u32 m0, s41, 131072
s_add_u32 s40, s44, s58
buffer_load_dwordx4 v156, s[8:11], s40 offen lds
s_add_u32 m0, s59, 65536
s_add_u32 s40, s45, s57
buffer_load_dwordx4 v152, s[12:15], s40 offen lds
buffer_load_dwordx4 v153, s[12:15], s40 offen offset:1024 lds
buffer_load_dwordx4 v154, s[12:15], s40 offen offset:2048 lds
buffer_load_dwordx4 v155, s[12:15], s40 offen offset:3072 lds
s_lshr_b32 s41, s59, 2
s_add_u32 s41, s41, s54
s_add_u32 m0, s41, 136192
s_add_u32 s40, s44, s58
s_add_u32 s40, s40, 46080
buffer_load_dwordx4 v161, s[8:11], s40 offen lds
s_add_u32 s45, s45, 262144
s_add_u32 m0, s59, 81920
s_add_u32 s40, s45, s57
buffer_load_dwordx4 v152, s[12:15], s40 offen lds
buffer_load_dwordx4 v153, s[12:15], s40 offen offset:1024 lds
buffer_load_dwordx4 v154, s[12:15], s40 offen offset:2048 lds
buffer_load_dwordx4 v155, s[12:15], s40 offen offset:3072 lds
s_add_u32 s44, s44, 128
s_add_u32 s54, s54, 10240
s_cmp_eq_u32 s54, 30720
s_cselect_b32 s54, 0, s54
s_lshr_b32 s41, s59, 2
s_add_u32 s41, s41, s54
s_add_u32 m0, s41, 131072
s_add_u32 s40, s44, s58
buffer_load_dwordx4 v156, s[8:11], s40 offen lds
s_add_u32 s45, s45, 262144
s_add_u32 m0, s59, 98304
s_add_u32 s40, s45, s57
buffer_load_dwordx4 v152, s[12:15], s40 offen lds
buffer_load_dwordx4 v153, s[12:15], s40 offen offset:1024 lds
buffer_load_dwordx4 v154, s[12:15], s40 offen offset:2048 lds
buffer_load_dwordx4 v155, s[12:15], s40 offen offset:3072 lds
s_lshr_b32 s41, s59, 2
s_add_u32 s41, s41, s54
s_add_u32 m0, s41, 136192
s_add_u32 s40, s44, s58
s_add_u32 s40, s40, 46080
buffer_load_dwordx4 v161, s[8:11], s40 offen lds
s_add_u32 s45, s45, 262144
s_waitcnt vmcnt(10)
s_barrier
s_add_u32 m0, s59, 114688
s_add_u32 s40, s45, s57
buffer_load_dwordx4 v152, s[12:15], s40 offen lds
buffer_load_dwordx4 v153, s[12:15], s40 offen offset:1024 lds
buffer_load_dwordx4 v154, s[12:15], s40 offen offset:2048 lds
buffer_load_dwordx4 v155, s[12:15], s40 offen offset:3072 lds
s_add_u32 s44, s44, 128
s_add_u32 s54, s54, 10240
s_cmp_eq_u32 s54, 30720
s_cselect_b32 s54, 0, s54
s_lshr_b32 s41, s59, 2
s_add_u32 s41, s41, s54
s_add_u32 m0, s41, 131072
s_add_u32 s40, s44, s58
buffer_load_dwordx4 v156, s[8:11], s40 offen lds
s_add_u32 s45, s45, 262144
ds_read_b64_tr_b16 v[80:81], v159
ds_read_b64_tr_b16 v[82:83], v159 offset:2048
ds_read_b64_tr_b16 v[84:85], v159 offset:8
ds_read_b64_tr_b16 v[86:87], v159 offset:2056
ds_read_b64_tr_b16 v[88:89], v160
ds_read_b64_tr_b16 v[90:91], v160 offset:2048
ds_read_b64_tr_b16 v[92:93], v160 offset:8
ds_read_b64_tr_b16 v[94:95], v160 offset:2056
ds_read_b128 v[112:115], v167
ds_read_b128 v[116:119], v167 offset:2048
ds_read_b128 v[120:123], v167 offset:4096
ds_read_b128 v[124:127], v167 offset:6144
ds_read_b128 v[128:131], v167 offset:8192
s_waitcnt lgkmcnt(0)
s_mov_b32 s38, 0
qloop_86:
s_waitcnt vmcnt(10)
s_barrier
v_mfma_f32_16x16x32_bf16 v[0:3], v[80:83], v[112:115], v[0:3]
ds_read_b64_tr_b16 v[96:97], v159 offset:16384
ds_read_b64_tr_b16 v[98:99], v159 offset:18432
v_mfma_f32_16x16x32_bf16 v[20:23], v[84:87], v[112:115], v[20:23]
ds_read_b64_tr_b16 v[100:101], v159 offset:16392
s_add_u32 m0, s59, 65536
s_add_u32 s40, s45, s57
buffer_load_dwordx4 v152, s[12:15], s40 offen lds
v_mfma_f32_16x16x32_bf16 v[40:43], v[88:91], v[112:115], v[40:43]
ds_read_b64_tr_b16 v[102:103], v159 offset:18440
v_mfma_f32_16x16x32_bf16 v[60:63], v[92:95], v[112:115], v[60:63]
ds_read_b64_tr_b16 v[104:105], v160 offset:16384
ds_read_b64_tr_b16 v[106:107], v160 offset:18432
buffer_load_dwordx4 v153, s[12:15], s40 offen offset:1024 lds
v_mfma_f32_16x16x32_bf16 v[4:7], v[80:83], v[116:119], v[4:7]
ds_read_b64_tr_b16 v[108:109], v160 offset:16392
v_mfma_f32_16x16x32_bf16 v[24:27], v[84:87], v[116:119], v[24:27]
ds_read_b64_tr_b16 v[110:111], v160 offset:18440
buffer_load_dwordx4 v154, s[12:15], s40 offen offset:2048 lds
v_mfma_f32_16x16x32_bf16 v[44:47], v[88:91], v[116:119], v[44:47]
ds_read_b128 v[132:135], v168
ds_read_b128 v[136:139], v168 offset:2048
v_mfma_f32_16x16x32_bf16 v[64:67], v[92:95], v[116:119], v[64:67]
ds_read_b128 v[140:143], v168 offset:4096
v_mfma_f32_16x16x32_bf16 v[8:11], v[80:83], v[120:123], v[8:11]
ds_read_b128 v[144:147], v168 offset:6144
buffer_load_dwordx4 v155, s[12:15], s40 offen offset:3072 lds
v_mfma_f32_16x16x32_bf16 v[28:31], v[84:87], v[120:123], v[28:31]
ds_read_b128 v[148:151], v168 offset:8192
v_mfma_f32_16x16x32_bf16 v[48:51], v[88:91], v[120:123], v[48:51]
s_lshr_b32 s41, s59, 2
s_add_u32 s41, s41, s54
s_add_u32 m0, s41, 136192
s_add_u32 s40, s44, s58
s_add_u32 s40, s40, 46080
buffer_load_dwordx4 v161, s[8:11], s40 offen lds
s_add_u32 s45, s45, 262144
v_mfma_f32_16x16x32_bf16 v[68:71], v[92:95], v[120:123], v[68:71]
v_mfma_f32_16x16x32_bf16 v[12:15], v[80:83], v[124:127], v[12:15]
v_mfma_f32_16x16x32_bf16 v[32:35], v[84:87], v[124:127], v[32:35]
v_mfma_f32_16x16x32_bf16 v[52:55], v[88:91], v[124:127], v[52:55]
v_mfma_f32_16x16x32_bf16 v[72:75], v[92:95], v[124:127], v[72:75]
v_mfma_f32_16x16x32_bf16 v[16:19], v[80:83], v[128:131], v[16:19]
v_mfma_f32_16x16x32_bf16 v[36:39], v[84:87], v[128:131], v[36:39]
v_mfma_f32_16x16x32_bf16 v[56:59], v[88:91], v[128:131], v[56:59]
v_mfma_f32_16x16x32_bf16 v[76:79], v[92:95], v[128:131], v[76:79]
s_waitcnt lgkmcnt(0)
s_waitcnt vmcnt(10)
s_barrier
v_mfma_f32_16x16x32_bf16 v[0:3], v[96:99], v[132:135], v[0:3]
s_add_u32 s55, s55, 10240
s_cmp_eq_u32 s55, 30720
s_cselect_b32 s55, 0, s55
v_add_u32 v167, s55, v162
v_add_u32 v168, s55, v163
ds_read_b64_tr_b16 v[80:81], v159 offset:32768
v_mfma_f32_16x16x32_bf16 v[20:23], v[100:103], v[132:135], v[20:23]
ds_read_b64_tr_b16 v[82:83], v159 offset:34816
s_add_u32 m0, s59, 81920
s_add_u32 s40, s45, s57
buffer_load_dwordx4 v152, s[12:15], s40 offen lds
v_mfma_f32_16x16x32_bf16 v[40:43], v[104:107], v[132:135], v[40:43]
ds_read_b64_tr_b16 v[84:85], v159 offset:32776
ds_read_b64_tr_b16 v[86:87], v159 offset:34824
v_mfma_f32_16x16x32_bf16 v[60:63], v[108:111], v[132:135], v[60:63]
ds_read_b64_tr_b16 v[88:89], v160 offset:32768
buffer_load_dwordx4 v153, s[12:15], s40 offen offset:1024 lds
v_mfma_f32_16x16x32_bf16 v[4:7], v[96:99], v[136:139], v[4:7]
ds_read_b64_tr_b16 v[90:91], v160 offset:34816
v_mfma_f32_16x16x32_bf16 v[24:27], v[100:103], v[136:139], v[24:27]
ds_read_b64_tr_b16 v[92:93], v160 offset:32776
ds_read_b64_tr_b16 v[94:95], v160 offset:34824
buffer_load_dwordx4 v154, s[12:15], s40 offen offset:2048 lds
v_mfma_f32_16x16x32_bf16 v[44:47], v[104:107], v[136:139], v[44:47]
ds_read_b128 v[112:115], v167
v_mfma_f32_16x16x32_bf16 v[64:67], v[108:111], v[136:139], v[64:67]
ds_read_b128 v[116:119], v167 offset:2048
ds_read_b128 v[120:123], v167 offset:4096
v_mfma_f32_16x16x32_bf16 v[8:11], v[96:99], v[140:143], v[8:11]
ds_read_b128 v[124:127], v167 offset:6144
buffer_load_dwordx4 v155, s[12:15], s40 offen offset:3072 lds
v_mfma_f32_16x16x32_bf16 v[28:31], v[100:103], v[140:143], v[28:31]
ds_read_b128 v[128:131], v167 offset:8192
v_mfma_f32_16x16x32_bf16 v[48:51], v[104:107], v[140:143], v[48:51]
s_add_u32 s44, s44, 128
s_add_u32 s54, s54, 10240
s_cmp_eq_u32 s54, 30720
s_cselect_b32 s54, 0, s54
s_lshr_b32 s41, s59, 2
s_add_u32 s41, s41, s54
s_add_u32 m0, s41, 131072
s_add_u32 s40, s44, s58
buffer_load_dwordx4 v156, s[8:11], s40 offen lds
s_add_u32 s45, s45, 262144
v_mfma_f32_16x16x32_bf16 v[68:71], v[108:111], v[140:143], v[68:71]
v_mfma_f32_16x16x32_bf16 v[12:15], v[96:99], v[144:147], v[12:15]
v_mfma_f32_16x16x32_bf16 v[32:35], v[100:103], v[144:147], v[32:35]
v_mfma_f32_16x16x32_bf16 v[52:55], v[104:107], v[144:147], v[52:55]
v_mfma_f32_16x16x32_bf16 v[72:75], v[108:111], v[144:147], v[72:75]
v_mfma_f32_16x16x32_bf16 v[16:19], v[96:99], v[148:151], v[16:19]
v_mfma_f32_16x16x32_bf16 v[36:39], v[100:103], v[148:151], v[36:39]
v_mfma_f32_16x16x32_bf16 v[56:59], v[104:107], v[148:151], v[56:59]
v_mfma_f32_16x16x32_bf16 v[76:79], v[108:111], v[148:151], v[76:79]
s_waitcnt lgkmcnt(0)
s_waitcnt vmcnt(10)
s_barrier
v_mfma_f32_16x16x32_bf16 v[0:3], v[80:83], v[112:115], v[0:3]
ds_read_b64_tr_b16 v[96:97], v159 offset:49152
ds_read_b64_tr_b16 v[98:99], v159 offset:51200
v_mfma_f32_16x16x32_bf16 v[20:23], v[84:87], v[112:115], v[20:23]
ds_read_b64_tr_b16 v[100:101], v159 offset:49160
s_add_u32 m0, s59, 98304
s_add_u32 s40, s45, s57
buffer_load_dwordx4 v152, s[12:15], s40 offen lds
v_mfma_f32_16x16x32_bf16 v[40:43], v[88:91], v[112:115], v[40:43]
ds_read_b64_tr_b16 v[102:103], v159 offset:51208
v_mfma_f32_16x16x32_bf16 v[60:63], v[92:95], v[112:115], v[60:63]
ds_read_b64_tr_b16 v[104:105], v160 offset:49152
ds_read_b64_tr_b16 v[106:107], v160 offset:51200
buffer_load_dwordx4 v153, s[12:15], s40 offen offset:1024 lds
v_mfma_f32_16x16x32_bf16 v[4:7], v[80:83], v[116:119], v[4:7]
ds_read_b64_tr_b16 v[108:109], v160 offset:49160
v_mfma_f32_16x16x32_bf16 v[24:27], v[84:87], v[116:119], v[24:27]
ds_read_b64_tr_b16 v[110:111], v160 offset:51208
buffer_load_dwordx4 v154, s[12:15], s40 offen offset:2048 lds
v_mfma_f32_16x16x32_bf16 v[44:47], v[88:91], v[116:119], v[44:47]
ds_read_b128 v[132:135], v168
ds_read_b128 v[136:139], v168 offset:2048
v_mfma_f32_16x16x32_bf16 v[64:67], v[92:95], v[116:119], v[64:67]
ds_read_b128 v[140:143], v168 offset:4096
v_mfma_f32_16x16x32_bf16 v[8:11], v[80:83], v[120:123], v[8:11]
ds_read_b128 v[144:147], v168 offset:6144
buffer_load_dwordx4 v155, s[12:15], s40 offen offset:3072 lds
v_mfma_f32_16x16x32_bf16 v[28:31], v[84:87], v[120:123], v[28:31]
ds_read_b128 v[148:151], v168 offset:8192
v_mfma_f32_16x16x32_bf16 v[48:51], v[88:91], v[120:123], v[48:51]
s_lshr_b32 s41, s59, 2
s_add_u32 s41, s41, s54
s_add_u32 m0, s41, 136192
s_add_u32 s40, s44, s58
s_add_u32 s40, s40, 46080
buffer_load_dwordx4 v161, s[8:11], s40 offen lds
s_add_u32 s45, s45, 262144
v_mfma_f32_16x16x32_bf16 v[68:71], v[92:95], v[120:123], v[68:71]
v_mfma_f32_16x16x32_bf16 v[12:15], v[80:83], v[124:127], v[12:15]
v_mfma_f32_16x16x32_bf16 v[32:35], v[84:87], v[124:127], v[32:35]
v_mfma_f32_16x16x32_bf16 v[52:55], v[88:91], v[124:127], v[52:55]
v_mfma_f32_16x16x32_bf16 v[72:75], v[92:95], v[124:127], v[72:75]
v_mfma_f32_16x16x32_bf16 v[16:19], v[80:83], v[128:131], v[16:19]
v_mfma_f32_16x16x32_bf16 v[36:39], v[84:87], v[128:131], v[36:39]
v_mfma_f32_16x16x32_bf16 v[56:59], v[88:91], v[128:131], v[56:59]
v_mfma_f32_16x16x32_bf16 v[76:79], v[92:95], v[128:131], v[76:79]
s_waitcnt lgkmcnt(0)
s_waitcnt vmcnt(10)
s_barrier
v_mfma_f32_16x16x32_bf16 v[0:3], v[96:99], v[132:135], v[0:3]
s_add_u32 s55, s55, 10240
s_cmp_eq_u32 s55, 30720
s_cselect_b32 s55, 0, s55
v_add_u32 v167, s55, v162
v_add_u32 v168, s55, v163
ds_read_b64_tr_b16 v[80:81], v159
v_mfma_f32_16x16x32_bf16 v[20:23], v[100:103], v[132:135], v[20:23]
ds_read_b64_tr_b16 v[82:83], v159 offset:2048
s_add_u32 m0, s59, 114688
s_add_u32 s40, s45, s57
buffer_load_dwordx4 v152, s[12:15], s40 offen lds
v_mfma_f32_16x16x32_bf16 v[40:43], v[104:107], v[132:135], v[40:43]
ds_read_b64_tr_b16 v[84:85], v159 offset:8
ds_read_b64_tr_b16 v[86:87], v159 offset:2056
v_mfma_f32_16x16x32_bf16 v[60:63], v[108:111], v[132:135], v[60:63]
ds_read_b64_tr_b16 v[88:89], v160
buffer_load_dwordx4 v153, s[12:15], s40 offen offset:1024 lds
v_mfma_f32_16x16x32_bf16 v[4:7], v[96:99], v[136:139], v[4:7]
ds_read_b64_tr_b16 v[90:91], v160 offset:2048
v_mfma_f32_16x16x32_bf16 v[24:27], v[100:103], v[136:139], v[24:27]
ds_read_b64_tr_b16 v[92:93], v160 offset:8
ds_read_b64_tr_b16 v[94:95], v160 offset:2056
buffer_load_dwordx4 v154, s[12:15], s40 offen offset:2048 lds
v_mfma_f32_16x16x32_bf16 v[44:47], v[104:107], v[136:139], v[44:47]
ds_read_b128 v[112:115], v167
v_mfma_f32_16x16x32_bf16 v[64:67], v[108:111], v[136:139], v[64:67]
ds_read_b128 v[116:119], v167 offset:2048
ds_read_b128 v[120:123], v167 offset:4096
v_mfma_f32_16x16x32_bf16 v[8:11], v[96:99], v[140:143], v[8:11]
ds_read_b128 v[124:127], v167 offset:6144
buffer_load_dwordx4 v155, s[12:15], s40 offen offset:3072 lds
v_mfma_f32_16x16x32_bf16 v[28:31], v[100:103], v[140:143], v[28:31]
ds_read_b128 v[128:131], v167 offset:8192
v_mfma_f32_16x16x32_bf16 v[48:51], v[104:107], v[140:143], v[48:51]
s_add_u32 s44, s44, 128
s_add_u32 s54, s54, 10240
s_cmp_eq_u32 s54, 30720
s_cselect_b32 s54, 0, s54
s_lshr_b32 s41, s59, 2
s_add_u32 s41, s41, s54
s_add_u32 m0, s41, 131072
s_add_u32 s40, s44, s58
buffer_load_dwordx4 v156, s[8:11], s40 offen lds
s_add_u32 s45, s45, 262144
v_mfma_f32_16x16x32_bf16 v[68:71], v[108:111], v[140:143], v[68:71]
v_mfma_f32_16x16x32_bf16 v[12:15], v[96:99], v[144:147], v[12:15]
v_mfma_f32_16x16x32_bf16 v[32:35], v[100:103], v[144:147], v[32:35]
v_mfma_f32_16x16x32_bf16 v[52:55], v[104:107], v[144:147], v[52:55]
v_mfma_f32_16x16x32_bf16 v[72:75], v[108:111], v[144:147], v[72:75]
v_mfma_f32_16x16x32_bf16 v[16:19], v[96:99], v[148:151], v[16:19]
v_mfma_f32_16x16x32_bf16 v[36:39], v[100:103], v[148:151], v[36:39]
v_mfma_f32_16x16x32_bf16 v[56:59], v[104:107], v[148:151], v[56:59]
v_mfma_f32_16x16x32_bf16 v[76:79], v[108:111], v[148:151], v[76:79]
s_waitcnt lgkmcnt(0)
s_add_u32 s38, s38, 1
s_cmp_lt_u32 s38, 3
s_cbranch_scc1 qloop_86
s_lshr_b32 s40, s49, 1
s_or_b32 s40, s40, s3
s_cmp_lg_u32 s40, 0
s_cbranch_scc1 fpub_87
s_lshl_b32 s40, s97, 2
v_mov_b32 v226, s40
v_mov_b32 v227, 1
s_mov_b64 s[42:43], exec
s_mov_b64 exec, 1
global_atomic_add v226, v227, s[68:69] sc1
s_mov_b64 exec, s[42:43]
fpub_87:
s_waitcnt vmcnt(10)
s_barrier
v_mfma_f32_16x16x32_bf16 v[0:3], v[80:83], v[112:115], v[0:3]
ds_read_b64_tr_b16 v[96:97], v159 offset:16384
ds_read_b64_tr_b16 v[98:99], v159 offset:18432
v_mfma_f32_16x16x32_bf16 v[20:23], v[84:87], v[112:115], v[20:23]
ds_read_b64_tr_b16 v[100:101], v159 offset:16392
s_add_u32 m0, s59, 65536
s_add_u32 s40, s45, s57
buffer_load_dwordx4 v152, s[12:15], s40 offen lds
v_mfma_f32_16x16x32_bf16 v[40:43], v[88:91], v[112:115], v[40:43]
ds_read_b64_tr_b16 v[102:103], v159 offset:18440
v_mfma_f32_16x16x32_bf16 v[60:63], v[92:95], v[112:115], v[60:63]
ds_read_b64_tr_b16 v[104:105], v160 offset:16384
ds_read_b64_tr_b16 v[106:107], v160 offset:18432
buffer_load_dwordx4 v153, s[12:15], s40 offen offset:1024 lds
v_mfma_f32_16x16x32_bf16 v[4:7], v[80:83], v[116:119], v[4:7]
ds_read_b64_tr_b16 v[108:109], v160 offset:16392
v_mfma_f32_16x16x32_bf16 v[24:27], v[84:87], v[116:119], v[24:27]
ds_read_b64_tr_b16 v[110:111], v160 offset:18440
buffer_load_dwordx4 v154, s[12:15], s40 offen offset:2048 lds
v_mfma_f32_16x16x32_bf16 v[44:47], v[88:91], v[116:119], v[44:47]
ds_read_b128 v[132:135], v168
ds_read_b128 v[136:139], v168 offset:2048
v_mfma_f32_16x16x32_bf16 v[64:67], v[92:95], v[116:119], v[64:67]
ds_read_b128 v[140:143], v168 offset:4096
v_mfma_f32_16x16x32_bf16 v[8:11], v[80:83], v[120:123], v[8:11]
ds_read_b128 v[144:147], v168 offset:6144
buffer_load_dwordx4 v155, s[12:15], s40 offen offset:3072 lds
v_mfma_f32_16x16x32_bf16 v[28:31], v[84:87], v[120:123], v[28:31]
ds_read_b128 v[148:151], v168 offset:8192
v_mfma_f32_16x16x32_bf16 v[48:51], v[88:91], v[120:123], v[48:51]
s_lshr_b32 s41, s59, 2
s_add_u32 s41, s41, s54
s_add_u32 m0, s41, 136192
s_add_u32 s40, s44, s58
s_add_u32 s40, s40, 46080
buffer_load_dwordx4 v161, s[8:11], s40 offen lds
s_add_u32 s45, s45, 262144
v_mfma_f32_16x16x32_bf16 v[68:71], v[92:95], v[120:123], v[68:71]
v_mfma_f32_16x16x32_bf16 v[12:15], v[80:83], v[124:127], v[12:15]
v_mfma_f32_16x16x32_bf16 v[32:35], v[84:87], v[124:127], v[32:35]
v_mfma_f32_16x16x32_bf16 v[52:55], v[88:91], v[124:127], v[52:55]
v_mfma_f32_16x16x32_bf16 v[72:75], v[92:95], v[124:127], v[72:75]
v_mfma_f32_16x16x32_bf16 v[16:19], v[80:83], v[128:131], v[16:19]
v_mfma_f32_16x16x32_bf16 v[36:39], v[84:87], v[128:131], v[36:39]
v_mfma_f32_16x16x32_bf16 v[56:59], v[88:91], v[128:131], v[56:59]
v_mfma_f32_16x16x32_bf16 v[76:79], v[92:95], v[128:131], v[76:79]
s_waitcnt lgkmcnt(0)
s_waitcnt vmcnt(10)
s_barrier
v_mfma_f32_16x16x32_bf16 v[0:3], v[96:99], v[132:135], v[0:3]
s_add_u32 s55, s55, 10240
s_cmp_eq_u32 s55, 30720
s_cselect_b32 s55, 0, s55
v_add_u32 v167, s55, v162
v_add_u32 v168, s55, v163
ds_read_b64_tr_b16 v[80:81], v159 offset:32768
v_mfma_f32_16x16x32_bf16 v[20:23], v[100:103], v[132:135], v[20:23]
ds_read_b64_tr_b16 v[82:83], v159 offset:34816
s_add_u32 m0, s59, 81920
s_add_u32 s40, s45, s57
buffer_load_dwordx4 v152, s[12:15], s40 offen lds
v_mfma_f32_16x16x32_bf16 v[40:43], v[104:107], v[132:135], v[40:43]
ds_read_b64_tr_b16 v[84:85], v159 offset:32776
ds_read_b64_tr_b16 v[86:87], v159 offset:34824
v_mfma_f32_16x16x32_bf16 v[60:63], v[108:111], v[132:135], v[60:63]
ds_read_b64_tr_b16 v[88:89], v160 offset:32768
buffer_load_dwordx4 v153, s[12:15], s40 offen offset:1024 lds
v_mfma_f32_16x16x32_bf16 v[4:7], v[96:99], v[136:139], v[4:7]
ds_read_b64_tr_b16 v[90:91], v160 offset:34816
v_mfma_f32_16x16x32_bf16 v[24:27], v[100:103], v[136:139], v[24:27]
ds_read_b64_tr_b16 v[92:93], v160 offset:32776
ds_read_b64_tr_b16 v[94:95], v160 offset:34824
buffer_load_dwordx4 v154, s[12:15], s40 offen offset:2048 lds
v_mfma_f32_16x16x32_bf16 v[44:47], v[104:107], v[136:139], v[44:47]
ds_read_b128 v[112:115], v167
v_mfma_f32_16x16x32_bf16 v[64:67], v[108:111], v[136:139], v[64:67]
ds_read_b128 v[116:119], v167 offset:2048
ds_read_b128 v[120:123], v167 offset:4096
v_mfma_f32_16x16x32_bf16 v[8:11], v[96:99], v[140:143], v[8:11]
ds_read_b128 v[124:127], v167 offset:6144
buffer_load_dwordx4 v155, s[12:15], s40 offen offset:3072 lds
v_mfma_f32_16x16x32_bf16 v[28:31], v[100:103], v[140:143], v[28:31]
ds_read_b128 v[128:131], v167 offset:8192
v_mfma_f32_16x16x32_bf16 v[48:51], v[104:107], v[140:143], v[48:51]
s_add_u32 s44, s44, 128
s_add_u32 s54, s54, 10240
s_cmp_eq_u32 s54, 30720
s_cselect_b32 s54, 0, s54
s_lshr_b32 s41, s59, 2
s_add_u32 s41, s41, s54
s_add_u32 m0, s41, 131072
s_add_u32 s40, s44, s58
buffer_load_dwordx4 v156, s[8:11], s40 offen lds
s_add_u32 s45, s45, 262144
v_mfma_f32_16x16x32_bf16 v[68:71], v[108:111], v[140:143], v[68:71]
v_mfma_f32_16x16x32_bf16 v[12:15], v[96:99], v[144:147], v[12:15]
v_mfma_f32_16x16x32_bf16 v[32:35], v[100:103], v[144:147], v[32:35]
v_mfma_f32_16x16x32_bf16 v[52:55], v[104:107], v[144:147], v[52:55]
v_mfma_f32_16x16x32_bf16 v[72:75], v[108:111], v[144:147], v[72:75]
v_mfma_f32_16x16x32_bf16 v[16:19], v[96:99], v[148:151], v[16:19]
v_mfma_f32_16x16x32_bf16 v[36:39], v[100:103], v[148:151], v[36:39]
v_mfma_f32_16x16x32_bf16 v[56:59], v[104:107], v[148:151], v[56:59]
v_mfma_f32_16x16x32_bf16 v[76:79], v[108:111], v[148:151], v[76:79]
s_waitcnt lgkmcnt(0)
s_waitcnt vmcnt(10)
s_barrier
v_mfma_f32_16x16x32_bf16 v[0:3], v[80:83], v[112:115], v[0:3]
ds_read_b64_tr_b16 v[96:97], v159 offset:49152
ds_read_b64_tr_b16 v[98:99], v159 offset:51200
v_mfma_f32_16x16x32_bf16 v[20:23], v[84:87], v[112:115], v[20:23]
ds_read_b64_tr_b16 v[100:101], v159 offset:49160
v_mfma_f32_16x16x32_bf16 v[40:43], v[88:91], v[112:115], v[40:43]
ds_read_b64_tr_b16 v[102:103], v159 offset:51208
v_mfma_f32_16x16x32_bf16 v[60:63], v[92:95], v[112:115], v[60:63]
ds_read_b64_tr_b16 v[104:105], v160 offset:49152
ds_read_b64_tr_b16 v[106:107], v160 offset:51200
v_mfma_f32_16x16x32_bf16 v[4:7], v[80:83], v[116:119], v[4:7]
ds_read_b64_tr_b16 v[108:109], v160 offset:49160
v_mfma_f32_16x16x32_bf16 v[24:27], v[84:87], v[116:119], v[24:27]
ds_read_b64_tr_b16 v[110:111], v160 offset:51208
v_mfma_f32_16x16x32_bf16 v[44:47], v[88:91], v[116:119], v[44:47]
ds_read_b128 v[132:135], v168
ds_read_b128 v[136:139], v168 offset:2048
v_mfma_f32_16x16x32_bf16 v[64:67], v[92:95], v[116:119], v[64:67]
ds_read_b128 v[140:143], v168 offset:4096
v_mfma_f32_16x16x32_bf16 v[8:11], v[80:83], v[120:123], v[8:11]
ds_read_b128 v[144:147], v168 offset:6144
v_mfma_f32_16x16x32_bf16 v[28:31], v[84:87], v[120:123], v[28:31]
ds_read_b128 v[148:151], v168 offset:8192
v_mfma_f32_16x16x32_bf16 v[48:51], v[88:91], v[120:123], v[48:51]
v_mfma_f32_16x16x32_bf16 v[68:71], v[92:95], v[120:123], v[68:71]
v_mfma_f32_16x16x32_bf16 v[12:15], v[80:83], v[124:127], v[12:15]
v_mfma_f32_16x16x32_bf16 v[32:35], v[84:87], v[124:127], v[32:35]
v_mfma_f32_16x16x32_bf16 v[52:55], v[88:91], v[124:127], v[52:55]
v_mfma_f32_16x16x32_bf16 v[72:75], v[92:95], v[124:127], v[72:75]
v_mfma_f32_16x16x32_bf16 v[16:19], v[80:83], v[128:131], v[16:19]
v_mfma_f32_16x16x32_bf16 v[36:39], v[84:87], v[128:131], v[36:39]
v_mfma_f32_16x16x32_bf16 v[56:59], v[88:91], v[128:131], v[56:59]
v_mfma_f32_16x16x32_bf16 v[76:79], v[92:95], v[128:131], v[76:79]
s_waitcnt lgkmcnt(0)
s_waitcnt vmcnt(5)
s_barrier
v_mfma_f32_16x16x32_bf16 v[0:3], v[96:99], v[132:135], v[0:3]
s_add_u32 s55, s55, 10240
s_cmp_eq_u32 s55, 30720
s_cselect_b32 s55, 0, s55
v_add_u32 v167, s55, v162
v_add_u32 v168, s55, v163
ds_read_b64_tr_b16 v[80:81], v159
v_mfma_f32_16x16x32_bf16 v[20:23], v[100:103], v[132:135], v[20:23]
ds_read_b64_tr_b16 v[82:83], v159 offset:2048
v_mfma_f32_16x16x32_bf16 v[40:43], v[104:107], v[132:135], v[40:43]
ds_read_b64_tr_b16 v[84:85], v159 offset:8
ds_read_b64_tr_b16 v[86:87], v159 offset:2056
v_mfma_f32_16x16x32_bf16 v[60:63], v[108:111], v[132:135], v[60:63]
ds_read_b64_tr_b16 v[88:89], v160
v_mfma_f32_16x16x32_bf16 v[4:7], v[96:99], v[136:139], v[4:7]
ds_read_b64_tr_b16 v[90:91], v160 offset:2048
v_mfma_f32_16x16x32_bf16 v[24:27], v[100:103], v[136:139], v[24:27]
ds_read_b64_tr_b16 v[92:93], v160 offset:8
ds_read_b64_tr_b16 v[94:95], v160 offset:2056
v_mfma_f32_16x16x32_bf16 v[44:47], v[104:107], v[136:139], v[44:47]
ds_read_b128 v[112:115], v167
v_mfma_f32_16x16x32_bf16 v[64:67], v[108:111], v[136:139], v[64:67]
ds_read_b128 v[116:119], v167 offset:2048
ds_read_b128 v[120:123], v167 offset:4096
v_mfma_f32_16x16x32_bf16 v[8:11], v[96:99], v[140:143], v[8:11]
ds_read_b128 v[124:127], v167 offset:6144
v_mfma_f32_16x16x32_bf16 v[28:31], v[100:103], v[140:143], v[28:31]
ds_read_b128 v[128:131], v167 offset:8192
v_mfma_f32_16x16x32_bf16 v[48:51], v[104:107], v[140:143], v[48:51]
v_mfma_f32_16x16x32_bf16 v[68:71], v[108:111], v[140:143], v[68:71]
v_mfma_f32_16x16x32_bf16 v[12:15], v[96:99], v[144:147], v[12:15]
v_mfma_f32_16x16x32_bf16 v[32:35], v[100:103], v[144:147], v[32:35]
v_mfma_f32_16x16x32_bf16 v[52:55], v[104:107], v[144:147], v[52:55]
v_mfma_f32_16x16x32_bf16 v[72:75], v[108:111], v[144:147], v[72:75]
v_mfma_f32_16x16x32_bf16 v[16:19], v[96:99], v[148:151], v[16:19]
v_mfma_f32_16x16x32_bf16 v[36:39], v[100:103], v[148:151], v[36:39]
v_mfma_f32_16x16x32_bf16 v[56:59], v[104:107], v[148:151], v[56:59]
v_mfma_f32_16x16x32_bf16 v[76:79], v[108:111], v[148:151], v[76:79]
s_waitcnt lgkmcnt(0)
s_waitcnt vmcnt(0)
s_barrier
v_mfma_f32_16x16x32_bf16 v[0:3], v[80:83], v[112:115], v[0:3]
ds_read_b64_tr_b16 v[96:97], v159 offset:16384
ds_read_b64_tr_b16 v[98:99], v159 offset:18432
v_mfma_f32_16x16x32_bf16 v[20:23], v[84:87], v[112:115], v[20:23]
ds_read_b64_tr_b16 v[100:101], v159 offset:16392
v_mfma_f32_16x16x32_bf16 v[40:43], v[88:91], v[112:115], v[40:43]
ds_read_b64_tr_b16 v[102:103], v159 offset:18440
v_mfma_f32_16x16x32_bf16 v[60:63], v[92:95], v[112:115], v[60:63]
ds_read_b64_tr_b16 v[104:105], v160 offset:16384
ds_read_b64_tr_b16 v[106:107], v160 offset:18432
v_mfma_f32_16x16x32_bf16 v[4:7], v[80:83], v[116:119], v[4:7]
ds_read_b64_tr_b16 v[108:109], v160 offset:16392
v_mfma_f32_16x16x32_bf16 v[24:27], v[84:87], v[116:119], v[24:27]
ds_read_b64_tr_b16 v[110:111], v160 offset:18440
v_mfma_f32_16x16x32_bf16 v[44:47], v[88:91], v[116:119], v[44:47]
ds_read_b128 v[132:135], v168
ds_read_b128 v[136:139], v168 offset:2048
v_mfma_f32_16x16x32_bf16 v[64:67], v[92:95], v[116:119], v[64:67]
ds_read_b128 v[140:143], v168 offset:4096
v_mfma_f32_16x16x32_bf16 v[8:11], v[80:83], v[120:123], v[8:11]
ds_read_b128 v[144:147], v168 offset:6144
v_mfma_f32_16x16x32_bf16 v[28:31], v[84:87], v[120:123], v[28:31]
ds_read_b128 v[148:151], v168 offset:8192
v_mfma_f32_16x16x32_bf16 v[48:51], v[88:91], v[120:123], v[48:51]
v_mfma_f32_16x16x32_bf16 v[68:71], v[92:95], v[120:123], v[68:71]
v_mfma_f32_16x16x32_bf16 v[12:15], v[80:83], v[124:127], v[12:15]
v_mfma_f32_16x16x32_bf16 v[32:35], v[84:87], v[124:127], v[32:35]
v_mfma_f32_16x16x32_bf16 v[52:55], v[88:91], v[124:127], v[52:55]
v_mfma_f32_16x16x32_bf16 v[72:75], v[92:95], v[124:127], v[72:75]
v_mfma_f32_16x16x32_bf16 v[16:19], v[80:83], v[128:131], v[16:19]
v_mfma_f32_16x16x32_bf16 v[36:39], v[84:87], v[128:131], v[36:39]
v_mfma_f32_16x16x32_bf16 v[56:59], v[88:91], v[128:131], v[56:59]
v_mfma_f32_16x16x32_bf16 v[76:79], v[92:95], v[128:131], v[76:79]
s_waitcnt lgkmcnt(0)
v_mfma_f32_16x16x32_bf16 v[0:3], v[96:99], v[132:135], v[0:3]
v_mfma_f32_16x16x32_bf16 v[20:23], v[100:103], v[132:135], v[20:23]
v_mfma_f32_16x16x32_bf16 v[40:43], v[104:107], v[132:135], v[40:43]
v_mfma_f32_16x16x32_bf16 v[60:63], v[108:111], v[132:135], v[60:63]
v_mfma_f32_16x16x32_bf16 v[4:7], v[96:99], v[136:139], v[4:7]
v_mfma_f32_16x16x32_bf16 v[24:27], v[100:103], v[136:139], v[24:27]
v_mfma_f32_16x16x32_bf16 v[44:47], v[104:107], v[136:139], v[44:47]
v_mfma_f32_16x16x32_bf16 v[64:67], v[108:111], v[136:139], v[64:67]
v_mfma_f32_16x16x32_bf16 v[8:11], v[96:99], v[140:143], v[8:11]
v_mfma_f32_16x16x32_bf16 v[28:31], v[100:103], v[140:143], v[28:31]
v_mfma_f32_16x16x32_bf16 v[48:51], v[104:107], v[140:143], v[48:51]
v_mfma_f32_16x16x32_bf16 v[68:71], v[108:111], v[140:143], v[68:71]
v_mfma_f32_16x16x32_bf16 v[12:15], v[96:99], v[144:147], v[12:15]
v_mfma_f32_16x16x32_bf16 v[32:35], v[100:103], v[144:147], v[32:35]
v_mfma_f32_16x16x32_bf16 v[52:55], v[104:107], v[144:147], v[52:55]
v_mfma_f32_16x16x32_bf16 v[72:75], v[108:111], v[144:147], v[72:75]
v_mfma_f32_16x16x32_bf16 v[16:19], v[96:99], v[148:151], v[16:19]
v_mfma_f32_16x16x32_bf16 v[36:39], v[100:103], v[148:151], v[36:39]
v_mfma_f32_16x16x32_bf16 v[56:59], v[104:107], v[148:151], v[56:59]
v_mfma_f32_16x16x32_bf16 v[76:79], v[108:111], v[148:151], v[76:79]
qdone_81:
s_barrier
v_cvt_pk_bf16_f32 v80, v0, v1
v_cvt_pk_bf16_f32 v81, v2, v3
v_cvt_pk_bf16_f32 v82, v20, v21
v_cvt_pk_bf16_f32 v83, v22, v23
v_cvt_pk_bf16_f32 v84, v4, v5
v_cvt_pk_bf16_f32 v85, v6, v7
v_cvt_pk_bf16_f32 v86, v24, v25
v_cvt_pk_bf16_f32 v87, v26, v27
v_cvt_pk_bf16_f32 v88, v8, v9
v_cvt_pk_bf16_f32 v89, v10, v11
v_cvt_pk_bf16_f32 v90, v28, v29
v_cvt_pk_bf16_f32 v91, v30, v31
v_cvt_pk_bf16_f32 v92, v12, v13
v_cvt_pk_bf16_f32 v93, v14, v15
v_cvt_pk_bf16_f32 v94, v32, v33
v_cvt_pk_bf16_f32 v95, v34, v35
v_cvt_pk_bf16_f32 v96, v16, v17
v_cvt_pk_bf16_f32 v97, v18, v19
v_cvt_pk_bf16_f32 v98, v36, v37
v_cvt_pk_bf16_f32 v99, v38, v39
v_cvt_pk_bf16_f32 v100, v40, v41
v_cvt_pk_bf16_f32 v101, v42, v43
v_cvt_pk_bf16_f32 v102, v60, v61
v_cvt_pk_bf16_f32 v103, v62, v63
v_cvt_pk_bf16_f32 v104, v44, v45
v_cvt_pk_bf16_f32 v105, v46, v47
v_cvt_pk_bf16_f32 v106, v64, v65
v_cvt_pk_bf16_f32 v107, v66, v67
v_cvt_pk_bf16_f32 v108, v48, v49
v_cvt_pk_bf16_f32 v109, v50, v51
v_cvt_pk_bf16_f32 v110, v68, v69
v_cvt_pk_bf16_f32 v111, v70, v71
v_cvt_pk_bf16_f32 v112, v52, v53
v_cvt_pk_bf16_f32 v113, v54, v55
v_cvt_pk_bf16_f32 v114, v72, v73
v_cvt_pk_bf16_f32 v115, v74, v75
v_cvt_pk_bf16_f32 v116, v56, v57
v_cvt_pk_bf16_f32 v117, v58, v59
v_cvt_pk_bf16_f32 v118, v76, v77
v_cvt_pk_bf16_f32 v119, v78, v79
s_lshl_b32 s40, s3, 14
s_add_u32 s40, s40, 65536
v_add_u32 v164, s40, v209
s_lshl_b32 s41, s3, 11
s_add_u32 s41, s41, 131072
v_add_u32 v165, s41, v209
ds_write_b128 v164, v[80:83]
ds_write_b128 v164, v[84:87] offset:1024
ds_write_b128 v164, v[88:91] offset:2048
ds_write_b128 v164, v[92:95] offset:3072
ds_write_b128 v164, v[96:99] offset:4096
ds_write_b128 v164, v[100:103] offset:5120
ds_write_b128 v164, v[104:107] offset:6144
ds_write_b128 v164, v[108:111] offset:7168
ds_write_b128 v165, v[112:115]
ds_write_b128 v165, v[116:119] offset:1024
s_waitcnt lgkmcnt(0)
s_barrier
s_cmp_eq_u32 s53, 1
s_cbranch_scc1 qs_h1_88
s_lshl_b32 s40, s52, 15
s_add_u32 s40, s40, 65536
v_add_u32 v164, s40, v209
s_lshl_b32 s40, s52, 12
s_add_u32 s40, s40, 131072
v_add_u32 v165, s40, v209
ds_read_b128 a[0:3], v164
ds_read_b128 a[4:7], v164 offset:1024
ds_read_b128 a[8:11], v164 offset:2048
ds_read_b128 a[20:23], v164 offset:5120
ds_read_b128 a[24:27], v164 offset:6144
ds_read_b128 a[28:31], v164 offset:7168
ds_read_b128 a[40:43], v164 offset:16384
ds_read_b128 a[44:47], v164 offset:17408
ds_read_b128 a[48:51], v164 offset:18432
ds_read_b128 a[60:63], v164 offset:21504
ds_read_b128 a[64:67], v164 offset:22528
ds_read_b128 a[68:71], v164 offset:23552
s_waitcnt lgkmcnt(0)
s_barrier
s_waitcnt vmcnt(63)
s_barrier
ds_read_b128 a[160:163], v191
ds_read_b128 a[176:179], v191 offset:4096
ds_read_b128 a[164:167], v192
ds_read_b128 a[180:183], v192 offset:4096
ds_read_b128 a[168:171], v193
ds_read_b128 a[184:187], v193 offset:4096
ds_read_b128 a[172:175], v194
ds_read_b128 a[188:191], v194 offset:4096
v_mov_b32 v64, 0
v_mov_b32 v65, 0
v_mov_b32 v66, 0
v_mov_b32 v67, 0
v_mov_b32 v68, 0
v_mov_b32 v69, 0
v_mov_b32 v70, 0
v_mov_b32 v71, 0
v_mov_b32 v72, 0
v_mov_b32 v73, 0
v_mov_b32 v74, 0
v_mov_b32 v75, 0
v_mov_b32 v76, 0
v_mov_b32 v77, 0
v_mov_b32 v78, 0
v_mov_b32 v79, 0
v_mov_b32 v80, 0
v_mov_b32 v81, 0
v_mov_b32 v82, 0
v_mov_b32 v83, 0
v_mov_b32 v84, 0
v_mov_b32 v85, 0
v_mov_b32 v86, 0
v_mov_b32 v87, 0
v_mov_b32 v88, 0
v_mov_b32 v89, 0
v_mov_b32 v90, 0
v_mov_b32 v91, 0
v_mov_b32 v92, 0
v_mov_b32 v93, 0
v_mov_b32 v94, 0
v_mov_b32 v95, 0
v_mov_b32 v189, 0
v_accvgpr_write_b32 a232, v189
v_accvgpr_write_b32 a233, v189
v_accvgpr_write_b32 a234, v189
v_accvgpr_write_b32 a235, v189
s_waitcnt lgkmcnt(0)
v_mfma_f32_16x16x32_bf16 v[160:163], a[160:163], a[0:3], 0
v_mfma_f32_16x16x32_bf16 v[164:167], a[176:179], a[0:3], 0
v_mfma_f32_16x16x32_bf16 v[160:163], a[164:167], a[20:23], v[160:163]
v_mfma_f32_16x16x32_bf16 v[164:167], a[180:183], a[20:23], v[164:167]
v_mfma_f32_16x16x32_bf16 v[160:163], a[168:171], a[40:43], v[160:163]
v_mfma_f32_16x16x32_bf16 v[164:167], a[184:187], a[40:43], v[164:167]
v_mfma_f32_16x16x32_bf16 v[160:163], a[172:175], a[60:63], v[160:163]
v_mfma_f32_16x16x32_bf16 v[164:167], a[188:191], a[60:63], v[164:167]
v_mfma_f32_16x16x32_bf16 v[168:171], a[160:163], a[4:7], 0
s_nop 5
v_max3_f32 v189, v160, v161, v162
v_max3_f32 v190, v163, v164, v165
v_max3_f32 v189, v189, v166, v167
v_mfma_f32_16x16x32_bf16 v[172:175], a[176:179], a[4:7], 0
v_max_f32 v189, v189, v190
v_mov_b32 v190, v189
s_nop 1
v_permlane32_swap_b32 v189, v190
v_max_f32 v189, v189, v190
v_mfma_f32_16x16x32_bf16 v[168:171], a[164:167], a[24:27], v[168:171]
v_mov_b32 v190, v189
s_nop 1
v_permlane16_swap_b32 v189, v190
v_max_f32 v189, v189, v190
v_mfma_f32_16x16x32_bf16 v[172:175], a[180:183], a[24:27], v[172:175]
v_mul_f32 v184, s28, v189
v_fma_f32 v160, v160, s28, -v184
v_fma_f32 v161, v161, s28, -v184
v_mfma_f32_16x16x32_bf16 v[168:171], a[168:171], a[44:47], v[168:171]
v_fma_f32 v162, v162, s28, -v184
v_fma_f32 v163, v163, s28, -v184
v_fma_f32 v164, v164, s28, -v184
v_fma_f32 v165, v165, s28, -v184
v_mfma_f32_16x16x32_bf16 v[172:175], a[184:187], a[44:47], v[172:175]
v_fma_f32 v166, v166, s28, -v184
v_fma_f32 v167, v167, s28, -v184
v_exp_f32 v160, v160
v_mfma_f32_16x16x32_bf16 v[168:171], a[172:175], a[64:67], v[168:171]
v_exp_f32 v161, v161
v_mfma_f32_16x16x32_bf16 v[172:175], a[188:191], a[64:67], v[172:175]
v_exp_f32 v162, v162
v_exp_f32 v163, v163
s_waitcnt vmcnt(63)
s_barrier
v_exp_f32 v164, v164
ds_read_b64_tr_b16 a[192:193], v195 offset:8192
ds_read_b64_tr_b16 a[194:195], v195 offset:12288
ds_read_b64_tr_b16 a[196:197], v196 offset:8192
ds_read_b64_tr_b16 a[198:199], v196 offset:12288
v_exp_f32 v165, v165
ds_read_b64_tr_b16 a[200:201], v197 offset:8192
ds_read_b64_tr_b16 a[202:203], v197 offset:12288
v_exp_f32 v166, v166
ds_read_b64_tr_b16 a[204:205], v198 offset:8192
ds_read_b64_tr_b16 a[206:207], v198 offset:12288
ds_read_b64_tr_b16 a[208:209], v199 offset:8192
ds_read_b64_tr_b16 a[210:211], v199 offset:12288
v_exp_f32 v167, v167
ds_read_b64_tr_b16 a[212:213], v200 offset:8192
ds_read_b64_tr_b16 a[214:215], v200 offset:12288
v_cvt_pk_bf16_f32 v176, v160, v161
ds_read_b64_tr_b16 a[216:217], v201 offset:8192
ds_read_b64_tr_b16 a[218:219], v201 offset:12288
v_cvt_pk_bf16_f32 v177, v162, v163
v_cvt_pk_bf16_f32 v178, v164, v165
ds_read_b64_tr_b16 a[220:221], v202 offset:8192
ds_read_b64_tr_b16 a[222:223], v202 offset:12288
v_cvt_pk_bf16_f32 v179, v166, v167
s_waitcnt vmcnt(63)
s_barrier
v_mfma_f32_16x16x32_bf16 v[160:163], a[160:163], a[8:11], 0
ds_read_b128 a[160:163], v191 offset:16384
v_mfma_f32_16x16x32_bf16 v[164:167], a[176:179], a[8:11], 0
ds_read_b128 a[176:179], v191 offset:20480
v_max3_f32 v189, v168, v169, v170
v_max3_f32 v190, v171, v172, v173
v_mfma_f32_16x16x32_bf16 v[160:163], a[164:167], a[28:31], v[160:163]
ds_read_b128 a[164:167], v192 offset:16384
v_max3_f32 v189, v189, v174, v175
v_max_f32 v189, v189, v190
v_mfma_f32_16x16x32_bf16 v[164:167], a[180:183], a[28:31], v[164:167]
ds_read_b128 a[180:183], v192 offset:20480
v_mov_b32 v190, v189
s_nop 1
v_permlane32_swap_b32 v189, v190
v_mfma_f32_16x16x32_bf16 v[160:163], a[168:171], a[48:51], v[160:163]
ds_read_b128 a[168:171], v193 offset:16384
v_max_f32 v189, v189, v190
v_mov_b32 v190, v189
v_mfma_f32_16x16x32_bf16 v[164:167], a[184:187], a[48:51], v[164:167]
ds_read_b128 a[184:187], v193 offset:20480
v_permlane16_swap_b32 v189, v190
v_max_f32 v189, v189, v190
v_mfma_f32_16x16x32_bf16 v[160:163], a[172:175], a[68:71], v[160:163]
ds_read_b128 a[172:175], v194 offset:16384
v_mul_f32 v185, s28, v189
v_fma_f32 v168, v168, s28, -v185
v_mfma_f32_16x16x32_bf16 v[164:167], a[188:191], a[68:71], v[164:167]
ds_read_b128 a[188:191], v194 offset:20480
v_fma_f32 v169, v169, s28, -v185
v_fma_f32 v170, v170, s28, -v185
s_waitcnt lgkmcnt(8)
v_mfma_f32_16x16x32_bf16 v[0:3], a[192:195], v[176:179], 0
v_fma_f32 v171, v171, s28, -v185
v_mfma_f32_16x16x32_bf16 v[4:7], a[196:199], v[176:179], 0
v_fma_f32 v172, v172, s28, -v185
v_fma_f32 v173, v173, s28, -v185
v_fma_f32 v174, v174, s28, -v185
v_mfma_f32_16x16x32_bf16 v[8:11], a[200:203], v[176:179], 0
v_fma_f32 v175, v175, s28, -v185
v_exp_f32 v168, v168
v_mfma_f32_16x16x32_bf16 v[12:15], a[204:207], v[176:179], 0
v_exp_f32 v169, v169
v_exp_f32 v170, v170
v_mfma_f32_16x16x32_bf16 v[16:19], a[208:211], v[176:179], 0
v_exp_f32 v171, v171
v_mfma_f32_16x16x32_bf16 v[20:23], a[212:215], v[176:179], 0
v_exp_f32 v172, v172
v_exp_f32 v173, v173
v_mfma_f32_16x16x32_bf16 v[24:27], a[216:219], v[176:179], 0
v_exp_f32 v174, v174
v_mfma_f32_16x16x32_bf16 v[28:31], a[220:223], v[176:179], 0
v_exp_f32 v175, v175
v_cvt_pk_bf16_f32 v180, v168, v169
v_mfma_f32_16x16x32_bf16 a[224:227], a[244:247], v[176:179], 0
v_cvt_pk_bf16_f32 v181, v170, v171
v_cvt_pk_bf16_f32 v182, v172, v173
v_cvt_pk_bf16_f32 v183, v174, v175
s_waitcnt lgkmcnt(0)
v_mfma_f32_16x16x32_bf16 v[168:171], a[160:163], a[0:3], 0
v_max3_f32 v189, v160, v161, v162
v_max3_f32 v190, v163, v164, v165
v_mfma_f32_16x16x32_bf16 v[172:175], a[176:179], a[0:3], 0
s_add_u32 s40, s34, s32
s_and_b32 s40, s40, 31
s_lshl_b32 s40, s40, 13
s_lshr_b32 s41, s34, 5
s_lshl_b32 s41, s41, 18
s_add_u32 s40, s40, s41
s_add_u32 s35, s40, s33
s_add_u32 s34, s34, 1
s_add_u32 m0, s37, 49152
s_nop 0
buffer_load_dwordx4 v203, s[16:19], s35 offen nt lds
v_mfma_f32_16x16x32_bf16 v[168:171], a[164:167], a[20:23], v[168:171]
v_mfma_f32_16x16x32_bf16 v[172:175], a[180:183], a[20:23], v[172:175]
buffer_load_dwordx4 v204, s[16:19], s35 offen offset:1024 nt lds
v_mfma_f32_16x16x32_bf16 v[168:171], a[168:171], a[40:43], v[168:171]
v_max3_f32 v189, v189, v166, v167
v_mfma_f32_16x16x32_bf16 v[172:175], a[184:187], a[40:43], v[172:175]
v_max_f32 v189, v189, v190
v_mov_b32 v190, v189
s_nop 1
v_permlane32_swap_b32 v189, v190
v_max_f32 v189, v189, v190
v_mfma_f32_16x16x32_bf16 v[168:171], a[172:175], a[60:63], v[168:171]
s_add_u32 m0, s37, 57344
s_nop 0
buffer_load_dwordx4 v207, s[20:23], s35 offen nt lds
v_mfma_f32_16x16x32_bf16 v[172:175], a[188:191], a[60:63], v[172:175]
v_mov_b32 v190, v189
s_nop 1
v_permlane16_swap_b32 v189, v190
v_max_f32 v189, v189, v190
v_mfma_f32_16x16x32_bf16 v[32:35], a[192:195], v[180:183], 0
buffer_load_dwordx4 v208, s[20:23], s35 offen offset:1024 nt lds
v_mul_f32 v186, s28, v189
v_fma_f32 v160, v160, s28, -v186
v_fma_f32 v161, v161, s28, -v186
v_mfma_f32_16x16x32_bf16 v[36:39], a[196:199], v[180:183], 0
v_fma_f32 v162, v162, s28, -v186
v_fma_f32 v163, v163, s28, -v186
v_fma_f32 v164, v164, s28, -v186
v_mfma_f32_16x16x32_bf16 v[40:43], a[200:203], v[180:183], 0
v_fma_f32 v165, v165, s28, -v186
v_fma_f32 v166, v166, s28, -v186
v_fma_f32 v167, v167, s28, -v186
v_mfma_f32_16x16x32_bf16 v[44:47], a[204:207], v[180:183], 0
v_exp_f32 v160, v160
v_exp_f32 v161, v161
v_mfma_f32_16x16x32_bf16 v[48:51], a[208:211], v[180:183], 0
v_exp_f32 v162, v162
v_mfma_f32_16x16x32_bf16 v[52:55], a[212:215], v[180:183], 0
v_exp_f32 v163, v163
v_exp_f32 v164, v164
v_mfma_f32_16x16x32_bf16 v[56:59], a[216:219], v[180:183], 0
v_exp_f32 v165, v165
v_exp_f32 v166, v166
v_mfma_f32_16x16x32_bf16 v[60:63], a[220:223], v[180:183], 0
v_exp_f32 v167, v167
v_cvt_pk_bf16_f32 v176, v160, v161
v_mfma_f32_16x16x32_bf16 a[228:231], a[244:247], v[180:183], 0
v_cvt_pk_bf16_f32 v177, v162, v163
v_cvt_pk_bf16_f32 v178, v164, v165
v_cvt_pk_bf16_f32 v179, v166, v167
s_mov_b32 s38, 0
loop_89:
v_mfma_f32_16x16x32_bf16 v[160:163], a[160:163], a[4:7], 0
v_fma_f32 v168, v168, s28, -v184
v_fma_f32 v169, v169, s28, -v184
v_fma_f32 v170, v170, s28, -v184
v_mfma_f32_16x16x32_bf16 v[164:167], a[176:179], a[4:7], 0
v_fma_f32 v171, v171, s28, -v184
v_fma_f32 v172, v172, s28, -v184
v_fma_f32 v173, v173, s28, -v184
v_mfma_f32_16x16x32_bf16 v[160:163], a[164:167], a[24:27], v[160:163]
v_fma_f32 v174, v174, s28, -v184
v_fma_f32 v175, v175, s28, -v184
v_max3_f32 v189, v168, v169, v170
v_mfma_f32_16x16x32_bf16 v[164:167], a[180:183], a[24:27], v[164:167]
v_max3_f32 v190, v171, v172, v173
v_max3_f32 v189, v189, v174, v175
v_max_f32 v189, v189, v190
v_mfma_f32_16x16x32_bf16 v[160:163], a[168:171], a[44:47], v[160:163]
v_cmp_lt_f32 vcc, 0x41000000, v189
s_cbranch_vccnz stub_90
back_91:
v_exp_f32 v168, v168
v_mfma_f32_16x16x32_bf16 v[164:167], a[184:187], a[44:47], v[164:167]
v_exp_f32 v169, v169
s_nop 0
v_mfma_f32_16x16x32_bf16 v[160:163], a[172:175], a[64:67], v[160:163]
v_exp_f32 v170, v170
v_exp_f32 v171, v171
v_mfma_f32_16x16x32_bf16 v[164:167], a[188:191], a[64:67], v[164:167]
v_exp_f32 v172, v172
s_waitcnt vmcnt(8)
s_barrier
v_mfma_f32_16x16x32_bf16 v[64:67], a[192:195], v[176:179], v[64:67]
ds_read_b64_tr_b16 a[192:193], v195 offset:24576
ds_read_b64_tr_b16 a[194:195], v195 offset:28672
v_mfma_f32_16x16x32_bf16 v[68:71], a[196:199], v[176:179], v[68:71]
ds_read_b64_tr_b16 a[196:197], v196 offset:24576
ds_read_b64_tr_b16 a[198:199], v196 offset:28672
v_mfma_f32_16x16x32_bf16 v[72:75], a[200:203], v[176:179], v[72:75]
ds_read_b64_tr_b16 a[200:201], v197 offset:24576
ds_read_b64_tr_b16 a[202:203], v197 offset:28672
v_exp_f32 v173, v173
v_mfma_f32_16x16x32_bf16 v[76:79], a[204:207], v[176:179], v[76:79]
ds_read_b64_tr_b16 a[204:205], v198 offset:24576
ds_read_b64_tr_b16 a[206:207], v198 offset:28672
v_mfma_f32_16x16x32_bf16 v[80:83], a[208:211], v[176:179], v[80:83]
ds_read_b64_tr_b16 a[208:209], v199 offset:24576
ds_read_b64_tr_b16 a[210:211], v199 offset:28672
v_exp_f32 v174, v174
v_mfma_f32_16x16x32_bf16 v[84:87], a[212:215], v[176:179], v[84:87]
ds_read_b64_tr_b16 a[212:213], v200 offset:24576
ds_read_b64_tr_b16 a[214:215], v200 offset:28672
v_mfma_f32_16x16x32_bf16 v[88:91], a[216:219], v[176:179], v[88:91]
ds_read_b64_tr_b16 a[216:217], v201 offset:24576
ds_read_b64_tr_b16 a[218:219], v201 offset:28672
v_exp_f32 v175, v175
v_mfma_f32_16x16x32_bf16 v[92:95], a[220:223], v[176:179], v[92:95]
ds_read_b64_tr_b16 a[220:221], v202 offset:24576
ds_read_b64_tr_b16 a[222:223], v202 offset:28672
v_cvt_pk_bf16_f32 v180, v168, v169
v_mfma_f32_16x16x32_bf16 a[232:235], a[244:247], v[176:179], a[232:235]
v_cvt_pk_bf16_f32 v181, v170, v171
v_cvt_pk_bf16_f32 v182, v172, v173
v_cvt_pk_bf16_f32 v183, v174, v175
s_waitcnt vmcnt(6)
s_barrier
v_mfma_f32_16x16x32_bf16 v[168:171], a[160:163], a[8:11], 0
ds_read_b128 a[160:163], v191 offset:32768
v_mfma_f32_16x16x32_bf16 v[172:175], a[176:179], a[8:11], 0
ds_read_b128 a[176:179], v191 offset:36864
v_fma_f32 v160, v160, s28, -v185
v_mfma_f32_16x16x32_bf16 v[168:171], a[164:167], a[28:31], v[168:171]
ds_read_b128 a[164:167], v192 offset:32768
v_fma_f32 v161, v161, s28, -v185
v_fma_f32 v162, v162, s28, -v185
v_mfma_f32_16x16x32_bf16 v[172:175], a[180:183], a[28:31], v[172:175]
ds_read_b128 a[180:183], v192 offset:36864
v_fma_f32 v163, v163, s28, -v185
v_fma_f32 v164, v164, s28, -v185
v_mfma_f32_16x16x32_bf16 v[168:171], a[168:171], a[48:51], v[168:171]
ds_read_b128 a[168:171], v193 offset:32768
v_fma_f32 v165, v165, s28, -v185
v_mfma_f32_16x16x32_bf16 v[172:175], a[184:187], a[48:51], v[172:175]
ds_read_b128 a[184:187], v193 offset:36864
v_fma_f32 v166, v166, s28, -v185
v_fma_f32 v167, v167, s28, -v185
v_mfma_f32_16x16x32_bf16 v[168:171], a[172:175], a[68:71], v[168:171]
ds_read_b128 a[172:175], v194 offset:32768
v_max3_f32 v189, v160, v161, v162
v_max3_f32 v190, v163, v164, v165
v_mfma_f32_16x16x32_bf16 v[172:175], a[188:191], a[68:71], v[172:175]
ds_read_b128 a[188:191], v194 offset:36864
v_max3_f32 v189, v189, v166, v167
s_waitcnt lgkmcnt(8)
v_mfma_f32_16x16x32_bf16 v[0:3], a[192:195], v[180:183], v[0:3]
v_max_f32 v189, v189, v190
v_cmp_lt_f32 vcc, 0x41000000, v189
v_mfma_f32_16x16x32_bf16 v[4:7], a[196:199], v[180:183], v[4:7]
s_cbranch_vccnz stub_92
back_93:
v_exp_f32 v160, v160
v_mfma_f32_16x16x32_bf16 v[8:11], a[200:203], v[180:183], v[8:11]
v_exp_f32 v161, v161
v_mfma_f32_16x16x32_bf16 v[12:15], a[204:207], v[180:183], v[12:15]
v_exp_f32 v162, v162
v_mfma_f32_16x16x32_bf16 v[16:19], a[208:211], v[180:183], v[16:19]
v_exp_f32 v163, v163
v_exp_f32 v164, v164
v_mfma_f32_16x16x32_bf16 v[20:23], a[212:215], v[180:183], v[20:23]
v_exp_f32 v165, v165
v_mfma_f32_16x16x32_bf16 v[24:27], a[216:219], v[180:183], v[24:27]
v_exp_f32 v166, v166
v_mfma_f32_16x16x32_bf16 v[28:31], a[220:223], v[180:183], v[28:31]
v_exp_f32 v167, v167
v_cvt_pk_bf16_f32 v176, v160, v161
v_mfma_f32_16x16x32_bf16 a[224:227], a[244:247], v[180:183], a[224:227]
v_cvt_pk_bf16_f32 v177, v162, v163
v_cvt_pk_bf16_f32 v178, v164, v165
v_cvt_pk_bf16_f32 v179, v166, v167
s_waitcnt lgkmcnt(0)
v_mfma_f32_16x16x32_bf16 v[160:163], a[160:163], a[0:3], 0
v_fma_f32 v168, v168, s28, -v186
v_fma_f32 v169, v169, s28, -v186
v_mfma_f32_16x16x32_bf16 v[164:167], a[176:179], a[0:3], 0
s_add_u32 s40, s34, s32
s_and_b32 s40, s40, 31
s_lshl_b32 s40, s40, 13
s_lshr_b32 s41, s34, 5
s_lshl_b32 s41, s41, 18
s_add_u32 s40, s40, s41
s_add_u32 s35, s40, s33
s_add_u32 s34, s34, 1
s_add_u32 m0, s37, 0
s_nop 0
buffer_load_dwordx4 v203, s[16:19], s35 offen nt lds
v_mfma_f32_16x16x32_bf16 v[160:163], a[164:167], a[20:23], v[160:163]
v_mfma_f32_16x16x32_bf16 v[164:167], a[180:183], a[20:23], v[164:167]
buffer_load_dwordx4 v204, s[16:19], s35 offen offset:1024 nt lds
v_mfma_f32_16x16x32_bf16 v[160:163], a[168:171], a[40:43], v[160:163]
v_mfma_f32_16x16x32_bf16 v[164:167], a[184:187], a[40:43], v[164:167]
v_fma_f32 v170, v170, s28, -v186
v_fma_f32 v171, v171, s28, -v186
v_fma_f32 v172, v172, s28, -v186
v_mfma_f32_16x16x32_bf16 v[160:163], a[172:175], a[60:63], v[160:163]
s_add_u32 m0, s37, 8192
s_nop 0
buffer_load_dwordx4 v207, s[20:23], s35 offen nt lds
v_mfma_f32_16x16x32_bf16 v[164:167], a[188:191], a[60:63], v[164:167]
v_fma_f32 v173, v173, s28, -v186
v_fma_f32 v174, v174, s28, -v186
v_fma_f32 v175, v175, s28, -v186
v_mfma_f32_16x16x32_bf16 v[32:35], a[192:195], v[176:179], v[32:35]
buffer_load_dwordx4 v208, s[20:23], s35 offen offset:1024 nt lds
v_max3_f32 v189, v168, v169, v170
v_max3_f32 v190, v171, v172, v173
v_mfma_f32_16x16x32_bf16 v[36:39], a[196:199], v[176:179], v[36:39]
v_max3_f32 v189, v189, v174, v175
v_max_f32 v189, v189, v190
v_cmp_lt_f32 vcc, 0x41000000, v189
v_mfma_f32_16x16x32_bf16 v[40:43], a[200:203], v[176:179], v[40:43]
s_cbranch_vccnz stub_94
back_95:
v_exp_f32 v168, v168
v_mfma_f32_16x16x32_bf16 v[44:47], a[204:207], v[176:179], v[44:47]
v_exp_f32 v169, v169
v_exp_f32 v170, v170
v_mfma_f32_16x16x32_bf16 v[48:51], a[208:211], v[176:179], v[48:51]
v_exp_f32 v171, v171
v_mfma_f32_16x16x32_bf16 v[52:55], a[212:215], v[176:179], v[52:55]
v_exp_f32 v172, v172
v_exp_f32 v173, v173
v_mfma_f32_16x16x32_bf16 v[56:59], a[216:219], v[176:179], v[56:59]
v_exp_f32 v174, v174
v_mfma_f32_16x16x32_bf16 v[60:63], a[220:223], v[176:179], v[60:63]
v_exp_f32 v175, v175
v_cvt_pk_bf16_f32 v180, v168, v169
v_mfma_f32_16x16x32_bf16 a[228:231], a[244:247], v[176:179], a[228:231]
v_cvt_pk_bf16_f32 v181, v170, v171
v_cvt_pk_bf16_f32 v182, v172, v173
v_cvt_pk_bf16_f32 v183, v174, v175
v_mfma_f32_16x16x32_bf16 v[168:171], a[160:163], a[4:7], 0
v_fma_f32 v160, v160, s28, -v184
v_fma_f32 v161, v161, s28, -v184
v_fma_f32 v162, v162, s28, -v184
v_mfma_f32_16x16x32_bf16 v[172:175], a[176:179], a[4:7], 0
v_fma_f32 v163, v163, s28, -v184
v_fma_f32 v164, v164, s28, -v184
v_fma_f32 v165, v165, s28, -v184
v_mfma_f32_16x16x32_bf16 v[168:171], a[164:167], a[24:27], v[168:171]
v_fma_f32 v166, v166, s28, -v184
v_fma_f32 v167, v167, s28, -v184
v_max3_f32 v189, v160, v161, v162
v_mfma_f32_16x16x32_bf16 v[172:175], a[180:183], a[24:27], v[172:175]
v_max3_f32 v190, v163, v164, v165
v_max3_f32 v189, v189, v166, v167
v_max_f32 v189, v189, v190
v_mfma_f32_16x16x32_bf16 v[168:171], a[168:171], a[44:47], v[168:171]
v_cmp_lt_f32 vcc, 0x41000000, v189
s_cbranch_vccnz stub_96
back_97:
v_exp_f32 v160, v160
v_mfma_f32_16x16x32_bf16 v[172:175], a[184:187], a[44:47], v[172:175]
v_exp_f32 v161, v161
s_nop 0
v_mfma_f32_16x16x32_bf16 v[168:171], a[172:175], a[64:67], v[168:171]
v_exp_f32 v162, v162
v_exp_f32 v163, v163
v_mfma_f32_16x16x32_bf16 v[172:175], a[188:191], a[64:67], v[172:175]
v_exp_f32 v164, v164
s_waitcnt vmcnt(8)
s_barrier
v_mfma_f32_16x16x32_bf16 v[64:67], a[192:195], v[180:183], v[64:67]
ds_read_b64_tr_b16 a[192:193], v195 offset:40960
ds_read_b64_tr_b16 a[194:195], v195 offset:45056
v_mfma_f32_16x16x32_bf16 v[68:71], a[196:199], v[180:183], v[68:71]
ds_read_b64_tr_b16 a[196:197], v196 offset:40960
ds_read_b64_tr_b16 a[198:199], v196 offset:45056
v_mfma_f32_16x16x32_bf16 v[72:75], a[200:203], v[180:183], v[72:75]
ds_read_b64_tr_b16 a[200:201], v197 offset:40960
ds_read_b64_tr_b16 a[202:203], v197 offset:45056
v_exp_f32 v165, v165
v_mfma_f32_16x16x32_bf16 v[76:79], a[204:207], v[180:183], v[76:79]
ds_read_b64_tr_b16 a[204:205], v198 offset:40960
ds_read_b64_tr_b16 a[206:207], v198 offset:45056
v_mfma_f32_16x16x32_bf16 v[80:83], a[208:211], v[180:183], v[80:83]
ds_read_b64_tr_b16 a[208:209], v199 offset:40960
ds_read_b64_tr_b16 a[210:211], v199 offset:45056
v_exp_f32 v166, v166
v_mfma_f32_16x16x32_bf16 v[84:87], a[212:215], v[180:183], v[84:87]
ds_read_b64_tr_b16 a[212:213], v200 offset:40960
ds_read_b64_tr_b16 a[214:215], v200 offset:45056
v_mfma_f32_16x16x32_bf16 v[88:91], a[216:219], v[180:183], v[88:91]
ds_read_b64_tr_b16 a[216:217], v201 offset:40960
ds_read_b64_tr_b16 a[218:219], v201 offset:45056
v_exp_f32 v167, v167
v_mfma_f32_16x16x32_bf16 v[92:95], a[220:223], v[180:183], v[92:95]
ds_read_b64_tr_b16 a[220:221], v202 offset:40960
ds_read_b64_tr_b16 a[222:223], v202 offset:45056
v_cvt_pk_bf16_f32 v176, v160, v161
v_mfma_f32_16x16x32_bf16 a[232:235], a[244:247], v[180:183], a[232:235]
v_cvt_pk_bf16_f32 v177, v162, v163
v_cvt_pk_bf16_f32 v178, v164, v165
v_cvt_pk_bf16_f32 v179, v166, v167
s_waitcnt vmcnt(6)
s_barrier
v_mfma_f32_16x16x32_bf16 v[160:163], a[160:163], a[8:11], 0
ds_read_b128 a[160:163], v191 offset:49152
v_mfma_f32_16x16x32_bf16 v[164:167], a[176:179], a[8:11], 0
ds_read_b128 a[176:179], v191 offset:53248
v_fma_f32 v168, v168, s28, -v185
v_mfma_f32_16x16x32_bf16 v[160:163], a[164:167], a[28:31], v[160:163]
ds_read_b128 a[164:167], v192 offset:49152
v_fma_f32 v169, v169, s28, -v185
v_fma_f32 v170, v170, s28, -v185
v_mfma_f32_16x16x32_bf16 v[164:167], a[180:183], a[28:31], v[164:167]
ds_read_b128 a[180:183], v192 offset:53248
v_fma_f32 v171, v171, s28, -v185
v_fma_f32 v172, v172, s28, -v185
v_mfma_f32_16x16x32_bf16 v[160:163], a[168:171], a[48:51], v[160:163]
ds_read_b128 a[168:171], v193 offset:49152
v_fma_f32 v173, v173, s28, -v185
v_mfma_f32_16x16x32_bf16 v[164:167], a[184:187], a[48:51], v[164:167]
ds_read_b128 a[184:187], v193 offset:53248
v_fma_f32 v174, v174, s28, -v185
v_fma_f32 v175, v175, s28, -v185
v_mfma_f32_16x16x32_bf16 v[160:163], a[172:175], a[68:71], v[160:163]
ds_read_b128 a[172:175], v194 offset:49152
v_max3_f32 v189, v168, v169, v170
v_max3_f32 v190, v171, v172, v173
v_mfma_f32_16x16x32_bf16 v[164:167], a[188:191], a[68:71], v[164:167]
ds_read_b128 a[188:191], v194 offset:53248
v_max3_f32 v189, v189, v174, v175
s_waitcnt lgkmcnt(8)
v_mfma_f32_16x16x32_bf16 v[0:3], a[192:195], v[176:179], v[0:3]
v_max_f32 v189, v189, v190
v_cmp_lt_f32 vcc, 0x41000000, v189
v_mfma_f32_16x16x32_bf16 v[4:7], a[196:199], v[176:179], v[4:7]
s_cbranch_vccnz stub_98
back_99:
v_exp_f32 v168, v168
v_mfma_f32_16x16x32_bf16 v[8:11], a[200:203], v[176:179], v[8:11]
v_exp_f32 v169, v169
v_mfma_f32_16x16x32_bf16 v[12:15], a[204:207], v[176:179], v[12:15]
v_exp_f32 v170, v170
v_mfma_f32_16x16x32_bf16 v[16:19], a[208:211], v[176:179], v[16:19]
v_exp_f32 v171, v171
v_exp_f32 v172, v172
v_mfma_f32_16x16x32_bf16 v[20:23], a[212:215], v[176:179], v[20:23]
v_exp_f32 v173, v173
v_mfma_f32_16x16x32_bf16 v[24:27], a[216:219], v[176:179], v[24:27]
v_exp_f32 v174, v174
v_mfma_f32_16x16x32_bf16 v[28:31], a[220:223], v[176:179], v[28:31]
v_exp_f32 v175, v175
v_cvt_pk_bf16_f32 v180, v168, v169
v_mfma_f32_16x16x32_bf16 a[224:227], a[244:247], v[176:179], a[224:227]
v_cvt_pk_bf16_f32 v181, v170, v171
v_cvt_pk_bf16_f32 v182, v172, v173
v_cvt_pk_bf16_f32 v183, v174, v175
s_waitcnt lgkmcnt(0)
v_mfma_f32_16x16x32_bf16 v[168:171], a[160:163], a[0:3], 0
v_fma_f32 v160, v160, s28, -v186
v_fma_f32 v161, v161, s28, -v186
v_mfma_f32_16x16x32_bf16 v[172:175], a[176:179], a[0:3], 0
s_add_u32 s40, s34, s32
s_and_b32 s40, s40, 31
s_lshl_b32 s40, s40, 13
s_lshr_b32 s41, s34, 5
s_lshl_b32 s41, s41, 18
s_add_u32 s40, s40, s41
s_add_u32 s35, s40, s33
s_add_u32 s34, s34, 1
s_add_u32 m0, s37, 16384
s_nop 0
buffer_load_dwordx4 v203, s[16:19], s35 offen nt lds
v_mfma_f32_16x16x32_bf16 v[168:171], a[164:167], a[20:23], v[168:171]
v_mfma_f32_16x16x32_bf16 v[172:175], a[180:183], a[20:23], v[172:175]
buffer_load_dwordx4 v204, s[16:19], s35 offen offset:1024 nt lds
v_mfma_f32_16x16x32_bf16 v[168:171], a[168:171], a[40:43], v[168:171]
v_mfma_f32_16x16x32_bf16 v[172:175], a[184:187], a[40:43], v[172:175]
v_fma_f32 v162, v162, s28, -v186
v_fma_f32 v163, v163, s28, -v186
v_fma_f32 v164, v164, s28, -v186
v_mfma_f32_16x16x32_bf16 v[168:171], a[172:175], a[60:63], v[168:171]
s_add_u32 m0, s37, 24576
s_nop 0
buffer_load_dwordx4 v207, s[20:23], s35 offen nt lds
v_mfma_f32_16x16x32_bf16 v[172:175], a[188:191], a[60:63], v[172:175]
v_fma_f32 v165, v165, s28, -v186
v_fma_f32 v166, v166, s28, -v186
v_fma_f32 v167, v167, s28, -v186
v_mfma_f32_16x16x32_bf16 v[32:35], a[192:195], v[180:183], v[32:35]
buffer_load_dwordx4 v208, s[20:23], s35 offen offset:1024 nt lds
v_max3_f32 v189, v160, v161, v162
v_max3_f32 v190, v163, v164, v165
v_mfma_f32_16x16x32_bf16 v[36:39], a[196:199], v[180:183], v[36:39]
v_max3_f32 v189, v189, v166, v167
v_max_f32 v189, v189, v190
v_cmp_lt_f32 vcc, 0x41000000, v189
v_mfma_f32_16x16x32_bf16 v[40:43], a[200:203], v[180:183], v[40:43]
s_cbranch_vccnz stub_100
back_101:
v_exp_f32 v160, v160
v_mfma_f32_16x16x32_bf16 v[44:47], a[204:207], v[180:183], v[44:47]
v_exp_f32 v161, v161
v_exp_f32 v162, v162
v_mfma_f32_16x16x32_bf16 v[48:51], a[208:211], v[180:183], v[48:51]
v_exp_f32 v163, v163
v_mfma_f32_16x16x32_bf16 v[52:55], a[212:215], v[180:183], v[52:55]
v_exp_f32 v164, v164
v_exp_f32 v165, v165
v_mfma_f32_16x16x32_bf16 v[56:59], a[216:219], v[180:183], v[56:59]
v_exp_f32 v166, v166
v_mfma_f32_16x16x32_bf16 v[60:63], a[220:223], v[180:183], v[60:63]
v_exp_f32 v167, v167
v_cvt_pk_bf16_f32 v176, v160, v161
v_mfma_f32_16x16x32_bf16 a[228:231], a[244:247], v[180:183], a[228:231]
v_cvt_pk_bf16_f32 v177, v162, v163
v_cvt_pk_bf16_f32 v178, v164, v165
v_cvt_pk_bf16_f32 v179, v166, v167
v_mfma_f32_16x16x32_bf16 v[160:163], a[160:163], a[4:7], 0
v_fma_f32 v168, v168, s28, -v184
v_fma_f32 v169, v169, s28, -v184
v_fma_f32 v170, v170, s28, -v184
v_mfma_f32_16x16x32_bf16 v[164:167], a[176:179], a[4:7], 0
v_fma_f32 v171, v171, s28, -v184
v_fma_f32 v172, v172, s28, -v184
v_fma_f32 v173, v173, s28, -v184
v_mfma_f32_16x16x32_bf16 v[160:163], a[164:167], a[24:27], v[160:163]
v_fma_f32 v174, v174, s28, -v184
v_fma_f32 v175, v175, s28, -v184
v_max3_f32 v189, v168, v169, v170
v_mfma_f32_16x16x32_bf16 v[164:167], a[180:183], a[24:27], v[164:167]
v_max3_f32 v190, v171, v172, v173
v_max3_f32 v189, v189, v174, v175
v_max_f32 v189, v189, v190
v_mfma_f32_16x16x32_bf16 v[160:163], a[168:171], a[44:47], v[160:163]
v_cmp_lt_f32 vcc, 0x41000000, v189
s_cbranch_vccnz stub_102
back_103:
v_exp_f32 v168, v168
v_mfma_f32_16x16x32_bf16 v[164:167], a[184:187], a[44:47], v[164:167]
v_exp_f32 v169, v169
s_nop 0
v_mfma_f32_16x16x32_bf16 v[160:163], a[172:175], a[64:67], v[160:163]
v_exp_f32 v170, v170
v_exp_f32 v171, v171
v_mfma_f32_16x16x32_bf16 v[164:167], a[188:191], a[64:67], v[164:167]
v_exp_f32 v172, v172
s_waitcnt vmcnt(8)
s_barrier
v_mfma_f32_16x16x32_bf16 v[64:67], a[192:195], v[176:179], v[64:67]
ds_read_b64_tr_b16 a[192:193], v195 offset:57344
ds_read_b64_tr_b16 a[194:195], v195 offset:61440
v_mfma_f32_16x16x32_bf16 v[68:71], a[196:199], v[176:179], v[68:71]
ds_read_b64_tr_b16 a[196:197], v196 offset:57344
ds_read_b64_tr_b16 a[198:199], v196 offset:61440
v_mfma_f32_16x16x32_bf16 v[72:75], a[200:203], v[176:179], v[72:75]
ds_read_b64_tr_b16 a[200:201], v197 offset:57344
ds_read_b64_tr_b16 a[202:203], v197 offset:61440
v_exp_f32 v173, v173
v_mfma_f32_16x16x32_bf16 v[76:79], a[204:207], v[176:179], v[76:79]
ds_read_b64_tr_b16 a[204:205], v198 offset:57344
ds_read_b64_tr_b16 a[206:207], v198 offset:61440
v_mfma_f32_16x16x32_bf16 v[80:83], a[208:211], v[176:179], v[80:83]
ds_read_b64_tr_b16 a[208:209], v199 offset:57344
ds_read_b64_tr_b16 a[210:211], v199 offset:61440
v_exp_f32 v174, v174
v_mfma_f32_16x16x32_bf16 v[84:87], a[212:215], v[176:179], v[84:87]
ds_read_b64_tr_b16 a[212:213], v200 offset:57344
ds_read_b64_tr_b16 a[214:215], v200 offset:61440
v_mfma_f32_16x16x32_bf16 v[88:91], a[216:219], v[176:179], v[88:91]
ds_read_b64_tr_b16 a[216:217], v201 offset:57344
ds_read_b64_tr_b16 a[218:219], v201 offset:61440
v_exp_f32 v175, v175
v_mfma_f32_16x16x32_bf16 v[92:95], a[220:223], v[176:179], v[92:95]
ds_read_b64_tr_b16 a[220:221], v202 offset:57344
ds_read_b64_tr_b16 a[222:223], v202 offset:61440
v_cvt_pk_bf16_f32 v180, v168, v169
v_mfma_f32_16x16x32_bf16 a[232:235], a[244:247], v[176:179], a[232:235]
v_cvt_pk_bf16_f32 v181, v170, v171
v_cvt_pk_bf16_f32 v182, v172, v173
v_cvt_pk_bf16_f32 v183, v174, v175
s_waitcnt vmcnt(6)
s_barrier
v_mfma_f32_16x16x32_bf16 v[168:171], a[160:163], a[8:11], 0
ds_read_b128 a[160:163], v191
v_mfma_f32_16x16x32_bf16 v[172:175], a[176:179], a[8:11], 0
ds_read_b128 a[176:179], v191 offset:4096
v_fma_f32 v160, v160, s28, -v185
v_mfma_f32_16x16x32_bf16 v[168:171], a[164:167], a[28:31], v[168:171]
ds_read_b128 a[164:167], v192
v_fma_f32 v161, v161, s28, -v185
v_fma_f32 v162, v162, s28, -v185
v_mfma_f32_16x16x32_bf16 v[172:175], a[180:183], a[28:31], v[172:175]
ds_read_b128 a[180:183], v192 offset:4096
v_fma_f32 v163, v163, s28, -v185
v_fma_f32 v164, v164, s28, -v185
v_mfma_f32_16x16x32_bf16 v[168:171], a[168:171], a[48:51], v[168:171]
ds_read_b128 a[168:171], v193
v_fma_f32 v165, v165, s28, -v185
v_mfma_f32_16x16x32_bf16 v[172:175], a[184:187], a[48:51], v[172:175]
ds_read_b128 a[184:187], v193 offset:4096
v_fma_f32 v166, v166, s28, -v185
v_fma_f32 v167, v167, s28, -v185
v_mfma_f32_16x16x32_bf16 v[168:171], a[172:175], a[68:71], v[168:171]
ds_read_b128 a[172:175], v194
v_max3_f32 v189, v160, v161, v162
v_max3_f32 v190, v163, v164, v165
v_mfma_f32_16x16x32_bf16 v[172:175], a[188:191], a[68:71], v[172:175]
ds_read_b128 a[188:191], v194 offset:4096
v_max3_f32 v189, v189, v166, v167
s_waitcnt lgkmcnt(8)
v_mfma_f32_16x16x32_bf16 v[0:3], a[192:195], v[180:183], v[0:3]
v_max_f32 v189, v189, v190
v_cmp_lt_f32 vcc, 0x41000000, v189
v_mfma_f32_16x16x32_bf16 v[4:7], a[196:199], v[180:183], v[4:7]
s_cbranch_vccnz stub_104
back_105:
v_exp_f32 v160, v160
v_mfma_f32_16x16x32_bf16 v[8:11], a[200:203], v[180:183], v[8:11]
v_exp_f32 v161, v161
v_mfma_f32_16x16x32_bf16 v[12:15], a[204:207], v[180:183], v[12:15]
v_exp_f32 v162, v162
v_mfma_f32_16x16x32_bf16 v[16:19], a[208:211], v[180:183], v[16:19]
v_exp_f32 v163, v163
v_exp_f32 v164, v164
v_mfma_f32_16x16x32_bf16 v[20:23], a[212:215], v[180:183], v[20:23]
v_exp_f32 v165, v165
v_mfma_f32_16x16x32_bf16 v[24:27], a[216:219], v[180:183], v[24:27]
v_exp_f32 v166, v166
v_mfma_f32_16x16x32_bf16 v[28:31], a[220:223], v[180:183], v[28:31]
v_exp_f32 v167, v167
v_cvt_pk_bf16_f32 v176, v160, v161
v_mfma_f32_16x16x32_bf16 a[224:227], a[244:247], v[180:183], a[224:227]
v_cvt_pk_bf16_f32 v177, v162, v163
v_cvt_pk_bf16_f32 v178, v164, v165
v_cvt_pk_bf16_f32 v179, v166, v167
s_waitcnt lgkmcnt(0)
v_mfma_f32_16x16x32_bf16 v[160:163], a[160:163], a[0:3], 0
v_fma_f32 v168, v168, s28, -v186
v_fma_f32 v169, v169, s28, -v186
v_mfma_f32_16x16x32_bf16 v[164:167], a[176:179], a[0:3], 0
s_add_u32 s40, s34, s32
s_and_b32 s40, s40, 31
s_lshl_b32 s40, s40, 13
s_lshr_b32 s41, s34, 5
s_lshl_b32 s41, s41, 18
s_add_u32 s40, s40, s41
s_add_u32 s35, s40, s33
s_add_u32 s34, s34, 1
s_add_u32 m0, s37, 32768
s_nop 0
buffer_load_dwordx4 v203, s[16:19], s35 offen nt lds
v_mfma_f32_16x16x32_bf16 v[160:163], a[164:167], a[20:23], v[160:163]
v_mfma_f32_16x16x32_bf16 v[164:167], a[180:183], a[20:23], v[164:167]
buffer_load_dwordx4 v204, s[16:19], s35 offen offset:1024 nt lds
v_mfma_f32_16x16x32_bf16 v[160:163], a[168:171], a[40:43], v[160:163]
v_mfma_f32_16x16x32_bf16 v[164:167], a[184:187], a[40:43], v[164:167]
v_fma_f32 v170, v170, s28, -v186
v_fma_f32 v171, v171, s28, -v186
v_fma_f32 v172, v172, s28, -v186
v_mfma_f32_16x16x32_bf16 v[160:163], a[172:175], a[60:63], v[160:163]
s_add_u32 m0, s37, 40960
s_nop 0
buffer_load_dwordx4 v207, s[20:23], s35 offen nt lds
v_mfma_f32_16x16x32_bf16 v[164:167], a[188:191], a[60:63], v[164:167]
v_fma_f32 v173, v173, s28, -v186
v_fma_f32 v174, v174, s28, -v186
v_fma_f32 v175, v175, s28, -v186
v_mfma_f32_16x16x32_bf16 v[32:35], a[192:195], v[176:179], v[32:35]
buffer_load_dwordx4 v208, s[20:23], s35 offen offset:1024 nt lds
v_max3_f32 v189, v168, v169, v170
v_max3_f32 v190, v171, v172, v173
v_mfma_f32_16x16x32_bf16 v[36:39], a[196:199], v[176:179], v[36:39]
v_max3_f32 v189, v189, v174, v175
v_max_f32 v189, v189, v190
v_cmp_lt_f32 vcc, 0x41000000, v189
v_mfma_f32_16x16x32_bf16 v[40:43], a[200:203], v[176:179], v[40:43]
s_cbranch_vccnz stub_106
back_107:
v_exp_f32 v168, v168
v_mfma_f32_16x16x32_bf16 v[44:47], a[204:207], v[176:179], v[44:47]
v_exp_f32 v169, v169
v_exp_f32 v170, v170
v_mfma_f32_16x16x32_bf16 v[48:51], a[208:211], v[176:179], v[48:51]
v_exp_f32 v171, v171
v_mfma_f32_16x16x32_bf16 v[52:55], a[212:215], v[176:179], v[52:55]
v_exp_f32 v172, v172
v_exp_f32 v173, v173
v_mfma_f32_16x16x32_bf16 v[56:59], a[216:219], v[176:179], v[56:59]
v_exp_f32 v174, v174
v_mfma_f32_16x16x32_bf16 v[60:63], a[220:223], v[176:179], v[60:63]
v_exp_f32 v175, v175
v_cvt_pk_bf16_f32 v180, v168, v169
v_mfma_f32_16x16x32_bf16 a[228:231], a[244:247], v[176:179], a[228:231]
v_cvt_pk_bf16_f32 v181, v170, v171
v_cvt_pk_bf16_f32 v182, v172, v173
v_cvt_pk_bf16_f32 v183, v174, v175
v_mfma_f32_16x16x32_bf16 v[168:171], a[160:163], a[4:7], 0
v_fma_f32 v160, v160, s28, -v184
v_fma_f32 v161, v161, s28, -v184
v_fma_f32 v162, v162, s28, -v184
v_mfma_f32_16x16x32_bf16 v[172:175], a[176:179], a[4:7], 0
v_fma_f32 v163, v163, s28, -v184
v_fma_f32 v164, v164, s28, -v184
v_fma_f32 v165, v165, s28, -v184
v_mfma_f32_16x16x32_bf16 v[168:171], a[164:167], a[24:27], v[168:171]
v_fma_f32 v166, v166, s28, -v184
v_fma_f32 v167, v167, s28, -v184
v_max3_f32 v189, v160, v161, v162
v_mfma_f32_16x16x32_bf16 v[172:175], a[180:183], a[24:27], v[172:175]
v_max3_f32 v190, v163, v164, v165
v_max3_f32 v189, v189, v166, v167
v_max_f32 v189, v189, v190
v_mfma_f32_16x16x32_bf16 v[168:171], a[168:171], a[44:47], v[168:171]
v_cmp_lt_f32 vcc, 0x41000000, v189
s_cbranch_vccnz stub_108
back_109:
v_exp_f32 v160, v160
v_mfma_f32_16x16x32_bf16 v[172:175], a[184:187], a[44:47], v[172:175]
v_exp_f32 v161, v161
s_nop 0
v_mfma_f32_16x16x32_bf16 v[168:171], a[172:175], a[64:67], v[168:171]
v_exp_f32 v162, v162
v_exp_f32 v163, v163
v_mfma_f32_16x16x32_bf16 v[172:175], a[188:191], a[64:67], v[172:175]
v_exp_f32 v164, v164
s_waitcnt vmcnt(8)
s_barrier
v_mfma_f32_16x16x32_bf16 v[64:67], a[192:195], v[180:183], v[64:67]
ds_read_b64_tr_b16 a[192:193], v195 offset:8192
ds_read_b64_tr_b16 a[194:195], v195 offset:12288
v_mfma_f32_16x16x32_bf16 v[68:71], a[196:199], v[180:183], v[68:71]
ds_read_b64_tr_b16 a[196:197], v196 offset:8192
ds_read_b64_tr_b16 a[198:199], v196 offset:12288
v_mfma_f32_16x16x32_bf16 v[72:75], a[200:203], v[180:183], v[72:75]
ds_read_b64_tr_b16 a[200:201], v197 offset:8192
ds_read_b64_tr_b16 a[202:203], v197 offset:12288
v_exp_f32 v165, v165
v_mfma_f32_16x16x32_bf16 v[76:79], a[204:207], v[180:183], v[76:79]
ds_read_b64_tr_b16 a[204:205], v198 offset:8192
ds_read_b64_tr_b16 a[206:207], v198 offset:12288
v_mfma_f32_16x16x32_bf16 v[80:83], a[208:211], v[180:183], v[80:83]
ds_read_b64_tr_b16 a[208:209], v199 offset:8192
ds_read_b64_tr_b16 a[210:211], v199 offset:12288
v_exp_f32 v166, v166
v_mfma_f32_16x16x32_bf16 v[84:87], a[212:215], v[180:183], v[84:87]
ds_read_b64_tr_b16 a[212:213], v200 offset:8192
ds_read_b64_tr_b16 a[214:215], v200 offset:12288
v_mfma_f32_16x16x32_bf16 v[88:91], a[216:219], v[180:183], v[88:91]
ds_read_b64_tr_b16 a[216:217], v201 offset:8192
ds_read_b64_tr_b16 a[218:219], v201 offset:12288
v_exp_f32 v167, v167
v_mfma_f32_16x16x32_bf16 v[92:95], a[220:223], v[180:183], v[92:95]
ds_read_b64_tr_b16 a[220:221], v202 offset:8192
ds_read_b64_tr_b16 a[222:223], v202 offset:12288
v_cvt_pk_bf16_f32 v176, v160, v161
v_mfma_f32_16x16x32_bf16 a[232:235], a[244:247], v[180:183], a[232:235]
v_cvt_pk_bf16_f32 v177, v162, v163
v_cvt_pk_bf16_f32 v178, v164, v165
v_cvt_pk_bf16_f32 v179, v166, v167
s_waitcnt vmcnt(6)
s_barrier
v_mfma_f32_16x16x32_bf16 v[160:163], a[160:163], a[8:11], 0
ds_read_b128 a[160:163], v191 offset:16384
v_mfma_f32_16x16x32_bf16 v[164:167], a[176:179], a[8:11], 0
ds_read_b128 a[176:179], v191 offset:20480
v_fma_f32 v168, v168, s28, -v185
v_mfma_f32_16x16x32_bf16 v[160:163], a[164:167], a[28:31], v[160:163]
ds_read_b128 a[164:167], v192 offset:16384
v_fma_f32 v169, v169, s28, -v185
v_fma_f32 v170, v170, s28, -v185
v_mfma_f32_16x16x32_bf16 v[164:167], a[180:183], a[28:31], v[164:167]
ds_read_b128 a[180:183], v192 offset:20480
v_fma_f32 v171, v171, s28, -v185
v_fma_f32 v172, v172, s28, -v185
v_mfma_f32_16x16x32_bf16 v[160:163], a[168:171], a[48:51], v[160:163]
ds_read_b128 a[168:171], v193 offset:16384
v_fma_f32 v173, v173, s28, -v185
v_mfma_f32_16x16x32_bf16 v[164:167], a[184:187], a[48:51], v[164:167]
ds_read_b128 a[184:187], v193 offset:20480
v_fma_f32 v174, v174, s28, -v185
v_fma_f32 v175, v175, s28, -v185
v_mfma_f32_16x16x32_bf16 v[160:163], a[172:175], a[68:71], v[160:163]
ds_read_b128 a[172:175], v194 offset:16384
v_max3_f32 v189, v168, v169, v170
v_max3_f32 v190, v171, v172, v173
v_mfma_f32_16x16x32_bf16 v[164:167], a[188:191], a[68:71], v[164:167]
ds_read_b128 a[188:191], v194 offset:20480
v_max3_f32 v189, v189, v174, v175
s_waitcnt lgkmcnt(8)
v_mfma_f32_16x16x32_bf16 v[0:3], a[192:195], v[176:179], v[0:3]
v_max_f32 v189, v189, v190
v_cmp_lt_f32 vcc, 0x41000000, v189
v_mfma_f32_16x16x32_bf16 v[4:7], a[196:199], v[176:179], v[4:7]
s_cbranch_vccnz stub_110
back_111:
v_exp_f32 v168, v168
v_mfma_f32_16x16x32_bf16 v[8:11], a[200:203], v[176:179], v[8:11]
v_exp_f32 v169, v169
v_mfma_f32_16x16x32_bf16 v[12:15], a[204:207], v[176:179], v[12:15]
v_exp_f32 v170, v170
v_mfma_f32_16x16x32_bf16 v[16:19], a[208:211], v[176:179], v[16:19]
v_exp_f32 v171, v171
v_exp_f32 v172, v172
v_mfma_f32_16x16x32_bf16 v[20:23], a[212:215], v[176:179], v[20:23]
v_exp_f32 v173, v173
v_mfma_f32_16x16x32_bf16 v[24:27], a[216:219], v[176:179], v[24:27]
v_exp_f32 v174, v174
v_mfma_f32_16x16x32_bf16 v[28:31], a[220:223], v[176:179], v[28:31]
v_exp_f32 v175, v175
v_cvt_pk_bf16_f32 v180, v168, v169
v_mfma_f32_16x16x32_bf16 a[224:227], a[244:247], v[176:179], a[224:227]
v_cvt_pk_bf16_f32 v181, v170, v171
v_cvt_pk_bf16_f32 v182, v172, v173
v_cvt_pk_bf16_f32 v183, v174, v175
s_waitcnt lgkmcnt(0)
v_mfma_f32_16x16x32_bf16 v[168:171], a[160:163], a[0:3], 0
v_fma_f32 v160, v160, s28, -v186
v_fma_f32 v161, v161, s28, -v186
v_mfma_f32_16x16x32_bf16 v[172:175], a[176:179], a[0:3], 0
s_add_u32 s40, s34, s32
s_and_b32 s40, s40, 31
s_lshl_b32 s40, s40, 13
s_lshr_b32 s41, s34, 5
s_lshl_b32 s41, s41, 18
s_add_u32 s40, s40, s41
s_add_u32 s35, s40, s33
s_add_u32 s34, s34, 1
s_add_u32 m0, s37, 49152
s_nop 0
buffer_load_dwordx4 v203, s[16:19], s35 offen nt lds
v_mfma_f32_16x16x32_bf16 v[168:171], a[164:167], a[20:23], v[168:171]
v_mfma_f32_16x16x32_bf16 v[172:175], a[180:183], a[20:23], v[172:175]
buffer_load_dwordx4 v204, s[16:19], s35 offen offset:1024 nt lds
v_mfma_f32_16x16x32_bf16 v[168:171], a[168:171], a[40:43], v[168:171]
v_mfma_f32_16x16x32_bf16 v[172:175], a[184:187], a[40:43], v[172:175]
v_fma_f32 v162, v162, s28, -v186
v_fma_f32 v163, v163, s28, -v186
v_fma_f32 v164, v164, s28, -v186
v_mfma_f32_16x16x32_bf16 v[168:171], a[172:175], a[60:63], v[168:171]
s_add_u32 m0, s37, 57344
s_nop 0
buffer_load_dwordx4 v207, s[20:23], s35 offen nt lds
v_mfma_f32_16x16x32_bf16 v[172:175], a[188:191], a[60:63], v[172:175]
v_fma_f32 v165, v165, s28, -v186
v_fma_f32 v166, v166, s28, -v186
v_fma_f32 v167, v167, s28, -v186
v_mfma_f32_16x16x32_bf16 v[32:35], a[192:195], v[180:183], v[32:35]
buffer_load_dwordx4 v208, s[20:23], s35 offen offset:1024 nt lds
v_max3_f32 v189, v160, v161, v162
v_max3_f32 v190, v163, v164, v165
v_mfma_f32_16x16x32_bf16 v[36:39], a[196:199], v[180:183], v[36:39]
v_max3_f32 v189, v189, v166, v167
v_max_f32 v189, v189, v190
v_cmp_lt_f32 vcc, 0x41000000, v189
v_mfma_f32_16x16x32_bf16 v[40:43], a[200:203], v[180:183], v[40:43]
s_cbranch_vccnz stub_112
back_113:
v_exp_f32 v160, v160
v_mfma_f32_16x16x32_bf16 v[44:47], a[204:207], v[180:183], v[44:47]
v_exp_f32 v161, v161
v_exp_f32 v162, v162
v_mfma_f32_16x16x32_bf16 v[48:51], a[208:211], v[180:183], v[48:51]
v_exp_f32 v163, v163
v_mfma_f32_16x16x32_bf16 v[52:55], a[212:215], v[180:183], v[52:55]
v_exp_f32 v164, v164
v_exp_f32 v165, v165
v_mfma_f32_16x16x32_bf16 v[56:59], a[216:219], v[180:183], v[56:59]
v_exp_f32 v166, v166
v_mfma_f32_16x16x32_bf16 v[60:63], a[220:223], v[180:183], v[60:63]
v_exp_f32 v167, v167
v_cvt_pk_bf16_f32 v176, v160, v161
v_mfma_f32_16x16x32_bf16 a[228:231], a[244:247], v[180:183], a[228:231]
v_cvt_pk_bf16_f32 v177, v162, v163
v_cvt_pk_bf16_f32 v178, v164, v165
v_cvt_pk_bf16_f32 v179, v166, v167
s_add_u32 s38, s38, 1
s_cmp_lt_u32 s38, 7
s_cbranch_scc1 loop_89
v_mfma_f32_16x16x32_bf16 v[160:163], a[160:163], a[4:7], 0
v_fma_f32 v168, v168, s28, -v184
v_fma_f32 v169, v169, s28, -v184
v_fma_f32 v170, v170, s28, -v184
v_mfma_f32_16x16x32_bf16 v[164:167], a[176:179], a[4:7], 0
v_fma_f32 v171, v171, s28, -v184
v_fma_f32 v172, v172, s28, -v184
v_fma_f32 v173, v173, s28, -v184
v_mfma_f32_16x16x32_bf16 v[160:163], a[164:167], a[24:27], v[160:163]
v_fma_f32 v174, v174, s28, -v184
v_fma_f32 v175, v175, s28, -v184
v_max3_f32 v189, v168, v169, v170
v_mfma_f32_16x16x32_bf16 v[164:167], a[180:183], a[24:27], v[164:167]
v_max3_f32 v190, v171, v172, v173
v_max3_f32 v189, v189, v174, v175
v_max_f32 v189, v189, v190
v_mfma_f32_16x16x32_bf16 v[160:163], a[168:171], a[44:47], v[160:163]
v_cmp_lt_f32 vcc, 0x41000000, v189
s_cbranch_vccnz stub_114
back_115:
v_exp_f32 v168, v168
v_mfma_f32_16x16x32_bf16 v[164:167], a[184:187], a[44:47], v[164:167]
v_exp_f32 v169, v169
s_nop 0
v_mfma_f32_16x16x32_bf16 v[160:163], a[172:175], a[64:67], v[160:163]
v_exp_f32 v170, v170
v_exp_f32 v171, v171
v_mfma_f32_16x16x32_bf16 v[164:167], a[188:191], a[64:67], v[164:167]
v_exp_f32 v172, v172
s_waitcnt vmcnt(8)
s_barrier
v_mfma_f32_16x16x32_bf16 v[64:67], a[192:195], v[176:179], v[64:67]
ds_read_b64_tr_b16 a[192:193], v195 offset:24576
ds_read_b64_tr_b16 a[194:195], v195 offset:28672
v_mfma_f32_16x16x32_bf16 v[68:71], a[196:199], v[176:179], v[68:71]
ds_read_b64_tr_b16 a[196:197], v196 offset:24576
ds_read_b64_tr_b16 a[198:199], v196 offset:28672
v_mfma_f32_16x16x32_bf16 v[72:75], a[200:203], v[176:179], v[72:75]
ds_read_b64_tr_b16 a[200:201], v197 offset:24576
ds_read_b64_tr_b16 a[202:203], v197 offset:28672
v_exp_f32 v173, v173
v_mfma_f32_16x16x32_bf16 v[76:79], a[204:207], v[176:179], v[76:79]
ds_read_b64_tr_b16 a[204:205], v198 offset:24576
ds_read_b64_tr_b16 a[206:207], v198 offset:28672
v_mfma_f32_16x16x32_bf16 v[80:83], a[208:211], v[176:179], v[80:83]
ds_read_b64_tr_b16 a[208:209], v199 offset:24576
ds_read_b64_tr_b16 a[210:211], v199 offset:28672
v_exp_f32 v174, v174
v_mfma_f32_16x16x32_bf16 v[84:87], a[212:215], v[176:179], v[84:87]
ds_read_b64_tr_b16 a[212:213], v200 offset:24576
ds_read_b64_tr_b16 a[214:215], v200 offset:28672
v_mfma_f32_16x16x32_bf16 v[88:91], a[216:219], v[176:179], v[88:91]
ds_read_b64_tr_b16 a[216:217], v201 offset:24576
ds_read_b64_tr_b16 a[218:219], v201 offset:28672
v_exp_f32 v175, v175
v_mfma_f32_16x16x32_bf16 v[92:95], a[220:223], v[176:179], v[92:95]
ds_read_b64_tr_b16 a[220:221], v202 offset:24576
ds_read_b64_tr_b16 a[222:223], v202 offset:28672
v_cvt_pk_bf16_f32 v180, v168, v169
v_mfma_f32_16x16x32_bf16 a[232:235], a[244:247], v[176:179], a[232:235]
v_cvt_pk_bf16_f32 v181, v170, v171
v_cvt_pk_bf16_f32 v182, v172, v173
v_cvt_pk_bf16_f32 v183, v174, v175
s_waitcnt vmcnt(6)
s_barrier
v_mfma_f32_16x16x32_bf16 v[168:171], a[160:163], a[8:11], 0
ds_read_b128 a[160:163], v191 offset:32768
v_mfma_f32_16x16x32_bf16 v[172:175], a[176:179], a[8:11], 0
ds_read_b128 a[176:179], v191 offset:36864
v_fma_f32 v160, v160, s28, -v185
v_mfma_f32_16x16x32_bf16 v[168:171], a[164:167], a[28:31], v[168:171]
ds_read_b128 a[164:167], v192 offset:32768
v_fma_f32 v161, v161, s28, -v185
v_fma_f32 v162, v162, s28, -v185
v_mfma_f32_16x16x32_bf16 v[172:175], a[180:183], a[28:31], v[172:175]
ds_read_b128 a[180:183], v192 offset:36864
v_fma_f32 v163, v163, s28, -v185
v_fma_f32 v164, v164, s28, -v185
v_mfma_f32_16x16x32_bf16 v[168:171], a[168:171], a[48:51], v[168:171]
ds_read_b128 a[168:171], v193 offset:32768
v_fma_f32 v165, v165, s28, -v185
v_mfma_f32_16x16x32_bf16 v[172:175], a[184:187], a[48:51], v[172:175]
ds_read_b128 a[184:187], v193 offset:36864
v_fma_f32 v166, v166, s28, -v185
v_fma_f32 v167, v167, s28, -v185
v_mfma_f32_16x16x32_bf16 v[168:171], a[172:175], a[68:71], v[168:171]
ds_read_b128 a[172:175], v194 offset:32768
v_max3_f32 v189, v160, v161, v162
v_max3_f32 v190, v163, v164, v165
v_mfma_f32_16x16x32_bf16 v[172:175], a[188:191], a[68:71], v[172:175]
ds_read_b128 a[188:191], v194 offset:36864
v_max3_f32 v189, v189, v166, v167
s_waitcnt lgkmcnt(8)
v_mfma_f32_16x16x32_bf16 v[0:3], a[192:195], v[180:183], v[0:3]
v_max_f32 v189, v189, v190
v_cmp_lt_f32 vcc, 0x41000000, v189
v_mfma_f32_16x16x32_bf16 v[4:7], a[196:199], v[180:183], v[4:7]
s_cbranch_vccnz stub_116
back_117:
v_exp_f32 v160, v160
v_mfma_f32_16x16x32_bf16 v[8:11], a[200:203], v[180:183], v[8:11]
v_exp_f32 v161, v161
v_mfma_f32_16x16x32_bf16 v[12:15], a[204:207], v[180:183], v[12:15]
v_exp_f32 v162, v162
v_mfma_f32_16x16x32_bf16 v[16:19], a[208:211], v[180:183], v[16:19]
v_exp_f32 v163, v163
v_exp_f32 v164, v164
v_mfma_f32_16x16x32_bf16 v[20:23], a[212:215], v[180:183], v[20:23]
v_exp_f32 v165, v165
v_mfma_f32_16x16x32_bf16 v[24:27], a[216:219], v[180:183], v[24:27]
v_exp_f32 v166, v166
v_mfma_f32_16x16x32_bf16 v[28:31], a[220:223], v[180:183], v[28:31]
v_exp_f32 v167, v167
v_cvt_pk_bf16_f32 v176, v160, v161
v_mfma_f32_16x16x32_bf16 a[224:227], a[244:247], v[180:183], a[224:227]
v_cvt_pk_bf16_f32 v177, v162, v163
v_cvt_pk_bf16_f32 v178, v164, v165
v_cvt_pk_bf16_f32 v179, v166, v167
s_waitcnt lgkmcnt(0)
v_mfma_f32_16x16x32_bf16 v[160:163], a[160:163], a[0:3], 0
v_fma_f32 v168, v168, s28, -v186
v_fma_f32 v169, v169, s28, -v186
v_mfma_f32_16x16x32_bf16 v[164:167], a[176:179], a[0:3], 0
s_add_u32 s40, s34, s32
s_and_b32 s40, s40, 31
s_lshl_b32 s40, s40, 13
s_lshr_b32 s41, s34, 5
s_lshl_b32 s41, s41, 18
s_add_u32 s40, s40, s41
s_add_u32 s35, s40, s33
s_add_u32 s34, s34, 1
s_add_u32 m0, s37, 0
s_nop 0
buffer_load_dwordx4 v203, s[16:19], s35 offen nt lds
v_mfma_f32_16x16x32_bf16 v[160:163], a[164:167], a[20:23], v[160:163]
v_mfma_f32_16x16x32_bf16 v[164:167], a[180:183], a[20:23], v[164:167]
buffer_load_dwordx4 v204, s[16:19], s35 offen offset:1024 nt lds
v_mfma_f32_16x16x32_bf16 v[160:163], a[168:171], a[40:43], v[160:163]
v_mfma_f32_16x16x32_bf16 v[164:167], a[184:187], a[40:43], v[164:167]
v_fma_f32 v170, v170, s28, -v186
v_fma_f32 v171, v171, s28, -v186
v_fma_f32 v172, v172, s28, -v186
v_mfma_f32_16x16x32_bf16 v[160:163], a[172:175], a[60:63], v[160:163]
s_add_u32 m0, s37, 8192
s_nop 0
buffer_load_dwordx4 v207, s[20:23], s35 offen nt lds
v_mfma_f32_16x16x32_bf16 v[164:167], a[188:191], a[60:63], v[164:167]
v_fma_f32 v173, v173, s28, -v186
v_fma_f32 v174, v174, s28, -v186
v_fma_f32 v175, v175, s28, -v186
v_mfma_f32_16x16x32_bf16 v[32:35], a[192:195], v[176:179], v[32:35]
buffer_load_dwordx4 v208, s[20:23], s35 offen offset:1024 nt lds
v_max3_f32 v189, v168, v169, v170
v_max3_f32 v190, v171, v172, v173
v_mfma_f32_16x16x32_bf16 v[36:39], a[196:199], v[176:179], v[36:39]
v_max3_f32 v189, v189, v174, v175
v_max_f32 v189, v189, v190
v_cmp_lt_f32 vcc, 0x41000000, v189
v_mfma_f32_16x16x32_bf16 v[40:43], a[200:203], v[176:179], v[40:43]
s_cbranch_vccnz stub_118
back_119:
v_exp_f32 v168, v168
v_mfma_f32_16x16x32_bf16 v[44:47], a[204:207], v[176:179], v[44:47]
v_exp_f32 v169, v169
v_exp_f32 v170, v170
v_mfma_f32_16x16x32_bf16 v[48:51], a[208:211], v[176:179], v[48:51]
v_exp_f32 v171, v171
v_mfma_f32_16x16x32_bf16 v[52:55], a[212:215], v[176:179], v[52:55]
v_exp_f32 v172, v172
v_exp_f32 v173, v173
v_mfma_f32_16x16x32_bf16 v[56:59], a[216:219], v[176:179], v[56:59]
v_exp_f32 v174, v174
v_mfma_f32_16x16x32_bf16 v[60:63], a[220:223], v[176:179], v[60:63]
v_exp_f32 v175, v175
v_cvt_pk_bf16_f32 v180, v168, v169
v_mfma_f32_16x16x32_bf16 a[228:231], a[244:247], v[176:179], a[228:231]
v_cvt_pk_bf16_f32 v181, v170, v171
v_cvt_pk_bf16_f32 v182, v172, v173
v_cvt_pk_bf16_f32 v183, v174, v175
v_mfma_f32_16x16x32_bf16 v[168:171], a[160:163], a[4:7], 0
v_fma_f32 v160, v160, s28, -v184
v_fma_f32 v161, v161, s28, -v184
v_fma_f32 v162, v162, s28, -v184
v_mfma_f32_16x16x32_bf16 v[172:175], a[176:179], a[4:7], 0
v_fma_f32 v163, v163, s28, -v184
v_fma_f32 v164, v164, s28, -v184
v_fma_f32 v165, v165, s28, -v184
v_mfma_f32_16x16x32_bf16 v[168:171], a[164:167], a[24:27], v[168:171]
v_fma_f32 v166, v166, s28, -v184
v_fma_f32 v167, v167, s28, -v184
v_max3_f32 v189, v160, v161, v162
v_mfma_f32_16x16x32_bf16 v[172:175], a[180:183], a[24:27], v[172:175]
v_max3_f32 v190, v163, v164, v165
v_max3_f32 v189, v189, v166, v167
v_max_f32 v189, v189, v190
v_mfma_f32_16x16x32_bf16 v[168:171], a[168:171], a[44:47], v[168:171]
v_cmp_lt_f32 vcc, 0x41000000, v189
s_cbranch_vccnz stub_120
back_121:
v_exp_f32 v160, v160
v_mfma_f32_16x16x32_bf16 v[172:175], a[184:187], a[44:47], v[172:175]
v_exp_f32 v161, v161
s_nop 0
v_mfma_f32_16x16x32_bf16 v[168:171], a[172:175], a[64:67], v[168:171]
v_exp_f32 v162, v162
v_exp_f32 v163, v163
v_mfma_f32_16x16x32_bf16 v[172:175], a[188:191], a[64:67], v[172:175]
v_exp_f32 v164, v164
s_waitcnt vmcnt(8)
s_barrier
v_mfma_f32_16x16x32_bf16 v[64:67], a[192:195], v[180:183], v[64:67]
ds_read_b64_tr_b16 a[192:193], v195 offset:40960
ds_read_b64_tr_b16 a[194:195], v195 offset:45056
v_mfma_f32_16x16x32_bf16 v[68:71], a[196:199], v[180:183], v[68:71]
ds_read_b64_tr_b16 a[196:197], v196 offset:40960
ds_read_b64_tr_b16 a[198:199], v196 offset:45056
v_mfma_f32_16x16x32_bf16 v[72:75], a[200:203], v[180:183], v[72:75]
ds_read_b64_tr_b16 a[200:201], v197 offset:40960
ds_read_b64_tr_b16 a[202:203], v197 offset:45056
v_exp_f32 v165, v165
v_mfma_f32_16x16x32_bf16 v[76:79], a[204:207], v[180:183], v[76:79]
ds_read_b64_tr_b16 a[204:205], v198 offset:40960
ds_read_b64_tr_b16 a[206:207], v198 offset:45056
v_mfma_f32_16x16x32_bf16 v[80:83], a[208:211], v[180:183], v[80:83]
ds_read_b64_tr_b16 a[208:209], v199 offset:40960
ds_read_b64_tr_b16 a[210:211], v199 offset:45056
v_exp_f32 v166, v166
v_mfma_f32_16x16x32_bf16 v[84:87], a[212:215], v[180:183], v[84:87]
ds_read_b64_tr_b16 a[212:213], v200 offset:40960
ds_read_b64_tr_b16 a[214:215], v200 offset:45056
v_mfma_f32_16x16x32_bf16 v[88:91], a[216:219], v[180:183], v[88:91]
ds_read_b64_tr_b16 a[216:217], v201 offset:40960
ds_read_b64_tr_b16 a[218:219], v201 offset:45056
v_exp_f32 v167, v167
v_mfma_f32_16x16x32_bf16 v[92:95], a[220:223], v[180:183], v[92:95]
ds_read_b64_tr_b16 a[220:221], v202 offset:40960
ds_read_b64_tr_b16 a[222:223], v202 offset:45056
v_cvt_pk_bf16_f32 v176, v160, v161
v_mfma_f32_16x16x32_bf16 a[232:235], a[244:247], v[180:183], a[232:235]
v_cvt_pk_bf16_f32 v177, v162, v163
v_cvt_pk_bf16_f32 v178, v164, v165
v_cvt_pk_bf16_f32 v179, v166, v167
s_waitcnt vmcnt(6)
s_barrier
v_mfma_f32_16x16x32_bf16 v[160:163], a[160:163], a[8:11], 0
ds_read_b128 a[160:163], v191 offset:49152
v_mfma_f32_16x16x32_bf16 v[164:167], a[176:179], a[8:11], 0
ds_read_b128 a[176:179], v191 offset:53248
v_fma_f32 v168, v168, s28, -v185
v_mfma_f32_16x16x32_bf16 v[160:163], a[164:167], a[28:31], v[160:163]
ds_read_b128 a[164:167], v192 offset:49152
v_fma_f32 v169, v169, s28, -v185
v_fma_f32 v170, v170, s28, -v185
v_mfma_f32_16x16x32_bf16 v[164:167], a[180:183], a[28:31], v[164:167]
ds_read_b128 a[180:183], v192 offset:53248
v_fma_f32 v171, v171, s28, -v185
v_fma_f32 v172, v172, s28, -v185
v_mfma_f32_16x16x32_bf16 v[160:163], a[168:171], a[48:51], v[160:163]
ds_read_b128 a[168:171], v193 offset:49152
v_fma_f32 v173, v173, s28, -v185
v_mfma_f32_16x16x32_bf16 v[164:167], a[184:187], a[48:51], v[164:167]
ds_read_b128 a[184:187], v193 offset:53248
v_fma_f32 v174, v174, s28, -v185
v_fma_f32 v175, v175, s28, -v185
v_mfma_f32_16x16x32_bf16 v[160:163], a[172:175], a[68:71], v[160:163]
ds_read_b128 a[172:175], v194 offset:49152
v_max3_f32 v189, v168, v169, v170
v_max3_f32 v190, v171, v172, v173
v_mfma_f32_16x16x32_bf16 v[164:167], a[188:191], a[68:71], v[164:167]
ds_read_b128 a[188:191], v194 offset:53248
v_max3_f32 v189, v189, v174, v175
s_waitcnt lgkmcnt(8)
v_mfma_f32_16x16x32_bf16 v[0:3], a[192:195], v[176:179], v[0:3]
v_max_f32 v189, v189, v190
v_cmp_lt_f32 vcc, 0x41000000, v189
v_mfma_f32_16x16x32_bf16 v[4:7], a[196:199], v[176:179], v[4:7]
s_cbranch_vccnz stub_122
back_123:
v_exp_f32 v168, v168
v_mfma_f32_16x16x32_bf16 v[8:11], a[200:203], v[176:179], v[8:11]
v_exp_f32 v169, v169
v_mfma_f32_16x16x32_bf16 v[12:15], a[204:207], v[176:179], v[12:15]
v_exp_f32 v170, v170
v_mfma_f32_16x16x32_bf16 v[16:19], a[208:211], v[176:179], v[16:19]
v_exp_f32 v171, v171
v_exp_f32 v172, v172
v_mfma_f32_16x16x32_bf16 v[20:23], a[212:215], v[176:179], v[20:23]
v_exp_f32 v173, v173
v_mfma_f32_16x16x32_bf16 v[24:27], a[216:219], v[176:179], v[24:27]
v_exp_f32 v174, v174
v_mfma_f32_16x16x32_bf16 v[28:31], a[220:223], v[176:179], v[28:31]
v_exp_f32 v175, v175
v_cvt_pk_bf16_f32 v180, v168, v169
v_mfma_f32_16x16x32_bf16 a[224:227], a[244:247], v[176:179], a[224:227]
v_cvt_pk_bf16_f32 v181, v170, v171
v_cvt_pk_bf16_f32 v182, v172, v173
v_cvt_pk_bf16_f32 v183, v174, v175
s_waitcnt lgkmcnt(0)
v_mfma_f32_16x16x32_bf16 v[168:171], a[160:163], a[0:3], 0
v_fma_f32 v160, v160, s28, -v186
v_fma_f32 v161, v161, s28, -v186
v_mfma_f32_16x16x32_bf16 v[172:175], a[176:179], a[0:3], 0
s_add_u32 s40, s34, s32
s_and_b32 s40, s40, 31
s_lshl_b32 s40, s40, 13
s_lshr_b32 s41, s34, 5
s_lshl_b32 s41, s41, 18
s_add_u32 s40, s40, s41
s_add_u32 s35, s40, s33
s_add_u32 s34, s34, 1
s_add_u32 m0, s37, 16384
s_nop 0
buffer_load_dwordx4 v203, s[16:19], s35 offen nt lds
v_mfma_f32_16x16x32_bf16 v[168:171], a[164:167], a[20:23], v[168:171]
v_mfma_f32_16x16x32_bf16 v[172:175], a[180:183], a[20:23], v[172:175]
buffer_load_dwordx4 v204, s[16:19], s35 offen offset:1024 nt lds
v_mfma_f32_16x16x32_bf16 v[168:171], a[168:171], a[40:43], v[168:171]
v_mfma_f32_16x16x32_bf16 v[172:175], a[184:187], a[40:43], v[172:175]
v_fma_f32 v162, v162, s28, -v186
v_fma_f32 v163, v163, s28, -v186
v_fma_f32 v164, v164, s28, -v186
v_mfma_f32_16x16x32_bf16 v[168:171], a[172:175], a[60:63], v[168:171]
s_add_u32 m0, s37, 24576
s_nop 0
buffer_load_dwordx4 v207, s[20:23], s35 offen nt lds
v_mfma_f32_16x16x32_bf16 v[172:175], a[188:191], a[60:63], v[172:175]
v_fma_f32 v165, v165, s28, -v186
v_fma_f32 v166, v166, s28, -v186
v_fma_f32 v167, v167, s28, -v186
v_mfma_f32_16x16x32_bf16 v[32:35], a[192:195], v[180:183], v[32:35]
buffer_load_dwordx4 v208, s[20:23], s35 offen offset:1024 nt lds
v_max3_f32 v189, v160, v161, v162
v_max3_f32 v190, v163, v164, v165
v_mfma_f32_16x16x32_bf16 v[36:39], a[196:199], v[180:183], v[36:39]
v_max3_f32 v189, v189, v166, v167
v_max_f32 v189, v189, v190
v_cmp_lt_f32 vcc, 0x41000000, v189
v_mfma_f32_16x16x32_bf16 v[40:43], a[200:203], v[180:183], v[40:43]
s_cbranch_vccnz stub_124
back_125:
v_exp_f32 v160, v160
v_mfma_f32_16x16x32_bf16 v[44:47], a[204:207], v[180:183], v[44:47]
v_exp_f32 v161, v161
v_exp_f32 v162, v162
v_mfma_f32_16x16x32_bf16 v[48:51], a[208:211], v[180:183], v[48:51]
v_exp_f32 v163, v163
v_mfma_f32_16x16x32_bf16 v[52:55], a[212:215], v[180:183], v[52:55]
v_exp_f32 v164, v164
v_exp_f32 v165, v165
v_mfma_f32_16x16x32_bf16 v[56:59], a[216:219], v[180:183], v[56:59]
v_exp_f32 v166, v166
v_mfma_f32_16x16x32_bf16 v[60:63], a[220:223], v[180:183], v[60:63]
v_exp_f32 v167, v167
v_cvt_pk_bf16_f32 v176, v160, v161
v_mfma_f32_16x16x32_bf16 a[228:231], a[244:247], v[180:183], a[228:231]
v_cvt_pk_bf16_f32 v177, v162, v163
v_cvt_pk_bf16_f32 v178, v164, v165
v_cvt_pk_bf16_f32 v179, v166, v167
s_mul_i32 s43, s48, 36864
s_mul_i32 s42, s3, 9216
s_add_u32 s43, s43, s42
buffer_load_dwordx4 a[0:3], v209, s[60:63], s43 offen
s_add_u32 s43, s43, 1024
buffer_load_dwordx4 a[0:3], v209, s[60:63], s43 offen
s_add_u32 s43, s43, 1024
buffer_load_dwordx4 a[0:3], v209, s[60:63], s43 offen
s_add_u32 s43, s43, 1024
buffer_load_dwordx4 a[0:3], v209, s[60:63], s43 offen
s_add_u32 s43, s43, 1024
buffer_load_dwordx4 a[0:3], v209, s[60:63], s43 offen
s_add_u32 s43, s43, 1024
buffer_load_dwordx4 a[0:3], v209, s[60:63], s43 offen
s_add_u32 s43, s43, 1024
buffer_load_dwordx4 a[0:3], v209, s[60:63], s43 offen
s_add_u32 s43, s43, 1024
buffer_load_dwordx4 a[0:3], v209, s[60:63], s43 offen
s_add_u32 s43, s43, 1024
buffer_load_dwordx4 a[0:3], v209, s[60:63], s43 offen
s_add_u32 s43, s43, 1024
v_mfma_f32_16x16x32_bf16 v[160:163], a[160:163], a[4:7], 0
v_fma_f32 v168, v168, s28, -v184
v_fma_f32 v169, v169, s28, -v184
v_fma_f32 v170, v170, s28, -v184
v_mfma_f32_16x16x32_bf16 v[164:167], a[176:179], a[4:7], 0
v_fma_f32 v171, v171, s28, -v184
v_fma_f32 v172, v172, s28, -v184
v_fma_f32 v173, v173, s28, -v184
v_mfma_f32_16x16x32_bf16 v[160:163], a[164:167], a[24:27], v[160:163]
v_fma_f32 v174, v174, s28, -v184
v_fma_f32 v175, v175, s28, -v184
v_max3_f32 v189, v168, v169, v170
v_mfma_f32_16x16x32_bf16 v[164:167], a[180:183], a[24:27], v[164:167]
v_max3_f32 v190, v171, v172, v173
v_max3_f32 v189, v189, v174, v175
v_max_f32 v189, v189, v190
v_mfma_f32_16x16x32_bf16 v[160:163], a[168:171], a[44:47], v[160:163]
v_cmp_lt_f32 vcc, 0x41000000, v189
s_cbranch_vccnz stub_126
back_127:
v_exp_f32 v168, v168
v_mfma_f32_16x16x32_bf16 v[164:167], a[184:187], a[44:47], v[164:167]
v_exp_f32 v169, v169
s_nop 0
v_mfma_f32_16x16x32_bf16 v[160:163], a[172:175], a[64:67], v[160:163]
v_exp_f32 v170, v170
v_exp_f32 v171, v171
v_mfma_f32_16x16x32_bf16 v[164:167], a[188:191], a[64:67], v[164:167]
v_exp_f32 v172, v172
s_waitcnt vmcnt(17)
s_barrier
v_mfma_f32_16x16x32_bf16 v[64:67], a[192:195], v[176:179], v[64:67]
ds_read_b64_tr_b16 a[192:193], v195 offset:57344
ds_read_b64_tr_b16 a[194:195], v195 offset:61440
v_mfma_f32_16x16x32_bf16 v[68:71], a[196:199], v[176:179], v[68:71]
ds_read_b64_tr_b16 a[196:197], v196 offset:57344
ds_read_b64_tr_b16 a[198:199], v196 offset:61440
v_mfma_f32_16x16x32_bf16 v[72:75], a[200:203], v[176:179], v[72:75]
ds_read_b64_tr_b16 a[200:201], v197 offset:57344
ds_read_b64_tr_b16 a[202:203], v197 offset:61440
v_exp_f32 v173, v173
v_mfma_f32_16x16x32_bf16 v[76:79], a[204:207], v[176:179], v[76:79]
ds_read_b64_tr_b16 a[204:205], v198 offset:57344
ds_read_b64_tr_b16 a[206:207], v198 offset:61440
v_mfma_f32_16x16x32_bf16 v[80:83], a[208:211], v[176:179], v[80:83]
ds_read_b64_tr_b16 a[208:209], v199 offset:57344
ds_read_b64_tr_b16 a[210:211], v199 offset:61440
v_exp_f32 v174, v174
v_mfma_f32_16x16x32_bf16 v[84:87], a[212:215], v[176:179], v[84:87]
ds_read_b64_tr_b16 a[212:213], v200 offset:57344
ds_read_b64_tr_b16 a[214:215], v200 offset:61440
v_mfma_f32_16x16x32_bf16 v[88:91], a[216:219], v[176:179], v[88:91]
ds_read_b64_tr_b16 a[216:217], v201 offset:57344
ds_read_b64_tr_b16 a[218:219], v201 offset:61440
v_exp_f32 v175, v175
v_mfma_f32_16x16x32_bf16 v[92:95], a[220:223], v[176:179], v[92:95]
ds_read_b64_tr_b16 a[220:221], v202 offset:57344
ds_read_b64_tr_b16 a[222:223], v202 offset:61440
v_cvt_pk_bf16_f32 v180, v168, v169
v_mfma_f32_16x16x32_bf16 a[232:235], a[244:247], v[176:179], a[232:235]
v_cvt_pk_bf16_f32 v181, v170, v171
v_cvt_pk_bf16_f32 v182, v172, v173
v_cvt_pk_bf16_f32 v183, v174, v175
s_waitcnt vmcnt(15)
s_barrier
v_mfma_f32_16x16x32_bf16 v[168:171], a[160:163], a[8:11], 0
ds_read_b128 a[160:163], v191
v_mfma_f32_16x16x32_bf16 v[172:175], a[176:179], a[8:11], 0
ds_read_b128 a[176:179], v191 offset:4096
v_fma_f32 v160, v160, s28, -v185
v_mfma_f32_16x16x32_bf16 v[168:171], a[164:167], a[28:31], v[168:171]
ds_read_b128 a[164:167], v192
v_fma_f32 v161, v161, s28, -v185
v_fma_f32 v162, v162, s28, -v185
v_mfma_f32_16x16x32_bf16 v[172:175], a[180:183], a[28:31], v[172:175]
ds_read_b128 a[180:183], v192 offset:4096
v_fma_f32 v163, v163, s28, -v185
v_fma_f32 v164, v164, s28, -v185
v_mfma_f32_16x16x32_bf16 v[168:171], a[168:171], a[48:51], v[168:171]
ds_read_b128 a[168:171], v193
v_fma_f32 v165, v165, s28, -v185
v_mfma_f32_16x16x32_bf16 v[172:175], a[184:187], a[48:51], v[172:175]
ds_read_b128 a[184:187], v193 offset:4096
v_fma_f32 v166, v166, s28, -v185
v_fma_f32 v167, v167, s28, -v185
v_mfma_f32_16x16x32_bf16 v[168:171], a[172:175], a[68:71], v[168:171]
ds_read_b128 a[172:175], v194
v_max3_f32 v189, v160, v161, v162
v_max3_f32 v190, v163, v164, v165
v_mfma_f32_16x16x32_bf16 v[172:175], a[188:191], a[68:71], v[172:175]
ds_read_b128 a[188:191], v194 offset:4096
v_max3_f32 v189, v189, v166, v167
s_waitcnt lgkmcnt(8)
v_mfma_f32_16x16x32_bf16 v[0:3], a[192:195], v[180:183], v[0:3]
v_max_f32 v189, v189, v190
v_cmp_lt_f32 vcc, 0x41000000, v189
v_mfma_f32_16x16x32_bf16 v[4:7], a[196:199], v[180:183], v[4:7]
s_cbranch_vccnz stub_128
back_129:
v_exp_f32 v160, v160
v_mfma_f32_16x16x32_bf16 v[8:11], a[200:203], v[180:183], v[8:11]
v_exp_f32 v161, v161
v_mfma_f32_16x16x32_bf16 v[12:15], a[204:207], v[180:183], v[12:15]
v_exp_f32 v162, v162
v_mfma_f32_16x16x32_bf16 v[16:19], a[208:211], v[180:183], v[16:19]
v_exp_f32 v163, v163
v_exp_f32 v164, v164
v_mfma_f32_16x16x32_bf16 v[20:23], a[212:215], v[180:183], v[20:23]
v_exp_f32 v165, v165
v_mfma_f32_16x16x32_bf16 v[24:27], a[216:219], v[180:183], v[24:27]
v_exp_f32 v166, v166
v_mfma_f32_16x16x32_bf16 v[28:31], a[220:223], v[180:183], v[28:31]
v_exp_f32 v167, v167
v_cvt_pk_bf16_f32 v176, v160, v161
v_mfma_f32_16x16x32_bf16 a[224:227], a[244:247], v[180:183], a[224:227]
v_cvt_pk_bf16_f32 v177, v162, v163
v_cvt_pk_bf16_f32 v178, v164, v165
v_cvt_pk_bf16_f32 v179, v166, v167
s_waitcnt lgkmcnt(0)
s_add_u32 s40, s34, s32
s_and_b32 s40, s40, 31
s_lshl_b32 s40, s40, 13
s_lshr_b32 s41, s34, 5
s_lshl_b32 s41, s41, 18
s_add_u32 s40, s40, s41
s_add_u32 s35, s40, s33
s_add_u32 s34, s34, 1
s_add_u32 m0, s37, 32768
s_nop 0
buffer_load_dwordx4 v203, s[16:19], s35 offen nt lds
v_mfma_f32_16x16x32_bf16 v[32:35], a[192:195], v[176:179], v[32:35]
v_mfma_f32_16x16x32_bf16 v[36:39], a[196:199], v[176:179], v[36:39]
buffer_load_dwordx4 v204, s[16:19], s35 offen offset:1024 nt lds
v_fma_f32 v168, v168, s28, -v186
v_fma_f32 v169, v169, s28, -v186
v_mfma_f32_16x16x32_bf16 v[40:43], a[200:203], v[176:179], v[40:43]
s_add_u32 m0, s37, 40960
s_nop 0
buffer_load_dwordx4 v207, s[20:23], s35 offen nt lds
v_fma_f32 v170, v170, s28, -v186
v_fma_f32 v171, v171, s28, -v186
v_mfma_f32_16x16x32_bf16 v[44:47], a[204:207], v[176:179], v[44:47]
v_fma_f32 v172, v172, s28, -v186
v_fma_f32 v173, v173, s28, -v186
v_fma_f32 v174, v174, s28, -v186
v_fma_f32 v175, v175, s28, -v186
v_max3_f32 v189, v168, v169, v170
v_max3_f32 v190, v171, v172, v173
v_mfma_f32_16x16x32_bf16 v[48:51], a[208:211], v[176:179], v[48:51]
buffer_load_dwordx4 v208, s[20:23], s35 offen offset:1024 nt lds
v_max3_f32 v189, v189, v174, v175
v_max_f32 v189, v189, v190
v_cmp_lt_f32 vcc, 0x41000000, v189
s_cbranch_vccnz stub_130
back_131:
v_mfma_f32_16x16x32_bf16 v[52:55], a[212:215], v[176:179], v[52:55]
v_exp_f32 v168, v168
v_exp_f32 v169, v169
v_mfma_f32_16x16x32_bf16 v[56:59], a[216:219], v[176:179], v[56:59]
v_exp_f32 v170, v170
v_exp_f32 v171, v171
v_exp_f32 v172, v172
v_mfma_f32_16x16x32_bf16 v[60:63], a[220:223], v[176:179], v[60:63]
v_exp_f32 v173, v173
v_exp_f32 v174, v174
v_mfma_f32_16x16x32_bf16 a[228:231], a[244:247], v[176:179], a[228:231]
v_exp_f32 v175, v175
v_cvt_pk_bf16_f32 v180, v168, v169
v_cvt_pk_bf16_f32 v181, v170, v171
v_cvt_pk_bf16_f32 v182, v172, v173
v_cvt_pk_bf16_f32 v183, v174, v175
s_nop 1
v_mfma_f32_16x16x32_bf16 v[64:67], a[192:195], v[180:183], v[64:67]
v_mfma_f32_16x16x32_bf16 v[68:71], a[196:199], v[180:183], v[68:71]
v_mfma_f32_16x16x32_bf16 v[72:75], a[200:203], v[180:183], v[72:75]
v_mfma_f32_16x16x32_bf16 v[76:79], a[204:207], v[180:183], v[76:79]
v_mfma_f32_16x16x32_bf16 v[80:83], a[208:211], v[180:183], v[80:83]
v_mfma_f32_16x16x32_bf16 v[84:87], a[212:215], v[180:183], v[84:87]
v_mfma_f32_16x16x32_bf16 v[88:91], a[216:219], v[180:183], v[88:91]
v_mfma_f32_16x16x32_bf16 v[92:95], a[220:223], v[180:183], v[92:95]
v_mfma_f32_16x16x32_bf16 a[232:235], a[244:247], v[180:183], a[232:235]
att_epi0:
s_mul_i32 s40, s52, 20480
s_add_u32 s40, s40, 0
v_add_u32 v189, s40, v209
v_accvgpr_read_b32 v212, a224
v_rcp_f32 v216, v212
s_nop 0
v_mul_f32 v0, v0, v216
v_mul_f32 v1, v1, v216
v_mul_f32 v2, v2, v216
v_mul_f32 v3, v3, v216
v_mul_f32 v4, v4, v216
v_mul_f32 v5, v5, v216
v_mul_f32 v6, v6, v216
v_mul_f32 v7, v7, v216
v_cvt_pk_bf16_f32 v0, v0, v1
v_cvt_pk_bf16_f32 v1, v2, v3
v_cvt_pk_bf16_f32 v2, v4, v5
v_cvt_pk_bf16_f32 v3, v6, v7
v_mul_f32 v8, v8, v216
v_mul_f32 v9, v9, v216
v_mul_f32 v10, v10, v216
v_mul_f32 v11, v11, v216
v_mul_f32 v12, v12, v216
v_mul_f32 v13, v13, v216
v_mul_f32 v14, v14, v216
v_mul_f32 v15, v15, v216
v_cvt_pk_bf16_f32 v8, v8, v9
v_cvt_pk_bf16_f32 v9, v10, v11
v_cvt_pk_bf16_f32 v10, v12, v13
v_cvt_pk_bf16_f32 v11, v14, v15
v_mul_f32 v16, v16, v216
v_mul_f32 v17, v17, v216
v_mul_f32 v18, v18, v216
v_mul_f32 v19, v19, v216
v_mul_f32 v20, v20, v216
v_mul_f32 v21, v21, v216
v_mul_f32 v22, v22, v216
v_mul_f32 v23, v23, v216
v_cvt_pk_bf16_f32 v16, v16, v17
v_cvt_pk_bf16_f32 v17, v18, v19
v_cvt_pk_bf16_f32 v18, v20, v21
v_cvt_pk_bf16_f32 v19, v22, v23
v_mul_f32 v24, v24, v216
v_mul_f32 v25, v25, v216
v_mul_f32 v26, v26, v216
v_mul_f32 v27, v27, v216
v_mul_f32 v28, v28, v216
v_mul_f32 v29, v29, v216
v_mul_f32 v30, v30, v216
v_mul_f32 v31, v31, v216
v_cvt_pk_bf16_f32 v24, v24, v25
v_cvt_pk_bf16_f32 v25, v26, v27
v_cvt_pk_bf16_f32 v26, v28, v29
v_cvt_pk_bf16_f32 v27, v30, v31
v_accvgpr_read_b32 v213, a228
v_rcp_f32 v217, v213
s_nop 0
v_mul_f32 v32, v32, v217
v_mul_f32 v33, v33, v217
v_mul_f32 v34, v34, v217
v_mul_f32 v35, v35, v217
v_mul_f32 v36, v36, v217
v_mul_f32 v37, v37, v217
v_mul_f32 v38, v38, v217
v_mul_f32 v39, v39, v217
v_cvt_pk_bf16_f32 v32, v32, v33
v_cvt_pk_bf16_f32 v33, v34, v35
v_cvt_pk_bf16_f32 v34, v36, v37
v_cvt_pk_bf16_f32 v35, v38, v39
v_mul_f32 v40, v40, v217
v_mul_f32 v41, v41, v217
v_mul_f32 v42, v42, v217
v_mul_f32 v43, v43, v217
v_mul_f32 v44, v44, v217
v_mul_f32 v45, v45, v217
v_mul_f32 v46, v46, v217
v_mul_f32 v47, v47, v217
v_cvt_pk_bf16_f32 v40, v40, v41
v_cvt_pk_bf16_f32 v41, v42, v43
v_cvt_pk_bf16_f32 v42, v44, v45
v_cvt_pk_bf16_f32 v43, v46, v47
v_mul_f32 v48, v48, v217
v_mul_f32 v49, v49, v217
v_mul_f32 v50, v50, v217
v_mul_f32 v51, v51, v217
v_mul_f32 v52, v52, v217
v_mul_f32 v53, v53, v217
v_mul_f32 v54, v54, v217
v_mul_f32 v55, v55, v217
v_cvt_pk_bf16_f32 v48, v48, v49
v_cvt_pk_bf16_f32 v49, v50, v51
v_cvt_pk_bf16_f32 v50, v52, v53
v_cvt_pk_bf16_f32 v51, v54, v55
v_mul_f32 v56, v56, v217
v_mul_f32 v57, v57, v217
v_mul_f32 v58, v58, v217
v_mul_f32 v59, v59, v217
v_mul_f32 v60, v60, v217
v_mul_f32 v61, v61, v217
v_mul_f32 v62, v62, v217
v_mul_f32 v63, v63, v217
v_cvt_pk_bf16_f32 v56, v56, v57
v_cvt_pk_bf16_f32 v57, v58, v59
v_cvt_pk_bf16_f32 v58, v60, v61
v_cvt_pk_bf16_f32 v59, v62, v63
v_accvgpr_read_b32 v214, a232
v_rcp_f32 v218, v214
s_nop 0
v_mul_f32 v64, v64, v218
v_mul_f32 v65, v65, v218
v_mul_f32 v66, v66, v218
v_mul_f32 v67, v67, v218
v_mul_f32 v68, v68, v218
v_mul_f32 v69, v69, v218
v_mul_f32 v70, v70, v218
v_mul_f32 v71, v71, v218
v_cvt_pk_bf16_f32 v64, v64, v65
v_cvt_pk_bf16_f32 v65, v66, v67
v_cvt_pk_bf16_f32 v66, v68, v69
v_cvt_pk_bf16_f32 v67, v70, v71
v_mul_f32 v72, v72, v218
v_mul_f32 v73, v73, v218
v_mul_f32 v74, v74, v218
v_mul_f32 v75, v75, v218
v_mul_f32 v76, v76, v218
v_mul_f32 v77, v77, v218
v_mul_f32 v78, v78, v218
v_mul_f32 v79, v79, v218
v_cvt_pk_bf16_f32 v72, v72, v73
v_cvt_pk_bf16_f32 v73, v74, v75
v_cvt_pk_bf16_f32 v74, v76, v77
v_cvt_pk_bf16_f32 v75, v78, v79
v_mul_f32 v80, v80, v218
v_mul_f32 v81, v81, v218
v_mul_f32 v82, v82, v218
v_mul_f32 v83, v83, v218
v_mul_f32 v84, v84, v218
v_mul_f32 v85, v85, v218
v_mul_f32 v86, v86, v218
v_mul_f32 v87, v87, v218
v_cvt_pk_bf16_f32 v80, v80, v81
v_cvt_pk_bf16_f32 v81, v82, v83
v_cvt_pk_bf16_f32 v82, v84, v85
v_cvt_pk_bf16_f32 v83, v86, v87
v_mul_f32 v88, v88, v218
v_mul_f32 v89, v89, v218
v_mul_f32 v90, v90, v218
v_mul_f32 v91, v91, v218
v_mul_f32 v92, v92, v218
v_mul_f32 v93, v93, v218
v_mul_f32 v94, v94, v218
v_mul_f32 v95, v95, v218
v_cvt_pk_bf16_f32 v88, v88, v89
v_cvt_pk_bf16_f32 v89, v90, v91
v_cvt_pk_bf16_f32 v90, v92, v93
v_cvt_pk_bf16_f32 v91, v94, v95
s_waitcnt vmcnt(0)
s_barrier
ds_write_b128 v189, v[0:3]
s_mul_i32 s44, s3, 9216
s_lshl_b32 s45, s3, 10
s_add_u32 s57, s45, 40960
s_add_u32 s58, s44, 0
s_add_u32 m0, s57, 0
s_nop 0
buffer_load_dwordx4 v221, s[60:63], s58 offen lds
ds_write_b128 v189, v[8:11] offset:5120
s_add_u32 m0, s57, 3968
s_nop 0
buffer_load_dwordx4 v221, s[60:63], s58 offen offset:128 lds
s_add_u32 m0, s57, 7936
s_nop 0
buffer_load_dwordx4 v221, s[60:63], s58 offen offset:256 lds
ds_write_b128 v189, v[16:19] offset:10240
s_add_u32 m0, s57, 11904
s_nop 0
buffer_load_dwordx4 v221, s[60:63], s58 offen offset:384 lds
s_add_u32 m0, s57, 15872
s_nop 0
buffer_load_dwordx4 v221, s[60:63], s58 offen offset:512 lds
ds_write_b128 v189, v[24:27] offset:15360
s_add_u32 m0, s57, 19840
s_nop 0
buffer_load_dwordx4 v221, s[60:63], s58 offen offset:640 lds
s_add_u32 m0, s57, 23808
s_nop 0
buffer_load_dwordx4 v221, s[60:63], s58 offen offset:768 lds
ds_write_b128 v189, v[32:35] offset:1024
s_add_u32 m0, s57, 27776
s_nop 0
buffer_load_dwordx4 v221, s[60:63], s58 offen offset:896 lds
s_add_u32 m0, s57, 31744
s_nop 0
buffer_load_dwordx4 v221, s[60:63], s58 offen offset:1024 lds
ds_write_b128 v189, v[40:43] offset:6144
s_add_u32 s57, s45, 77824
s_add_u32 s58, s44, 36864
s_add_u32 m0, s57, 0
s_nop 0
buffer_load_dwordx4 v221, s[60:63], s58 offen lds
ds_write_b128 v189, v[48:51] offset:11264
s_add_u32 m0, s57, 3968
s_nop 0
buffer_load_dwordx4 v221, s[60:63], s58 offen offset:128 lds
s_add_u32 m0, s57, 7936
s_nop 0
buffer_load_dwordx4 v221, s[60:63], s58 offen offset:256 lds
ds_write_b128 v189, v[56:59] offset:16384
s_add_u32 m0, s57, 11904
s_nop 0
buffer_load_dwordx4 v221, s[60:63], s58 offen offset:384 lds
s_add_u32 m0, s57, 15872
s_nop 0
buffer_load_dwordx4 v221, s[60:63], s58 offen offset:512 lds
ds_write_b128 v189, v[64:67] offset:2048
s_add_u32 m0, s57, 19840
s_nop 0
buffer_load_dwordx4 v221, s[60:63], s58 offen offset:640 lds
s_add_u32 m0, s57, 23808
s_nop 0
buffer_load_dwordx4 v221, s[60:63], s58 offen offset:768 lds
ds_write_b128 v189, v[72:75] offset:7168
s_add_u32 m0, s57, 27776
s_nop 0
buffer_load_dwordx4 v221, s[60:63], s58 offen offset:896 lds
s_add_u32 m0, s57, 31744
s_nop 0
buffer_load_dwordx4 v221, s[60:63], s58 offen offset:1024 lds
ds_write_b128 v189, v[80:83] offset:12288
ds_write_b128 v189, v[88:91] offset:17408
s_waitcnt lgkmcnt(0)
s_branch att_post
qs_h1_88:
s_lshl_b32 s40, s52, 15
s_add_u32 s40, s40, 65536
v_add_u32 v164, s40, v209
s_lshl_b32 s40, s52, 12
s_add_u32 s40, s40, 131072
v_add_u32 v165, s40, v209
ds_read_b128 a[0:3], v164 offset:3072
ds_read_b128 a[4:7], v164 offset:4096
ds_read_b128 a[20:23], v165
ds_read_b128 a[24:27], v165 offset:1024
ds_read_b128 a[40:43], v164 offset:19456
ds_read_b128 a[44:47], v164 offset:20480
ds_read_b128 a[60:63], v165 offset:2048
ds_read_b128 a[64:67], v165 offset:3072
s_waitcnt lgkmcnt(0)
s_barrier
s_waitcnt vmcnt(63)
s_barrier
ds_read_b128 a[160:163], v191
ds_read_b128 a[176:179], v191 offset:4096
ds_read_b128 a[164:167], v192
ds_read_b128 a[180:183], v192 offset:4096
ds_read_b128 a[168:171], v193
ds_read_b128 a[184:187], v193 offset:4096
ds_read_b128 a[172:175], v194
ds_read_b128 a[188:191], v194 offset:4096
v_mov_b32 v32, 0
v_mov_b32 v33, 0
v_mov_b32 v34, 0
v_mov_b32 v35, 0
v_mov_b32 v36, 0
v_mov_b32 v37, 0
v_mov_b32 v38, 0
v_mov_b32 v39, 0
v_mov_b32 v40, 0
v_mov_b32 v41, 0
v_mov_b32 v42, 0
v_mov_b32 v43, 0
v_mov_b32 v44, 0
v_mov_b32 v45, 0
v_mov_b32 v46, 0
v_mov_b32 v47, 0
v_mov_b32 v48, 0
v_mov_b32 v49, 0
v_mov_b32 v50, 0
v_mov_b32 v51, 0
v_mov_b32 v52, 0
v_mov_b32 v53, 0
v_mov_b32 v54, 0
v_mov_b32 v55, 0
v_mov_b32 v56, 0
v_mov_b32 v57, 0
v_mov_b32 v58, 0
v_mov_b32 v59, 0
v_mov_b32 v60, 0
v_mov_b32 v61, 0
v_mov_b32 v62, 0
v_mov_b32 v63, 0
v_mov_b32 v189, 0
v_accvgpr_write_b32 a228, v189
v_accvgpr_write_b32 a229, v189
v_accvgpr_write_b32 a230, v189
v_accvgpr_write_b32 a231, v189
s_waitcnt lgkmcnt(0)
v_mfma_f32_16x16x32_bf16 v[160:163], a[160:163], a[0:3], 0
v_mfma_f32_16x16x32_bf16 v[164:167], a[176:179], a[0:3], 0
v_mfma_f32_16x16x32_bf16 v[160:163], a[164:167], a[20:23], v[160:163]
v_mfma_f32_16x16x32_bf16 v[164:167], a[180:183], a[20:23], v[164:167]
v_mfma_f32_16x16x32_bf16 v[160:163], a[168:171], a[40:43], v[160:163]
v_mfma_f32_16x16x32_bf16 v[164:167], a[184:187], a[40:43], v[164:167]
v_mfma_f32_16x16x32_bf16 v[160:163], a[172:175], a[60:63], v[160:163]
v_mfma_f32_16x16x32_bf16 v[164:167], a[188:191], a[60:63], v[164:167]
s_waitcnt vmcnt(63)
s_barrier
s_nop 4
v_max3_f32 v189, v160, v161, v162
v_max3_f32 v190, v163, v164, v165
ds_read_b64_tr_b16 a[192:193], v195 offset:8192
ds_read_b64_tr_b16 a[194:195], v195 offset:12288
v_max3_f32 v189, v189, v166, v167
v_max_f32 v189, v189, v190
ds_read_b64_tr_b16 a[196:197], v196 offset:8192
ds_read_b64_tr_b16 a[198:199], v196 offset:12288
v_mov_b32 v190, v189
s_nop 1
v_permlane32_swap_b32 v189, v190
ds_read_b64_tr_b16 a[200:201], v197 offset:8192
ds_read_b64_tr_b16 a[202:203], v197 offset:12288
v_max_f32 v189, v189, v190
v_mov_b32 v190, v189
ds_read_b64_tr_b16 a[204:205], v198 offset:8192
ds_read_b64_tr_b16 a[206:207], v198 offset:12288
v_permlane16_swap_b32 v189, v190
v_max_f32 v189, v189, v190
ds_read_b64_tr_b16 a[208:209], v199 offset:8192
ds_read_b64_tr_b16 a[210:211], v199 offset:12288
v_mul_f32 v184, s28, v189
v_fma_f32 v160, v160, s28, -v184
ds_read_b64_tr_b16 a[212:213], v200 offset:8192
ds_read_b64_tr_b16 a[214:215], v200 offset:12288
v_fma_f32 v161, v161, s28, -v184
v_fma_f32 v162, v162, s28, -v184
ds_read_b64_tr_b16 a[216:217], v201 offset:8192
ds_read_b64_tr_b16 a[218:219], v201 offset:12288
v_fma_f32 v163, v163, s28, -v184
v_fma_f32 v164, v164, s28, -v184
ds_read_b64_tr_b16 a[220:221], v202 offset:8192
ds_read_b64_tr_b16 a[222:223], v202 offset:12288
v_fma_f32 v165, v165, s28, -v184
s_waitcnt vmcnt(63)
s_barrier
v_mfma_f32_16x16x32_bf16 v[168:171], a[160:163], a[4:7], 0
ds_read_b128 a[160:163], v191 offset:16384
v_fma_f32 v166, v166, s28, -v184
v_mfma_f32_16x16x32_bf16 v[172:175], a[176:179], a[4:7], 0
ds_read_b128 a[176:179], v191 offset:20480
v_fma_f32 v167, v167, s28, -v184
v_exp_f32 v160, v160
v_mfma_f32_16x16x32_bf16 v[168:171], a[164:167], a[24:27], v[168:171]
ds_read_b128 a[164:167], v192 offset:16384
v_exp_f32 v161, v161
v_exp_f32 v162, v162
v_mfma_f32_16x16x32_bf16 v[172:175], a[180:183], a[24:27], v[172:175]
ds_read_b128 a[180:183], v192 offset:20480
v_exp_f32 v163, v163
v_mfma_f32_16x16x32_bf16 v[168:171], a[168:171], a[44:47], v[168:171]
ds_read_b128 a[168:171], v193 offset:16384
v_exp_f32 v164, v164
v_exp_f32 v165, v165
v_mfma_f32_16x16x32_bf16 v[172:175], a[184:187], a[44:47], v[172:175]
ds_read_b128 a[184:187], v193 offset:20480
v_exp_f32 v166, v166
v_mfma_f32_16x16x32_bf16 v[168:171], a[172:175], a[64:67], v[168:171]
ds_read_b128 a[172:175], v194 offset:16384
v_exp_f32 v167, v167
v_cvt_pk_bf16_f32 v176, v160, v161
v_mfma_f32_16x16x32_bf16 v[172:175], a[188:191], a[64:67], v[172:175]
ds_read_b128 a[188:191], v194 offset:20480
v_cvt_pk_bf16_f32 v177, v162, v163
v_cvt_pk_bf16_f32 v178, v164, v165
v_cvt_pk_bf16_f32 v179, v166, v167
s_waitcnt lgkmcnt(0)
v_mfma_f32_16x16x32_bf16 v[160:163], a[160:163], a[0:3], 0
v_max3_f32 v189, v168, v169, v170
s_nop 0
v_max3_f32 v190, v171, v172, v173
v_mfma_f32_16x16x32_bf16 v[164:167], a[176:179], a[0:3], 0
s_add_u32 s40, s34, s32
s_and_b32 s40, s40, 31
s_lshl_b32 s40, s40, 13
s_lshr_b32 s41, s34, 5
s_lshl_b32 s41, s41, 18
s_add_u32 s40, s40, s41
s_add_u32 s35, s40, s33
s_add_u32 s34, s34, 1
s_add_u32 m0, s37, 49152
s_nop 0
buffer_load_dwordx4 v203, s[16:19], s35 offen nt lds
v_mfma_f32_16x16x32_bf16 v[160:163], a[164:167], a[20:23], v[160:163]
v_mfma_f32_16x16x32_bf16 v[164:167], a[180:183], a[20:23], v[164:167]
buffer_load_dwordx4 v204, s[16:19], s35 offen offset:1024 nt lds
v_mfma_f32_16x16x32_bf16 v[160:163], a[168:171], a[40:43], v[160:163]
v_max3_f32 v189, v189, v174, v175
v_mfma_f32_16x16x32_bf16 v[164:167], a[184:187], a[40:43], v[164:167]
v_max_f32 v189, v189, v190
v_mov_b32 v190, v189
s_nop 1
v_permlane32_swap_b32 v189, v190
v_max_f32 v189, v189, v190
v_mfma_f32_16x16x32_bf16 v[160:163], a[172:175], a[60:63], v[160:163]
s_add_u32 m0, s37, 57344
s_nop 0
buffer_load_dwordx4 v207, s[20:23], s35 offen nt lds
v_mfma_f32_16x16x32_bf16 v[164:167], a[188:191], a[60:63], v[164:167]
v_mov_b32 v190, v189
s_nop 1
v_permlane16_swap_b32 v189, v190
v_max_f32 v189, v189, v190
v_mfma_f32_16x16x32_bf16 v[0:3], a[192:195], v[176:179], 0
buffer_load_dwordx4 v208, s[20:23], s35 offen offset:1024 nt lds
v_mul_f32 v185, s28, v189
v_fma_f32 v168, v168, s28, -v185
v_fma_f32 v169, v169, s28, -v185
v_mfma_f32_16x16x32_bf16 v[4:7], a[196:199], v[176:179], 0
v_fma_f32 v170, v170, s28, -v185
v_fma_f32 v171, v171, s28, -v185
v_fma_f32 v172, v172, s28, -v185
v_mfma_f32_16x16x32_bf16 v[8:11], a[200:203], v[176:179], 0
v_fma_f32 v173, v173, s28, -v185
v_fma_f32 v174, v174, s28, -v185
v_fma_f32 v175, v175, s28, -v185
v_mfma_f32_16x16x32_bf16 v[12:15], a[204:207], v[176:179], 0
v_exp_f32 v168, v168
v_exp_f32 v169, v169
v_mfma_f32_16x16x32_bf16 v[16:19], a[208:211], v[176:179], 0
v_exp_f32 v170, v170
v_mfma_f32_16x16x32_bf16 v[20:23], a[212:215], v[176:179], 0
v_exp_f32 v171, v171
v_exp_f32 v172, v172
v_mfma_f32_16x16x32_bf16 v[24:27], a[216:219], v[176:179], 0
v_exp_f32 v173, v173
v_exp_f32 v174, v174
v_mfma_f32_16x16x32_bf16 v[28:31], a[220:223], v[176:179], 0
v_exp_f32 v175, v175
v_cvt_pk_bf16_f32 v180, v168, v169
v_mfma_f32_16x16x32_bf16 a[224:227], a[244:247], v[176:179], 0
v_cvt_pk_bf16_f32 v181, v170, v171
v_cvt_pk_bf16_f32 v182, v172, v173
v_cvt_pk_bf16_f32 v183, v174, v175
s_mov_b32 s38, 0
loop_132:
s_waitcnt vmcnt(8)
s_barrier
v_mfma_f32_16x16x32_bf16 v[32:35], a[192:195], v[180:183], v[32:35]
ds_read_b64_tr_b16 a[192:193], v195 offset:24576
ds_read_b64_tr_b16 a[194:195], v195 offset:28672
v_mfma_f32_16x16x32_bf16 v[36:39], a[196:199], v[180:183], v[36:39]
ds_read_b64_tr_b16 a[196:197], v196 offset:24576
ds_read_b64_tr_b16 a[198:199], v196 offset:28672
v_fma_f32 v160, v160, s28, -v184
v_mfma_f32_16x16x32_bf16 v[40:43], a[200:203], v[180:183], v[40:43]
ds_read_b64_tr_b16 a[200:201], v197 offset:24576
ds_read_b64_tr_b16 a[202:203], v197 offset:28672
v_fma_f32 v161, v161, s28, -v184
v_fma_f32 v162, v162, s28, -v184
v_mfma_f32_16x16x32_bf16 v[44:47], a[204:207], v[180:183], v[44:47]
ds_read_b64_tr_b16 a[204:205], v198 offset:24576
ds_read_b64_tr_b16 a[206:207], v198 offset:28672
v_fma_f32 v163, v163, s28, -v184
v_fma_f32 v164, v164, s28, -v184
v_mfma_f32_16x16x32_bf16 v[48:51], a[208:211], v[180:183], v[48:51]
ds_read_b64_tr_b16 a[208:209], v199 offset:24576
ds_read_b64_tr_b16 a[210:211], v199 offset:28672
v_fma_f32 v165, v165, s28, -v184
v_mfma_f32_16x16x32_bf16 v[52:55], a[212:215], v[180:183], v[52:55]
ds_read_b64_tr_b16 a[212:213], v200 offset:24576
ds_read_b64_tr_b16 a[214:215], v200 offset:28672
v_fma_f32 v166, v166, s28, -v184
v_fma_f32 v167, v167, s28, -v184
v_mfma_f32_16x16x32_bf16 v[56:59], a[216:219], v[180:183], v[56:59]
ds_read_b64_tr_b16 a[216:217], v201 offset:24576
ds_read_b64_tr_b16 a[218:219], v201 offset:28672
v_max3_f32 v189, v160, v161, v162
v_max3_f32 v190, v163, v164, v165
v_mfma_f32_16x16x32_bf16 v[60:63], a[220:223], v[180:183], v[60:63]
ds_read_b64_tr_b16 a[220:221], v202 offset:24576
ds_read_b64_tr_b16 a[222:223], v202 offset:28672
v_max3_f32 v189, v189, v166, v167
v_mfma_f32_16x16x32_bf16 a[228:231], a[244:247], v[180:183], a[228:231]
v_max_f32 v189, v189, v190
v_cmp_lt_f32 vcc, 0x41000000, v189
s_cbranch_vccnz stub_133
back_134:
s_waitcnt vmcnt(6)
s_barrier
v_mfma_f32_16x16x32_bf16 v[168:171], a[160:163], a[4:7], 0
ds_read_b128 a[160:163], v191 offset:32768
v_exp_f32 v160, v160
v_mfma_f32_16x16x32_bf16 v[172:175], a[176:179], a[4:7], 0
ds_read_b128 a[176:179], v191 offset:36864
v_exp_f32 v161, v161
v_mfma_f32_16x16x32_bf16 v[168:171], a[164:167], a[24:27], v[168:171]
ds_read_b128 a[164:167], v192 offset:32768
v_exp_f32 v162, v162
v_mfma_f32_16x16x32_bf16 v[172:175], a[180:183], a[24:27], v[172:175]
ds_read_b128 a[180:183], v192 offset:36864
v_exp_f32 v163, v163
v_exp_f32 v164, v164
v_mfma_f32_16x16x32_bf16 v[168:171], a[168:171], a[44:47], v[168:171]
ds_read_b128 a[168:171], v193 offset:32768
v_exp_f32 v165, v165
v_mfma_f32_16x16x32_bf16 v[172:175], a[184:187], a[44:47], v[172:175]
ds_read_b128 a[184:187], v193 offset:36864
v_exp_f32 v166, v166
v_mfma_f32_16x16x32_bf16 v[168:171], a[172:175], a[64:67], v[168:171]
ds_read_b128 a[172:175], v194 offset:32768
v_exp_f32 v167, v167
v_cvt_pk_bf16_f32 v176, v160, v161
v_mfma_f32_16x16x32_bf16 v[172:175], a[188:191], a[64:67], v[172:175]
ds_read_b128 a[188:191], v194 offset:36864
v_cvt_pk_bf16_f32 v177, v162, v163
v_cvt_pk_bf16_f32 v178, v164, v165
v_cvt_pk_bf16_f32 v179, v166, v167
s_waitcnt lgkmcnt(0)
v_mfma_f32_16x16x32_bf16 v[160:163], a[160:163], a[0:3], 0
v_fma_f32 v168, v168, s28, -v185
v_fma_f32 v169, v169, s28, -v185
v_mfma_f32_16x16x32_bf16 v[164:167], a[176:179], a[0:3], 0
s_add_u32 s40, s34, s32
s_and_b32 s40, s40, 31
s_lshl_b32 s40, s40, 13
s_lshr_b32 s41, s34, 5
s_lshl_b32 s41, s41, 18
s_add_u32 s40, s40, s41
s_add_u32 s35, s40, s33
s_add_u32 s34, s34, 1
s_add_u32 m0, s37, 0
s_nop 0
buffer_load_dwordx4 v203, s[16:19], s35 offen nt lds
v_mfma_f32_16x16x32_bf16 v[160:163], a[164:167], a[20:23], v[160:163]
v_mfma_f32_16x16x32_bf16 v[164:167], a[180:183], a[20:23], v[164:167]
buffer_load_dwordx4 v204, s[16:19], s35 offen offset:1024 nt lds
v_mfma_f32_16x16x32_bf16 v[160:163], a[168:171], a[40:43], v[160:163]
v_mfma_f32_16x16x32_bf16 v[164:167], a[184:187], a[40:43], v[164:167]
v_fma_f32 v170, v170, s28, -v185
v_fma_f32 v171, v171, s28, -v185
v_fma_f32 v172, v172, s28, -v185
v_mfma_f32_16x16x32_bf16 v[160:163], a[172:175], a[60:63], v[160:163]
s_add_u32 m0, s37, 8192
s_nop 0
buffer_load_dwordx4 v207, s[20:23], s35 offen nt lds
v_mfma_f32_16x16x32_bf16 v[164:167], a[188:191], a[60:63], v[164:167]
v_fma_f32 v173, v173, s28, -v185
v_fma_f32 v174, v174, s28, -v185
v_fma_f32 v175, v175, s28, -v185
v_mfma_f32_16x16x32_bf16 v[0:3], a[192:195], v[176:179], v[0:3]
buffer_load_dwordx4 v208, s[20:23], s35 offen offset:1024 nt lds
v_max3_f32 v189, v168, v169, v170
v_max3_f32 v190, v171, v172, v173
v_mfma_f32_16x16x32_bf16 v[4:7], a[196:199], v[176:179], v[4:7]
v_max3_f32 v189, v189, v174, v175
v_max_f32 v189, v189, v190
v_cmp_lt_f32 vcc, 0x41000000, v189
v_mfma_f32_16x16x32_bf16 v[8:11], a[200:203], v[176:179], v[8:11]
s_cbranch_vccnz stub_135
back_136:
v_exp_f32 v168, v168
v_mfma_f32_16x16x32_bf16 v[12:15], a[204:207], v[176:179], v[12:15]
v_exp_f32 v169, v169
v_exp_f32 v170, v170
v_mfma_f32_16x16x32_bf16 v[16:19], a[208:211], v[176:179], v[16:19]
v_exp_f32 v171, v171
v_mfma_f32_16x16x32_bf16 v[20:23], a[212:215], v[176:179], v[20:23]
v_exp_f32 v172, v172
v_exp_f32 v173, v173
v_mfma_f32_16x16x32_bf16 v[24:27], a[216:219], v[176:179], v[24:27]
v_exp_f32 v174, v174
v_mfma_f32_16x16x32_bf16 v[28:31], a[220:223], v[176:179], v[28:31]
v_exp_f32 v175, v175
v_cvt_pk_bf16_f32 v180, v168, v169
v_mfma_f32_16x16x32_bf16 a[224:227], a[244:247], v[176:179], a[224:227]
v_cvt_pk_bf16_f32 v181, v170, v171
v_cvt_pk_bf16_f32 v182, v172, v173
v_cvt_pk_bf16_f32 v183, v174, v175
s_waitcnt vmcnt(8)
s_barrier
v_mfma_f32_16x16x32_bf16 v[32:35], a[192:195], v[180:183], v[32:35]
ds_read_b64_tr_b16 a[192:193], v195 offset:40960
ds_read_b64_tr_b16 a[194:195], v195 offset:45056
v_mfma_f32_16x16x32_bf16 v[36:39], a[196:199], v[180:183], v[36:39]
ds_read_b64_tr_b16 a[196:197], v196 offset:40960
ds_read_b64_tr_b16 a[198:199], v196 offset:45056
v_fma_f32 v160, v160, s28, -v184
v_mfma_f32_16x16x32_bf16 v[40:43], a[200:203], v[180:183], v[40:43]
ds_read_b64_tr_b16 a[200:201], v197 offset:40960
ds_read_b64_tr_b16 a[202:203], v197 offset:45056
v_fma_f32 v161, v161, s28, -v184
v_fma_f32 v162, v162, s28, -v184
v_mfma_f32_16x16x32_bf16 v[44:47], a[204:207], v[180:183], v[44:47]
ds_read_b64_tr_b16 a[204:205], v198 offset:40960
ds_read_b64_tr_b16 a[206:207], v198 offset:45056
v_fma_f32 v163, v163, s28, -v184
v_fma_f32 v164, v164, s28, -v184
v_mfma_f32_16x16x32_bf16 v[48:51], a[208:211], v[180:183], v[48:51]
ds_read_b64_tr_b16 a[208:209], v199 offset:40960
ds_read_b64_tr_b16 a[210:211], v199 offset:45056
v_fma_f32 v165, v165, s28, -v184
v_mfma_f32_16x16x32_bf16 v[52:55], a[212:215], v[180:183], v[52:55]
ds_read_b64_tr_b16 a[212:213], v200 offset:40960
ds_read_b64_tr_b16 a[214:215], v200 offset:45056
v_fma_f32 v166, v166, s28, -v184
v_fma_f32 v167, v167, s28, -v184
v_mfma_f32_16x16x32_bf16 v[56:59], a[216:219], v[180:183], v[56:59]
ds_read_b64_tr_b16 a[216:217], v201 offset:40960
ds_read_b64_tr_b16 a[218:219], v201 offset:45056
v_max3_f32 v189, v160, v161, v162
v_max3_f32 v190, v163, v164, v165
v_mfma_f32_16x16x32_bf16 v[60:63], a[220:223], v[180:183], v[60:63]
ds_read_b64_tr_b16 a[220:221], v202 offset:40960
ds_read_b64_tr_b16 a[222:223], v202 offset:45056
v_max3_f32 v189, v189, v166, v167
v_mfma_f32_16x16x32_bf16 a[228:231], a[244:247], v[180:183], a[228:231]
v_max_f32 v189, v189, v190
v_cmp_lt_f32 vcc, 0x41000000, v189
s_cbranch_vccnz stub_137
back_138:
s_waitcnt vmcnt(6)
s_barrier
v_mfma_f32_16x16x32_bf16 v[168:171], a[160:163], a[4:7], 0
ds_read_b128 a[160:163], v191 offset:49152
v_exp_f32 v160, v160
v_mfma_f32_16x16x32_bf16 v[172:175], a[176:179], a[4:7], 0
ds_read_b128 a[176:179], v191 offset:53248
v_exp_f32 v161, v161
v_mfma_f32_16x16x32_bf16 v[168:171], a[164:167], a[24:27], v[168:171]
ds_read_b128 a[164:167], v192 offset:49152
v_exp_f32 v162, v162
v_mfma_f32_16x16x32_bf16 v[172:175], a[180:183], a[24:27], v[172:175]
ds_read_b128 a[180:183], v192 offset:53248
v_exp_f32 v163, v163
v_exp_f32 v164, v164
v_mfma_f32_16x16x32_bf16 v[168:171], a[168:171], a[44:47], v[168:171]
ds_read_b128 a[168:171], v193 offset:49152
v_exp_f32 v165, v165
v_mfma_f32_16x16x32_bf16 v[172:175], a[184:187], a[44:47], v[172:175]
ds_read_b128 a[184:187], v193 offset:53248
v_exp_f32 v166, v166
v_mfma_f32_16x16x32_bf16 v[168:171], a[172:175], a[64:67], v[168:171]
ds_read_b128 a[172:175], v194 offset:49152
v_exp_f32 v167, v167
v_cvt_pk_bf16_f32 v176, v160, v161
v_mfma_f32_16x16x32_bf16 v[172:175], a[188:191], a[64:67], v[172:175]
ds_read_b128 a[188:191], v194 offset:53248
v_cvt_pk_bf16_f32 v177, v162, v163
v_cvt_pk_bf16_f32 v178, v164, v165
v_cvt_pk_bf16_f32 v179, v166, v167
s_waitcnt lgkmcnt(0)
v_mfma_f32_16x16x32_bf16 v[160:163], a[160:163], a[0:3], 0
v_fma_f32 v168, v168, s28, -v185
v_fma_f32 v169, v169, s28, -v185
v_mfma_f32_16x16x32_bf16 v[164:167], a[176:179], a[0:3], 0
s_add_u32 s40, s34, s32
s_and_b32 s40, s40, 31
s_lshl_b32 s40, s40, 13
s_lshr_b32 s41, s34, 5
s_lshl_b32 s41, s41, 18
s_add_u32 s40, s40, s41
s_add_u32 s35, s40, s33
s_add_u32 s34, s34, 1
s_add_u32 m0, s37, 16384
s_nop 0
buffer_load_dwordx4 v203, s[16:19], s35 offen nt lds
v_mfma_f32_16x16x32_bf16 v[160:163], a[164:167], a[20:23], v[160:163]
v_mfma_f32_16x16x32_bf16 v[164:167], a[180:183], a[20:23], v[164:167]
buffer_load_dwordx4 v204, s[16:19], s35 offen offset:1024 nt lds
v_mfma_f32_16x16x32_bf16 v[160:163], a[168:171], a[40:43], v[160:163]
v_mfma_f32_16x16x32_bf16 v[164:167], a[184:187], a[40:43], v[164:167]
v_fma_f32 v170, v170, s28, -v185
v_fma_f32 v171, v171, s28, -v185
v_fma_f32 v172, v172, s28, -v185
v_mfma_f32_16x16x32_bf16 v[160:163], a[172:175], a[60:63], v[160:163]
s_add_u32 m0, s37, 24576
s_nop 0
buffer_load_dwordx4 v207, s[20:23], s35 offen nt lds
v_mfma_f32_16x16x32_bf16 v[164:167], a[188:191], a[60:63], v[164:167]
v_fma_f32 v173, v173, s28, -v185
v_fma_f32 v174, v174, s28, -v185
v_fma_f32 v175, v175, s28, -v185
v_mfma_f32_16x16x32_bf16 v[0:3], a[192:195], v[176:179], v[0:3]
buffer_load_dwordx4 v208, s[20:23], s35 offen offset:1024 nt lds
v_max3_f32 v189, v168, v169, v170
v_max3_f32 v190, v171, v172, v173
v_mfma_f32_16x16x32_bf16 v[4:7], a[196:199], v[176:179], v[4:7]
v_max3_f32 v189, v189, v174, v175
v_max_f32 v189, v189, v190
v_cmp_lt_f32 vcc, 0x41000000, v189
v_mfma_f32_16x16x32_bf16 v[8:11], a[200:203], v[176:179], v[8:11]
s_cbranch_vccnz stub_139
back_140:
v_exp_f32 v168, v168
v_mfma_f32_16x16x32_bf16 v[12:15], a[204:207], v[176:179], v[12:15]
v_exp_f32 v169, v169
v_exp_f32 v170, v170
v_mfma_f32_16x16x32_bf16 v[16:19], a[208:211], v[176:179], v[16:19]
v_exp_f32 v171, v171
v_mfma_f32_16x16x32_bf16 v[20:23], a[212:215], v[176:179], v[20:23]
v_exp_f32 v172, v172
v_exp_f32 v173, v173
v_mfma_f32_16x16x32_bf16 v[24:27], a[216:219], v[176:179], v[24:27]
v_exp_f32 v174, v174
v_mfma_f32_16x16x32_bf16 v[28:31], a[220:223], v[176:179], v[28:31]
v_exp_f32 v175, v175
v_cvt_pk_bf16_f32 v180, v168, v169
v_mfma_f32_16x16x32_bf16 a[224:227], a[244:247], v[176:179], a[224:227]
v_cvt_pk_bf16_f32 v181, v170, v171
v_cvt_pk_bf16_f32 v182, v172, v173
v_cvt_pk_bf16_f32 v183, v174, v175
s_waitcnt vmcnt(8)
s_barrier
v_mfma_f32_16x16x32_bf16 v[32:35], a[192:195], v[180:183], v[32:35]
ds_read_b64_tr_b16 a[192:193], v195 offset:57344
ds_read_b64_tr_b16 a[194:195], v195 offset:61440
v_mfma_f32_16x16x32_bf16 v[36:39], a[196:199], v[180:183], v[36:39]
ds_read_b64_tr_b16 a[196:197], v196 offset:57344
ds_read_b64_tr_b16 a[198:199], v196 offset:61440
v_fma_f32 v160, v160, s28, -v184
v_mfma_f32_16x16x32_bf16 v[40:43], a[200:203], v[180:183], v[40:43]
ds_read_b64_tr_b16 a[200:201], v197 offset:57344
ds_read_b64_tr_b16 a[202:203], v197 offset:61440
v_fma_f32 v161, v161, s28, -v184
v_fma_f32 v162, v162, s28, -v184
v_mfma_f32_16x16x32_bf16 v[44:47], a[204:207], v[180:183], v[44:47]
ds_read_b64_tr_b16 a[204:205], v198 offset:57344
ds_read_b64_tr_b16 a[206:207], v198 offset:61440
v_fma_f32 v163, v163, s28, -v184
v_fma_f32 v164, v164, s28, -v184
v_mfma_f32_16x16x32_bf16 v[48:51], a[208:211], v[180:183], v[48:51]
ds_read_b64_tr_b16 a[208:209], v199 offset:57344
ds_read_b64_tr_b16 a[210:211], v199 offset:61440
v_fma_f32 v165, v165, s28, -v184
v_mfma_f32_16x16x32_bf16 v[52:55], a[212:215], v[180:183], v[52:55]
ds_read_b64_tr_b16 a[212:213], v200 offset:57344
ds_read_b64_tr_b16 a[214:215], v200 offset:61440
v_fma_f32 v166, v166, s28, -v184
v_fma_f32 v167, v167, s28, -v184
v_mfma_f32_16x16x32_bf16 v[56:59], a[216:219], v[180:183], v[56:59]
ds_read_b64_tr_b16 a[216:217], v201 offset:57344
ds_read_b64_tr_b16 a[218:219], v201 offset:61440
v_max3_f32 v189, v160, v161, v162
v_max3_f32 v190, v163, v164, v165
v_mfma_f32_16x16x32_bf16 v[60:63], a[220:223], v[180:183], v[60:63]
ds_read_b64_tr_b16 a[220:221], v202 offset:57344
ds_read_b64_tr_b16 a[222:223], v202 offset:61440
v_max3_f32 v189, v189, v166, v167
v_mfma_f32_16x16x32_bf16 a[228:231], a[244:247], v[180:183], a[228:231]
v_max_f32 v189, v189, v190
v_cmp_lt_f32 vcc, 0x41000000, v189
s_cbranch_vccnz stub_141
back_142:
s_waitcnt vmcnt(6)
s_barrier
v_mfma_f32_16x16x32_bf16 v[168:171], a[160:163], a[4:7], 0
ds_read_b128 a[160:163], v191
v_exp_f32 v160, v160
v_mfma_f32_16x16x32_bf16 v[172:175], a[176:179], a[4:7], 0
ds_read_b128 a[176:179], v191 offset:4096
v_exp_f32 v161, v161
v_mfma_f32_16x16x32_bf16 v[168:171], a[164:167], a[24:27], v[168:171]
ds_read_b128 a[164:167], v192
v_exp_f32 v162, v162
v_mfma_f32_16x16x32_bf16 v[172:175], a[180:183], a[24:27], v[172:175]
ds_read_b128 a[180:183], v192 offset:4096
v_exp_f32 v163, v163
v_exp_f32 v164, v164
v_mfma_f32_16x16x32_bf16 v[168:171], a[168:171], a[44:47], v[168:171]
ds_read_b128 a[168:171], v193
v_exp_f32 v165, v165
v_mfma_f32_16x16x32_bf16 v[172:175], a[184:187], a[44:47], v[172:175]
ds_read_b128 a[184:187], v193 offset:4096
v_exp_f32 v166, v166
v_mfma_f32_16x16x32_bf16 v[168:171], a[172:175], a[64:67], v[168:171]
ds_read_b128 a[172:175], v194
v_exp_f32 v167, v167
v_cvt_pk_bf16_f32 v176, v160, v161
v_mfma_f32_16x16x32_bf16 v[172:175], a[188:191], a[64:67], v[172:175]
ds_read_b128 a[188:191], v194 offset:4096
v_cvt_pk_bf16_f32 v177, v162, v163
v_cvt_pk_bf16_f32 v178, v164, v165
v_cvt_pk_bf16_f32 v179, v166, v167
s_waitcnt lgkmcnt(0)
v_mfma_f32_16x16x32_bf16 v[160:163], a[160:163], a[0:3], 0
v_fma_f32 v168, v168, s28, -v185
v_fma_f32 v169, v169, s28, -v185
v_mfma_f32_16x16x32_bf16 v[164:167], a[176:179], a[0:3], 0
s_add_u32 s40, s34, s32
s_and_b32 s40, s40, 31
s_lshl_b32 s40, s40, 13
s_lshr_b32 s41, s34, 5
s_lshl_b32 s41, s41, 18
s_add_u32 s40, s40, s41
s_add_u32 s35, s40, s33
s_add_u32 s34, s34, 1
s_add_u32 m0, s37, 32768
s_nop 0
buffer_load_dwordx4 v203, s[16:19], s35 offen nt lds
v_mfma_f32_16x16x32_bf16 v[160:163], a[164:167], a[20:23], v[160:163]
v_mfma_f32_16x16x32_bf16 v[164:167], a[180:183], a[20:23], v[164:167]
buffer_load_dwordx4 v204, s[16:19], s35 offen offset:1024 nt lds
v_mfma_f32_16x16x32_bf16 v[160:163], a[168:171], a[40:43], v[160:163]
v_mfma_f32_16x16x32_bf16 v[164:167], a[184:187], a[40:43], v[164:167]
v_fma_f32 v170, v170, s28, -v185
v_fma_f32 v171, v171, s28, -v185
v_fma_f32 v172, v172, s28, -v185
v_mfma_f32_16x16x32_bf16 v[160:163], a[172:175], a[60:63], v[160:163]
s_add_u32 m0, s37, 40960
s_nop 0
buffer_load_dwordx4 v207, s[20:23], s35 offen nt lds
v_mfma_f32_16x16x32_bf16 v[164:167], a[188:191], a[60:63], v[164:167]
v_fma_f32 v173, v173, s28, -v185
v_fma_f32 v174, v174, s28, -v185
v_fma_f32 v175, v175, s28, -v185
v_mfma_f32_16x16x32_bf16 v[0:3], a[192:195], v[176:179], v[0:3]
buffer_load_dwordx4 v208, s[20:23], s35 offen offset:1024 nt lds
v_max3_f32 v189, v168, v169, v170
v_max3_f32 v190, v171, v172, v173
v_mfma_f32_16x16x32_bf16 v[4:7], a[196:199], v[176:179], v[4:7]
v_max3_f32 v189, v189, v174, v175
v_max_f32 v189, v189, v190
v_cmp_lt_f32 vcc, 0x41000000, v189
v_mfma_f32_16x16x32_bf16 v[8:11], a[200:203], v[176:179], v[8:11]
s_cbranch_vccnz stub_143
back_144:
v_exp_f32 v168, v168
v_mfma_f32_16x16x32_bf16 v[12:15], a[204:207], v[176:179], v[12:15]
v_exp_f32 v169, v169
v_exp_f32 v170, v170
v_mfma_f32_16x16x32_bf16 v[16:19], a[208:211], v[176:179], v[16:19]
v_exp_f32 v171, v171
v_mfma_f32_16x16x32_bf16 v[20:23], a[212:215], v[176:179], v[20:23]
v_exp_f32 v172, v172
v_exp_f32 v173, v173
v_mfma_f32_16x16x32_bf16 v[24:27], a[216:219], v[176:179], v[24:27]
v_exp_f32 v174, v174
v_mfma_f32_16x16x32_bf16 v[28:31], a[220:223], v[176:179], v[28:31]
v_exp_f32 v175, v175
v_cvt_pk_bf16_f32 v180, v168, v169
v_mfma_f32_16x16x32_bf16 a[224:227], a[244:247], v[176:179], a[224:227]
v_cvt_pk_bf16_f32 v181, v170, v171
v_cvt_pk_bf16_f32 v182, v172, v173
v_cvt_pk_bf16_f32 v183, v174, v175
s_waitcnt vmcnt(8)
s_barrier
v_mfma_f32_16x16x32_bf16 v[32:35], a[192:195], v[180:183], v[32:35]
ds_read_b64_tr_b16 a[192:193], v195 offset:8192
ds_read_b64_tr_b16 a[194:195], v195 offset:12288
v_mfma_f32_16x16x32_bf16 v[36:39], a[196:199], v[180:183], v[36:39]
ds_read_b64_tr_b16 a[196:197], v196 offset:8192
ds_read_b64_tr_b16 a[198:199], v196 offset:12288
v_fma_f32 v160, v160, s28, -v184
v_mfma_f32_16x16x32_bf16 v[40:43], a[200:203], v[180:183], v[40:43]
ds_read_b64_tr_b16 a[200:201], v197 offset:8192
ds_read_b64_tr_b16 a[202:203], v197 offset:12288
v_fma_f32 v161, v161, s28, -v184
v_fma_f32 v162, v162, s28, -v184
v_mfma_f32_16x16x32_bf16 v[44:47], a[204:207], v[180:183], v[44:47]
ds_read_b64_tr_b16 a[204:205], v198 offset:8192
ds_read_b64_tr_b16 a[206:207], v198 offset:12288
v_fma_f32 v163, v163, s28, -v184
v_fma_f32 v164, v164, s28, -v184
v_mfma_f32_16x16x32_bf16 v[48:51], a[208:211], v[180:183], v[48:51]
ds_read_b64_tr_b16 a[208:209], v199 offset:8192
ds_read_b64_tr_b16 a[210:211], v199 offset:12288
v_fma_f32 v165, v165, s28, -v184
v_mfma_f32_16x16x32_bf16 v[52:55], a[212:215], v[180:183], v[52:55]
ds_read_b64_tr_b16 a[212:213], v200 offset:8192
ds_read_b64_tr_b16 a[214:215], v200 offset:12288
v_fma_f32 v166, v166, s28, -v184
v_fma_f32 v167, v167, s28, -v184
v_mfma_f32_16x16x32_bf16 v[56:59], a[216:219], v[180:183], v[56:59]
ds_read_b64_tr_b16 a[216:217], v201 offset:8192
ds_read_b64_tr_b16 a[218:219], v201 offset:12288
v_max3_f32 v189, v160, v161, v162
v_max3_f32 v190, v163, v164, v165
v_mfma_f32_16x16x32_bf16 v[60:63], a[220:223], v[180:183], v[60:63]
ds_read_b64_tr_b16 a[220:221], v202 offset:8192
ds_read_b64_tr_b16 a[222:223], v202 offset:12288
v_max3_f32 v189, v189, v166, v167
v_mfma_f32_16x16x32_bf16 a[228:231], a[244:247], v[180:183], a[228:231]
v_max_f32 v189, v189, v190
v_cmp_lt_f32 vcc, 0x41000000, v189
s_cbranch_vccnz stub_145
back_146:
s_waitcnt vmcnt(6)
s_barrier
v_mfma_f32_16x16x32_bf16 v[168:171], a[160:163], a[4:7], 0
ds_read_b128 a[160:163], v191 offset:16384
v_exp_f32 v160, v160
v_mfma_f32_16x16x32_bf16 v[172:175], a[176:179], a[4:7], 0
ds_read_b128 a[176:179], v191 offset:20480
v_exp_f32 v161, v161
v_mfma_f32_16x16x32_bf16 v[168:171], a[164:167], a[24:27], v[168:171]
ds_read_b128 a[164:167], v192 offset:16384
v_exp_f32 v162, v162
v_mfma_f32_16x16x32_bf16 v[172:175], a[180:183], a[24:27], v[172:175]
ds_read_b128 a[180:183], v192 offset:20480
v_exp_f32 v163, v163
v_exp_f32 v164, v164
v_mfma_f32_16x16x32_bf16 v[168:171], a[168:171], a[44:47], v[168:171]
ds_read_b128 a[168:171], v193 offset:16384
v_exp_f32 v165, v165
v_mfma_f32_16x16x32_bf16 v[172:175], a[184:187], a[44:47], v[172:175]
ds_read_b128 a[184:187], v193 offset:20480
v_exp_f32 v166, v166
v_mfma_f32_16x16x32_bf16 v[168:171], a[172:175], a[64:67], v[168:171]
ds_read_b128 a[172:175], v194 offset:16384
v_exp_f32 v167, v167
v_cvt_pk_bf16_f32 v176, v160, v161
v_mfma_f32_16x16x32_bf16 v[172:175], a[188:191], a[64:67], v[172:175]
ds_read_b128 a[188:191], v194 offset:20480
v_cvt_pk_bf16_f32 v177, v162, v163
v_cvt_pk_bf16_f32 v178, v164, v165
v_cvt_pk_bf16_f32 v179, v166, v167
s_waitcnt lgkmcnt(0)
v_mfma_f32_16x16x32_bf16 v[160:163], a[160:163], a[0:3], 0
v_fma_f32 v168, v168, s28, -v185
v_fma_f32 v169, v169, s28, -v185
v_mfma_f32_16x16x32_bf16 v[164:167], a[176:179], a[0:3], 0
s_add_u32 s40, s34, s32
s_and_b32 s40, s40, 31
s_lshl_b32 s40, s40, 13
s_lshr_b32 s41, s34, 5
s_lshl_b32 s41, s41, 18
s_add_u32 s40, s40, s41
s_add_u32 s35, s40, s33
s_add_u32 s34, s34, 1
s_add_u32 m0, s37, 49152
s_nop 0
buffer_load_dwordx4 v203, s[16:19], s35 offen nt lds
v_mfma_f32_16x16x32_bf16 v[160:163], a[164:167], a[20:23], v[160:163]
v_mfma_f32_16x16x32_bf16 v[164:167], a[180:183], a[20:23], v[164:167]
buffer_load_dwordx4 v204, s[16:19], s35 offen offset:1024 nt lds
v_mfma_f32_16x16x32_bf16 v[160:163], a[168:171], a[40:43], v[160:163]
v_mfma_f32_16x16x32_bf16 v[164:167], a[184:187], a[40:43], v[164:167]
v_fma_f32 v170, v170, s28, -v185
v_fma_f32 v171, v171, s28, -v185
v_fma_f32 v172, v172, s28, -v185
v_mfma_f32_16x16x32_bf16 v[160:163], a[172:175], a[60:63], v[160:163]
s_add_u32 m0, s37, 57344
s_nop 0
buffer_load_dwordx4 v207, s[20:23], s35 offen nt lds
v_mfma_f32_16x16x32_bf16 v[164:167], a[188:191], a[60:63], v[164:167]
v_fma_f32 v173, v173, s28, -v185
v_fma_f32 v174, v174, s28, -v185
v_fma_f32 v175, v175, s28, -v185
v_mfma_f32_16x16x32_bf16 v[0:3], a[192:195], v[176:179], v[0:3]
buffer_load_dwordx4 v208, s[20:23], s35 offen offset:1024 nt lds
v_max3_f32 v189, v168, v169, v170
v_max3_f32 v190, v171, v172, v173
v_mfma_f32_16x16x32_bf16 v[4:7], a[196:199], v[176:179], v[4:7]
v_max3_f32 v189, v189, v174, v175
v_max_f32 v189, v189, v190
v_cmp_lt_f32 vcc, 0x41000000, v189
v_mfma_f32_16x16x32_bf16 v[8:11], a[200:203], v[176:179], v[8:11]
s_cbranch_vccnz stub_147
back_148:
v_exp_f32 v168, v168
v_mfma_f32_16x16x32_bf16 v[12:15], a[204:207], v[176:179], v[12:15]
v_exp_f32 v169, v169
v_exp_f32 v170, v170
v_mfma_f32_16x16x32_bf16 v[16:19], a[208:211], v[176:179], v[16:19]
v_exp_f32 v171, v171
v_mfma_f32_16x16x32_bf16 v[20:23], a[212:215], v[176:179], v[20:23]
v_exp_f32 v172, v172
v_exp_f32 v173, v173
v_mfma_f32_16x16x32_bf16 v[24:27], a[216:219], v[176:179], v[24:27]
v_exp_f32 v174, v174
v_mfma_f32_16x16x32_bf16 v[28:31], a[220:223], v[176:179], v[28:31]
v_exp_f32 v175, v175
v_cvt_pk_bf16_f32 v180, v168, v169
v_mfma_f32_16x16x32_bf16 a[224:227], a[244:247], v[176:179], a[224:227]
v_cvt_pk_bf16_f32 v181, v170, v171
v_cvt_pk_bf16_f32 v182, v172, v173
v_cvt_pk_bf16_f32 v183, v174, v175
s_add_u32 s38, s38, 1
s_cmp_lt_u32 s38, 7
s_cbranch_scc1 loop_132
s_waitcnt vmcnt(8)
s_barrier
v_mfma_f32_16x16x32_bf16 v[32:35], a[192:195], v[180:183], v[32:35]
ds_read_b64_tr_b16 a[192:193], v195 offset:24576
ds_read_b64_tr_b16 a[194:195], v195 offset:28672
v_mfma_f32_16x16x32_bf16 v[36:39], a[196:199], v[180:183], v[36:39]
ds_read_b64_tr_b16 a[196:197], v196 offset:24576
ds_read_b64_tr_b16 a[198:199], v196 offset:28672
v_fma_f32 v160, v160, s28, -v184
v_mfma_f32_16x16x32_bf16 v[40:43], a[200:203], v[180:183], v[40:43]
ds_read_b64_tr_b16 a[200:201], v197 offset:24576
ds_read_b64_tr_b16 a[202:203], v197 offset:28672
v_fma_f32 v161, v161, s28, -v184
v_fma_f32 v162, v162, s28, -v184
v_mfma_f32_16x16x32_bf16 v[44:47], a[204:207], v[180:183], v[44:47]
ds_read_b64_tr_b16 a[204:205], v198 offset:24576
ds_read_b64_tr_b16 a[206:207], v198 offset:28672
v_fma_f32 v163, v163, s28, -v184
v_fma_f32 v164, v164, s28, -v184
v_mfma_f32_16x16x32_bf16 v[48:51], a[208:211], v[180:183], v[48:51]
ds_read_b64_tr_b16 a[208:209], v199 offset:24576
ds_read_b64_tr_b16 a[210:211], v199 offset:28672
v_fma_f32 v165, v165, s28, -v184
v_mfma_f32_16x16x32_bf16 v[52:55], a[212:215], v[180:183], v[52:55]
ds_read_b64_tr_b16 a[212:213], v200 offset:24576
ds_read_b64_tr_b16 a[214:215], v200 offset:28672
v_fma_f32 v166, v166, s28, -v184
v_fma_f32 v167, v167, s28, -v184
v_mfma_f32_16x16x32_bf16 v[56:59], a[216:219], v[180:183], v[56:59]
ds_read_b64_tr_b16 a[216:217], v201 offset:24576
ds_read_b64_tr_b16 a[218:219], v201 offset:28672
v_max3_f32 v189, v160, v161, v162
v_max3_f32 v190, v163, v164, v165
v_mfma_f32_16x16x32_bf16 v[60:63], a[220:223], v[180:183], v[60:63]
ds_read_b64_tr_b16 a[220:221], v202 offset:24576
ds_read_b64_tr_b16 a[222:223], v202 offset:28672
v_max3_f32 v189, v189, v166, v167
v_mfma_f32_16x16x32_bf16 a[228:231], a[244:247], v[180:183], a[228:231]
v_max_f32 v189, v189, v190
v_cmp_lt_f32 vcc, 0x41000000, v189
s_cbranch_vccnz stub_149
back_150:
s_waitcnt vmcnt(6)
s_barrier
v_mfma_f32_16x16x32_bf16 v[168:171], a[160:163], a[4:7], 0
ds_read_b128 a[160:163], v191 offset:32768
v_exp_f32 v160, v160
v_mfma_f32_16x16x32_bf16 v[172:175], a[176:179], a[4:7], 0
ds_read_b128 a[176:179], v191 offset:36864
v_exp_f32 v161, v161
v_mfma_f32_16x16x32_bf16 v[168:171], a[164:167], a[24:27], v[168:171]
ds_read_b128 a[164:167], v192 offset:32768
v_exp_f32 v162, v162
v_mfma_f32_16x16x32_bf16 v[172:175], a[180:183], a[24:27], v[172:175]
ds_read_b128 a[180:183], v192 offset:36864
v_exp_f32 v163, v163
v_exp_f32 v164, v164
v_mfma_f32_16x16x32_bf16 v[168:171], a[168:171], a[44:47], v[168:171]
ds_read_b128 a[168:171], v193 offset:32768
v_exp_f32 v165, v165
v_mfma_f32_16x16x32_bf16 v[172:175], a[184:187], a[44:47], v[172:175]
ds_read_b128 a[184:187], v193 offset:36864
v_exp_f32 v166, v166
v_mfma_f32_16x16x32_bf16 v[168:171], a[172:175], a[64:67], v[168:171]
ds_read_b128 a[172:175], v194 offset:32768
v_exp_f32 v167, v167
v_cvt_pk_bf16_f32 v176, v160, v161
v_mfma_f32_16x16x32_bf16 v[172:175], a[188:191], a[64:67], v[172:175]
ds_read_b128 a[188:191], v194 offset:36864
v_cvt_pk_bf16_f32 v177, v162, v163
v_cvt_pk_bf16_f32 v178, v164, v165
v_cvt_pk_bf16_f32 v179, v166, v167
s_waitcnt lgkmcnt(0)
v_mfma_f32_16x16x32_bf16 v[160:163], a[160:163], a[0:3], 0
v_fma_f32 v168, v168, s28, -v185
v_fma_f32 v169, v169, s28, -v185
v_mfma_f32_16x16x32_bf16 v[164:167], a[176:179], a[0:3], 0
s_add_u32 s40, s34, s32
s_and_b32 s40, s40, 31
s_lshl_b32 s40, s40, 13
s_lshr_b32 s41, s34, 5
s_lshl_b32 s41, s41, 18
s_add_u32 s40, s40, s41
s_add_u32 s35, s40, s33
s_add_u32 s34, s34, 1
s_add_u32 m0, s37, 0
s_nop 0
buffer_load_dwordx4 v203, s[16:19], s35 offen nt lds
v_mfma_f32_16x16x32_bf16 v[160:163], a[164:167], a[20:23], v[160:163]
v_mfma_f32_16x16x32_bf16 v[164:167], a[180:183], a[20:23], v[164:167]
buffer_load_dwordx4 v204, s[16:19], s35 offen offset:1024 nt lds
v_mfma_f32_16x16x32_bf16 v[160:163], a[168:171], a[40:43], v[160:163]
v_mfma_f32_16x16x32_bf16 v[164:167], a[184:187], a[40:43], v[164:167]
v_fma_f32 v170, v170, s28, -v185
v_fma_f32 v171, v171, s28, -v185
v_fma_f32 v172, v172, s28, -v185
v_mfma_f32_16x16x32_bf16 v[160:163], a[172:175], a[60:63], v[160:163]
s_add_u32 m0, s37, 8192
s_nop 0
buffer_load_dwordx4 v207, s[20:23], s35 offen nt lds
v_mfma_f32_16x16x32_bf16 v[164:167], a[188:191], a[60:63], v[164:167]
v_fma_f32 v173, v173, s28, -v185
v_fma_f32 v174, v174, s28, -v185
v_fma_f32 v175, v175, s28, -v185
v_mfma_f32_16x16x32_bf16 v[0:3], a[192:195], v[176:179], v[0:3]
buffer_load_dwordx4 v208, s[20:23], s35 offen offset:1024 nt lds
v_max3_f32 v189, v168, v169, v170
v_max3_f32 v190, v171, v172, v173
v_mfma_f32_16x16x32_bf16 v[4:7], a[196:199], v[176:179], v[4:7]
v_max3_f32 v189, v189, v174, v175
v_max_f32 v189, v189, v190
v_cmp_lt_f32 vcc, 0x41000000, v189
v_mfma_f32_16x16x32_bf16 v[8:11], a[200:203], v[176:179], v[8:11]
s_cbranch_vccnz stub_151
back_152:
v_exp_f32 v168, v168
v_mfma_f32_16x16x32_bf16 v[12:15], a[204:207], v[176:179], v[12:15]
v_exp_f32 v169, v169
v_exp_f32 v170, v170
v_mfma_f32_16x16x32_bf16 v[16:19], a[208:211], v[176:179], v[16:19]
v_exp_f32 v171, v171
v_mfma_f32_16x16x32_bf16 v[20:23], a[212:215], v[176:179], v[20:23]
v_exp_f32 v172, v172
v_exp_f32 v173, v173
v_mfma_f32_16x16x32_bf16 v[24:27], a[216:219], v[176:179], v[24:27]
v_exp_f32 v174, v174
v_mfma_f32_16x16x32_bf16 v[28:31], a[220:223], v[176:179], v[28:31]
v_exp_f32 v175, v175
v_cvt_pk_bf16_f32 v180, v168, v169
v_mfma_f32_16x16x32_bf16 a[224:227], a[244:247], v[176:179], a[224:227]
v_cvt_pk_bf16_f32 v181, v170, v171
v_cvt_pk_bf16_f32 v182, v172, v173
v_cvt_pk_bf16_f32 v183, v174, v175
s_waitcnt vmcnt(8)
s_barrier
v_mfma_f32_16x16x32_bf16 v[32:35], a[192:195], v[180:183], v[32:35]
ds_read_b64_tr_b16 a[192:193], v195 offset:40960
ds_read_b64_tr_b16 a[194:195], v195 offset:45056
v_mfma_f32_16x16x32_bf16 v[36:39], a[196:199], v[180:183], v[36:39]
ds_read_b64_tr_b16 a[196:197], v196 offset:40960
ds_read_b64_tr_b16 a[198:199], v196 offset:45056
v_fma_f32 v160, v160, s28, -v184
v_mfma_f32_16x16x32_bf16 v[40:43], a[200:203], v[180:183], v[40:43]
ds_read_b64_tr_b16 a[200:201], v197 offset:40960
ds_read_b64_tr_b16 a[202:203], v197 offset:45056
v_fma_f32 v161, v161, s28, -v184
v_fma_f32 v162, v162, s28, -v184
v_mfma_f32_16x16x32_bf16 v[44:47], a[204:207], v[180:183], v[44:47]
ds_read_b64_tr_b16 a[204:205], v198 offset:40960
ds_read_b64_tr_b16 a[206:207], v198 offset:45056
v_fma_f32 v163, v163, s28, -v184
v_fma_f32 v164, v164, s28, -v184
v_mfma_f32_16x16x32_bf16 v[48:51], a[208:211], v[180:183], v[48:51]
ds_read_b64_tr_b16 a[208:209], v199 offset:40960
ds_read_b64_tr_b16 a[210:211], v199 offset:45056
v_fma_f32 v165, v165, s28, -v184
v_mfma_f32_16x16x32_bf16 v[52:55], a[212:215], v[180:183], v[52:55]
ds_read_b64_tr_b16 a[212:213], v200 offset:40960
ds_read_b64_tr_b16 a[214:215], v200 offset:45056
v_fma_f32 v166, v166, s28, -v184
v_fma_f32 v167, v167, s28, -v184
v_mfma_f32_16x16x32_bf16 v[56:59], a[216:219], v[180:183], v[56:59]
ds_read_b64_tr_b16 a[216:217], v201 offset:40960
ds_read_b64_tr_b16 a[218:219], v201 offset:45056
v_max3_f32 v189, v160, v161, v162
v_max3_f32 v190, v163, v164, v165
v_mfma_f32_16x16x32_bf16 v[60:63], a[220:223], v[180:183], v[60:63]
ds_read_b64_tr_b16 a[220:221], v202 offset:40960
ds_read_b64_tr_b16 a[222:223], v202 offset:45056
v_max3_f32 v189, v189, v166, v167
v_mfma_f32_16x16x32_bf16 a[228:231], a[244:247], v[180:183], a[228:231]
v_max_f32 v189, v189, v190
v_cmp_lt_f32 vcc, 0x41000000, v189
s_cbranch_vccnz stub_153
back_154:
s_waitcnt vmcnt(6)
s_barrier
v_mfma_f32_16x16x32_bf16 v[168:171], a[160:163], a[4:7], 0
ds_read_b128 a[160:163], v191 offset:49152
v_exp_f32 v160, v160
v_mfma_f32_16x16x32_bf16 v[172:175], a[176:179], a[4:7], 0
ds_read_b128 a[176:179], v191 offset:53248
v_exp_f32 v161, v161
v_mfma_f32_16x16x32_bf16 v[168:171], a[164:167], a[24:27], v[168:171]
ds_read_b128 a[164:167], v192 offset:49152
v_exp_f32 v162, v162
v_mfma_f32_16x16x32_bf16 v[172:175], a[180:183], a[24:27], v[172:175]
ds_read_b128 a[180:183], v192 offset:53248
v_exp_f32 v163, v163
v_exp_f32 v164, v164
v_mfma_f32_16x16x32_bf16 v[168:171], a[168:171], a[44:47], v[168:171]
ds_read_b128 a[168:171], v193 offset:49152
v_exp_f32 v165, v165
v_mfma_f32_16x16x32_bf16 v[172:175], a[184:187], a[44:47], v[172:175]
ds_read_b128 a[184:187], v193 offset:53248
v_exp_f32 v166, v166
v_mfma_f32_16x16x32_bf16 v[168:171], a[172:175], a[64:67], v[168:171]
ds_read_b128 a[172:175], v194 offset:49152
v_exp_f32 v167, v167
v_cvt_pk_bf16_f32 v176, v160, v161
v_mfma_f32_16x16x32_bf16 v[172:175], a[188:191], a[64:67], v[172:175]
ds_read_b128 a[188:191], v194 offset:53248
v_cvt_pk_bf16_f32 v177, v162, v163
v_cvt_pk_bf16_f32 v178, v164, v165
v_cvt_pk_bf16_f32 v179, v166, v167
s_waitcnt lgkmcnt(0)
v_mfma_f32_16x16x32_bf16 v[160:163], a[160:163], a[0:3], 0
v_fma_f32 v168, v168, s28, -v185
v_fma_f32 v169, v169, s28, -v185
v_mfma_f32_16x16x32_bf16 v[164:167], a[176:179], a[0:3], 0
s_add_u32 s40, s34, s32
s_and_b32 s40, s40, 31
s_lshl_b32 s40, s40, 13
s_lshr_b32 s41, s34, 5
s_lshl_b32 s41, s41, 18
s_add_u32 s40, s40, s41
s_add_u32 s35, s40, s33
s_add_u32 s34, s34, 1
s_add_u32 m0, s37, 16384
s_nop 0
buffer_load_dwordx4 v203, s[16:19], s35 offen nt lds
v_mfma_f32_16x16x32_bf16 v[160:163], a[164:167], a[20:23], v[160:163]
v_mfma_f32_16x16x32_bf16 v[164:167], a[180:183], a[20:23], v[164:167]
buffer_load_dwordx4 v204, s[16:19], s35 offen offset:1024 nt lds
v_mfma_f32_16x16x32_bf16 v[160:163], a[168:171], a[40:43], v[160:163]
v_mfma_f32_16x16x32_bf16 v[164:167], a[184:187], a[40:43], v[164:167]
v_fma_f32 v170, v170, s28, -v185
v_fma_f32 v171, v171, s28, -v185
v_fma_f32 v172, v172, s28, -v185
v_mfma_f32_16x16x32_bf16 v[160:163], a[172:175], a[60:63], v[160:163]
s_add_u32 m0, s37, 24576
s_nop 0
buffer_load_dwordx4 v207, s[20:23], s35 offen nt lds
v_mfma_f32_16x16x32_bf16 v[164:167], a[188:191], a[60:63], v[164:167]
v_fma_f32 v173, v173, s28, -v185
v_fma_f32 v174, v174, s28, -v185
v_fma_f32 v175, v175, s28, -v185
v_mfma_f32_16x16x32_bf16 v[0:3], a[192:195], v[176:179], v[0:3]
buffer_load_dwordx4 v208, s[20:23], s35 offen offset:1024 nt lds
v_max3_f32 v189, v168, v169, v170
v_max3_f32 v190, v171, v172, v173
v_mfma_f32_16x16x32_bf16 v[4:7], a[196:199], v[176:179], v[4:7]
v_max3_f32 v189, v189, v174, v175
v_max_f32 v189, v189, v190
v_cmp_lt_f32 vcc, 0x41000000, v189
v_mfma_f32_16x16x32_bf16 v[8:11], a[200:203], v[176:179], v[8:11]
s_cbranch_vccnz stub_155
back_156:
v_exp_f32 v168, v168
v_mfma_f32_16x16x32_bf16 v[12:15], a[204:207], v[176:179], v[12:15]
v_exp_f32 v169, v169
v_exp_f32 v170, v170
v_mfma_f32_16x16x32_bf16 v[16:19], a[208:211], v[176:179], v[16:19]
v_exp_f32 v171, v171
v_mfma_f32_16x16x32_bf16 v[20:23], a[212:215], v[176:179], v[20:23]
v_exp_f32 v172, v172
v_exp_f32 v173, v173
v_mfma_f32_16x16x32_bf16 v[24:27], a[216:219], v[176:179], v[24:27]
v_exp_f32 v174, v174
v_mfma_f32_16x16x32_bf16 v[28:31], a[220:223], v[176:179], v[28:31]
v_exp_f32 v175, v175
v_cvt_pk_bf16_f32 v180, v168, v169
v_mfma_f32_16x16x32_bf16 a[224:227], a[244:247], v[176:179], a[224:227]
v_cvt_pk_bf16_f32 v181, v170, v171
v_cvt_pk_bf16_f32 v182, v172, v173
v_cvt_pk_bf16_f32 v183, v174, v175
s_mul_i32 s43, s48, 36864
s_mul_i32 s42, s3, 9216
s_add_u32 s43, s43, s42
buffer_load_dwordx4 a[0:3], v209, s[60:63], s43 offen
s_add_u32 s43, s43, 1024
buffer_load_dwordx4 a[0:3], v209, s[60:63], s43 offen
s_add_u32 s43, s43, 1024
buffer_load_dwordx4 a[0:3], v209, s[60:63], s43 offen
s_add_u32 s43, s43, 1024
buffer_load_dwordx4 a[0:3], v209, s[60:63], s43 offen
s_add_u32 s43, s43, 1024
buffer_load_dwordx4 a[0:3], v209, s[60:63], s43 offen
s_add_u32 s43, s43, 1024
buffer_load_dwordx4 a[0:3], v209, s[60:63], s43 offen
s_add_u32 s43, s43, 1024
buffer_load_dwordx4 a[0:3], v209, s[60:63], s43 offen
s_add_u32 s43, s43, 1024
buffer_load_dwordx4 a[0:3], v209, s[60:63], s43 offen
s_add_u32 s43, s43, 1024
buffer_load_dwordx4 a[0:3], v209, s[60:63], s43 offen
s_add_u32 s43, s43, 1024
s_waitcnt vmcnt(17)
s_barrier
v_mfma_f32_16x16x32_bf16 v[32:35], a[192:195], v[180:183], v[32:35]
ds_read_b64_tr_b16 a[192:193], v195 offset:57344
ds_read_b64_tr_b16 a[194:195], v195 offset:61440
v_mfma_f32_16x16x32_bf16 v[36:39], a[196:199], v[180:183], v[36:39]
ds_read_b64_tr_b16 a[196:197], v196 offset:57344
ds_read_b64_tr_b16 a[198:199], v196 offset:61440
v_fma_f32 v160, v160, s28, -v184
v_mfma_f32_16x16x32_bf16 v[40:43], a[200:203], v[180:183], v[40:43]
ds_read_b64_tr_b16 a[200:201], v197 offset:57344
ds_read_b64_tr_b16 a[202:203], v197 offset:61440
v_fma_f32 v161, v161, s28, -v184
v_fma_f32 v162, v162, s28, -v184
v_mfma_f32_16x16x32_bf16 v[44:47], a[204:207], v[180:183], v[44:47]
ds_read_b64_tr_b16 a[204:205], v198 offset:57344
ds_read_b64_tr_b16 a[206:207], v198 offset:61440
v_fma_f32 v163, v163, s28, -v184
v_fma_f32 v164, v164, s28, -v184
v_mfma_f32_16x16x32_bf16 v[48:51], a[208:211], v[180:183], v[48:51]
ds_read_b64_tr_b16 a[208:209], v199 offset:57344
ds_read_b64_tr_b16 a[210:211], v199 offset:61440
v_fma_f32 v165, v165, s28, -v184
v_mfma_f32_16x16x32_bf16 v[52:55], a[212:215], v[180:183], v[52:55]
ds_read_b64_tr_b16 a[212:213], v200 offset:57344
ds_read_b64_tr_b16 a[214:215], v200 offset:61440
v_fma_f32 v166, v166, s28, -v184
v_fma_f32 v167, v167, s28, -v184
v_mfma_f32_16x16x32_bf16 v[56:59], a[216:219], v[180:183], v[56:59]
ds_read_b64_tr_b16 a[216:217], v201 offset:57344
ds_read_b64_tr_b16 a[218:219], v201 offset:61440
v_max3_f32 v189, v160, v161, v162
v_max3_f32 v190, v163, v164, v165
v_mfma_f32_16x16x32_bf16 v[60:63], a[220:223], v[180:183], v[60:63]
ds_read_b64_tr_b16 a[220:221], v202 offset:57344
ds_read_b64_tr_b16 a[222:223], v202 offset:61440
v_max3_f32 v189, v189, v166, v167
v_mfma_f32_16x16x32_bf16 a[228:231], a[244:247], v[180:183], a[228:231]
v_max_f32 v189, v189, v190
v_cmp_lt_f32 vcc, 0x41000000, v189
s_cbranch_vccnz stub_157
back_158:
s_waitcnt vmcnt(15)
s_barrier
v_mfma_f32_16x16x32_bf16 v[168:171], a[160:163], a[4:7], 0
ds_read_b128 a[160:163], v191
v_exp_f32 v160, v160
v_mfma_f32_16x16x32_bf16 v[172:175], a[176:179], a[4:7], 0
ds_read_b128 a[176:179], v191 offset:4096
v_exp_f32 v161, v161
v_mfma_f32_16x16x32_bf16 v[168:171], a[164:167], a[24:27], v[168:171]
ds_read_b128 a[164:167], v192
v_exp_f32 v162, v162
v_mfma_f32_16x16x32_bf16 v[172:175], a[180:183], a[24:27], v[172:175]
ds_read_b128 a[180:183], v192 offset:4096
v_exp_f32 v163, v163
v_exp_f32 v164, v164
v_mfma_f32_16x16x32_bf16 v[168:171], a[168:171], a[44:47], v[168:171]
ds_read_b128 a[168:171], v193
v_exp_f32 v165, v165
v_mfma_f32_16x16x32_bf16 v[172:175], a[184:187], a[44:47], v[172:175]
ds_read_b128 a[184:187], v193 offset:4096
v_exp_f32 v166, v166
v_mfma_f32_16x16x32_bf16 v[168:171], a[172:175], a[64:67], v[168:171]
ds_read_b128 a[172:175], v194
v_exp_f32 v167, v167
v_cvt_pk_bf16_f32 v176, v160, v161
v_mfma_f32_16x16x32_bf16 v[172:175], a[188:191], a[64:67], v[172:175]
ds_read_b128 a[188:191], v194 offset:4096
v_cvt_pk_bf16_f32 v177, v162, v163
v_cvt_pk_bf16_f32 v178, v164, v165
v_cvt_pk_bf16_f32 v179, v166, v167
s_waitcnt lgkmcnt(0)
s_add_u32 s40, s34, s32
s_and_b32 s40, s40, 31
s_lshl_b32 s40, s40, 13
s_lshr_b32 s41, s34, 5
s_lshl_b32 s41, s41, 18
s_add_u32 s40, s40, s41
s_add_u32 s35, s40, s33
s_add_u32 s34, s34, 1
s_add_u32 m0, s37, 32768
s_nop 0
buffer_load_dwordx4 v203, s[16:19], s35 offen nt lds
v_mfma_f32_16x16x32_bf16 v[0:3], a[192:195], v[176:179], v[0:3]
v_mfma_f32_16x16x32_bf16 v[4:7], a[196:199], v[176:179], v[4:7]
buffer_load_dwordx4 v204, s[16:19], s35 offen offset:1024 nt lds
v_fma_f32 v168, v168, s28, -v185
v_fma_f32 v169, v169, s28, -v185
v_mfma_f32_16x16x32_bf16 v[8:11], a[200:203], v[176:179], v[8:11]
s_add_u32 m0, s37, 40960
s_nop 0
buffer_load_dwordx4 v207, s[20:23], s35 offen nt lds
v_fma_f32 v170, v170, s28, -v185
v_fma_f32 v171, v171, s28, -v185
v_mfma_f32_16x16x32_bf16 v[12:15], a[204:207], v[176:179], v[12:15]
v_fma_f32 v172, v172, s28, -v185
v_fma_f32 v173, v173, s28, -v185
v_fma_f32 v174, v174, s28, -v185
v_fma_f32 v175, v175, s28, -v185
v_max3_f32 v189, v168, v169, v170
v_max3_f32 v190, v171, v172, v173
v_mfma_f32_16x16x32_bf16 v[16:19], a[208:211], v[176:179], v[16:19]
buffer_load_dwordx4 v208, s[20:23], s35 offen offset:1024 nt lds
v_max3_f32 v189, v189, v174, v175
v_max_f32 v189, v189, v190
v_cmp_lt_f32 vcc, 0x41000000, v189
s_cbranch_vccnz stub_159
back_160:
v_mfma_f32_16x16x32_bf16 v[20:23], a[212:215], v[176:179], v[20:23]
v_exp_f32 v168, v168
v_exp_f32 v169, v169
v_mfma_f32_16x16x32_bf16 v[24:27], a[216:219], v[176:179], v[24:27]
v_exp_f32 v170, v170
v_exp_f32 v171, v171
v_exp_f32 v172, v172
v_mfma_f32_16x16x32_bf16 v[28:31], a[220:223], v[176:179], v[28:31]
v_exp_f32 v173, v173
v_exp_f32 v174, v174
v_mfma_f32_16x16x32_bf16 a[224:227], a[244:247], v[176:179], a[224:227]
v_exp_f32 v175, v175
v_cvt_pk_bf16_f32 v180, v168, v169
v_cvt_pk_bf16_f32 v181, v170, v171
v_cvt_pk_bf16_f32 v182, v172, v173
v_cvt_pk_bf16_f32 v183, v174, v175
s_nop 1
v_mfma_f32_16x16x32_bf16 v[32:35], a[192:195], v[180:183], v[32:35]
v_mfma_f32_16x16x32_bf16 v[36:39], a[196:199], v[180:183], v[36:39]
v_mfma_f32_16x16x32_bf16 v[40:43], a[200:203], v[180:183], v[40:43]
v_mfma_f32_16x16x32_bf16 v[44:47], a[204:207], v[180:183], v[44:47]
v_mfma_f32_16x16x32_bf16 v[48:51], a[208:211], v[180:183], v[48:51]
v_mfma_f32_16x16x32_bf16 v[52:55], a[212:215], v[180:183], v[52:55]
v_mfma_f32_16x16x32_bf16 v[56:59], a[216:219], v[180:183], v[56:59]
v_mfma_f32_16x16x32_bf16 v[60:63], a[220:223], v[180:183], v[60:63]
v_mfma_f32_16x16x32_bf16 a[228:231], a[244:247], v[180:183], a[228:231]
att_epi1:
s_mul_i32 s40, s52, 20480
s_add_u32 s40, s40, 3072
v_add_u32 v189, s40, v209
v_accvgpr_read_b32 v212, a224
v_rcp_f32 v216, v212
s_nop 0
v_mul_f32 v0, v0, v216
v_mul_f32 v1, v1, v216
v_mul_f32 v2, v2, v216
v_mul_f32 v3, v3, v216
v_mul_f32 v4, v4, v216
v_mul_f32 v5, v5, v216
v_mul_f32 v6, v6, v216
v_mul_f32 v7, v7, v216
v_cvt_pk_bf16_f32 v0, v0, v1
v_cvt_pk_bf16_f32 v1, v2, v3
v_cvt_pk_bf16_f32 v2, v4, v5
v_cvt_pk_bf16_f32 v3, v6, v7
v_mul_f32 v8, v8, v216
v_mul_f32 v9, v9, v216
v_mul_f32 v10, v10, v216
v_mul_f32 v11, v11, v216
v_mul_f32 v12, v12, v216
v_mul_f32 v13, v13, v216
v_mul_f32 v14, v14, v216
v_mul_f32 v15, v15, v216
v_cvt_pk_bf16_f32 v8, v8, v9
v_cvt_pk_bf16_f32 v9, v10, v11
v_cvt_pk_bf16_f32 v10, v12, v13
v_cvt_pk_bf16_f32 v11, v14, v15
v_mul_f32 v16, v16, v216
v_mul_f32 v17, v17, v216
v_mul_f32 v18, v18, v216
v_mul_f32 v19, v19, v216
v_mul_f32 v20, v20, v216
v_mul_f32 v21, v21, v216
v_mul_f32 v22, v22, v216
v_mul_f32 v23, v23, v216
v_cvt_pk_bf16_f32 v16, v16, v17
v_cvt_pk_bf16_f32 v17, v18, v19
v_cvt_pk_bf16_f32 v18, v20, v21
v_cvt_pk_bf16_f32 v19, v22, v23
v_mul_f32 v24, v24, v216
v_mul_f32 v25, v25, v216
v_mul_f32 v26, v26, v216
v_mul_f32 v27, v27, v216
v_mul_f32 v28, v28, v216
v_mul_f32 v29, v29, v216
v_mul_f32 v30, v30, v216
v_mul_f32 v31, v31, v216
v_cvt_pk_bf16_f32 v24, v24, v25
v_cvt_pk_bf16_f32 v25, v26, v27
v_cvt_pk_bf16_f32 v26, v28, v29
v_cvt_pk_bf16_f32 v27, v30, v31
v_accvgpr_read_b32 v213, a228
v_rcp_f32 v217, v213
s_nop 0
v_mul_f32 v32, v32, v217
v_mul_f32 v33, v33, v217
v_mul_f32 v34, v34, v217
v_mul_f32 v35, v35, v217
v_mul_f32 v36, v36, v217
v_mul_f32 v37, v37, v217
v_mul_f32 v38, v38, v217
v_mul_f32 v39, v39, v217
v_cvt_pk_bf16_f32 v32, v32, v33
v_cvt_pk_bf16_f32 v33, v34, v35
v_cvt_pk_bf16_f32 v34, v36, v37
v_cvt_pk_bf16_f32 v35, v38, v39
v_mul_f32 v40, v40, v217
v_mul_f32 v41, v41, v217
v_mul_f32 v42, v42, v217
v_mul_f32 v43, v43, v217
v_mul_f32 v44, v44, v217
v_mul_f32 v45, v45, v217
v_mul_f32 v46, v46, v217
v_mul_f32 v47, v47, v217
v_cvt_pk_bf16_f32 v40, v40, v41
v_cvt_pk_bf16_f32 v41, v42, v43
v_cvt_pk_bf16_f32 v42, v44, v45
v_cvt_pk_bf16_f32 v43, v46, v47
v_mul_f32 v48, v48, v217
v_mul_f32 v49, v49, v217
v_mul_f32 v50, v50, v217
v_mul_f32 v51, v51, v217
v_mul_f32 v52, v52, v217
v_mul_f32 v53, v53, v217
v_mul_f32 v54, v54, v217
v_mul_f32 v55, v55, v217
v_cvt_pk_bf16_f32 v48, v48, v49
v_cvt_pk_bf16_f32 v49, v50, v51
v_cvt_pk_bf16_f32 v50, v52, v53
v_cvt_pk_bf16_f32 v51, v54, v55
v_mul_f32 v56, v56, v217
v_mul_f32 v57, v57, v217
v_mul_f32 v58, v58, v217
v_mul_f32 v59, v59, v217
v_mul_f32 v60, v60, v217
v_mul_f32 v61, v61, v217
v_mul_f32 v62, v62, v217
v_mul_f32 v63, v63, v217
v_cvt_pk_bf16_f32 v56, v56, v57
v_cvt_pk_bf16_f32 v57, v58, v59
v_cvt_pk_bf16_f32 v58, v60, v61
v_cvt_pk_bf16_f32 v59, v62, v63
s_waitcnt vmcnt(0)
s_barrier
ds_write_b128 v189, v[0:3]
s_mul_i32 s44, s3, 9216
s_lshl_b32 s45, s3, 10
s_add_u32 s57, s45, 40960
s_add_u32 s58, s44, 0
s_add_u32 m0, s57, 0
s_nop 0
buffer_load_dwordx4 v221, s[60:63], s58 offen lds
ds_write_b128 v189, v[8:11] offset:5120
s_add_u32 m0, s57, 3968
s_nop 0
buffer_load_dwordx4 v221, s[60:63], s58 offen offset:128 lds
s_add_u32 m0, s57, 7936
s_nop 0
buffer_load_dwordx4 v221, s[60:63], s58 offen offset:256 lds
ds_write_b128 v189, v[16:19] offset:10240
s_add_u32 m0, s57, 11904
s_nop 0
buffer_load_dwordx4 v221, s[60:63], s58 offen offset:384 lds
s_add_u32 m0, s57, 15872
s_nop 0
buffer_load_dwordx4 v221, s[60:63], s58 offen offset:512 lds
ds_write_b128 v189, v[24:27] offset:15360
s_add_u32 m0, s57, 19840
s_nop 0
buffer_load_dwordx4 v221, s[60:63], s58 offen offset:640 lds
s_add_u32 m0, s57, 23808
s_nop 0
buffer_load_dwordx4 v221, s[60:63], s58 offen offset:768 lds
ds_write_b128 v189, v[32:35] offset:1024
s_add_u32 m0, s57, 27776
s_nop 0
buffer_load_dwordx4 v221, s[60:63], s58 offen offset:896 lds
s_add_u32 m0, s57, 31744
s_nop 0
buffer_load_dwordx4 v221, s[60:63], s58 offen offset:1024 lds
ds_write_b128 v189, v[40:43] offset:6144
s_add_u32 s57, s45, 77824
s_add_u32 s58, s44, 36864
s_add_u32 m0, s57, 0
s_nop 0
buffer_load_dwordx4 v221, s[60:63], s58 offen lds
ds_write_b128 v189, v[48:51] offset:11264
s_add_u32 m0, s57, 3968
s_nop 0
buffer_load_dwordx4 v221, s[60:63], s58 offen offset:128 lds
s_add_u32 m0, s57, 7936
s_nop 0
buffer_load_dwordx4 v221, s[60:63], s58 offen offset:256 lds
ds_write_b128 v189, v[56:59] offset:16384
s_add_u32 m0, s57, 11904
s_nop 0
buffer_load_dwordx4 v221, s[60:63], s58 offen offset:384 lds
s_add_u32 m0, s57, 15872
s_nop 0
buffer_load_dwordx4 v221, s[60:63], s58 offen offset:512 lds
s_add_u32 m0, s57, 19840
s_nop 0
buffer_load_dwordx4 v221, s[60:63], s58 offen offset:640 lds
s_add_u32 m0, s57, 23808
s_nop 0
buffer_load_dwordx4 v221, s[60:63], s58 offen offset:768 lds
s_add_u32 m0, s57, 27776
s_nop 0
buffer_load_dwordx4 v221, s[60:63], s58 offen offset:896 lds
s_add_u32 m0, s57, 31744
s_nop 0
buffer_load_dwordx4 v221, s[60:63], s58 offen offset:1024 lds
s_waitcnt lgkmcnt(0)
att_post:
s_barrier
s_lshl_b32 s40, s97, 2
v_mov_b32 v201, s40
global_load_dword v200, v201, s[68:69] sc1
s_add_u32 s57, s45, 114688
s_add_u32 s58, s44, 73728
s_add_u32 m0, s57, 0
s_nop 0
buffer_load_dwordx4 v221, s[60:63], s58 offen lds
s_add_u32 m0, s57, 3968
s_nop 0
buffer_load_dwordx4 v221, s[60:63], s58 offen offset:128 lds
s_add_u32 m0, s57, 7936
s_nop 0
buffer_load_dwordx4 v221, s[60:63], s58 offen offset:256 lds
s_add_u32 m0, s57, 11904
s_nop 0
buffer_load_dwordx4 v221, s[60:63], s58 offen offset:384 lds
s_add_u32 m0, s57, 15872
s_nop 0
buffer_load_dwordx4 v221, s[60:63], s58 offen offset:512 lds
s_add_u32 m0, s57, 19840
s_nop 0
buffer_load_dwordx4 v221, s[60:63], s58 offen offset:640 lds
s_add_u32 m0, s57, 23808
s_nop 0
buffer_load_dwordx4 v221, s[60:63], s58 offen offset:768 lds
s_add_u32 m0, s57, 27776
s_nop 0
buffer_load_dwordx4 v221, s[60:63], s58 offen offset:896 lds
s_add_u32 m0, s57, 31744
s_nop 0
buffer_load_dwordx4 v221, s[60:63], s58 offen offset:1024 lds
s_add_u32 s54, s45, 40960
s_add_u32 s55, s54, 110592
s_mov_b32 s59, 0
v_mov_b32 v192, v209
v_mov_b32 v188, v219
v_mov_b32 v189, v220
v_mov_b32 v190, v224
v_mov_b32 v191, v225
s_waitcnt vmcnt(18)
s_barrier
ds_read_b128 a[72:75], v192
ds_read_b128 a[76:79], v192 offset:1024
ds_read_b128 a[80:83], v192 offset:2048
ds_read_b128 a[84:87], v192 offset:3072
ds_read_b128 a[88:91], v192 offset:4096
ds_read_b64_tr_b16 a[0:1], v188
ds_read_b64_tr_b16 a[2:3], v188 offset:2048
ds_read_b64_tr_b16 a[4:5], v189
ds_read_b64_tr_b16 a[6:7], v189 offset:2048
ds_read_b64_tr_b16 a[8:9], v190
ds_read_b64_tr_b16 a[10:11], v190 offset:2048
ds_read_b64_tr_b16 a[12:13], v191
ds_read_b64_tr_b16 a[14:15], v191 offset:2048
ds_read_b64_tr_b16 a[16:17], v188 offset:4096
ds_read_b64_tr_b16 a[18:19], v188 offset:6144
ds_read_b64_tr_b16 a[20:21], v189 offset:4096
ds_read_b64_tr_b16 a[22:23], v189 offset:6144
ds_read_b64_tr_b16 a[24:25], v190 offset:4096
ds_read_b64_tr_b16 a[26:27], v190 offset:6144
ds_read_b64_tr_b16 a[28:29], v191 offset:4096
ds_read_b64_tr_b16 a[30:31], v191 offset:6144
ds_read_b64_tr_b16 a[32:33], v188 offset:8192
ds_read_b64_tr_b16 a[34:35], v188 offset:10240
s_waitcnt lgkmcnt(0)
s_waitcnt vmcnt(9)
s_barrier
s_add_u32 s59, s59, 36864
s_cmp_eq_u32 s59, 110592
s_cselect_b32 s59, 0, s59
v_add_u32 v188, s59, v219
v_add_u32 v189, s59, v220
v_add_u32 v190, s59, v224
v_add_u32 v191, s59, v225
v_add_u32 v192, 5120, v192
s_add_u32 s58, s58, 36864
s_add_u32 s57, s57, 36864
s_cmp_eq_u32 s57, s55
s_cselect_b32 s57, s54, s57
v_mfma_f32_16x16x32_bf16 v[0:3], a[0:3], a[72:75], 0
ds_read_b128 a[92:95], v192
v_mfma_f32_16x16x32_bf16 v[4:7], a[0:3], a[76:79], 0
ds_read_b128 a[96:99], v192 offset:1024
v_mfma_f32_16x16x32_bf16 v[8:11], a[0:3], a[80:83], 0
ds_read_b128 a[100:103], v192 offset:2048
s_add_u32 m0, s57, 0
v_mfma_f32_16x16x32_bf16 v[12:15], a[0:3], a[84:87], 0
ds_read_b128 a[104:107], v192 offset:3072
v_mfma_f32_16x16x32_bf16 v[16:19], a[0:3], a[88:91], 0
ds_read_b128 a[108:111], v192 offset:4096
v_mfma_f32_16x16x32_bf16 v[20:23], a[4:7], a[72:75], 0
ds_read_b64_tr_b16 a[36:37], v188
v_mfma_f32_16x16x32_bf16 v[24:27], a[4:7], a[76:79], 0
ds_read_b64_tr_b16 a[38:39], v188 offset:2048
buffer_load_dwordx4 v221, s[60:63], s58 offen lds
s_add_u32 m0, s57, 3968
v_mfma_f32_16x16x32_bf16 v[28:31], a[4:7], a[80:83], 0
ds_read_b64_tr_b16 a[40:41], v189
v_mfma_f32_16x16x32_bf16 v[32:35], a[4:7], a[84:87], 0
ds_read_b64_tr_b16 a[42:43], v189 offset:2048
v_mfma_f32_16x16x32_bf16 v[36:39], a[4:7], a[88:91], 0
ds_read_b64_tr_b16 a[44:45], v190
v_mfma_f32_16x16x32_bf16 v[40:43], a[8:11], a[72:75], 0
ds_read_b64_tr_b16 a[46:47], v190 offset:2048
buffer_load_dwordx4 v221, s[60:63], s58 offen offset:128 lds
s_add_u32 m0, s57, 7936
v_mfma_f32_16x16x32_bf16 v[44:47], a[8:11], a[76:79], 0
ds_read_b64_tr_b16 a[48:49], v191
v_mfma_f32_16x16x32_bf16 v[48:51], a[8:11], a[80:83], 0
ds_read_b64_tr_b16 a[50:51], v191 offset:2048
v_mfma_f32_16x16x32_bf16 v[52:55], a[8:11], a[84:87], 0
ds_read_b64_tr_b16 a[52:53], v188 offset:4096
v_mfma_f32_16x16x32_bf16 v[56:59], a[8:11], a[88:91], 0
ds_read_b64_tr_b16 a[54:55], v188 offset:6144
buffer_load_dwordx4 v221, s[60:63], s58 offen offset:256 lds
s_add_u32 m0, s57, 11904
v_mfma_f32_16x16x32_bf16 v[60:63], a[12:15], a[72:75], 0
ds_read_b64_tr_b16 a[56:57], v189 offset:4096
v_mfma_f32_16x16x32_bf16 v[64:67], a[12:15], a[76:79], 0
ds_read_b64_tr_b16 a[58:59], v189 offset:6144
v_mfma_f32_16x16x32_bf16 v[68:71], a[12:15], a[80:83], 0
ds_read_b64_tr_b16 a[60:61], v190 offset:4096
v_mfma_f32_16x16x32_bf16 v[72:75], a[12:15], a[84:87], 0
ds_read_b64_tr_b16 a[62:63], v190 offset:6144
buffer_load_dwordx4 v221, s[60:63], s58 offen offset:384 lds
s_add_u32 m0, s57, 15872
v_mfma_f32_16x16x32_bf16 v[76:79], a[12:15], a[88:91], 0
ds_read_b64_tr_b16 a[64:65], v191 offset:4096
v_mfma_f32_16x16x32_bf16 v[80:83], a[16:19], a[72:75], 0
ds_read_b64_tr_b16 a[66:67], v191 offset:6144
v_mfma_f32_16x16x32_bf16 v[84:87], a[16:19], a[76:79], 0
ds_read_b64_tr_b16 a[68:69], v188 offset:8192
buffer_load_dwordx4 v221, s[60:63], s58 offen offset:512 lds
s_add_u32 m0, s57, 19840
v_mfma_f32_16x16x32_bf16 v[88:91], a[16:19], a[80:83], 0
ds_read_b64_tr_b16 a[70:71], v188 offset:10240
v_mfma_f32_16x16x32_bf16 v[92:95], a[16:19], a[84:87], 0
v_mfma_f32_16x16x32_bf16 v[96:99], a[16:19], a[88:91], 0
v_mfma_f32_16x16x32_bf16 v[100:103], a[20:23], a[72:75], 0
buffer_load_dwordx4 v221, s[60:63], s58 offen offset:640 lds
s_add_u32 m0, s57, 23808
v_mfma_f32_16x16x32_bf16 v[104:107], a[20:23], a[76:79], 0
v_mfma_f32_16x16x32_bf16 v[108:111], a[20:23], a[80:83], 0
v_mfma_f32_16x16x32_bf16 v[112:115], a[20:23], a[84:87], 0
v_mfma_f32_16x16x32_bf16 v[116:119], a[20:23], a[88:91], 0
buffer_load_dwordx4 v221, s[60:63], s58 offen offset:768 lds
s_add_u32 m0, s57, 27776
v_mfma_f32_16x16x32_bf16 v[120:123], a[24:27], a[72:75], 0
v_mfma_f32_16x16x32_bf16 v[124:127], a[24:27], a[76:79], 0
v_mfma_f32_16x16x32_bf16 v[128:131], a[24:27], a[80:83], 0
v_mfma_f32_16x16x32_bf16 v[132:135], a[24:27], a[84:87], 0
buffer_load_dwordx4 v221, s[60:63], s58 offen offset:896 lds
s_add_u32 m0, s57, 31744
v_mfma_f32_16x16x32_bf16 v[136:139], a[24:27], a[88:91], 0
v_mfma_f32_16x16x32_bf16 v[140:143], a[28:31], a[72:75], 0
v_mfma_f32_16x16x32_bf16 v[144:147], a[28:31], a[76:79], 0
v_mfma_f32_16x16x32_bf16 v[148:151], a[28:31], a[80:83], 0
buffer_load_dwordx4 v221, s[60:63], s58 offen offset:1024 lds
v_mfma_f32_16x16x32_bf16 v[152:155], a[28:31], a[84:87], 0
v_mfma_f32_16x16x32_bf16 v[156:159], a[28:31], a[88:91], 0
v_mfma_f32_16x16x32_bf16 v[160:163], a[32:35], a[72:75], 0
v_mfma_f32_16x16x32_bf16 v[164:167], a[32:35], a[76:79], 0
v_mfma_f32_16x16x32_bf16 v[168:171], a[32:35], a[80:83], 0
v_mfma_f32_16x16x32_bf16 v[172:175], a[32:35], a[84:87], 0
v_mfma_f32_16x16x32_bf16 v[176:179], a[32:35], a[88:91], 0
s_waitcnt lgkmcnt(0)
s_mov_b32 s38, 0
gloop_161:
s_waitcnt vmcnt(9)
s_barrier
s_add_u32 s59, s59, 36864
s_cmp_eq_u32 s59, 110592
s_cselect_b32 s59, 0, s59
v_add_u32 v188, s59, v219
v_add_u32 v189, s59, v220
v_add_u32 v190, s59, v224
v_add_u32 v191, s59, v225
v_add_u32 v192, 5120, v192
s_add_u32 s58, s58, 36864
s_add_u32 s57, s57, 36864
s_cmp_eq_u32 s57, s55
s_cselect_b32 s57, s54, s57
v_mfma_f32_16x16x32_bf16 v[0:3], a[36:39], a[92:95], v[0:3]
ds_read_b128 a[72:75], v192
v_mfma_f32_16x16x32_bf16 v[4:7], a[36:39], a[96:99], v[4:7]
ds_read_b128 a[76:79], v192 offset:1024
v_mfma_f32_16x16x32_bf16 v[8:11], a[36:39], a[100:103], v[8:11]
ds_read_b128 a[80:83], v192 offset:2048
s_add_u32 m0, s57, 0
v_mfma_f32_16x16x32_bf16 v[12:15], a[36:39], a[104:107], v[12:15]
ds_read_b128 a[84:87], v192 offset:3072
v_mfma_f32_16x16x32_bf16 v[16:19], a[36:39], a[108:111], v[16:19]
ds_read_b128 a[88:91], v192 offset:4096
v_mfma_f32_16x16x32_bf16 v[20:23], a[40:43], a[92:95], v[20:23]
ds_read_b64_tr_b16 a[0:1], v188
v_mfma_f32_16x16x32_bf16 v[24:27], a[40:43], a[96:99], v[24:27]
ds_read_b64_tr_b16 a[2:3], v188 offset:2048
buffer_load_dwordx4 v221, s[60:63], s58 offen lds
s_add_u32 m0, s57, 3968
v_mfma_f32_16x16x32_bf16 v[28:31], a[40:43], a[100:103], v[28:31]
ds_read_b64_tr_b16 a[4:5], v189
v_mfma_f32_16x16x32_bf16 v[32:35], a[40:43], a[104:107], v[32:35]
ds_read_b64_tr_b16 a[6:7], v189 offset:2048
v_mfma_f32_16x16x32_bf16 v[36:39], a[40:43], a[108:111], v[36:39]
ds_read_b64_tr_b16 a[8:9], v190
v_mfma_f32_16x16x32_bf16 v[40:43], a[44:47], a[92:95], v[40:43]
ds_read_b64_tr_b16 a[10:11], v190 offset:2048
buffer_load_dwordx4 v221, s[60:63], s58 offen offset:128 lds
s_add_u32 m0, s57, 7936
v_mfma_f32_16x16x32_bf16 v[44:47], a[44:47], a[96:99], v[44:47]
ds_read_b64_tr_b16 a[12:13], v191
v_mfma_f32_16x16x32_bf16 v[48:51], a[44:47], a[100:103], v[48:51]
ds_read_b64_tr_b16 a[14:15], v191 offset:2048
v_mfma_f32_16x16x32_bf16 v[52:55], a[44:47], a[104:107], v[52:55]
ds_read_b64_tr_b16 a[16:17], v188 offset:4096
v_mfma_f32_16x16x32_bf16 v[56:59], a[44:47], a[108:111], v[56:59]
ds_read_b64_tr_b16 a[18:19], v188 offset:6144
buffer_load_dwordx4 v221, s[60:63], s58 offen offset:256 lds
s_add_u32 m0, s57, 11904
v_mfma_f32_16x16x32_bf16 v[60:63], a[48:51], a[92:95], v[60:63]
ds_read_b64_tr_b16 a[20:21], v189 offset:4096
v_mfma_f32_16x16x32_bf16 v[64:67], a[48:51], a[96:99], v[64:67]
ds_read_b64_tr_b16 a[22:23], v189 offset:6144
v_mfma_f32_16x16x32_bf16 v[68:71], a[48:51], a[100:103], v[68:71]
ds_read_b64_tr_b16 a[24:25], v190 offset:4096
v_mfma_f32_16x16x32_bf16 v[72:75], a[48:51], a[104:107], v[72:75]
ds_read_b64_tr_b16 a[26:27], v190 offset:6144
buffer_load_dwordx4 v221, s[60:63], s58 offen offset:384 lds
s_add_u32 m0, s57, 15872
v_mfma_f32_16x16x32_bf16 v[76:79], a[48:51], a[108:111], v[76:79]
ds_read_b64_tr_b16 a[28:29], v191 offset:4096
v_mfma_f32_16x16x32_bf16 v[80:83], a[52:55], a[92:95], v[80:83]
ds_read_b64_tr_b16 a[30:31], v191 offset:6144
v_mfma_f32_16x16x32_bf16 v[84:87], a[52:55], a[96:99], v[84:87]
ds_read_b64_tr_b16 a[32:33], v188 offset:8192
buffer_load_dwordx4 v221, s[60:63], s58 offen offset:512 lds
s_add_u32 m0, s57, 19840
v_mfma_f32_16x16x32_bf16 v[88:91], a[52:55], a[100:103], v[88:91]
ds_read_b64_tr_b16 a[34:35], v188 offset:10240
v_mfma_f32_16x16x32_bf16 v[92:95], a[52:55], a[104:107], v[92:95]
v_mfma_f32_16x16x32_bf16 v[96:99], a[52:55], a[108:111], v[96:99]
v_mfma_f32_16x16x32_bf16 v[100:103], a[56:59], a[92:95], v[100:103]
buffer_load_dwordx4 v221, s[60:63], s58 offen offset:640 lds
s_add_u32 m0, s57, 23808
v_mfma_f32_16x16x32_bf16 v[104:107], a[56:59], a[96:99], v[104:107]
v_mfma_f32_16x16x32_bf16 v[108:111], a[56:59], a[100:103], v[108:111]
v_mfma_f32_16x16x32_bf16 v[112:115], a[56:59], a[104:107], v[112:115]
v_mfma_f32_16x16x32_bf16 v[116:119], a[56:59], a[108:111], v[116:119]
buffer_load_dwordx4 v221, s[60:63], s58 offen offset:768 lds
s_add_u32 m0, s57, 27776
v_mfma_f32_16x16x32_bf16 v[120:123], a[60:63], a[92:95], v[120:123]
v_mfma_f32_16x16x32_bf16 v[124:127], a[60:63], a[96:99], v[124:127]
v_mfma_f32_16x16x32_bf16 v[128:131], a[60:63], a[100:103], v[128:131]
v_mfma_f32_16x16x32_bf16 v[132:135], a[60:63], a[104:107], v[132:135]
buffer_load_dwordx4 v221, s[60:63], s58 offen offset:896 lds
s_add_u32 m0, s57, 31744
v_mfma_f32_16x16x32_bf16 v[136:139], a[60:63], a[108:111], v[136:139]
v_mfma_f32_16x16x32_bf16 v[140:143], a[64:67], a[92:95], v[140:143]
v_mfma_f32_16x16x32_bf16 v[144:147], a[64:67], a[96:99], v[144:147]
v_mfma_f32_16x16x32_bf16 v[148:151], a[64:67], a[100:103], v[148:151]
buffer_load_dwordx4 v221, s[60:63], s58 offen offset:1024 lds
v_mfma_f32_16x16x32_bf16 v[152:155], a[64:67], a[104:107], v[152:155]
v_mfma_f32_16x16x32_bf16 v[156:159], a[64:67], a[108:111], v[156:159]
v_mfma_f32_16x16x32_bf16 v[160:163], a[68:71], a[92:95], v[160:163]
v_mfma_f32_16x16x32_bf16 v[164:167], a[68:71], a[96:99], v[164:167]
v_mfma_f32_16x16x32_bf16 v[168:171], a[68:71], a[100:103], v[168:171]
v_mfma_f32_16x16x32_bf16 v[172:175], a[68:71], a[104:107], v[172:175]
v_mfma_f32_16x16x32_bf16 v[176:179], a[68:71], a[108:111], v[176:179]
s_waitcnt lgkmcnt(0)
s_waitcnt vmcnt(9)
s_barrier
s_add_u32 s59, s59, 36864
s_cmp_eq_u32 s59, 110592
s_cselect_b32 s59, 0, s59
v_add_u32 v188, s59, v219
v_add_u32 v189, s59, v220
v_add_u32 v190, s59, v224
v_add_u32 v191, s59, v225
v_add_u32 v192, 5120, v192
s_add_u32 s58, s58, 36864
s_add_u32 s57, s57, 36864
s_cmp_eq_u32 s57, s55
s_cselect_b32 s57, s54, s57
v_mfma_f32_16x16x32_bf16 v[0:3], a[0:3], a[72:75], v[0:3]
ds_read_b128 a[92:95], v192
v_mfma_f32_16x16x32_bf16 v[4:7], a[0:3], a[76:79], v[4:7]
ds_read_b128 a[96:99], v192 offset:1024
v_mfma_f32_16x16x32_bf16 v[8:11], a[0:3], a[80:83], v[8:11]
ds_read_b128 a[100:103], v192 offset:2048
s_add_u32 m0, s57, 0
v_mfma_f32_16x16x32_bf16 v[12:15], a[0:3], a[84:87], v[12:15]
ds_read_b128 a[104:107], v192 offset:3072
v_mfma_f32_16x16x32_bf16 v[16:19], a[0:3], a[88:91], v[16:19]
ds_read_b128 a[108:111], v192 offset:4096
v_mfma_f32_16x16x32_bf16 v[20:23], a[4:7], a[72:75], v[20:23]
ds_read_b64_tr_b16 a[36:37], v188
v_mfma_f32_16x16x32_bf16 v[24:27], a[4:7], a[76:79], v[24:27]
ds_read_b64_tr_b16 a[38:39], v188 offset:2048
buffer_load_dwordx4 v221, s[60:63], s58 offen lds
s_add_u32 m0, s57, 3968
v_mfma_f32_16x16x32_bf16 v[28:31], a[4:7], a[80:83], v[28:31]
ds_read_b64_tr_b16 a[40:41], v189
v_mfma_f32_16x16x32_bf16 v[32:35], a[4:7], a[84:87], v[32:35]
ds_read_b64_tr_b16 a[42:43], v189 offset:2048
v_mfma_f32_16x16x32_bf16 v[36:39], a[4:7], a[88:91], v[36:39]
ds_read_b64_tr_b16 a[44:45], v190
v_mfma_f32_16x16x32_bf16 v[40:43], a[8:11], a[72:75], v[40:43]
ds_read_b64_tr_b16 a[46:47], v190 offset:2048
buffer_load_dwordx4 v221, s[60:63], s58 offen offset:128 lds
s_add_u32 m0, s57, 7936
v_mfma_f32_16x16x32_bf16 v[44:47], a[8:11], a[76:79], v[44:47]
ds_read_b64_tr_b16 a[48:49], v191
v_mfma_f32_16x16x32_bf16 v[48:51], a[8:11], a[80:83], v[48:51]
ds_read_b64_tr_b16 a[50:51], v191 offset:2048
v_mfma_f32_16x16x32_bf16 v[52:55], a[8:11], a[84:87], v[52:55]
ds_read_b64_tr_b16 a[52:53], v188 offset:4096
v_mfma_f32_16x16x32_bf16 v[56:59], a[8:11], a[88:91], v[56:59]
ds_read_b64_tr_b16 a[54:55], v188 offset:6144
buffer_load_dwordx4 v221, s[60:63], s58 offen offset:256 lds
s_add_u32 m0, s57, 11904
v_mfma_f32_16x16x32_bf16 v[60:63], a[12:15], a[72:75], v[60:63]
ds_read_b64_tr_b16 a[56:57], v189 offset:4096
v_mfma_f32_16x16x32_bf16 v[64:67], a[12:15], a[76:79], v[64:67]
ds_read_b64_tr_b16 a[58:59], v189 offset:6144
v_mfma_f32_16x16x32_bf16 v[68:71], a[12:15], a[80:83], v[68:71]
ds_read_b64_tr_b16 a[60:61], v190 offset:4096
v_mfma_f32_16x16x32_bf16 v[72:75], a[12:15], a[84:87], v[72:75]
ds_read_b64_tr_b16 a[62:63], v190 offset:6144
buffer_load_dwordx4 v221, s[60:63], s58 offen offset:384 lds
s_add_u32 m0, s57, 15872
v_mfma_f32_16x16x32_bf16 v[76:79], a[12:15], a[88:91], v[76:79]
ds_read_b64_tr_b16 a[64:65], v191 offset:4096
v_mfma_f32_16x16x32_bf16 v[80:83], a[16:19], a[72:75], v[80:83]
ds_read_b64_tr_b16 a[66:67], v191 offset:6144
v_mfma_f32_16x16x32_bf16 v[84:87], a[16:19], a[76:79], v[84:87]
ds_read_b64_tr_b16 a[68:69], v188 offset:8192
buffer_load_dwordx4 v221, s[60:63], s58 offen offset:512 lds
s_add_u32 m0, s57, 19840
v_mfma_f32_16x16x32_bf16 v[88:91], a[16:19], a[80:83], v[88:91]
ds_read_b64_tr_b16 a[70:71], v188 offset:10240
v_mfma_f32_16x16x32_bf16 v[92:95], a[16:19], a[84:87], v[92:95]
v_mfma_f32_16x16x32_bf16 v[96:99], a[16:19], a[88:91], v[96:99]
v_mfma_f32_16x16x32_bf16 v[100:103], a[20:23], a[72:75], v[100:103]
buffer_load_dwordx4 v221, s[60:63], s58 offen offset:640 lds
s_add_u32 m0, s57, 23808
v_mfma_f32_16x16x32_bf16 v[104:107], a[20:23], a[76:79], v[104:107]
v_mfma_f32_16x16x32_bf16 v[108:111], a[20:23], a[80:83], v[108:111]
v_mfma_f32_16x16x32_bf16 v[112:115], a[20:23], a[84:87], v[112:115]
v_mfma_f32_16x16x32_bf16 v[116:119], a[20:23], a[88:91], v[116:119]
buffer_load_dwordx4 v221, s[60:63], s58 offen offset:768 lds
s_add_u32 m0, s57, 27776
v_mfma_f32_16x16x32_bf16 v[120:123], a[24:27], a[72:75], v[120:123]
v_mfma_f32_16x16x32_bf16 v[124:127], a[24:27], a[76:79], v[124:127]
v_mfma_f32_16x16x32_bf16 v[128:131], a[24:27], a[80:83], v[128:131]
v_mfma_f32_16x16x32_bf16 v[132:135], a[24:27], a[84:87], v[132:135]
buffer_load_dwordx4 v221, s[60:63], s58 offen offset:896 lds
s_add_u32 m0, s57, 31744
v_mfma_f32_16x16x32_bf16 v[136:139], a[24:27], a[88:91], v[136:139]
v_mfma_f32_16x16x32_bf16 v[140:143], a[28:31], a[72:75], v[140:143]
v_mfma_f32_16x16x32_bf16 v[144:147], a[28:31], a[76:79], v[144:147]
v_mfma_f32_16x16x32_bf16 v[148:151], a[28:31], a[80:83], v[148:151]
buffer_load_dwordx4 v221, s[60:63], s58 offen offset:1024 lds
v_mfma_f32_16x16x32_bf16 v[152:155], a[28:31], a[84:87], v[152:155]
v_mfma_f32_16x16x32_bf16 v[156:159], a[28:31], a[88:91], v[156:159]
v_mfma_f32_16x16x32_bf16 v[160:163], a[32:35], a[72:75], v[160:163]
v_mfma_f32_16x16x32_bf16 v[164:167], a[32:35], a[76:79], v[164:167]
v_mfma_f32_16x16x32_bf16 v[168:171], a[32:35], a[80:83], v[168:171]
v_mfma_f32_16x16x32_bf16 v[172:175], a[32:35], a[84:87], v[172:175]
v_mfma_f32_16x16x32_bf16 v[176:179], a[32:35], a[88:91], v[176:179]
s_waitcnt lgkmcnt(0)
s_add_u32 s38, s38, 1
s_cmp_lt_u32 s38, 2
s_cbranch_scc1 gloop_161
s_waitcnt vmcnt(9)
s_barrier
s_add_u32 s59, s59, 36864
s_cmp_eq_u32 s59, 110592
s_cselect_b32 s59, 0, s59
v_add_u32 v188, s59, v219
v_add_u32 v189, s59, v220
v_add_u32 v190, s59, v224
v_add_u32 v191, s59, v225
v_add_u32 v192, 5120, v192
v_mfma_f32_16x16x32_bf16 v[0:3], a[36:39], a[92:95], v[0:3]
ds_read_b128 a[72:75], v192
v_mfma_f32_16x16x32_bf16 v[4:7], a[36:39], a[96:99], v[4:7]
ds_read_b128 a[76:79], v192 offset:1024
v_mfma_f32_16x16x32_bf16 v[8:11], a[36:39], a[100:103], v[8:11]
ds_read_b128 a[80:83], v192 offset:2048
v_mfma_f32_16x16x32_bf16 v[12:15], a[36:39], a[104:107], v[12:15]
ds_read_b128 a[84:87], v192 offset:3072
v_mfma_f32_16x16x32_bf16 v[16:19], a[36:39], a[108:111], v[16:19]
ds_read_b128 a[88:91], v192 offset:4096
v_mfma_f32_16x16x32_bf16 v[20:23], a[40:43], a[92:95], v[20:23]
ds_read_b64_tr_b16 a[0:1], v188
v_mfma_f32_16x16x32_bf16 v[24:27], a[40:43], a[96:99], v[24:27]
ds_read_b64_tr_b16 a[2:3], v188 offset:2048
v_mfma_f32_16x16x32_bf16 v[28:31], a[40:43], a[100:103], v[28:31]
ds_read_b64_tr_b16 a[4:5], v189
v_mfma_f32_16x16x32_bf16 v[32:35], a[40:43], a[104:107], v[32:35]
ds_read_b64_tr_b16 a[6:7], v189 offset:2048
v_mfma_f32_16x16x32_bf16 v[36:39], a[40:43], a[108:111], v[36:39]
ds_read_b64_tr_b16 a[8:9], v190
v_mfma_f32_16x16x32_bf16 v[40:43], a[44:47], a[92:95], v[40:43]
ds_read_b64_tr_b16 a[10:11], v190 offset:2048
v_mfma_f32_16x16x32_bf16 v[44:47], a[44:47], a[96:99], v[44:47]
ds_read_b64_tr_b16 a[12:13], v191
v_mfma_f32_16x16x32_bf16 v[48:51], a[44:47], a[100:103], v[48:51]
ds_read_b64_tr_b16 a[14:15], v191 offset:2048
v_mfma_f32_16x16x32_bf16 v[52:55], a[44:47], a[104:107], v[52:55]
ds_read_b64_tr_b16 a[16:17], v188 offset:4096
v_mfma_f32_16x16x32_bf16 v[56:59], a[44:47], a[108:111], v[56:59]
ds_read_b64_tr_b16 a[18:19], v188 offset:6144
v_mfma_f32_16x16x32_bf16 v[60:63], a[48:51], a[92:95], v[60:63]
ds_read_b64_tr_b16 a[20:21], v189 offset:4096
v_mfma_f32_16x16x32_bf16 v[64:67], a[48:51], a[96:99], v[64:67]
ds_read_b64_tr_b16 a[22:23], v189 offset:6144
v_mfma_f32_16x16x32_bf16 v[68:71], a[48:51], a[100:103], v[68:71]
ds_read_b64_tr_b16 a[24:25], v190 offset:4096
v_mfma_f32_16x16x32_bf16 v[72:75], a[48:51], a[104:107], v[72:75]
ds_read_b64_tr_b16 a[26:27], v190 offset:6144
v_mfma_f32_16x16x32_bf16 v[76:79], a[48:51], a[108:111], v[76:79]
ds_read_b64_tr_b16 a[28:29], v191 offset:4096
v_mfma_f32_16x16x32_bf16 v[80:83], a[52:55], a[92:95], v[80:83]
ds_read_b64_tr_b16 a[30:31], v191 offset:6144
v_mfma_f32_16x16x32_bf16 v[84:87], a[52:55], a[96:99], v[84:87]
ds_read_b64_tr_b16 a[32:33], v188 offset:8192
v_mfma_f32_16x16x32_bf16 v[88:91], a[52:55], a[100:103], v[88:91]
ds_read_b64_tr_b16 a[34:35], v188 offset:10240
v_mfma_f32_16x16x32_bf16 v[92:95], a[52:55], a[104:107], v[92:95]
v_mfma_f32_16x16x32_bf16 v[96:99], a[52:55], a[108:111], v[96:99]
v_mfma_f32_16x16x32_bf16 v[100:103], a[56:59], a[92:95], v[100:103]
v_mfma_f32_16x16x32_bf16 v[104:107], a[56:59], a[96:99], v[104:107]
v_mfma_f32_16x16x32_bf16 v[108:111], a[56:59], a[100:103], v[108:111]
v_mfma_f32_16x16x32_bf16 v[112:115], a[56:59], a[104:107], v[112:115]
v_mfma_f32_16x16x32_bf16 v[116:119], a[56:59], a[108:111], v[116:119]
v_mfma_f32_16x16x32_bf16 v[120:123], a[60:63], a[92:95], v[120:123]
v_mfma_f32_16x16x32_bf16 v[124:127], a[60:63], a[96:99], v[124:127]
v_mfma_f32_16x16x32_bf16 v[128:131], a[60:63], a[100:103], v[128:131]
v_mfma_f32_16x16x32_bf16 v[132:135], a[60:63], a[104:107], v[132:135]
v_mfma_f32_16x16x32_bf16 v[136:139], a[60:63], a[108:111], v[136:139]
v_mfma_f32_16x16x32_bf16 v[140:143], a[64:67], a[92:95], v[140:143]
v_mfma_f32_16x16x32_bf16 v[144:147], a[64:67], a[96:99], v[144:147]
v_mfma_f32_16x16x32_bf16 v[148:151], a[64:67], a[100:103], v[148:151]
v_mfma_f32_16x16x32_bf16 v[152:155], a[64:67], a[104:107], v[152:155]
v_mfma_f32_16x16x32_bf16 v[156:159], a[64:67], a[108:111], v[156:159]
v_mfma_f32_16x16x32_bf16 v[160:163], a[68:71], a[92:95], v[160:163]
v_mfma_f32_16x16x32_bf16 v[164:167], a[68:71], a[96:99], v[164:167]
v_mfma_f32_16x16x32_bf16 v[168:171], a[68:71], a[100:103], v[168:171]
v_mfma_f32_16x16x32_bf16 v[172:175], a[68:71], a[104:107], v[172:175]
v_mfma_f32_16x16x32_bf16 v[176:179], a[68:71], a[108:111], v[176:179]
s_waitcnt lgkmcnt(0)
s_mul_i32 s40, s3, 23552
v_add_u32 v246, s40, v209
s_waitcnt vmcnt(0)
s_barrier
s_add_u32 s59, s59, 36864
s_cmp_eq_u32 s59, 110592
s_cselect_b32 s59, 0, s59
v_add_u32 v188, s59, v219
v_add_u32 v189, s59, v220
v_add_u32 v190, s59, v224
v_add_u32 v191, s59, v225
v_add_u32 v192, 5120, v192
ds_read_b128 a[92:95], v192
v_mfma_f32_16x16x32_bf16 v[0:3], a[0:3], a[72:75], v[0:3]
ds_read_b128 a[96:99], v192 offset:1024
ds_read_b128 a[100:103], v192 offset:2048
v_mfma_f32_16x16x32_bf16 v[4:7], a[0:3], a[76:79], v[4:7]
ds_read_b128 a[104:107], v192 offset:3072
ds_read_b128 a[108:111], v192 offset:4096
v_mfma_f32_16x16x32_bf16 v[8:11], a[0:3], a[80:83], v[8:11]
ds_read_b64_tr_b16 a[36:37], v188
ds_read_b64_tr_b16 a[38:39], v188 offset:2048
v_mfma_f32_16x16x32_bf16 v[12:15], a[0:3], a[84:87], v[12:15]
ds_read_b64_tr_b16 a[40:41], v189
ds_read_b64_tr_b16 a[42:43], v189 offset:2048
v_mfma_f32_16x16x32_bf16 v[16:19], a[0:3], a[88:91], v[16:19]
ds_read_b64_tr_b16 a[44:45], v190
ds_read_b64_tr_b16 a[46:47], v190 offset:2048
v_mfma_f32_16x16x32_bf16 v[20:23], a[4:7], a[72:75], v[20:23]
ds_read_b64_tr_b16 a[48:49], v191
ds_read_b64_tr_b16 a[50:51], v191 offset:2048
v_mfma_f32_16x16x32_bf16 v[24:27], a[4:7], a[76:79], v[24:27]
ds_read_b64_tr_b16 a[52:53], v188 offset:4096
ds_read_b64_tr_b16 a[54:55], v188 offset:6144
v_mfma_f32_16x16x32_bf16 v[28:31], a[4:7], a[80:83], v[28:31]
ds_read_b64_tr_b16 a[56:57], v189 offset:4096
ds_read_b64_tr_b16 a[58:59], v189 offset:6144
v_mfma_f32_16x16x32_bf16 v[32:35], a[4:7], a[84:87], v[32:35]
ds_read_b64_tr_b16 a[60:61], v190 offset:4096
ds_read_b64_tr_b16 a[62:63], v190 offset:6144
v_mfma_f32_16x16x32_bf16 v[36:39], a[4:7], a[88:91], v[36:39]
ds_read_b64_tr_b16 a[64:65], v191 offset:4096
ds_read_b64_tr_b16 a[66:67], v191 offset:6144
v_mfma_f32_16x16x32_bf16 v[40:43], a[8:11], a[72:75], v[40:43]
ds_read_b64_tr_b16 a[68:69], v188 offset:8192
ds_read_b64_tr_b16 a[70:71], v188 offset:10240
v_mfma_f32_16x16x32_bf16 v[44:47], a[8:11], a[76:79], v[44:47]
v_mfma_f32_16x16x32_bf16 v[48:51], a[8:11], a[80:83], v[48:51]
v_mfma_f32_16x16x32_bf16 v[52:55], a[8:11], a[84:87], v[52:55]
v_mfma_f32_16x16x32_bf16 v[56:59], a[8:11], a[88:91], v[56:59]
s_waitcnt lgkmcnt(0)
v_mfma_f32_16x16x32_bf16 v[0:3], a[36:39], a[92:95], v[0:3]
v_mfma_f32_16x16x32_bf16 v[4:7], a[36:39], a[96:99], v[4:7]
v_mfma_f32_16x16x32_bf16 v[8:11], a[36:39], a[100:103], v[8:11]
v_mfma_f32_16x16x32_bf16 v[12:15], a[36:39], a[104:107], v[12:15]
v_mfma_f32_16x16x32_bf16 v[16:19], a[36:39], a[108:111], v[16:19]
v_mfma_f32_16x16x32_bf16 v[20:23], a[40:43], a[92:95], v[20:23]
s_nop 2
v_cvt_pk_bf16_f32 v0, v0, v1
v_cvt_pk_bf16_f32 v1, v2, v3
v_cvt_pk_bf16_f32 v2, v4, v5
v_cvt_pk_bf16_f32 v3, v6, v7
buffer_store_dwordx4 v[0:3], v246, s[24:27], 0 offen sc1
v_mfma_f32_16x16x32_bf16 v[24:27], a[40:43], a[96:99], v[24:27]
v_mfma_f32_16x16x32_bf16 v[28:31], a[40:43], a[100:103], v[28:31]
v_cvt_pk_bf16_f32 v8, v8, v9
v_cvt_pk_bf16_f32 v9, v10, v11
v_cvt_pk_bf16_f32 v10, v12, v13
v_cvt_pk_bf16_f32 v11, v14, v15
buffer_store_dwordx4 v[8:11], v246, s[24:27], 0 offen offset:1024 sc1
v_mfma_f32_16x16x32_bf16 v[32:35], a[40:43], a[104:107], v[32:35]
v_mfma_f32_16x16x32_bf16 v[36:39], a[40:43], a[108:111], v[36:39]
v_cvt_pk_bf16_f32 v16, v16, v17
v_cvt_pk_bf16_f32 v17, v18, v19
v_cvt_pk_bf16_f32 v18, v20, v21
v_cvt_pk_bf16_f32 v19, v22, v23
buffer_store_dwordx4 v[16:19], v246, s[24:27], 0 offen offset:2048 sc1
v_mfma_f32_16x16x32_bf16 v[40:43], a[44:47], a[92:95], v[40:43]
v_mfma_f32_16x16x32_bf16 v[44:47], a[44:47], a[96:99], v[44:47]
v_cvt_pk_bf16_f32 v24, v24, v25
v_cvt_pk_bf16_f32 v25, v26, v27
v_cvt_pk_bf16_f32 v26, v28, v29
v_cvt_pk_bf16_f32 v27, v30, v31
buffer_store_dwordx4 v[24:27], v246, s[24:27], 0 offen offset:3072 sc1
v_mfma_f32_16x16x32_bf16 v[48:51], a[44:47], a[100:103], v[48:51]
v_mfma_f32_16x16x32_bf16 v[52:55], a[44:47], a[104:107], v[52:55]
v_cvt_pk_bf16_f32 v32, v32, v33
v_cvt_pk_bf16_f32 v33, v34, v35
v_cvt_pk_bf16_f32 v34, v36, v37
v_cvt_pk_bf16_f32 v35, v38, v39
s_mov_b32 s41, 4096
buffer_store_dwordx4 v[32:35], v246, s[24:27], s41 offen sc1
v_mfma_f32_16x16x32_bf16 v[56:59], a[44:47], a[108:111], v[56:59]
v_mfma_f32_16x16x32_bf16 v[60:63], a[12:15], a[72:75], v[60:63]
v_mfma_f32_16x16x32_bf16 v[60:63], a[48:51], a[92:95], v[60:63]
v_cvt_pk_bf16_f32 v40, v40, v41
v_cvt_pk_bf16_f32 v41, v42, v43
v_cvt_pk_bf16_f32 v42, v44, v45
v_cvt_pk_bf16_f32 v43, v46, v47
s_mov_b32 s41, 5120
buffer_store_dwordx4 v[40:43], v246, s[24:27], s41 offen sc1
v_mfma_f32_16x16x32_bf16 v[64:67], a[12:15], a[76:79], v[64:67]
v_mfma_f32_16x16x32_bf16 v[64:67], a[48:51], a[96:99], v[64:67]
v_mfma_f32_16x16x32_bf16 v[68:71], a[12:15], a[80:83], v[68:71]
v_mfma_f32_16x16x32_bf16 v[68:71], a[48:51], a[100:103], v[68:71]
v_cvt_pk_bf16_f32 v48, v48, v49
v_cvt_pk_bf16_f32 v49, v50, v51
v_cvt_pk_bf16_f32 v50, v52, v53
v_cvt_pk_bf16_f32 v51, v54, v55
s_mov_b32 s41, 6144
buffer_store_dwordx4 v[48:51], v246, s[24:27], s41 offen sc1
v_mfma_f32_16x16x32_bf16 v[72:75], a[12:15], a[84:87], v[72:75]
v_mfma_f32_16x16x32_bf16 v[72:75], a[48:51], a[104:107], v[72:75]
v_mfma_f32_16x16x32_bf16 v[76:79], a[12:15], a[88:91], v[76:79]
v_mfma_f32_16x16x32_bf16 v[76:79], a[48:51], a[108:111], v[76:79]
v_cvt_pk_bf16_f32 v56, v56, v57
v_cvt_pk_bf16_f32 v57, v58, v59
v_cvt_pk_bf16_f32 v58, v60, v61
v_cvt_pk_bf16_f32 v59, v62, v63
s_mov_b32 s41, 7168
buffer_store_dwordx4 v[56:59], v246, s[24:27], s41 offen sc1
v_mfma_f32_16x16x32_bf16 v[80:83], a[16:19], a[72:75], v[80:83]
v_mfma_f32_16x16x32_bf16 v[80:83], a[52:55], a[92:95], v[80:83]
v_mfma_f32_16x16x32_bf16 v[84:87], a[16:19], a[76:79], v[84:87]
v_mfma_f32_16x16x32_bf16 v[84:87], a[52:55], a[96:99], v[84:87]
v_cvt_pk_bf16_f32 v64, v64, v65
v_cvt_pk_bf16_f32 v65, v66, v67
v_cvt_pk_bf16_f32 v66, v68, v69
v_cvt_pk_bf16_f32 v67, v70, v71
s_mov_b32 s41, 8192
buffer_store_dwordx4 v[64:67], v246, s[24:27], s41 offen sc1
v_mfma_f32_16x16x32_bf16 v[88:91], a[16:19], a[80:83], v[88:91]
v_mfma_f32_16x16x32_bf16 v[88:91], a[52:55], a[100:103], v[88:91]
v_mfma_f32_16x16x32_bf16 v[92:95], a[16:19], a[84:87], v[92:95]
v_mfma_f32_16x16x32_bf16 v[92:95], a[52:55], a[104:107], v[92:95]
v_cvt_pk_bf16_f32 v72, v72, v73
v_cvt_pk_bf16_f32 v73, v74, v75
v_cvt_pk_bf16_f32 v74, v76, v77
v_cvt_pk_bf16_f32 v75, v78, v79
s_mov_b32 s41, 9216
buffer_store_dwordx4 v[72:75], v246, s[24:27], s41 offen sc1
v_mfma_f32_16x16x32_bf16 v[96:99], a[16:19], a[88:91], v[96:99]
v_mfma_f32_16x16x32_bf16 v[96:99], a[52:55], a[108:111], v[96:99]
v_mfma_f32_16x16x32_bf16 v[100:103], a[20:23], a[72:75], v[100:103]
v_mfma_f32_16x16x32_bf16 v[100:103], a[56:59], a[92:95], v[100:103]
v_cvt_pk_bf16_f32 v80, v80, v81
v_cvt_pk_bf16_f32 v81, v82, v83
v_cvt_pk_bf16_f32 v82, v84, v85
v_cvt_pk_bf16_f32 v83, v86, v87
s_mov_b32 s41, 10240
buffer_store_dwordx4 v[80:83], v246, s[24:27], s41 offen sc1
v_mfma_f32_16x16x32_bf16 v[104:107], a[20:23], a[76:79], v[104:107]
v_mfma_f32_16x16x32_bf16 v[104:107], a[56:59], a[96:99], v[104:107]
v_mfma_f32_16x16x32_bf16 v[108:111], a[20:23], a[80:83], v[108:111]
v_mfma_f32_16x16x32_bf16 v[108:111], a[56:59], a[100:103], v[108:111]
v_cvt_pk_bf16_f32 v88, v88, v89
v_cvt_pk_bf16_f32 v89, v90, v91
v_cvt_pk_bf16_f32 v90, v92, v93
v_cvt_pk_bf16_f32 v91, v94, v95
s_mov_b32 s41, 11264
buffer_store_dwordx4 v[88:91], v246, s[24:27], s41 offen sc1
v_mfma_f32_16x16x32_bf16 v[112:115], a[20:23], a[84:87], v[112:115]
v_mfma_f32_16x16x32_bf16 v[112:115], a[56:59], a[104:107], v[112:115]
v_mfma_f32_16x16x32_bf16 v[116:119], a[20:23], a[88:91], v[116:119]
v_mfma_f32_16x16x32_bf16 v[116:119], a[56:59], a[108:111], v[116:119]
v_cvt_pk_bf16_f32 v96, v96, v97
v_cvt_pk_bf16_f32 v97, v98, v99
v_cvt_pk_bf16_f32 v98, v100, v101
v_cvt_pk_bf16_f32 v99, v102, v103
s_mov_b32 s41, 12288
buffer_store_dwordx4 v[96:99], v246, s[24:27], s41 offen sc1
v_mfma_f32_16x16x32_bf16 v[120:123], a[24:27], a[72:75], v[120:123]
v_mfma_f32_16x16x32_bf16 v[120:123], a[60:63], a[92:95], v[120:123]
v_mfma_f32_16x16x32_bf16 v[124:127], a[24:27], a[76:79], v[124:127]
v_mfma_f32_16x16x32_bf16 v[124:127], a[60:63], a[96:99], v[124:127]
v_cvt_pk_bf16_f32 v104, v104, v105
v_cvt_pk_bf16_f32 v105, v106, v107
v_cvt_pk_bf16_f32 v106, v108, v109
v_cvt_pk_bf16_f32 v107, v110, v111
s_mov_b32 s41, 13312
buffer_store_dwordx4 v[104:107], v246, s[24:27], s41 offen sc1
v_mfma_f32_16x16x32_bf16 v[128:131], a[24:27], a[80:83], v[128:131]
v_mfma_f32_16x16x32_bf16 v[128:131], a[60:63], a[100:103], v[128:131]
v_mfma_f32_16x16x32_bf16 v[132:135], a[24:27], a[84:87], v[132:135]
v_mfma_f32_16x16x32_bf16 v[132:135], a[60:63], a[104:107], v[132:135]
v_cvt_pk_bf16_f32 v112, v112, v113
v_cvt_pk_bf16_f32 v113, v114, v115
v_cvt_pk_bf16_f32 v114, v116, v117
v_cvt_pk_bf16_f32 v115, v118, v119
s_mov_b32 s41, 14336
buffer_store_dwordx4 v[112:115], v246, s[24:27], s41 offen sc1
v_mfma_f32_16x16x32_bf16 v[136:139], a[24:27], a[88:91], v[136:139]
v_mfma_f32_16x16x32_bf16 v[136:139], a[60:63], a[108:111], v[136:139]
v_mfma_f32_16x16x32_bf16 v[140:143], a[28:31], a[72:75], v[140:143]
v_mfma_f32_16x16x32_bf16 v[140:143], a[64:67], a[92:95], v[140:143]
v_cvt_pk_bf16_f32 v120, v120, v121
v_cvt_pk_bf16_f32 v121, v122, v123
v_cvt_pk_bf16_f32 v122, v124, v125
v_cvt_pk_bf16_f32 v123, v126, v127
s_mov_b32 s41, 15360
buffer_store_dwordx4 v[120:123], v246, s[24:27], s41 offen sc1
v_mfma_f32_16x16x32_bf16 v[144:147], a[28:31], a[76:79], v[144:147]
v_mfma_f32_16x16x32_bf16 v[144:147], a[64:67], a[96:99], v[144:147]
v_mfma_f32_16x16x32_bf16 v[148:151], a[28:31], a[80:83], v[148:151]
v_mfma_f32_16x16x32_bf16 v[148:151], a[64:67], a[100:103], v[148:151]
v_cvt_pk_bf16_f32 v128, v128, v129
v_cvt_pk_bf16_f32 v129, v130, v131
v_cvt_pk_bf16_f32 v130, v132, v133
v_cvt_pk_bf16_f32 v131, v134, v135
s_mov_b32 s41, 16384
buffer_store_dwordx4 v[128:131], v246, s[24:27], s41 offen sc1
v_mfma_f32_16x16x32_bf16 v[152:155], a[28:31], a[84:87], v[152:155]
v_mfma_f32_16x16x32_bf16 v[152:155], a[64:67], a[104:107], v[152:155]
v_mfma_f32_16x16x32_bf16 v[156:159], a[28:31], a[88:91], v[156:159]
v_mfma_f32_16x16x32_bf16 v[156:159], a[64:67], a[108:111], v[156:159]
v_cvt_pk_bf16_f32 v136, v136, v137
v_cvt_pk_bf16_f32 v137, v138, v139
v_cvt_pk_bf16_f32 v138, v140, v141
v_cvt_pk_bf16_f32 v139, v142, v143
s_mov_b32 s41, 17408
buffer_store_dwordx4 v[136:139], v246, s[24:27], s41 offen sc1
v_mfma_f32_16x16x32_bf16 v[160:163], a[32:35], a[72:75], v[160:163]
v_mfma_f32_16x16x32_bf16 v[160:163], a[68:71], a[92:95], v[160:163]
v_mfma_f32_16x16x32_bf16 v[164:167], a[32:35], a[76:79], v[164:167]
v_mfma_f32_16x16x32_bf16 v[164:167], a[68:71], a[96:99], v[164:167]
v_cvt_pk_bf16_f32 v144, v144, v145
v_cvt_pk_bf16_f32 v145, v146, v147
v_cvt_pk_bf16_f32 v146, v148, v149
v_cvt_pk_bf16_f32 v147, v150, v151
s_mov_b32 s41, 18432
buffer_store_dwordx4 v[144:147], v246, s[24:27], s41 offen sc1
v_mfma_f32_16x16x32_bf16 v[168:171], a[32:35], a[80:83], v[168:171]
v_mfma_f32_16x16x32_bf16 v[168:171], a[68:71], a[100:103], v[168:171]
v_mfma_f32_16x16x32_bf16 v[172:175], a[32:35], a[84:87], v[172:175]
v_mfma_f32_16x16x32_bf16 v[172:175], a[68:71], a[104:107], v[172:175]
v_cvt_pk_bf16_f32 v152, v152, v153
v_cvt_pk_bf16_f32 v153, v154, v155
v_cvt_pk_bf16_f32 v154, v156, v157
v_cvt_pk_bf16_f32 v155, v158, v159
s_mov_b32 s41, 19456
buffer_store_dwordx4 v[152:155], v246, s[24:27], s41 offen sc1
v_mfma_f32_16x16x32_bf16 v[176:179], a[32:35], a[88:91], v[176:179]
v_mfma_f32_16x16x32_bf16 v[176:179], a[68:71], a[108:111], v[176:179]
v_cvt_pk_bf16_f32 v160, v160, v161
v_cvt_pk_bf16_f32 v161, v162, v163
v_cvt_pk_bf16_f32 v162, v164, v165
v_cvt_pk_bf16_f32 v163, v166, v167
s_mov_b32 s41, 20480
buffer_store_dwordx4 v[160:163], v246, s[24:27], s41 offen sc1
v_cvt_pk_bf16_f32 v168, v168, v169
v_cvt_pk_bf16_f32 v169, v170, v171
v_cvt_pk_bf16_f32 v170, v172, v173
v_cvt_pk_bf16_f32 v171, v174, v175
s_mov_b32 s41, 21504
buffer_store_dwordx4 v[168:171], v246, s[24:27], s41 offen sc1
v_cvt_pk_bf16_f32 v176, v176, v177
v_cvt_pk_bf16_f32 v177, v178, v179
v_mov_b32 v178, 0
v_mov_b32 v179, 0
s_mov_b32 s41, 22528
buffer_store_dwordx4 v[176:179], v246, s[24:27], s41 offen sc1
v_and_b32 v202, 15, v210
v_mul_u32_u24 v202, 2304, v202
v_lshrrev_b32 v203, 4, v210
v_lshlrev_b32 v203, 3, v203
v_add_u32 v202, v202, v203
s_lshr_b32 s44, s49, 1
s_lshl_b32 s40, s3, 4
s_add_u32 s44, s44, s40
s_add_u32 s45, s44, 64
s_lshl_b32 s40, s44, 10
v_add_u32 v204, s40, v209
s_mul_i32 s54, s44, 2850
s_lshr_b32 s54, s54, 16
s_mul_i32 s40, s54, 23
s_sub_u32 s55, s44, s40
s_lshl_b32 s43, s55, 1
s_add_u32 s43, s43, 0
s_mul_i32 s41, s43, 52
s_lshr_b32 s41, s41, 8
s_mul_i32 s42, s41, 5
s_sub_u32 s42, s43, s42
s_mul_i32 s40, s54, 9
s_add_u32 s40, s40, s41
s_lshl_b32 s40, s40, 5
s_lshl_b32 s42, s42, 4
s_mul_i32 s41, s48, 80
s_add_u32 s42, s42, s41
s_mul_i32 s42, s42, 2304
s_add_u32 s40, s40, s42
s_mul_i32 s41, s96, 1152
s_add_u32 s32, s40, s41
s_lshl_b32 s43, s55, 1
s_add_u32 s43, s43, 1
s_mul_i32 s41, s43, 52
s_lshr_b32 s41, s41, 8
s_mul_i32 s42, s41, 5
s_sub_u32 s42, s43, s42
s_mul_i32 s40, s54, 9
s_add_u32 s40, s40, s41
s_lshl_b32 s40, s40, 5
s_lshl_b32 s42, s42, 4
s_mul_i32 s41, s48, 80
s_add_u32 s42, s42, s41
s_mul_i32 s42, s42, 2304
s_add_u32 s40, s40, s42
s_mul_i32 s41, s96, 1152
s_add_u32 s33, s40, s41
s_cmp_ge_u32 s43, 45
s_cselect_b32 s33, 1474560, s33
s_lshl_b32 s40, s45, 10
v_add_u32 v205, s40, v209
s_mul_i32 s54, s45, 2850
s_lshr_b32 s54, s54, 16
s_mul_i32 s40, s54, 23
s_sub_u32 s55, s45, s40
s_lshl_b32 s43, s55, 1
s_add_u32 s43, s43, 0
s_mul_i32 s41, s43, 52
s_lshr_b32 s41, s41, 8
s_mul_i32 s42, s41, 5
s_sub_u32 s42, s43, s42
s_mul_i32 s40, s54, 9
s_add_u32 s40, s40, s41
s_lshl_b32 s40, s40, 5
s_lshl_b32 s42, s42, 4
s_mul_i32 s41, s48, 80
s_add_u32 s42, s42, s41
s_mul_i32 s42, s42, 2304
s_add_u32 s40, s40, s42
s_mul_i32 s41, s96, 1152
s_add_u32 s34, s40, s41
s_lshl_b32 s43, s55, 1
s_add_u32 s43, s43, 1
s_mul_i32 s41, s43, 52
s_lshr_b32 s41, s41, 8
s_mul_i32 s42, s41, 5
s_sub_u32 s42, s43, s42
s_mul_i32 s40, s54, 9
s_add_u32 s40, s40, s41
s_lshl_b32 s40, s40, 5
s_lshl_b32 s42, s42, 4
s_mul_i32 s41, s48, 80
s_add_u32 s42, s42, s41
s_mul_i32 s42, s42, 2304
s_add_u32 s40, s40, s42
s_mul_i32 s41, s96, 1152
s_add_u32 s35, s40, s41
s_cmp_ge_u32 s43, 45
s_cselect_b32 s35, 1474560, s35
s_waitcnt vmcnt(0)
s_barrier
s_cmp_lg_u32 s3, 0
s_cbranch_scc1 poll_skip_164
s_mov_b64 s[42:43], exec
s_mov_b64 exec, 1
v_readfirstlane_b32 s40, v200
s_cmp_lg_u32 s40, 0
s_cbranch_scc1 polli_out_168
s_lshl_b32 s40, s97, 2
v_mov_b32 v247, s40
s_mov_b32 s38, 0
polli_167:
global_load_dword v249, v247, s[68:69] sc1
s_waitcnt vmcnt(0)
v_readfirstlane_b32 s40, v249
s_add_u32 s38, s38, 1
s_cmp_gt_u32 s38, 200000
s_cbranch_scc1 polli_out_168
s_cmp_eq_u32 s40, 0
s_cbranch_scc1 polli_167
polli_out_168:
s_mul_i32 s40, s97, 4352
s_add_u32 s40, s40, 33554432
v_mov_b32 v247, s40
v_mov_b32 v248, 1
global_atomic_add v249, v247, v248, s[50:51] sc0 sc1
s_waitcnt vmcnt(0)
v_readfirstlane_b32 s40, v249
s_cmp_ge_u32 s40, 15
s_cbranch_scc1 poll_out_166
s_mov_b32 s38, 0
poll_165:
global_load_dword v249, v247, s[50:51] sc1
s_waitcnt vmcnt(0)
v_readfirstlane_b32 s40, v249
s_add_u32 s38, s38, 1
s_cmp_gt_u32 s38, 200000
s_cbranch_scc1 poll_out_166
s_cmp_lt_u32 s40, 16
s_cbranch_scc1 poll_165
poll_out_166:
s_mov_b64 exec, s[42:43]
poll_skip_164:
s_barrier
s_mov_b32 s41, 0
buffer_load_dwordx4 v[0:3], v204, s[92:95], s41 offen sc1
s_mov_b32 s41, 94208
buffer_load_dwordx4 v[4:7], v204, s[92:95], s41 offen sc1
s_mov_b32 s41, 188416
buffer_load_dwordx4 v[8:11], v204, s[92:95], s41 offen sc1
s_mov_b32 s41, 282624
buffer_load_dwordx4 v[12:15], v204, s[92:95], s41 offen sc1
s_mov_b32 s41, 376832
buffer_load_dwordx4 v[16:19], v204, s[92:95], s41 offen sc1
s_mov_b32 s41, 471040
buffer_load_dwordx4 v[20:23], v204, s[92:95], s41 offen sc1
s_mov_b32 s41, 565248
buffer_load_dwordx4 v[24:27], v204, s[92:95], s41 offen sc1
s_mov_b32 s41, 659456
buffer_load_dwordx4 v[28:31], v204, s[92:95], s41 offen sc1
s_mov_b32 s41, 753664
buffer_load_dwordx4 v[32:35], v204, s[92:95], s41 offen sc1
s_mov_b32 s41, 847872
buffer_load_dwordx4 v[36:39], v204, s[92:95], s41 offen sc1
s_mov_b32 s41, 942080
buffer_load_dwordx4 v[40:43], v204, s[92:95], s41 offen sc1
s_mov_b32 s41, 1036288
buffer_load_dwordx4 v[44:47], v204, s[92:95], s41 offen sc1
s_mov_b32 s41, 1130496
buffer_load_dwordx4 v[48:51], v204, s[92:95], s41 offen sc1
s_mov_b32 s41, 1224704
buffer_load_dwordx4 v[52:55], v204, s[92:95], s41 offen sc1
s_mov_b32 s41, 1318912
buffer_load_dwordx4 v[56:59], v204, s[92:95], s41 offen sc1
s_mov_b32 s41, 1413120
buffer_load_dwordx4 v[60:63], v204, s[92:95], s41 offen sc1
s_cmp_ge_u32 s45, 92
s_cbranch_scc1 red_one_163
s_mov_b32 s41, 0
buffer_load_dwordx4 v[64:67], v205, s[92:95], s41 offen sc1
s_mov_b32 s41, 94208
buffer_load_dwordx4 v[68:71], v205, s[92:95], s41 offen sc1
s_mov_b32 s41, 188416
buffer_load_dwordx4 v[72:75], v205, s[92:95], s41 offen sc1
s_mov_b32 s41, 282624
buffer_load_dwordx4 v[76:79], v205, s[92:95], s41 offen sc1
s_mov_b32 s41, 376832
buffer_load_dwordx4 v[80:83], v205, s[92:95], s41 offen sc1
s_mov_b32 s41, 471040
buffer_load_dwordx4 v[84:87], v205, s[92:95], s41 offen sc1
s_mov_b32 s41, 565248
buffer_load_dwordx4 v[88:91], v205, s[92:95], s41 offen sc1
s_mov_b32 s41, 659456
buffer_load_dwordx4 v[92:95], v205, s[92:95], s41 offen sc1
s_mov_b32 s41, 753664
buffer_load_dwordx4 v[96:99], v205, s[92:95], s41 offen sc1
s_mov_b32 s41, 847872
buffer_load_dwordx4 v[100:103], v205, s[92:95], s41 offen sc1
s_mov_b32 s41, 942080
buffer_load_dwordx4 v[104:107], v205, s[92:95], s41 offen sc1
s_mov_b32 s41, 1036288
buffer_load_dwordx4 v[108:111], v205, s[92:95], s41 offen sc1
s_mov_b32 s41, 1130496
buffer_load_dwordx4 v[112:115], v205, s[92:95], s41 offen sc1
s_mov_b32 s41, 1224704
buffer_load_dwordx4 v[116:119], v205, s[92:95], s41 offen sc1
s_mov_b32 s41, 1318912
buffer_load_dwordx4 v[120:123], v205, s[92:95], s41 offen sc1
s_mov_b32 s41, 1413120
buffer_load_dwordx4 v[124:127], v205, s[92:95], s41 offen sc1
s_waitcnt vmcnt(16)
v_mfma_f32_16x16x32_bf16 v[128:131], a[248:251], v[0:3], 0
v_mfma_f32_16x16x32_bf16 v[132:135], a[252:255], v[0:3], 0
v_mfma_f32_16x16x32_bf16 v[128:131], a[248:251], v[4:7], v[128:131]
v_mfma_f32_16x16x32_bf16 v[132:135], a[252:255], v[4:7], v[132:135]
v_mfma_f32_16x16x32_bf16 v[128:131], a[248:251], v[8:11], v[128:131]
v_mfma_f32_16x16x32_bf16 v[132:135], a[252:255], v[8:11], v[132:135]
v_mfma_f32_16x16x32_bf16 v[128:131], a[248:251], v[12:15], v[128:131]
v_mfma_f32_16x16x32_bf16 v[132:135], a[252:255], v[12:15], v[132:135]
v_mfma_f32_16x16x32_bf16 v[128:131], a[248:251], v[16:19], v[128:131]
v_mfma_f32_16x16x32_bf16 v[132:135], a[252:255], v[16:19], v[132:135]
v_mfma_f32_16x16x32_bf16 v[128:131], a[248:251], v[20:23], v[128:131]
v_mfma_f32_16x16x32_bf16 v[132:135], a[252:255], v[20:23], v[132:135]
v_mfma_f32_16x16x32_bf16 v[128:131], a[248:251], v[24:27], v[128:131]
v_mfma_f32_16x16x32_bf16 v[132:135], a[252:255], v[24:27], v[132:135]
v_mfma_f32_16x16x32_bf16 v[128:131], a[248:251], v[28:31], v[128:131]
v_mfma_f32_16x16x32_bf16 v[132:135], a[252:255], v[28:31], v[132:135]
v_mfma_f32_16x16x32_bf16 v[128:131], a[248:251], v[32:35], v[128:131]
v_mfma_f32_16x16x32_bf16 v[132:135], a[252:255], v[32:35], v[132:135]
v_mfma_f32_16x16x32_bf16 v[128:131], a[248:251], v[36:39], v[128:131]
v_mfma_f32_16x16x32_bf16 v[132:135], a[252:255], v[36:39], v[132:135]
v_mfma_f32_16x16x32_bf16 v[128:131], a[248:251], v[40:43], v[128:131]
v_mfma_f32_16x16x32_bf16 v[132:135], a[252:255], v[40:43], v[132:135]
v_mfma_f32_16x16x32_bf16 v[128:131], a[248:251], v[44:47], v[128:131]
v_mfma_f32_16x16x32_bf16 v[132:135], a[252:255], v[44:47], v[132:135]
v_mfma_f32_16x16x32_bf16 v[128:131], a[248:251], v[48:51], v[128:131]
v_mfma_f32_16x16x32_bf16 v[132:135], a[252:255], v[48:51], v[132:135]
v_mfma_f32_16x16x32_bf16 v[128:131], a[248:251], v[52:55], v[128:131]
v_mfma_f32_16x16x32_bf16 v[132:135], a[252:255], v[52:55], v[132:135]
v_mfma_f32_16x16x32_bf16 v[128:131], a[248:251], v[56:59], v[128:131]
v_mfma_f32_16x16x32_bf16 v[132:135], a[252:255], v[56:59], v[132:135]
v_mfma_f32_16x16x32_bf16 v[128:131], a[248:251], v[60:63], v[128:131]
v_mfma_f32_16x16x32_bf16 v[132:135], a[252:255], v[60:63], v[132:135]
s_nop 6
v_cvt_pk_bf16_f32 v144, v128, v129
v_cvt_pk_bf16_f32 v145, v130, v131
buffer_store_dwordx2 v[144:145], v202, s[64:67], s32 offen nt
v_cvt_pk_bf16_f32 v146, v132, v133
v_cvt_pk_bf16_f32 v147, v134, v135
buffer_store_dwordx2 v[146:147], v202, s[64:67], s33 offen nt
s_waitcnt vmcnt(1)
v_mfma_f32_16x16x32_bf16 v[136:139], a[248:251], v[64:67], 0
v_mfma_f32_16x16x32_bf16 v[140:143], a[252:255], v[64:67], 0
v_mfma_f32_16x16x32_bf16 v[136:139], a[248:251], v[68:71], v[136:139]
v_mfma_f32_16x16x32_bf16 v[140:143], a[252:255], v[68:71], v[140:143]
v_mfma_f32_16x16x32_bf16 v[136:139], a[248:251], v[72:75], v[136:139]
v_mfma_f32_16x16x32_bf16 v[140:143], a[252:255], v[72:75], v[140:143]
v_mfma_f32_16x16x32_bf16 v[136:139], a[248:251], v[76:79], v[136:139]
v_mfma_f32_16x16x32_bf16 v[140:143], a[252:255], v[76:79], v[140:143]
v_mfma_f32_16x16x32_bf16 v[136:139], a[248:251], v[80:83], v[136:139]
v_mfma_f32_16x16x32_bf16 v[140:143], a[252:255], v[80:83], v[140:143]
v_mfma_f32_16x16x32_bf16 v[136:139], a[248:251], v[84:87], v[136:139]
v_mfma_f32_16x16x32_bf16 v[140:143], a[252:255], v[84:87], v[140:143]
v_mfma_f32_16x16x32_bf16 v[136:139], a[248:251], v[88:91], v[136:139]
v_mfma_f32_16x16x32_bf16 v[140:143], a[252:255], v[88:91], v[140:143]
v_mfma_f32_16x16x32_bf16 v[136:139], a[248:251], v[92:95], v[136:139]
v_mfma_f32_16x16x32_bf16 v[140:143], a[252:255], v[92:95], v[140:143]
v_mfma_f32_16x16x32_bf16 v[136:139], a[248:251], v[96:99], v[136:139]
v_mfma_f32_16x16x32_bf16 v[140:143], a[252:255], v[96:99], v[140:143]
v_mfma_f32_16x16x32_bf16 v[136:139], a[248:251], v[100:103], v[136:139]
v_mfma_f32_16x16x32_bf16 v[140:143], a[252:255], v[100:103], v[140:143]
v_mfma_f32_16x16x32_bf16 v[136:139], a[248:251], v[104:107], v[136:139]
v_mfma_f32_16x16x32_bf16 v[140:143], a[252:255], v[104:107], v[140:143]
v_mfma_f32_16x16x32_bf16 v[136:139], a[248:251], v[108:111], v[136:139]
v_mfma_f32_16x16x32_bf16 v[140:143], a[252:255], v[108:111], v[140:143]
v_mfma_f32_16x16x32_bf16 v[136:139], a[248:251], v[112:115], v[136:139]
v_mfma_f32_16x16x32_bf16 v[140:143], a[252:255], v[112:115], v[140:143]
v_mfma_f32_16x16x32_bf16 v[136:139], a[248:251], v[116:119], v[136:139]
v_mfma_f32_16x16x32_bf16 v[140:143], a[252:255], v[116:119], v[140:143]
v_mfma_f32_16x16x32_bf16 v[136:139], a[248:251], v[120:123], v[136:139]
v_mfma_f32_16x16x32_bf16 v[140:143], a[252:255], v[120:123], v[140:143]
v_mfma_f32_16x16x32_bf16 v[136:139], a[248:251], v[124:127], v[136:139]
v_mfma_f32_16x16x32_bf16 v[140:143], a[252:255], v[124:127], v[140:143]
s_nop 6
v_cvt_pk_bf16_f32 v148, v136, v137
v_cvt_pk_bf16_f32 v149, v138, v139
buffer_store_dwordx2 v[148:149], v202, s[64:67], s34 offen nt
v_cvt_pk_bf16_f32 v150, v140, v141
v_cvt_pk_bf16_f32 v151, v142, v143
buffer_store_dwordx2 v[150:151], v202, s[64:67], s35 offen nt
s_branch red_fin_162
red_one_163:
s_waitcnt vmcnt(0)
v_mfma_f32_16x16x32_bf16 v[128:131], a[248:251], v[0:3], 0
v_mfma_f32_16x16x32_bf16 v[132:135], a[252:255], v[0:3], 0
v_mfma_f32_16x16x32_bf16 v[128:131], a[248:251], v[4:7], v[128:131]
v_mfma_f32_16x16x32_bf16 v[132:135], a[252:255], v[4:7], v[132:135]
v_mfma_f32_16x16x32_bf16 v[128:131], a[248:251], v[8:11], v[128:131]
v_mfma_f32_16x16x32_bf16 v[132:135], a[252:255], v[8:11], v[132:135]
v_mfma_f32_16x16x32_bf16 v[128:131], a[248:251], v[12:15], v[128:131]
v_mfma_f32_16x16x32_bf16 v[132:135], a[252:255], v[12:15], v[132:135]
v_mfma_f32_16x16x32_bf16 v[128:131], a[248:251], v[16:19], v[128:131]
v_mfma_f32_16x16x32_bf16 v[132:135], a[252:255], v[16:19], v[132:135]
v_mfma_f32_16x16x32_bf16 v[128:131], a[248:251], v[20:23], v[128:131]
v_mfma_f32_16x16x32_bf16 v[132:135], a[252:255], v[20:23], v[132:135]
v_mfma_f32_16x16x32_bf16 v[128:131], a[248:251], v[24:27], v[128:131]
v_mfma_f32_16x16x32_bf16 v[132:135], a[252:255], v[24:27], v[132:135]
v_mfma_f32_16x16x32_bf16 v[128:131], a[248:251], v[28:31], v[128:131]
v_mfma_f32_16x16x32_bf16 v[132:135], a[252:255], v[28:31], v[132:135]
v_mfma_f32_16x16x32_bf16 v[128:131], a[248:251], v[32:35], v[128:131]
v_mfma_f32_16x16x32_bf16 v[132:135], a[252:255], v[32:35], v[132:135]
v_mfma_f32_16x16x32_bf16 v[128:131], a[248:251], v[36:39], v[128:131]
v_mfma_f32_16x16x32_bf16 v[132:135], a[252:255], v[36:39], v[132:135]
v_mfma_f32_16x16x32_bf16 v[128:131], a[248:251], v[40:43], v[128:131]
v_mfma_f32_16x16x32_bf16 v[132:135], a[252:255], v[40:43], v[132:135]
v_mfma_f32_16x16x32_bf16 v[128:131], a[248:251], v[44:47], v[128:131]
v_mfma_f32_16x16x32_bf16 v[132:135], a[252:255], v[44:47], v[132:135]
v_mfma_f32_16x16x32_bf16 v[128:131], a[248:251], v[48:51], v[128:131]
v_mfma_f32_16x16x32_bf16 v[132:135], a[252:255], v[48:51], v[132:135]
v_mfma_f32_16x16x32_bf16 v[128:131], a[248:251], v[52:55], v[128:131]
v_mfma_f32_16x16x32_bf16 v[132:135], a[252:255], v[52:55], v[132:135]
v_mfma_f32_16x16x32_bf16 v[128:131], a[248:251], v[56:59], v[128:131]
v_mfma_f32_16x16x32_bf16 v[132:135], a[252:255], v[56:59], v[132:135]
v_mfma_f32_16x16x32_bf16 v[128:131], a[248:251], v[60:63], v[128:131]
v_mfma_f32_16x16x32_bf16 v[132:135], a[252:255], v[60:63], v[132:135]
s_nop 6
v_cvt_pk_bf16_f32 v144, v128, v129
v_cvt_pk_bf16_f32 v145, v130, v131
buffer_store_dwordx2 v[144:145], v202, s[64:67], s32 offen nt
v_cvt_pk_bf16_f32 v146, v132, v133
v_cvt_pk_bf16_f32 v147, v134, v135
buffer_store_dwordx2 v[146:147], v202, s[64:67], s33 offen nt
red_fin_162:
att_fin:
att_end:
s_endpgm
stub_10:
s_call_b64 s[30:31], slow_0_1
s_branch back_11
stub_12:
s_call_b64 s[30:31], slow_1_0
s_branch back_13
stub_14:
s_call_b64 s[30:31], slow_2_1
s_branch back_15
stub_16:
s_call_b64 s[30:31], slow_0_0
s_branch back_17
stub_18:
s_call_b64 s[30:31], slow_1_1
s_branch back_19
stub_20:
s_call_b64 s[30:31], slow_2_0
s_branch back_21
stub_22:
s_call_b64 s[30:31], slow_0_1
s_branch back_23
stub_24:
s_call_b64 s[30:31], slow_1_0
s_branch back_25
stub_26:
s_call_b64 s[30:31], slow_2_1
s_branch back_27
stub_28:
s_call_b64 s[30:31], slow_0_0
s_branch back_29
stub_30:
s_call_b64 s[30:31], slow_1_1
s_branch back_31
stub_32:
s_call_b64 s[30:31], slow_2_0
s_branch back_33
stub_34:
s_call_b64 s[30:31], slow_0_1
s_branch back_35
stub_36:
s_call_b64 s[30:31], slow_1_0
s_branch back_37
stub_38:
s_call_b64 s[30:31], slow_2_1
s_branch back_39
stub_40:
s_call_b64 s[30:31], slow_0_0
s_branch back_41
stub_42:
s_call_b64 s[30:31], slow_1_1
s_branch back_43
stub_44:
s_call_b64 s[30:31], slow_2_0
s_branch back_45
stub_46:
s_call_b64 s[30:31], slow_0_1
s_branch back_47
stub_48:
s_call_b64 s[30:31], slow_1_0
s_branch back_49
stub_50:
s_call_b64 s[30:31], slow_2_1
s_branch back_51
stub_53:
s_call_b64 s[30:31], slow_0_0
s_branch back_54
stub_55:
s_call_b64 s[30:31], slow_1_1
s_branch back_56
stub_57:
s_call_b64 s[30:31], slow_0_0
s_branch back_58
stub_59:
s_call_b64 s[30:31], slow_1_1
s_branch back_60
stub_61:
s_call_b64 s[30:31], slow_0_0
s_branch back_62
stub_63:
s_call_b64 s[30:31], slow_1_1
s_branch back_64
stub_65:
s_call_b64 s[30:31], slow_0_0
s_branch back_66
stub_67:
s_call_b64 s[30:31], slow_1_1
s_branch back_68
stub_69:
s_call_b64 s[30:31], slow_0_0
s_branch back_70
stub_71:
s_call_b64 s[30:31], slow_1_1
s_branch back_72
stub_73:
s_call_b64 s[30:31], slow_0_0
s_branch back_74
stub_75:
s_call_b64 s[30:31], slow_1_1
s_branch back_76
stub_77:
s_call_b64 s[30:31], slow_0_0
s_branch back_78
stub_79:
s_call_b64 s[30:31], slow_1_1
s_branch back_80
stub_90:
s_call_b64 s[30:31], slow_0_1
s_branch back_91
stub_92:
s_call_b64 s[30:31], slow_1_0
s_branch back_93
stub_94:
s_call_b64 s[30:31], slow_2_1
s_branch back_95
stub_96:
s_call_b64 s[30:31], slow_0_0
s_branch back_97
stub_98:
s_call_b64 s[30:31], slow_1_1
s_branch back_99
stub_100:
s_call_b64 s[30:31], slow_2_0
s_branch back_101
stub_102:
s_call_b64 s[30:31], slow_0_1
s_branch back_103
stub_104:
s_call_b64 s[30:31], slow_1_0
s_branch back_105
stub_106:
s_call_b64 s[30:31], slow_2_1
s_branch back_107
stub_108:
s_call_b64 s[30:31], slow_0_0
s_branch back_109
stub_110:
s_call_b64 s[30:31], slow_1_1
s_branch back_111
stub_112:
s_call_b64 s[30:31], slow_2_0
s_branch back_113
stub_114:
s_call_b64 s[30:31], slow_0_1
s_branch back_115
stub_116:
s_call_b64 s[30:31], slow_1_0
s_branch back_117
stub_118:
s_call_b64 s[30:31], slow_2_1
s_branch back_119
stub_120:
s_call_b64 s[30:31], slow_0_0
s_branch back_121
stub_122:
s_call_b64 s[30:31], slow_1_1
s_branch back_123
stub_124:
s_call_b64 s[30:31], slow_2_0
s_branch back_125
stub_126:
s_call_b64 s[30:31], slow_0_1
s_branch back_127
stub_128:
s_call_b64 s[30:31], slow_1_0
s_branch back_129
stub_130:
s_call_b64 s[30:31], slow_2_1
s_branch back_131
stub_133:
s_call_b64 s[30:31], slow_0_0
s_branch back_134
stub_135:
s_call_b64 s[30:31], slow_1_1
s_branch back_136
stub_137:
s_call_b64 s[30:31], slow_0_0
s_branch back_138
stub_139:
s_call_b64 s[30:31], slow_1_1
s_branch back_140
stub_141:
s_call_b64 s[30:31], slow_0_0
s_branch back_142
stub_143:
s_call_b64 s[30:31], slow_1_1
s_branch back_144
stub_145:
s_call_b64 s[30:31], slow_0_0
s_branch back_146
stub_147:
s_call_b64 s[30:31], slow_1_1
s_branch back_148
stub_149:
s_call_b64 s[30:31], slow_0_0
s_branch back_150
stub_151:
s_call_b64 s[30:31], slow_1_1
s_branch back_152
stub_153:
s_call_b64 s[30:31], slow_0_0
s_branch back_154
stub_155:
s_call_b64 s[30:31], slow_1_1
s_branch back_156
stub_157:
s_call_b64 s[30:31], slow_0_0
s_branch back_158
stub_159:
s_call_b64 s[30:31], slow_1_1
s_branch back_160
slow_0_0:
s_nop 15
v_mov_b32 v190, v189
s_nop 1
v_permlane32_swap_b32 v189, v190
s_nop 1
v_max_f32 v189, v189, v190
v_mov_b32 v190, v189
s_nop 1
v_permlane16_swap_b32 v189, v190
s_nop 1
v_max_f32 v189, v189, v190
v_max_f32 v189, 0, v189
v_add_f32 v184, v184, v189
v_sub_f32 v160, v160, v189
v_sub_f32 v161, v161, v189
v_sub_f32 v162, v162, v189
v_sub_f32 v163, v163, v189
v_sub_f32 v164, v164, v189
v_sub_f32 v165, v165, v189
v_sub_f32 v166, v166, v189
v_sub_f32 v167, v167, v189
v_sub_f32 v190, 0, v189
v_exp_f32 v190, v190
s_nop 1
v_mul_f32 v0, v0, v190
v_mul_f32 v1, v1, v190
v_mul_f32 v2, v2, v190
v_mul_f32 v3, v3, v190
v_mul_f32 v4, v4, v190
v_mul_f32 v5, v5, v190
v_mul_f32 v6, v6, v190
v_mul_f32 v7, v7, v190
v_mul_f32 v8, v8, v190
v_mul_f32 v9, v9, v190
v_mul_f32 v10, v10, v190
v_mul_f32 v11, v11, v190
v_mul_f32 v12, v12, v190
v_mul_f32 v13, v13, v190
v_mul_f32 v14, v14, v190
v_mul_f32 v15, v15, v190
v_mul_f32 v16, v16, v190
v_mul_f32 v17, v17, v190
v_mul_f32 v18, v18, v190
v_mul_f32 v19, v19, v190
v_mul_f32 v20, v20, v190
v_mul_f32 v21, v21, v190
v_mul_f32 v22, v22, v190
v_mul_f32 v23, v23, v190
v_mul_f32 v24, v24, v190
v_mul_f32 v25, v25, v190
v_mul_f32 v26, v26, v190
v_mul_f32 v27, v27, v190
v_mul_f32 v28, v28, v190
v_mul_f32 v29, v29, v190
v_mul_f32 v30, v30, v190
v_mul_f32 v31, v31, v190
v_accvgpr_read_b32 v189, a224
s_nop 0
v_mul_f32 v189, v189, v190
s_nop 0
v_accvgpr_write_b32 a224, v189
v_accvgpr_read_b32 v189, a225
s_nop 0
v_mul_f32 v189, v189, v190
s_nop 0
v_accvgpr_write_b32 a225, v189
v_accvgpr_read_b32 v189, a226
s_nop 0
v_mul_f32 v189, v189, v190
s_nop 0
v_accvgpr_write_b32 a226, v189
v_accvgpr_read_b32 v189, a227
s_nop 0
v_mul_f32 v189, v189, v190
s_nop 0
v_accvgpr_write_b32 a227, v189
s_nop 7
s_setpc_b64 s[30:31]
slow_0_1:
s_nop 15
v_mov_b32 v190, v189
s_nop 1
v_permlane32_swap_b32 v189, v190
s_nop 1
v_max_f32 v189, v189, v190
v_mov_b32 v190, v189
s_nop 1
v_permlane16_swap_b32 v189, v190
s_nop 1
v_max_f32 v189, v189, v190
v_max_f32 v189, 0, v189
v_add_f32 v184, v184, v189
v_sub_f32 v168, v168, v189
v_sub_f32 v169, v169, v189
v_sub_f32 v170, v170, v189
v_sub_f32 v171, v171, v189
v_sub_f32 v172, v172, v189
v_sub_f32 v173, v173, v189
v_sub_f32 v174, v174, v189
v_sub_f32 v175, v175, v189
v_sub_f32 v190, 0, v189
v_exp_f32 v190, v190
s_nop 1
v_mul_f32 v0, v0, v190
v_mul_f32 v1, v1, v190
v_mul_f32 v2, v2, v190
v_mul_f32 v3, v3, v190
v_mul_f32 v4, v4, v190
v_mul_f32 v5, v5, v190
v_mul_f32 v6, v6, v190
v_mul_f32 v7, v7, v190
v_mul_f32 v8, v8, v190
v_mul_f32 v9, v9, v190
v_mul_f32 v10, v10, v190
v_mul_f32 v11, v11, v190
v_mul_f32 v12, v12, v190
v_mul_f32 v13, v13, v190
v_mul_f32 v14, v14, v190
v_mul_f32 v15, v15, v190
v_mul_f32 v16, v16, v190
v_mul_f32 v17, v17, v190
v_mul_f32 v18, v18, v190
v_mul_f32 v19, v19, v190
v_mul_f32 v20, v20, v190
v_mul_f32 v21, v21, v190
v_mul_f32 v22, v22, v190
v_mul_f32 v23, v23, v190
v_mul_f32 v24, v24, v190
v_mul_f32 v25, v25, v190
v_mul_f32 v26, v26, v190
v_mul_f32 v27, v27, v190
v_mul_f32 v28, v28, v190
v_mul_f32 v29, v29, v190
v_mul_f32 v30, v30, v190
v_mul_f32 v31, v31, v190
v_accvgpr_read_b32 v189, a224
s_nop 0
v_mul_f32 v189, v189, v190
s_nop 0
v_accvgpr_write_b32 a224, v189
v_accvgpr_read_b32 v189, a225
s_nop 0
v_mul_f32 v189, v189, v190
s_nop 0
v_accvgpr_write_b32 a225, v189
v_accvgpr_read_b32 v189, a226
s_nop 0
v_mul_f32 v189, v189, v190
s_nop 0
v_accvgpr_write_b32 a226, v189
v_accvgpr_read_b32 v189, a227
s_nop 0
v_mul_f32 v189, v189, v190
s_nop 0
v_accvgpr_write_b32 a227, v189
s_nop 7
s_setpc_b64 s[30:31]
slow_1_0:
s_nop 15
v_mov_b32 v190, v189
s_nop 1
v_permlane32_swap_b32 v189, v190
s_nop 1
v_max_f32 v189, v189, v190
v_mov_b32 v190, v189
s_nop 1
v_permlane16_swap_b32 v189, v190
s_nop 1
v_max_f32 v189, v189, v190
v_max_f32 v189, 0, v189
v_add_f32 v185, v185, v189
v_sub_f32 v160, v160, v189
v_sub_f32 v161, v161, v189
v_sub_f32 v162, v162, v189
v_sub_f32 v163, v163, v189
v_sub_f32 v164, v164, v189
v_sub_f32 v165, v165, v189
v_sub_f32 v166, v166, v189
v_sub_f32 v167, v167, v189
v_sub_f32 v190, 0, v189
v_exp_f32 v190, v190
s_nop 1
v_mul_f32 v32, v32, v190
v_mul_f32 v33, v33, v190
v_mul_f32 v34, v34, v190
v_mul_f32 v35, v35, v190
v_mul_f32 v36, v36, v190
v_mul_f32 v37, v37, v190
v_mul_f32 v38, v38, v190
v_mul_f32 v39, v39, v190
v_mul_f32 v40, v40, v190
v_mul_f32 v41, v41, v190
v_mul_f32 v42, v42, v190
v_mul_f32 v43, v43, v190
v_mul_f32 v44, v44, v190
v_mul_f32 v45, v45, v190
v_mul_f32 v46, v46, v190
v_mul_f32 v47, v47, v190
v_mul_f32 v48, v48, v190
v_mul_f32 v49, v49, v190
v_mul_f32 v50, v50, v190
v_mul_f32 v51, v51, v190
v_mul_f32 v52, v52, v190
v_mul_f32 v53, v53, v190
v_mul_f32 v54, v54, v190
v_mul_f32 v55, v55, v190
v_mul_f32 v56, v56, v190
v_mul_f32 v57, v57, v190
v_mul_f32 v58, v58, v190
v_mul_f32 v59, v59, v190
v_mul_f32 v60, v60, v190
v_mul_f32 v61, v61, v190
v_mul_f32 v62, v62, v190
v_mul_f32 v63, v63, v190
v_accvgpr_read_b32 v189, a228
s_nop 0
v_mul_f32 v189, v189, v190
s_nop 0
v_accvgpr_write_b32 a228, v189
v_accvgpr_read_b32 v189, a229
s_nop 0
v_mul_f32 v189, v189, v190
s_nop 0
v_accvgpr_write_b32 a229, v189
v_accvgpr_read_b32 v189, a230
s_nop 0
v_mul_f32 v189, v189, v190
s_nop 0
v_accvgpr_write_b32 a230, v189
v_accvgpr_read_b32 v189, a231
s_nop 0
v_mul_f32 v189, v189, v190
s_nop 0
v_accvgpr_write_b32 a231, v189
s_nop 7
s_setpc_b64 s[30:31]
slow_1_1:
s_nop 15
v_mov_b32 v190, v189
s_nop 1
v_permlane32_swap_b32 v189, v190
s_nop 1
v_max_f32 v189, v189, v190
v_mov_b32 v190, v189
s_nop 1
v_permlane16_swap_b32 v189, v190
s_nop 1
v_max_f32 v189, v189, v190
v_max_f32 v189, 0, v189
v_add_f32 v185, v185, v189
v_sub_f32 v168, v168, v189
v_sub_f32 v169, v169, v189
v_sub_f32 v170, v170, v189
v_sub_f32 v171, v171, v189
v_sub_f32 v172, v172, v189
v_sub_f32 v173, v173, v189
v_sub_f32 v174, v174, v189
v_sub_f32 v175, v175, v189
v_sub_f32 v190, 0, v189
v_exp_f32 v190, v190
s_nop 1
v_mul_f32 v32, v32, v190
v_mul_f32 v33, v33, v190
v_mul_f32 v34, v34, v190
v_mul_f32 v35, v35, v190
v_mul_f32 v36, v36, v190
v_mul_f32 v37, v37, v190
v_mul_f32 v38, v38, v190
v_mul_f32 v39, v39, v190
v_mul_f32 v40, v40, v190
v_mul_f32 v41, v41, v190
v_mul_f32 v42, v42, v190
v_mul_f32 v43, v43, v190
v_mul_f32 v44, v44, v190
v_mul_f32 v45, v45, v190
v_mul_f32 v46, v46, v190
v_mul_f32 v47, v47, v190
v_mul_f32 v48, v48, v190
v_mul_f32 v49, v49, v190
v_mul_f32 v50, v50, v190
v_mul_f32 v51, v51, v190
v_mul_f32 v52, v52, v190
v_mul_f32 v53, v53, v190
v_mul_f32 v54, v54, v190
v_mul_f32 v55, v55, v190
v_mul_f32 v56, v56, v190
v_mul_f32 v57, v57, v190
v_mul_f32 v58, v58, v190
v_mul_f32 v59, v59, v190
v_mul_f32 v60, v60, v190
v_mul_f32 v61, v61, v190
v_mul_f32 v62, v62, v190
v_mul_f32 v63, v63, v190
v_accvgpr_read_b32 v189, a228
s_nop 0
v_mul_f32 v189, v189, v190
s_nop 0
v_accvgpr_write_b32 a228, v189
v_accvgpr_read_b32 v189, a229
s_nop 0
v_mul_f32 v189, v189, v190
s_nop 0
v_accvgpr_write_b32 a229, v189
v_accvgpr_read_b32 v189, a230
s_nop 0
v_mul_f32 v189, v189, v190
s_nop 0
v_accvgpr_write_b32 a230, v189
v_accvgpr_read_b32 v189, a231
s_nop 0
v_mul_f32 v189, v189, v190
s_nop 0
v_accvgpr_write_b32 a231, v189
s_nop 7
s_setpc_b64 s[30:31]
slow_2_0:
s_nop 15
v_mov_b32 v190, v189
s_nop 1
v_permlane32_swap_b32 v189, v190
s_nop 1
v_max_f32 v189, v189, v190
v_mov_b32 v190, v189
s_nop 1
v_permlane16_swap_b32 v189, v190
s_nop 1
v_max_f32 v189, v189, v190
v_max_f32 v189, 0, v189
v_add_f32 v186, v186, v189
v_sub_f32 v160, v160, v189
v_sub_f32 v161, v161, v189
v_sub_f32 v162, v162, v189
v_sub_f32 v163, v163, v189
v_sub_f32 v164, v164, v189
v_sub_f32 v165, v165, v189
v_sub_f32 v166, v166, v189
v_sub_f32 v167, v167, v189
v_sub_f32 v190, 0, v189
v_exp_f32 v190, v190
s_nop 1
v_mul_f32 v64, v64, v190
v_mul_f32 v65, v65, v190
v_mul_f32 v66, v66, v190
v_mul_f32 v67, v67, v190
v_mul_f32 v68, v68, v190
v_mul_f32 v69, v69, v190
v_mul_f32 v70, v70, v190
v_mul_f32 v71, v71, v190
v_mul_f32 v72, v72, v190
v_mul_f32 v73, v73, v190
v_mul_f32 v74, v74, v190
v_mul_f32 v75, v75, v190
v_mul_f32 v76, v76, v190
v_mul_f32 v77, v77, v190
v_mul_f32 v78, v78, v190
v_mul_f32 v79, v79, v190
v_mul_f32 v80, v80, v190
v_mul_f32 v81, v81, v190
v_mul_f32 v82, v82, v190
v_mul_f32 v83, v83, v190
v_mul_f32 v84, v84, v190
v_mul_f32 v85, v85, v190
v_mul_f32 v86, v86, v190
v_mul_f32 v87, v87, v190
v_mul_f32 v88, v88, v190
v_mul_f32 v89, v89, v190
v_mul_f32 v90, v90, v190
v_mul_f32 v91, v91, v190
v_mul_f32 v92, v92, v190
v_mul_f32 v93, v93, v190
v_mul_f32 v94, v94, v190
v_mul_f32 v95, v95, v190
v_accvgpr_read_b32 v189, a232
s_nop 0
v_mul_f32 v189, v189, v190
s_nop 0
v_accvgpr_write_b32 a232, v189
v_accvgpr_read_b32 v189, a233
s_nop 0
v_mul_f32 v189, v189, v190
s_nop 0
v_accvgpr_write_b32 a233, v189
v_accvgpr_read_b32 v189, a234
s_nop 0
v_mul_f32 v189, v189, v190
s_nop 0
v_accvgpr_write_b32 a234, v189
v_accvgpr_read_b32 v189, a235
s_nop 0
v_mul_f32 v189, v189, v190
s_nop 0
v_accvgpr_write_b32 a235, v189
s_nop 7
s_setpc_b64 s[30:31]
slow_2_1:
s_nop 15
v_mov_b32 v190, v189
s_nop 1
v_permlane32_swap_b32 v189, v190
s_nop 1
v_max_f32 v189, v189, v190
v_mov_b32 v190, v189
s_nop 1
v_permlane16_swap_b32 v189, v190
s_nop 1
v_max_f32 v189, v189, v190
v_max_f32 v189, 0, v189
v_add_f32 v186, v186, v189
v_sub_f32 v168, v168, v189
v_sub_f32 v169, v169, v189
v_sub_f32 v170, v170, v189
v_sub_f32 v171, v171, v189
v_sub_f32 v172, v172, v189
v_sub_f32 v173, v173, v189
v_sub_f32 v174, v174, v189
v_sub_f32 v175, v175, v189
v_sub_f32 v190, 0, v189
v_exp_f32 v190, v190
s_nop 1
v_mul_f32 v64, v64, v190
v_mul_f32 v65, v65, v190
v_mul_f32 v66, v66, v190
v_mul_f32 v67, v67, v190
v_mul_f32 v68, v68, v190
v_mul_f32 v69, v69, v190
v_mul_f32 v70, v70, v190
v_mul_f32 v71, v71, v190
v_mul_f32 v72, v72, v190
v_mul_f32 v73, v73, v190
v_mul_f32 v74, v74, v190
v_mul_f32 v75, v75, v190
v_mul_f32 v76, v76, v190
v_mul_f32 v77, v77, v190
v_mul_f32 v78, v78, v190
v_mul_f32 v79, v79, v190
v_mul_f32 v80, v80, v190
v_mul_f32 v81, v81, v190
v_mul_f32 v82, v82, v190
v_mul_f32 v83, v83, v190
v_mul_f32 v84, v84, v190
v_mul_f32 v85, v85, v190
v_mul_f32 v86, v86, v190
v_mul_f32 v87, v87, v190
v_mul_f32 v88, v88, v190
v_mul_f32 v89, v89, v190
v_mul_f32 v90, v90, v190
v_mul_f32 v91, v91, v190
v_mul_f32 v92, v92, v190
v_mul_f32 v93, v93, v190
v_mul_f32 v94, v94, v190
v_mul_f32 v95, v95, v190
v_accvgpr_read_b32 v189, a232
s_nop 0
v_mul_f32 v189, v189, v190
s_nop 0
v_accvgpr_write_b32 a232, v189
v_accvgpr_read_b32 v189, a233
s_nop 0
v_mul_f32 v189, v189, v190
s_nop 0
v_accvgpr_write_b32 a233, v189
v_accvgpr_read_b32 v189, a234
s_nop 0
v_mul_f32 v189, v189, v190
s_nop 0
v_accvgpr_write_b32 a234, v189
v_accvgpr_read_b32 v189, a235
s_nop 0
v_mul_f32 v189, v189, v190
s_nop 0
v_accvgpr_write_b32 a235, v189
s_nop 7
s_setpc_b64 s[30:31]
.section .rodata,"a"
.p2align 6
.amdhsa_kernel concat_heads__gqa_block_cached__mha_block_cached__near_ridge_kernel
.amdhsa_next_free_vgpr 512
.amdhsa_next_free_sgpr 102
.amdhsa_accum_offset 256
.amdhsa_group_segment_fixed_size 0
.amdhsa_kernarg_size 104
.amdhsa_user_sgpr_count 2
.amdhsa_user_sgpr_kernarg_segment_ptr 1
.amdhsa_system_sgpr_workgroup_id_x 1
.amdhsa_float_denorm_mode_32 3
.end_amdhsa_kernel
```
